```python
import torch

def _softmax(x, axis=-1):
    return torch.softmax(x, dim=axis)

def _gelu(x):
    return torch.nn.functional.gelu(x, approximate='tanh')

def _silu(x):
    return torch.nn.functional.silu(x)

def _sigmoid(x):
    return torch.sigmoid(x)

def _layernorm(x, axis=-1, eps=1e-05):
    m = x.mean(dim=axis, keepdim=True)
    v = x.var(dim=axis, keepdim=True, unbiased=False)
    return (x - m) / torch.sqrt(v + eps)

def _scatter_add(tgt, idx, src, axis=0):
    return tgt.clone().index_add_(axis, idx, src)

def _segment_sum(src, seg, n):
    out = torch.zeros((n,) + src.shape[1:], dtype=src.dtype)
    return out.index_add_(0, seg, src)

def _pad(x, pw):
    flat = tuple((v for pair in reversed(pw) for v in pair))
    return torch.nn.functional.pad(x, flat)
kernel_name = 'recurrent_scan__memory_aug_recurrent_mem_tr__geglu_ffn__prompt'

def setup_inputs():

    _w = lambda a: (lambda t: t.to(torch.bfloat16) if t.is_floating_point() else t)(torch.as_tensor(a))

    def _A_setup():
        B, S, Dm = (1, 2048, 576)
        H, Dh = (32, 128)
        M, seg = (8, 32)
        seg = min(seg, S)
        S = S // seg * seg
        return {'x': _w((lambda *s: torch.randn(*s, dtype=torch.bfloat16) * 0.05)(B, S, Dm)), 'mem0': _w((lambda *s: torch.randn(*s, dtype=torch.bfloat16) * 0.2)(B, M, Dm)), 'Wq': _w((lambda *s: torch.randn(*s, dtype=torch.bfloat16) * 0.8)(Dm, H, Dh) * Dm ** (-0.5)), 'Wk': _w((lambda *s: torch.randn(*s, dtype=torch.bfloat16) * 0.8)(Dm, H, Dh) * Dm ** (-0.5)), 'Wv': _w((lambda *s: torch.randn(*s, dtype=torch.bfloat16) * 0.2)(Dm, H, Dh) * Dm ** (-0.5)), 'Wo': _w((lambda *s: torch.randn(*s, dtype=torch.bfloat16) * 0.2)(H, Dh, Dm) * (H * Dh) ** (-0.5)), 'seg_len': seg}
    _A_in = _A_setup()

    def _B_setup():
        B, S, D, F = (1, 2048, 576, 4608)
        return {'x': _w((lambda *s: torch.randn(*s, dtype=torch.bfloat16) * 0.05)(B, S, D)), 'w_gate': _w((lambda *s: torch.randn(*s, dtype=torch.bfloat16) * 0.1)(D, F)), 'w_up': _w((lambda *s: torch.randn(*s, dtype=torch.bfloat16) * 0.1)(D, F)), 'w_down': _w((lambda *s: torch.randn(*s, dtype=torch.bfloat16) * 0.1)(F, D))}
    _B_in = _B_setup()
    return {'A_x': _A_in['x'], 'A_mem0': _A_in['mem0'], 'A_Wq': _A_in['Wq'], 'A_Wk': _A_in['Wk'], 'A_Wv': _A_in['Wv'], 'A_Wo': _A_in['Wo'], 'A_seg_len': _A_in['seg_len'], 'B_x': _B_in['x'], 'B_w_gate': _B_in['w_gate'], 'B_w_up': _B_in['w_up'], 'B_w_down': _B_in['w_down']}

def reference(A_x, A_mem0, A_Wq, A_Wk, A_Wv, A_Wo, A_seg_len, B_x, B_w_gate, B_w_up, B_w_down):

    def _A_ref(x, mem0, Wq, Wk, Wv, Wo, seg_len):
        B, S, Dm = x.shape
        H, Dh = (Wq.shape[1], Wq.shape[2])
        M = mem0.shape[1]
        scale = Dh ** (-0.5)
        n_seg = S // seg_len
        L = M + seg_len
        idx = torch.arange(L)
        mask = (idx[:, None] < M) | (idx[:, None] >= idx[None, :])
        mem = mem0
        outs = []
        for s in range(n_seg):
            xs = x[:, s * seg_len:(s + 1) * seg_len, :].clone()
            h = torch.concatenate([mem, xs], axis=1)
            q = torch.einsum('btd,dhe->bhte', h, Wq)
            k = torch.einsum('btd,dhe->bhte', h, Wk)
            v = torch.einsum('btd,dhe->bhte', h, Wv)
            scores = torch.einsum('bhqe,bhke->bhqk', q, k) * scale
            scores = torch.where(mask[None, None], scores, -1000000000.0)
            p = _softmax(scores, axis=-1)
            o = torch.einsum('bhqk,bhke->bhqe', p, v)
            o = torch.einsum('bhte,hed->btd', o, Wo)
            mem = o[:, :M, :].clone()
            outs.append(o[:, M:, :])
        return torch.concatenate(outs, axis=1)

    def _B_ref(x, w_gate, w_up, w_down):
        return _gelu(x @ w_gate) * (x @ w_up) @ w_down
    x = A_x
    xn = _layernorm(x, axis=-1)
    s = _A_ref(xn, A_mem0, A_Wq, A_Wk, A_Wv, A_Wo, A_seg_len)
    g = _silu(_B_ref(xn, B_w_gate, B_w_up, B_w_down))
    return x + s * g
```

```asm
; @launch grid=(256,1,1) block=(256,1,1) lds=163840
.amdgcn_target "amdgcn-amd-amdhsa--gfx950"
.text
.globl recurrent_scan__memory_aug_recurrent_mem_tr__geglu_ffn__prompt_kernel
.p2align 8
.type recurrent_scan__memory_aug_recurrent_mem_tr__geglu_ffn__prompt_kernel,@function
recurrent_scan__memory_aug_recurrent_mem_tr__geglu_ffn__prompt_kernel:
s_cmp_lt_u32 s2,256
s_cbranch_scc1 L_go
s_endpgm
L_go:
s_load_dwordx2 s[8:9],s[0:1],104
s_load_dwordx2 s[12:13],s[0:1],16
s_load_dwordx2 s[16:17],s[0:1],24
s_load_dwordx2 s[20:21],s[0:1],32
s_load_dwordx2 s[24:25],s[0:1],40
s_load_dwordx2 s[28:29],s[0:1],8
s_load_dwordx2 s[32:33],s[0:1],96
s_load_dwordx2 s[36:37],s[0:1],0
s_load_dwordx2 s[40:41],s[0:1],64
s_load_dwordx2 s[44:45],s[0:1],72
s_load_dwordx2 s[48:49],s[0:1],80
s_load_dwordx2 s[52:53],s[0:1],88
s_mov_b32 s10,268435456
s_mov_b32 s11,0x20000
s_mov_b32 s14,4718592
s_mov_b32 s15,0x20000
s_mov_b32 s18,4718592
s_mov_b32 s19,0x20000
s_mov_b32 s22,4718592
s_mov_b32 s23,0x20000
s_mov_b32 s26,4718592
s_mov_b32 s27,0x20000
s_mov_b32 s30,9216
s_mov_b32 s31,0x20000
s_mov_b32 s34,256
s_mov_b32 s35,0x20000
s_mov_b32 s38,2359296
s_mov_b32 s39,0x20000
s_mov_b32 s42,5308416
s_mov_b32 s43,0x20000
s_mov_b32 s46,5308416
s_mov_b32 s47,0x20000
s_mov_b32 s50,5308416
s_mov_b32 s51,0x20000
s_mov_b32 s54,2359296
s_mov_b32 s55,0x20000
s_getreg_b32 s62,hwreg(HW_REG_XCC_ID,0,4)
v_lshrrev_b32 v1,6,v0
s_nop 0
v_readfirstlane_b32 s60,v1
s_waitcnt lgkmcnt(0)
s_and_b32 s65,s2,7
s_lshr_b32 s64,s2,3
s_mul_i32 s64,s64,7
s_add_u32 s64,s64,s65
s_sub_u32 s64,s64,2
s_cmp_eq_u32 s65,0
s_cbranch_scc1 L_noln
s_cmp_ge_u32 s64,128
s_cbranch_scc1 L_noln
s_mov_b32 s86,s64
v_and_b32 v3,63,v0
v_and_b32 v4,15,v3
v_mul_u32_u24 v4,1152,v4
v_lshrrev_b32 v5,4,v3
v_lshl_add_u32 v4,v5,4,v4
v_lshlrev_b32 v5,4,v3
s_mul_i32 s65,s60,5
s_cmp_eq_u32 s60,3
s_cselect_b32 s65,14,s65
s_mul_i32 s66,s64,18432
s_lshl_b32 s68,s65,6
s_add_u32 s66,s66,s68
s_mul_i32 s67,s64,18
s_add_u32 s67,s67,s65
s_lshl_b32 s67,s67,10
s_add_u32 s67,s67,1048576
s_cmp_lt_u32 s60,2
s_cselect_b32 s68,0,0x40000000
s_add_u32 s69,s68,s66
s_add_u32 s70,s68,s67
s_add_u32 s70,s70,4096
buffer_load_dwordx4 v[16:19],v4,s[36:39],s66 offen offset:0
buffer_load_dwordx4 v[20:23],v4,s[36:39],s66 offen offset:64
buffer_load_dwordx4 v[24:27],v4,s[36:39],s66 offen offset:128
buffer_load_dwordx4 v[28:31],v4,s[36:39],s66 offen offset:192
buffer_load_dwordx4 v[32:35],v4,s[36:39],s69 offen offset:256
v_lshlrev_b32 v12,2,v0
v_and_b32 v13,15,v0
v_lshlrev_b32 v13,2,v13
v_mov_b32 v6,0
v_mov_b32 v7,0
s_waitcnt vmcnt(4)
v_lshlrev_b32 v40,16,v16
v_and_b32 v41,0xffff0000,v16
v_add_f32 v6,v6,v40
v_add_f32 v7,v7,v41
v_lshlrev_b32 v42,16,v17
v_and_b32 v43,0xffff0000,v17
v_add_f32 v6,v6,v42
v_add_f32 v7,v7,v43
v_lshlrev_b32 v44,16,v18
v_and_b32 v45,0xffff0000,v18
v_add_f32 v6,v6,v44
v_add_f32 v7,v7,v45
v_lshlrev_b32 v46,16,v19
v_and_b32 v47,0xffff0000,v19
v_add_f32 v6,v6,v46
v_add_f32 v7,v7,v47
s_waitcnt vmcnt(3)
v_lshlrev_b32 v48,16,v20
v_and_b32 v49,0xffff0000,v20
v_add_f32 v6,v6,v48
v_add_f32 v7,v7,v49
v_lshlrev_b32 v50,16,v21
v_and_b32 v51,0xffff0000,v21
v_add_f32 v6,v6,v50
v_add_f32 v7,v7,v51
v_lshlrev_b32 v52,16,v22
v_and_b32 v53,0xffff0000,v22
v_add_f32 v6,v6,v52
v_add_f32 v7,v7,v53
v_lshlrev_b32 v54,16,v23
v_and_b32 v55,0xffff0000,v23
v_add_f32 v6,v6,v54
v_add_f32 v7,v7,v55
s_waitcnt vmcnt(2)
v_lshlrev_b32 v56,16,v24
v_and_b32 v57,0xffff0000,v24
v_add_f32 v6,v6,v56
v_add_f32 v7,v7,v57
v_lshlrev_b32 v58,16,v25
v_and_b32 v59,0xffff0000,v25
v_add_f32 v6,v6,v58
v_add_f32 v7,v7,v59
v_lshlrev_b32 v60,16,v26
v_and_b32 v61,0xffff0000,v26
v_add_f32 v6,v6,v60
v_add_f32 v7,v7,v61
v_lshlrev_b32 v62,16,v27
v_and_b32 v63,0xffff0000,v27
v_add_f32 v6,v6,v62
v_add_f32 v7,v7,v63
s_waitcnt vmcnt(1)
v_lshlrev_b32 v64,16,v28
v_and_b32 v65,0xffff0000,v28
v_add_f32 v6,v6,v64
v_add_f32 v7,v7,v65
v_lshlrev_b32 v66,16,v29
v_and_b32 v67,0xffff0000,v29
v_add_f32 v6,v6,v66
v_add_f32 v7,v7,v67
v_lshlrev_b32 v68,16,v30
v_and_b32 v69,0xffff0000,v30
v_add_f32 v6,v6,v68
v_add_f32 v7,v7,v69
v_lshlrev_b32 v70,16,v31
v_and_b32 v71,0xffff0000,v31
v_add_f32 v6,v6,v70
v_add_f32 v7,v7,v71
s_waitcnt vmcnt(0)
v_lshlrev_b32 v72,16,v32
v_and_b32 v73,0xffff0000,v32
v_add_f32 v6,v6,v72
v_add_f32 v7,v7,v73
v_lshlrev_b32 v74,16,v33
v_and_b32 v75,0xffff0000,v33
v_add_f32 v6,v6,v74
v_add_f32 v7,v7,v75
v_lshlrev_b32 v76,16,v34
v_and_b32 v77,0xffff0000,v34
v_add_f32 v6,v6,v76
v_add_f32 v7,v7,v77
v_lshlrev_b32 v78,16,v35
v_and_b32 v79,0xffff0000,v35
v_add_f32 v6,v6,v78
v_add_f32 v7,v7,v79
v_add_f32 v6,v6,v7
ds_write_b32 v12,v6 offset:256
s_waitcnt lgkmcnt(0)
s_barrier
ds_read_b32 v84,v13 offset:256
ds_read_b32 v85,v13 offset:320
ds_read_b32 v86,v13 offset:384
ds_read_b32 v87,v13 offset:448
ds_read_b32 v88,v13 offset:512
ds_read_b32 v89,v13 offset:576
ds_read_b32 v90,v13 offset:640
ds_read_b32 v91,v13 offset:704
ds_read_b32 v92,v13 offset:768
ds_read_b32 v93,v13 offset:832
ds_read_b32 v94,v13 offset:896
ds_read_b32 v95,v13 offset:960
ds_read_b32 v96,v13 offset:1024
ds_read_b32 v97,v13 offset:1088
ds_read_b32 v98,v13 offset:1152
ds_read_b32 v99,v13 offset:1216
s_waitcnt lgkmcnt(0)
v_add_f32 v84,v84,v92
v_add_f32 v85,v85,v93
v_add_f32 v86,v86,v94
v_add_f32 v87,v87,v95
v_add_f32 v88,v88,v96
v_add_f32 v89,v89,v97
v_add_f32 v90,v90,v98
v_add_f32 v91,v91,v99
v_add_f32 v84,v84,v88
v_add_f32 v85,v85,v89
v_add_f32 v86,v86,v90
v_add_f32 v87,v87,v91
v_add_f32 v84,v84,v86
v_add_f32 v85,v85,v87
v_add_f32 v84,v84,v85
v_mul_f32 v6,0x3ae38e39,v84
v_mov_b32 v7,0
v_mov_b32 v8,0
v_sub_f32 v10,v40,v6
v_sub_f32 v11,v41,v6
v_fmac_f32 v7,v10,v10
v_fmac_f32 v8,v11,v11
v_sub_f32 v10,v42,v6
v_sub_f32 v11,v43,v6
v_fmac_f32 v7,v10,v10
v_fmac_f32 v8,v11,v11
v_sub_f32 v10,v44,v6
v_sub_f32 v11,v45,v6
v_fmac_f32 v7,v10,v10
v_fmac_f32 v8,v11,v11
v_sub_f32 v10,v46,v6
v_sub_f32 v11,v47,v6
v_fmac_f32 v7,v10,v10
v_fmac_f32 v8,v11,v11
v_sub_f32 v10,v48,v6
v_sub_f32 v11,v49,v6
v_fmac_f32 v7,v10,v10
v_fmac_f32 v8,v11,v11
v_sub_f32 v10,v50,v6
v_sub_f32 v11,v51,v6
v_fmac_f32 v7,v10,v10
v_fmac_f32 v8,v11,v11
v_sub_f32 v10,v52,v6
v_sub_f32 v11,v53,v6
v_fmac_f32 v7,v10,v10
v_fmac_f32 v8,v11,v11
v_sub_f32 v10,v54,v6
v_sub_f32 v11,v55,v6
v_fmac_f32 v7,v10,v10
v_fmac_f32 v8,v11,v11
v_sub_f32 v10,v56,v6
v_sub_f32 v11,v57,v6
v_fmac_f32 v7,v10,v10
v_fmac_f32 v8,v11,v11
v_sub_f32 v10,v58,v6
v_sub_f32 v11,v59,v6
v_fmac_f32 v7,v10,v10
v_fmac_f32 v8,v11,v11
v_sub_f32 v10,v60,v6
v_sub_f32 v11,v61,v6
v_fmac_f32 v7,v10,v10
v_fmac_f32 v8,v11,v11
v_sub_f32 v10,v62,v6
v_sub_f32 v11,v63,v6
v_fmac_f32 v7,v10,v10
v_fmac_f32 v8,v11,v11
v_sub_f32 v10,v64,v6
v_sub_f32 v11,v65,v6
v_fmac_f32 v7,v10,v10
v_fmac_f32 v8,v11,v11
v_sub_f32 v10,v66,v6
v_sub_f32 v11,v67,v6
v_fmac_f32 v7,v10,v10
v_fmac_f32 v8,v11,v11
v_sub_f32 v10,v68,v6
v_sub_f32 v11,v69,v6
v_fmac_f32 v7,v10,v10
v_fmac_f32 v8,v11,v11
v_sub_f32 v10,v70,v6
v_sub_f32 v11,v71,v6
v_fmac_f32 v7,v10,v10
v_fmac_f32 v8,v11,v11
s_cmp_lt_u32 s60,2
s_cbranch_scc0 Lln_v4
v_sub_f32 v10,v72,v6
v_sub_f32 v11,v73,v6
v_fmac_f32 v7,v10,v10
v_fmac_f32 v8,v11,v11
v_sub_f32 v10,v74,v6
v_sub_f32 v11,v75,v6
v_fmac_f32 v7,v10,v10
v_fmac_f32 v8,v11,v11
v_sub_f32 v10,v76,v6
v_sub_f32 v11,v77,v6
v_fmac_f32 v7,v10,v10
v_fmac_f32 v8,v11,v11
v_sub_f32 v10,v78,v6
v_sub_f32 v11,v79,v6
v_fmac_f32 v7,v10,v10
v_fmac_f32 v8,v11,v11
Lln_v4:
v_add_f32 v7,v7,v8
ds_write_b32 v12,v7 offset:1280
s_waitcnt lgkmcnt(0)
s_barrier
ds_read_b32 v84,v13 offset:1280
ds_read_b32 v85,v13 offset:1344
ds_read_b32 v86,v13 offset:1408
ds_read_b32 v87,v13 offset:1472
ds_read_b32 v88,v13 offset:1536
ds_read_b32 v89,v13 offset:1600
ds_read_b32 v90,v13 offset:1664
ds_read_b32 v91,v13 offset:1728
ds_read_b32 v92,v13 offset:1792
ds_read_b32 v93,v13 offset:1856
ds_read_b32 v94,v13 offset:1920
ds_read_b32 v95,v13 offset:1984
ds_read_b32 v96,v13 offset:2048
ds_read_b32 v97,v13 offset:2112
ds_read_b32 v98,v13 offset:2176
ds_read_b32 v99,v13 offset:2240
s_waitcnt lgkmcnt(0)
v_add_f32 v84,v84,v92
v_add_f32 v85,v85,v93
v_add_f32 v86,v86,v94
v_add_f32 v87,v87,v95
v_add_f32 v88,v88,v96
v_add_f32 v89,v89,v97
v_add_f32 v90,v90,v98
v_add_f32 v91,v91,v99
v_add_f32 v84,v84,v88
v_add_f32 v85,v85,v89
v_add_f32 v86,v86,v90
v_add_f32 v87,v87,v91
v_add_f32 v84,v84,v86
v_add_f32 v85,v85,v87
v_add_f32 v84,v84,v85
v_mul_f32 v7,0x3ae38e39,v84
v_cvt_pk_bf16_f32 v6,v6,v6
v_and_b32 v6,0xffff0000,v6
v_cvt_pk_bf16_f32 v7,v7,v7
v_and_b32 v7,0xffff0000,v7
v_add_f32 v7,0x3727c5ac,v7
v_cvt_pk_bf16_f32 v7,v7,v7
v_and_b32 v7,0xffff0000,v7
v_sqrt_f32 v7,v7
s_nop 0
v_cvt_pk_bf16_f32 v7,v7,v7
v_and_b32 v7,0xffff0000,v7
v_rcp_f32 v8,v7
s_nop 0
v_sub_f32 v40,v40,v6
v_sub_f32 v41,v41,v6
v_cvt_pk_bf16_f32 v10,v40,v41
v_lshlrev_b32 v40,16,v10
v_and_b32 v41,0xffff0000,v10
v_mul_f32 v40,v40,v8
v_mul_f32 v41,v41,v8
v_cvt_pk_bf16_f32 v16,v40,v41
v_sub_f32 v42,v42,v6
v_sub_f32 v43,v43,v6
v_cvt_pk_bf16_f32 v10,v42,v43
v_lshlrev_b32 v42,16,v10
v_and_b32 v43,0xffff0000,v10
v_mul_f32 v42,v42,v8
v_mul_f32 v43,v43,v8
v_cvt_pk_bf16_f32 v17,v42,v43
v_sub_f32 v44,v44,v6
v_sub_f32 v45,v45,v6
v_cvt_pk_bf16_f32 v10,v44,v45
v_lshlrev_b32 v44,16,v10
v_and_b32 v45,0xffff0000,v10
v_mul_f32 v44,v44,v8
v_mul_f32 v45,v45,v8
v_cvt_pk_bf16_f32 v18,v44,v45
v_sub_f32 v46,v46,v6
v_sub_f32 v47,v47,v6
v_cvt_pk_bf16_f32 v10,v46,v47
v_lshlrev_b32 v46,16,v10
v_and_b32 v47,0xffff0000,v10
v_mul_f32 v46,v46,v8
v_mul_f32 v47,v47,v8
v_cvt_pk_bf16_f32 v19,v46,v47
buffer_store_dwordx4 v[16:19],v5,s[8:11],s67 offen offset:0 sc1
v_sub_f32 v48,v48,v6
v_sub_f32 v49,v49,v6
v_cvt_pk_bf16_f32 v10,v48,v49
v_lshlrev_b32 v48,16,v10
v_and_b32 v49,0xffff0000,v10
v_mul_f32 v48,v48,v8
v_mul_f32 v49,v49,v8
v_cvt_pk_bf16_f32 v20,v48,v49
v_sub_f32 v50,v50,v6
v_sub_f32 v51,v51,v6
v_cvt_pk_bf16_f32 v10,v50,v51
v_lshlrev_b32 v50,16,v10
v_and_b32 v51,0xffff0000,v10
v_mul_f32 v50,v50,v8
v_mul_f32 v51,v51,v8
v_cvt_pk_bf16_f32 v21,v50,v51
v_sub_f32 v52,v52,v6
v_sub_f32 v53,v53,v6
v_cvt_pk_bf16_f32 v10,v52,v53
v_lshlrev_b32 v52,16,v10
v_and_b32 v53,0xffff0000,v10
v_mul_f32 v52,v52,v8
v_mul_f32 v53,v53,v8
v_cvt_pk_bf16_f32 v22,v52,v53
v_sub_f32 v54,v54,v6
v_sub_f32 v55,v55,v6
v_cvt_pk_bf16_f32 v10,v54,v55
v_lshlrev_b32 v54,16,v10
v_and_b32 v55,0xffff0000,v10
v_mul_f32 v54,v54,v8
v_mul_f32 v55,v55,v8
v_cvt_pk_bf16_f32 v23,v54,v55
buffer_store_dwordx4 v[20:23],v5,s[8:11],s67 offen offset:1024 sc1
v_sub_f32 v56,v56,v6
v_sub_f32 v57,v57,v6
v_cvt_pk_bf16_f32 v10,v56,v57
v_lshlrev_b32 v56,16,v10
v_and_b32 v57,0xffff0000,v10
v_mul_f32 v56,v56,v8
v_mul_f32 v57,v57,v8
v_cvt_pk_bf16_f32 v24,v56,v57
v_sub_f32 v58,v58,v6
v_sub_f32 v59,v59,v6
v_cvt_pk_bf16_f32 v10,v58,v59
v_lshlrev_b32 v58,16,v10
v_and_b32 v59,0xffff0000,v10
v_mul_f32 v58,v58,v8
v_mul_f32 v59,v59,v8
v_cvt_pk_bf16_f32 v25,v58,v59
v_sub_f32 v60,v60,v6
v_sub_f32 v61,v61,v6
v_cvt_pk_bf16_f32 v10,v60,v61
v_lshlrev_b32 v60,16,v10
v_and_b32 v61,0xffff0000,v10
v_mul_f32 v60,v60,v8
v_mul_f32 v61,v61,v8
v_cvt_pk_bf16_f32 v26,v60,v61
v_sub_f32 v62,v62,v6
v_sub_f32 v63,v63,v6
v_cvt_pk_bf16_f32 v10,v62,v63
v_lshlrev_b32 v62,16,v10
v_and_b32 v63,0xffff0000,v10
v_mul_f32 v62,v62,v8
v_mul_f32 v63,v63,v8
v_cvt_pk_bf16_f32 v27,v62,v63
buffer_store_dwordx4 v[24:27],v5,s[8:11],s67 offen offset:2048 sc1
v_sub_f32 v64,v64,v6
v_sub_f32 v65,v65,v6
v_cvt_pk_bf16_f32 v10,v64,v65
v_lshlrev_b32 v64,16,v10
v_and_b32 v65,0xffff0000,v10
v_mul_f32 v64,v64,v8
v_mul_f32 v65,v65,v8
v_cvt_pk_bf16_f32 v28,v64,v65
v_sub_f32 v66,v66,v6
v_sub_f32 v67,v67,v6
v_cvt_pk_bf16_f32 v10,v66,v67
v_lshlrev_b32 v66,16,v10
v_and_b32 v67,0xffff0000,v10
v_mul_f32 v66,v66,v8
v_mul_f32 v67,v67,v8
v_cvt_pk_bf16_f32 v29,v66,v67
v_sub_f32 v68,v68,v6
v_sub_f32 v69,v69,v6
v_cvt_pk_bf16_f32 v10,v68,v69
v_lshlrev_b32 v68,16,v10
v_and_b32 v69,0xffff0000,v10
v_mul_f32 v68,v68,v8
v_mul_f32 v69,v69,v8
v_cvt_pk_bf16_f32 v30,v68,v69
v_sub_f32 v70,v70,v6
v_sub_f32 v71,v71,v6
v_cvt_pk_bf16_f32 v10,v70,v71
v_lshlrev_b32 v70,16,v10
v_and_b32 v71,0xffff0000,v10
v_mul_f32 v70,v70,v8
v_mul_f32 v71,v71,v8
v_cvt_pk_bf16_f32 v31,v70,v71
buffer_store_dwordx4 v[28:31],v5,s[8:11],s67 offen offset:3072 sc1
v_sub_f32 v72,v72,v6
v_sub_f32 v73,v73,v6
v_cvt_pk_bf16_f32 v10,v72,v73
v_lshlrev_b32 v72,16,v10
v_and_b32 v73,0xffff0000,v10
v_mul_f32 v72,v72,v8
v_mul_f32 v73,v73,v8
v_cvt_pk_bf16_f32 v32,v72,v73
v_sub_f32 v74,v74,v6
v_sub_f32 v75,v75,v6
v_cvt_pk_bf16_f32 v10,v74,v75
v_lshlrev_b32 v74,16,v10
v_and_b32 v75,0xffff0000,v10
v_mul_f32 v74,v74,v8
v_mul_f32 v75,v75,v8
v_cvt_pk_bf16_f32 v33,v74,v75
v_sub_f32 v76,v76,v6
v_sub_f32 v77,v77,v6
v_cvt_pk_bf16_f32 v10,v76,v77
v_lshlrev_b32 v76,16,v10
v_and_b32 v77,0xffff0000,v10
v_mul_f32 v76,v76,v8
v_mul_f32 v77,v77,v8
v_cvt_pk_bf16_f32 v34,v76,v77
v_sub_f32 v78,v78,v6
v_sub_f32 v79,v79,v6
v_cvt_pk_bf16_f32 v10,v78,v79
v_lshlrev_b32 v78,16,v10
v_and_b32 v79,0xffff0000,v10
v_mul_f32 v78,v78,v8
v_mul_f32 v79,v79,v8
v_cvt_pk_bf16_f32 v35,v78,v79
buffer_store_dwordx4 v[32:35],v5,s[8:11],s70 offen sc1
s_mov_b32 s65,160
s_cmp_lg_u32 s60,0
s_cbranch_scc1 Lwd_init
s_mov_b32 s71,0x800000
v_mov_b32 v2,0
s_mov_b64 exec,1
Lw_init:
buffer_load_dword v1,v2,s[32:35],s65 offen sc1
s_sub_u32 s71,s71,1
s_cbranch_scc1 Lwe_init
s_waitcnt vmcnt(0)
v_cmp_gt_u32 vcc,1,v1
s_cbranch_vccz Lwe_init
s_sleep 1
s_branch Lw_init
Lwe_init:
s_waitcnt vmcnt(0)
s_mov_b64 exec,-1
Lwd_init:
s_barrier
s_lshr_b32 s64,s86,4
s_lshl_b32 s64,s64,7
s_add_u32 s64,s64,4096
s_waitcnt vmcnt(0)
s_barrier
s_cmp_lg_u32 s60,0
s_cbranch_scc1 Lsg_ln
v_mov_b32 v1,1
v_mov_b32 v2,0
s_mov_b64 exec,1
buffer_atomic_add v1,v2,s[8:11],s64 offen
s_mov_b64 exec,-1
Lsg_ln:
L_noln:
s_cmp_lg_u32 s2,1
s_cbranch_scc1 L_noinit
v_lshlrev_b32 v1,4,v0
v_mov_b64 v[4:5],0
v_mov_b64 v[6:7],0
s_mov_b32 s64,4096
buffer_store_dwordx4 v[4:7],v1,s[8:11],s64 offen sc1
s_mov_b32 s64,8192
buffer_store_dwordx4 v[4:7],v1,s[8:11],s64 offen sc1
s_mov_b32 s64,12288
buffer_store_dwordx4 v[4:7],v1,s[8:11],s64 offen sc1
s_mov_b32 s64,16384
buffer_store_dwordx4 v[4:7],v1,s[8:11],s64 offen sc1
s_waitcnt vmcnt(0)
s_barrier
v_mov_b32 v1,1
v_mov_b32 v2,0
s_mov_b64 exec,1
buffer_store_dword v1,v2,s[32:35],0 offen offset:160 sc1
s_mov_b64 exec,-1
L_noinit:
s_lshr_b32 s61,s2,3
s_cmp_eq_u32 s62,0
s_cbranch_scc1 L_rec
s_branch L_par
L_rec:
s_mov_b32 s3,0
L_rec2:
v_lshrrev_b32 v10,6,v0
v_and_b32 v11,63,v0
v_readfirstlane_b32 s60,v10
v_lshlrev_b32 v0,4,v11
Lr_try:
s_lshl_b32 s75,1,s61
v_mov_b32 v64,s75
v_mov_b32 v65,0
s_cmp_eq_u32 s60,0
s_cselect_b64 exec,1,0
buffer_atomic_or v64,v65,s[32:35],0 offen offset:0 sc0
s_mov_b64 exec,-1
s_cmp_lg_u32 s61,0
s_cbranch_scc1 Lr_nomem0a

v_bfe_u32 v17,v11,2,2
v_and_b32 v18,1,v11
v_lshl_add_u32 v17,v17,1,v18
v_mul_u32_u24 v17,1152,v17
v_bfe_u32 v18,v11,1,1
v_lshl_add_u32 v17,v18,4,v17
v_lshrrev_b32 v18,4,v11
v_lshl_add_u32 v17,v18,5,v17
s_lshl_b32 s75,s60,8
buffer_load_dwordx4 v[68:71],v17,s[28:31],s75 offen
buffer_load_dwordx4 v[72:75],v17,s[28:31],s75 offen offset:128
buffer_load_dwordx4 v[76:79],v17,s[28:31],0 offen offset:1024
Lr_nomem0a:
s_cmp_eq_u32 s60,1
s_cbranch_scc1 Lr_pro1
s_cmp_eq_u32 s60,2
s_cbranch_scc1 Lr_pro2
s_cmp_eq_u32 s60,3
s_cbranch_scc1 Lr_pro3
Lr_pro0:
v_lshrrev_b32 v12,4,v0
v_lshrrev_b32 v13,4,v12
v_and_b32 v14,1,v13
v_or_b32 v14,0,v14
v_lshlrev_b32 v14,1,v14
v_and_b32 v15,15,v12
v_xor_b32 v15,v15,v14
v_lshlrev_b32 v15,4,v15
v_add_u32 v13,0,v13
v_lshl_add_u32 v66,v13,13,v15
v_lshrrev_b32 v13,3,v12
v_mul_u32_u24 v13,1152,v13
v_and_b32 v15,7,v12
v_xor_b32 v15,0,v15
v_lshl_add_u32 v67,v15,4,v13
v_lshrrev_b32 v13,4,v12
v_bfe_u32 v14,v12,2,2
v_and_b32 v15,3,v12
v_lshrrev_b32 v16,1,v13
v_and_b32 v17,1,v13
v_and_b32 v18,1,v14
v_lshrrev_b32 v19,1,v14
v_lshlrev_b32 v20,4,v16
v_lshl_add_u32 v20,v17,2,v20
v_add_u32 v20,v20,v18
v_lshl_add_u32 v20,v19,3,v20
v_lshl_add_u32 v21,v17,1,v18
v_lshl_add_u32 v21,v19,2,v21
v_lshlrev_b32 v20,8,v20
v_lshl_add_u32 v20,v15,3,v20
v_xor_b32 v22,0,v21
v_lshl_add_u32 v60,v22,5,v20
v_xor_b32 v22,1,v21
v_lshl_add_u32 v61,v22,5,v20
v_lshlrev_b32 v20,5,v17
v_lshl_add_u32 v20,v16,2,v20
v_add_u32 v20,v20,v18
v_lshl_add_u32 v20,v19,4,v20
v_lshlrev_b32 v20,7,v20
v_lshl_add_u32 v20,v15,3,v20
v_lshl_add_u32 v21,v17,1,v19
v_xor_b32 v21,0,v21
v_lshl_add_u32 v62,v21,5,v20
s_lshl_b32 s76,s61,8
s_mul_i32 s77,s61,147456
s_mov_b32 m0,16384
s_add_u32 s75,s76,0
buffer_load_dwordx4 v66,s[12:15],s75 offen  lds
s_mov_b32 m0,20480
s_add_u32 s75,s76,131072
buffer_load_dwordx4 v66,s[12:15],s75 offen  lds
s_mov_b32 m0,24576
s_add_u32 s75,s76,262144
buffer_load_dwordx4 v66,s[12:15],s75 offen  lds
s_mov_b32 m0,28672
s_add_u32 s75,s76,393216
buffer_load_dwordx4 v66,s[12:15],s75 offen  lds
s_mov_b32 m0,32768
s_add_u32 s75,s76,524288
buffer_load_dwordx4 v66,s[12:15],s75 offen  lds
s_mov_b32 m0,36864
s_add_u32 s75,s76,655360
buffer_load_dwordx4 v66,s[12:15],s75 offen  lds
s_mov_b32 m0,40960
s_add_u32 s75,s76,786432
buffer_load_dwordx4 v66,s[12:15],s75 offen  lds
s_mov_b32 m0,45056
s_add_u32 s75,s76,917504
buffer_load_dwordx4 v66,s[12:15],s75 offen  lds
s_mov_b32 m0,49152
s_add_u32 s75,s76,1048576
buffer_load_dwordx4 v66,s[12:15],s75 offen  lds
s_mov_b32 m0,53248
s_add_u32 s75,s76,1179648
buffer_load_dwordx4 v66,s[12:15],s75 offen  lds
s_mov_b32 m0,57344
s_add_u32 s75,s76,1310720
buffer_load_dwordx4 v66,s[12:15],s75 offen  lds
s_mov_b32 m0,61440
s_add_u32 s75,s76,1441792
buffer_load_dwordx4 v66,s[12:15],s75 offen  lds
s_mov_b32 m0,65536
s_add_u32 s75,s76,1572864
buffer_load_dwordx4 v66,s[12:15],s75 offen  lds
s_mov_b32 m0,69632
s_add_u32 s75,s76,1703936
buffer_load_dwordx4 v66,s[12:15],s75 offen  lds
s_mov_b32 m0,73728
s_add_u32 s75,s76,1835008
buffer_load_dwordx4 v66,s[12:15],s75 offen  lds
s_mov_b32 m0,77824
s_add_u32 s75,s76,1966080
buffer_load_dwordx4 v66,s[12:15],s75 offen  lds
s_mov_b32 m0,81920
s_add_u32 s75,s76,2097152
buffer_load_dwordx4 v66,s[12:15],s75 offen  lds
s_mov_b32 m0,86016
s_add_u32 s75,s76,2228224
buffer_load_dwordx4 v66,s[12:15],s75 offen  lds
s_mov_b32 m0,90112
s_add_u32 s75,s76,2359296
buffer_load_dwordx4 v66,s[12:15],s75 offen  lds
s_mov_b32 m0,94208
s_add_u32 s75,s76,2490368
buffer_load_dwordx4 v66,s[12:15],s75 offen  lds
s_mov_b32 m0,98304
s_add_u32 s75,s76,2621440
buffer_load_dwordx4 v66,s[12:15],s75 offen  lds
s_mov_b32 m0,102400
s_add_u32 s75,s76,2752512
buffer_load_dwordx4 v66,s[12:15],s75 offen  lds
s_mov_b32 m0,106496
s_add_u32 s75,s76,2883584
buffer_load_dwordx4 v66,s[12:15],s75 offen  lds
s_mov_b32 m0,110592
s_add_u32 s75,s76,3014656
buffer_load_dwordx4 v66,s[12:15],s75 offen  lds
s_mov_b32 m0,114688
s_add_u32 s75,s76,3145728
buffer_load_dwordx4 v66,s[12:15],s75 offen  lds
s_mov_b32 m0,118784
s_add_u32 s75,s76,3276800
buffer_load_dwordx4 v66,s[12:15],s75 offen  lds
s_mov_b32 m0,122880
s_add_u32 s75,s76,3407872
buffer_load_dwordx4 v66,s[12:15],s75 offen  lds
s_mov_b32 m0,126976
s_add_u32 s75,s76,3538944
buffer_load_dwordx4 v66,s[12:15],s75 offen  lds
s_mov_b32 m0,131072
s_add_u32 s75,s76,3670016
buffer_load_dwordx4 v66,s[12:15],s75 offen  lds
s_mov_b32 m0,135168
s_add_u32 s75,s76,3801088
buffer_load_dwordx4 v66,s[12:15],s75 offen  lds
s_mov_b32 m0,139264
s_add_u32 s75,s76,3932160
buffer_load_dwordx4 v66,s[12:15],s75 offen  lds
s_mov_b32 m0,143360
s_add_u32 s75,s76,4063232
buffer_load_dwordx4 v66,s[12:15],s75 offen  lds
s_mov_b32 m0,147456
s_add_u32 s75,s76,0
buffer_load_dwordx4 v66,s[16:19],s75 offen  lds
s_mov_b32 m0,151552
s_add_u32 s75,s76,131072
buffer_load_dwordx4 v66,s[16:19],s75 offen  lds
s_mov_b32 m0,155648
s_add_u32 s75,s76,262144
buffer_load_dwordx4 v66,s[16:19],s75 offen  lds
s_mov_b32 m0,159744
s_add_u32 s75,s76,393216
buffer_load_dwordx4 v66,s[16:19],s75 offen  lds
s_branch Lr_mid
Lr_pro2_0:
s_lshl_b32 s76,s61,8
s_mul_i32 s77,s61,147456
s_waitcnt vmcnt(32)
s_waitcnt lgkmcnt(0)
s_barrier
v_add_u32 v63,16384,v60
ds_read_b64_tr_b16 a[0:1],v63 offset:0
ds_read_b64_tr_b16 a[2:3],v63 offset:512
ds_read_b64_tr_b16 a[4:5],v63 offset:8192
ds_read_b64_tr_b16 a[6:7],v63 offset:8704
v_add_u32 v63,16384,v61
ds_read_b64_tr_b16 a[8:9],v63 offset:0
ds_read_b64_tr_b16 a[10:11],v63 offset:512
ds_read_b64_tr_b16 a[12:13],v63 offset:8192
ds_read_b64_tr_b16 a[14:15],v63 offset:8704
s_waitcnt vmcnt(28)
s_waitcnt lgkmcnt(0)
s_barrier
s_mov_b32 m0,16384
s_add_u32 s75,s76,1048576
buffer_load_dwordx4 v66,s[16:19],s75 offen  lds
s_mov_b32 m0,20480
s_add_u32 s75,s76,1179648
buffer_load_dwordx4 v66,s[16:19],s75 offen  lds
s_mov_b32 m0,24576
s_add_u32 s75,s76,1310720
buffer_load_dwordx4 v66,s[16:19],s75 offen  lds
s_mov_b32 m0,28672
s_add_u32 s75,s76,1441792
buffer_load_dwordx4 v66,s[16:19],s75 offen  lds
v_add_u32 v63,32768,v60
ds_read_b64_tr_b16 a[16:17],v63 offset:0
ds_read_b64_tr_b16 a[18:19],v63 offset:512
ds_read_b64_tr_b16 a[20:21],v63 offset:8192
ds_read_b64_tr_b16 a[22:23],v63 offset:8704
v_add_u32 v63,32768,v61
ds_read_b64_tr_b16 a[24:25],v63 offset:0
ds_read_b64_tr_b16 a[26:27],v63 offset:512
ds_read_b64_tr_b16 a[28:29],v63 offset:8192
ds_read_b64_tr_b16 a[30:31],v63 offset:8704
s_waitcnt vmcnt(28)
s_waitcnt lgkmcnt(0)
s_barrier
s_mov_b32 m0,32768
s_add_u32 s75,s76,2097152
buffer_load_dwordx4 v66,s[16:19],s75 offen  lds
s_mov_b32 m0,36864
s_add_u32 s75,s76,2228224
buffer_load_dwordx4 v66,s[16:19],s75 offen  lds
s_mov_b32 m0,40960
s_add_u32 s75,s76,2359296
buffer_load_dwordx4 v66,s[16:19],s75 offen  lds
s_mov_b32 m0,45056
s_add_u32 s75,s76,2490368
buffer_load_dwordx4 v66,s[16:19],s75 offen  lds
v_add_u32 v63,49152,v60
ds_read_b64_tr_b16 a[32:33],v63 offset:0
ds_read_b64_tr_b16 a[34:35],v63 offset:512
ds_read_b64_tr_b16 a[36:37],v63 offset:8192
ds_read_b64_tr_b16 a[38:39],v63 offset:8704
v_add_u32 v63,49152,v61
ds_read_b64_tr_b16 a[40:41],v63 offset:0
ds_read_b64_tr_b16 a[42:43],v63 offset:512
ds_read_b64_tr_b16 a[44:45],v63 offset:8192
ds_read_b64_tr_b16 a[46:47],v63 offset:8704
s_waitcnt vmcnt(28)
s_waitcnt lgkmcnt(0)
s_barrier
s_mov_b32 m0,49152
s_add_u32 s75,s76,3145728
buffer_load_dwordx4 v66,s[16:19],s75 offen  lds
s_mov_b32 m0,53248
s_add_u32 s75,s76,3276800
buffer_load_dwordx4 v66,s[16:19],s75 offen  lds
s_mov_b32 m0,57344
s_add_u32 s75,s76,3407872
buffer_load_dwordx4 v66,s[16:19],s75 offen  lds
s_mov_b32 m0,61440
s_add_u32 s75,s76,3538944
buffer_load_dwordx4 v66,s[16:19],s75 offen  lds
v_add_u32 v63,65536,v60
ds_read_b64_tr_b16 a[48:49],v63 offset:0
ds_read_b64_tr_b16 a[50:51],v63 offset:512
ds_read_b64_tr_b16 a[52:53],v63 offset:8192
ds_read_b64_tr_b16 a[54:55],v63 offset:8704
v_add_u32 v63,65536,v61
ds_read_b64_tr_b16 a[56:57],v63 offset:0
ds_read_b64_tr_b16 a[58:59],v63 offset:512
ds_read_b64_tr_b16 a[60:61],v63 offset:8192
ds_read_b64_tr_b16 a[62:63],v63 offset:8704
s_waitcnt vmcnt(28)
s_waitcnt lgkmcnt(0)
s_barrier
s_mov_b32 m0,65536
s_add_u32 s75,s76,4194304
buffer_load_dwordx4 v66,s[16:19],s75 offen  lds
s_mov_b32 m0,69632
s_add_u32 s75,s76,4325376
buffer_load_dwordx4 v66,s[16:19],s75 offen  lds
s_mov_b32 m0,73728
s_add_u32 s75,s76,4456448
buffer_load_dwordx4 v66,s[16:19],s75 offen  lds
s_mov_b32 m0,77824
s_add_u32 s75,s76,4587520
buffer_load_dwordx4 v66,s[16:19],s75 offen  lds
v_add_u32 v63,81920,v60
ds_read_b64_tr_b16 a[64:65],v63 offset:0
ds_read_b64_tr_b16 a[66:67],v63 offset:512
ds_read_b64_tr_b16 a[68:69],v63 offset:8192
ds_read_b64_tr_b16 a[70:71],v63 offset:8704
v_add_u32 v63,81920,v61
ds_read_b64_tr_b16 a[72:73],v63 offset:0
ds_read_b64_tr_b16 a[74:75],v63 offset:512
ds_read_b64_tr_b16 a[76:77],v63 offset:8192
ds_read_b64_tr_b16 a[78:79],v63 offset:8704
s_waitcnt vmcnt(28)
s_waitcnt lgkmcnt(0)
s_barrier
s_mov_b32 m0,81920
s_add_u32 s75,s76,1048576
buffer_load_dwordx4 v66,s[20:23],s75 offen  lds
s_mov_b32 m0,86016
s_add_u32 s75,s76,1179648
buffer_load_dwordx4 v66,s[20:23],s75 offen  lds
s_mov_b32 m0,90112
s_add_u32 s75,s76,1310720
buffer_load_dwordx4 v66,s[20:23],s75 offen  lds
s_mov_b32 m0,94208
s_add_u32 s75,s76,1441792
buffer_load_dwordx4 v66,s[20:23],s75 offen  lds
v_add_u32 v63,98304,v60
ds_read_b64_tr_b16 a[80:81],v63 offset:0
ds_read_b64_tr_b16 a[82:83],v63 offset:512
ds_read_b64_tr_b16 a[84:85],v63 offset:8192
ds_read_b64_tr_b16 a[86:87],v63 offset:8704
v_add_u32 v63,98304,v61
ds_read_b64_tr_b16 a[88:89],v63 offset:0
ds_read_b64_tr_b16 a[90:91],v63 offset:512
ds_read_b64_tr_b16 a[92:93],v63 offset:8192
ds_read_b64_tr_b16 a[94:95],v63 offset:8704
s_waitcnt vmcnt(28)
s_waitcnt lgkmcnt(0)
s_barrier
s_mov_b32 m0,98304
s_add_u32 s75,s76,1572864
buffer_load_dwordx4 v66,s[20:23],s75 offen  lds
s_mov_b32 m0,102400
s_add_u32 s75,s76,1703936
buffer_load_dwordx4 v66,s[20:23],s75 offen  lds
s_mov_b32 m0,106496
s_add_u32 s75,s76,1835008
buffer_load_dwordx4 v66,s[20:23],s75 offen  lds
s_mov_b32 m0,110592
s_add_u32 s75,s76,1966080
buffer_load_dwordx4 v66,s[20:23],s75 offen  lds
v_add_u32 v63,114688,v60
ds_read_b64_tr_b16 a[96:97],v63 offset:0
ds_read_b64_tr_b16 a[98:99],v63 offset:512
ds_read_b64_tr_b16 a[100:101],v63 offset:8192
ds_read_b64_tr_b16 a[102:103],v63 offset:8704
v_add_u32 v63,114688,v61
ds_read_b64_tr_b16 a[104:105],v63 offset:0
ds_read_b64_tr_b16 a[106:107],v63 offset:512
ds_read_b64_tr_b16 a[108:109],v63 offset:8192
ds_read_b64_tr_b16 a[110:111],v63 offset:8704
s_waitcnt vmcnt(28)
s_waitcnt lgkmcnt(0)
s_barrier
s_mov_b32 m0,114688
s_add_u32 s75,s76,2097152
buffer_load_dwordx4 v66,s[20:23],s75 offen  lds
s_mov_b32 m0,118784
s_add_u32 s75,s76,2228224
buffer_load_dwordx4 v66,s[20:23],s75 offen  lds
s_mov_b32 m0,122880
s_add_u32 s75,s76,2359296
buffer_load_dwordx4 v66,s[20:23],s75 offen  lds
s_mov_b32 m0,126976
s_add_u32 s75,s76,2490368
buffer_load_dwordx4 v66,s[20:23],s75 offen  lds
v_add_u32 v63,131072,v60
ds_read_b64_tr_b16 a[112:113],v63 offset:0
ds_read_b64_tr_b16 a[114:115],v63 offset:512
ds_read_b64_tr_b16 a[116:117],v63 offset:8192
ds_read_b64_tr_b16 a[118:119],v63 offset:8704
v_add_u32 v63,131072,v61
ds_read_b64_tr_b16 a[120:121],v63 offset:0
ds_read_b64_tr_b16 a[122:123],v63 offset:512
ds_read_b64_tr_b16 a[124:125],v63 offset:8192
ds_read_b64_tr_b16 a[126:127],v63 offset:8704
s_waitcnt vmcnt(28)
s_waitcnt lgkmcnt(0)
s_barrier
s_mov_b32 m0,131072
s_add_u32 s75,s76,2621440
buffer_load_dwordx4 v66,s[20:23],s75 offen  lds
s_mov_b32 m0,135168
s_add_u32 s75,s76,2752512
buffer_load_dwordx4 v66,s[20:23],s75 offen  lds
s_mov_b32 m0,139264
s_add_u32 s75,s76,2883584
buffer_load_dwordx4 v66,s[20:23],s75 offen  lds
s_mov_b32 m0,143360
s_add_u32 s75,s76,3014656
buffer_load_dwordx4 v66,s[20:23],s75 offen  lds
v_add_u32 v63,147456,v60
ds_read_b64_tr_b16 a[128:129],v63 offset:0
ds_read_b64_tr_b16 a[130:131],v63 offset:512
ds_read_b64_tr_b16 a[132:133],v63 offset:8192
ds_read_b64_tr_b16 a[134:135],v63 offset:8704
v_add_u32 v63,147456,v61
ds_read_b64_tr_b16 a[136:137],v63 offset:0
ds_read_b64_tr_b16 a[138:139],v63 offset:512
ds_read_b64_tr_b16 a[140:141],v63 offset:8192
ds_read_b64_tr_b16 a[142:143],v63 offset:8704
s_waitcnt vmcnt(28)
s_waitcnt lgkmcnt(0)
s_barrier
s_add_u32 s75,s62,1
v_mov_b32 v64,s75
v_mov_b32 v65,s61
s_mov_b64 exec,1
buffer_store_byte v64,v65,s[32:35],0 offen offset:128 sc1
s_mov_b64 exec,-1
s_mov_b32 m0,147456
s_add_u32 s75,s76,3145728
buffer_load_dwordx4 v66,s[20:23],s75 offen  lds
s_mov_b32 m0,151552
s_add_u32 s75,s76,3276800
buffer_load_dwordx4 v66,s[20:23],s75 offen  lds
s_mov_b32 m0,155648
s_add_u32 s75,s76,3407872
buffer_load_dwordx4 v66,s[20:23],s75 offen  lds
s_mov_b32 m0,159744
s_add_u32 s75,s76,3538944
buffer_load_dwordx4 v66,s[20:23],s75 offen  lds
v_add_u32 v63,16384,v60
ds_read_b64_tr_b16 a[144:145],v63 offset:0
ds_read_b64_tr_b16 a[146:147],v63 offset:512
ds_read_b64_tr_b16 a[148:149],v63 offset:8192
ds_read_b64_tr_b16 a[150:151],v63 offset:8704
v_add_u32 v63,16384,v61
ds_read_b64_tr_b16 a[152:153],v63 offset:0
ds_read_b64_tr_b16 a[154:155],v63 offset:512
ds_read_b64_tr_b16 a[156:157],v63 offset:8192
ds_read_b64_tr_b16 a[158:159],v63 offset:8704
s_waitcnt vmcnt(29)
s_waitcnt lgkmcnt(0)
s_barrier
s_mov_b32 m0,16384
s_add_u32 s75,s76,3670016
buffer_load_dwordx4 v66,s[20:23],s75 offen  lds
s_mov_b32 m0,20480
s_add_u32 s75,s76,3801088
buffer_load_dwordx4 v66,s[20:23],s75 offen  lds
s_mov_b32 m0,24576
s_add_u32 s75,s76,3932160
buffer_load_dwordx4 v66,s[20:23],s75 offen  lds
s_mov_b32 m0,28672
s_add_u32 s75,s76,4063232
buffer_load_dwordx4 v66,s[20:23],s75 offen  lds
v_add_u32 v63,32768,v60
ds_read_b64_tr_b16 a[160:161],v63 offset:0
ds_read_b64_tr_b16 a[162:163],v63 offset:512
ds_read_b64_tr_b16 a[164:165],v63 offset:8192
ds_read_b64_tr_b16 a[166:167],v63 offset:8704
v_add_u32 v63,32768,v61
ds_read_b64_tr_b16 a[168:169],v63 offset:0
ds_read_b64_tr_b16 a[170:171],v63 offset:512
ds_read_b64_tr_b16 a[172:173],v63 offset:8192
ds_read_b64_tr_b16 a[174:175],v63 offset:8704
s_waitcnt vmcnt(29)
s_waitcnt lgkmcnt(0)
s_barrier
s_mov_b32 m0,32768
s_add_u32 s75,s76,4194304
buffer_load_dwordx4 v66,s[20:23],s75 offen  lds
s_mov_b32 m0,36864
s_add_u32 s75,s76,4325376
buffer_load_dwordx4 v66,s[20:23],s75 offen  lds
s_mov_b32 m0,40960
s_add_u32 s75,s76,4456448
buffer_load_dwordx4 v66,s[20:23],s75 offen  lds
s_mov_b32 m0,45056
s_add_u32 s75,s76,4587520
buffer_load_dwordx4 v66,s[20:23],s75 offen  lds
v_add_u32 v63,49152,v60
ds_read_b64_tr_b16 a[176:177],v63 offset:0
ds_read_b64_tr_b16 a[178:179],v63 offset:512
ds_read_b64_tr_b16 a[180:181],v63 offset:8192
ds_read_b64_tr_b16 a[182:183],v63 offset:8704
v_add_u32 v63,49152,v61
ds_read_b64_tr_b16 a[184:185],v63 offset:0
ds_read_b64_tr_b16 a[186:187],v63 offset:512
ds_read_b64_tr_b16 a[188:189],v63 offset:8192
ds_read_b64_tr_b16 a[190:191],v63 offset:8704
s_waitcnt vmcnt(29)
s_waitcnt lgkmcnt(0)
s_barrier
s_mov_b32 m0,49152
s_add_u32 s75,s77,0
buffer_load_dwordx4 v67,s[24:27],s75 offen  lds
s_mov_b32 m0,50176
s_add_u32 s75,s77,9216
buffer_load_dwordx4 v67,s[24:27],s75 offen  lds
s_mov_b32 m0,57344
s_add_u32 s75,s77,73728
buffer_load_dwordx4 v67,s[24:27],s75 offen  lds
s_mov_b32 m0,58368
s_add_u32 s75,s77,82944
buffer_load_dwordx4 v67,s[24:27],s75 offen  lds
v_add_u32 v63,65536,v60
ds_read_b64_tr_b16 a[192:193],v63 offset:0
ds_read_b64_tr_b16 a[194:195],v63 offset:512
ds_read_b64_tr_b16 a[196:197],v63 offset:8192
ds_read_b64_tr_b16 a[198:199],v63 offset:8704
v_add_u32 v63,65536,v61
ds_read_b64_tr_b16 a[200:201],v63 offset:0
ds_read_b64_tr_b16 a[202:203],v63 offset:512
ds_read_b64_tr_b16 a[204:205],v63 offset:8192
ds_read_b64_tr_b16 a[206:207],v63 offset:8704
s_waitcnt vmcnt(29)
s_waitcnt lgkmcnt(0)
s_barrier
s_mov_b32 m0,65536
s_add_u32 s75,s77,128
buffer_load_dwordx4 v67,s[24:27],s75 offen  lds
s_mov_b32 m0,66560
s_add_u32 s75,s77,9344
buffer_load_dwordx4 v67,s[24:27],s75 offen  lds
s_mov_b32 m0,73728
s_add_u32 s75,s77,73856
buffer_load_dwordx4 v67,s[24:27],s75 offen  lds
s_mov_b32 m0,74752
s_add_u32 s75,s77,83072
buffer_load_dwordx4 v67,s[24:27],s75 offen  lds
v_add_u32 v63,81920,v60
ds_read_b64_tr_b16 a[208:209],v63 offset:0
ds_read_b64_tr_b16 a[210:211],v63 offset:512
ds_read_b64_tr_b16 a[212:213],v63 offset:8192
ds_read_b64_tr_b16 a[214:215],v63 offset:8704
v_add_u32 v63,81920,v61
ds_read_b64_tr_b16 a[216:217],v63 offset:0
ds_read_b64_tr_b16 a[218:219],v63 offset:512
ds_read_b64_tr_b16 a[220:221],v63 offset:8192
ds_read_b64_tr_b16 a[222:223],v63 offset:8704
s_waitcnt vmcnt(29)
s_waitcnt lgkmcnt(0)
s_barrier
s_mov_b32 m0,81920
s_add_u32 s75,s77,256
buffer_load_dwordx4 v67,s[24:27],s75 offen  lds
s_mov_b32 m0,82944
s_add_u32 s75,s77,9472
buffer_load_dwordx4 v67,s[24:27],s75 offen  lds
s_mov_b32 m0,90112
s_add_u32 s75,s77,73984
buffer_load_dwordx4 v67,s[24:27],s75 offen  lds
s_mov_b32 m0,91136
s_add_u32 s75,s77,83200
buffer_load_dwordx4 v67,s[24:27],s75 offen  lds
v_add_u32 v63,98304,v60
ds_read_b64_tr_b16 a[224:225],v63 offset:0
ds_read_b64_tr_b16 a[226:227],v63 offset:512
ds_read_b64_tr_b16 a[228:229],v63 offset:8192
ds_read_b64_tr_b16 a[230:231],v63 offset:8704
v_add_u32 v63,98304,v61
ds_read_b64_tr_b16 a[232:233],v63 offset:0
ds_read_b64_tr_b16 a[234:235],v63 offset:512
ds_read_b64_tr_b16 a[236:237],v63 offset:8192
ds_read_b64_tr_b16 a[238:239],v63 offset:8704
s_waitcnt vmcnt(29)
s_waitcnt lgkmcnt(0)
s_barrier
s_mov_b32 m0,98304
s_add_u32 s75,s77,384
buffer_load_dwordx4 v67,s[24:27],s75 offen  lds
s_mov_b32 m0,99328
s_add_u32 s75,s77,9600
buffer_load_dwordx4 v67,s[24:27],s75 offen  lds
s_mov_b32 m0,106496
s_add_u32 s75,s77,74112
buffer_load_dwordx4 v67,s[24:27],s75 offen  lds
s_mov_b32 m0,107520
s_add_u32 s75,s77,83328
buffer_load_dwordx4 v67,s[24:27],s75 offen  lds
v_add_u32 v63,114688,v60
ds_read_b64_tr_b16 a[240:241],v63 offset:0
ds_read_b64_tr_b16 a[242:243],v63 offset:512
ds_read_b64_tr_b16 a[244:245],v63 offset:8192
ds_read_b64_tr_b16 a[246:247],v63 offset:8704
v_add_u32 v63,114688,v61
ds_read_b64_tr_b16 a[248:249],v63 offset:0
ds_read_b64_tr_b16 a[250:251],v63 offset:512
ds_read_b64_tr_b16 a[252:253],v63 offset:8192
ds_read_b64_tr_b16 a[254:255],v63 offset:8704
s_waitcnt vmcnt(29)
s_waitcnt lgkmcnt(0)
s_barrier
s_mov_b32 m0,114688
s_add_u32 s75,s77,512
buffer_load_dwordx4 v67,s[24:27],s75 offen  lds
s_mov_b32 m0,115712
s_add_u32 s75,s77,9728
buffer_load_dwordx4 v67,s[24:27],s75 offen  lds
s_mov_b32 m0,122880
s_add_u32 s75,s77,74240
buffer_load_dwordx4 v67,s[24:27],s75 offen  lds
s_mov_b32 m0,123904
s_add_u32 s75,s77,83456
buffer_load_dwordx4 v67,s[24:27],s75 offen  lds
v_add_u32 v63,131072,v60
ds_read_b64_tr_b16 v[80:81],v63 offset:0
ds_read_b64_tr_b16 v[82:83],v63 offset:512
ds_read_b64_tr_b16 v[84:85],v63 offset:8192
ds_read_b64_tr_b16 v[86:87],v63 offset:8704
v_add_u32 v63,131072,v61
ds_read_b64_tr_b16 v[88:89],v63 offset:0
ds_read_b64_tr_b16 v[90:91],v63 offset:512
ds_read_b64_tr_b16 v[92:93],v63 offset:8192
ds_read_b64_tr_b16 v[94:95],v63 offset:8704
s_waitcnt vmcnt(28)
s_waitcnt lgkmcnt(0)
s_barrier
s_mov_b32 m0,131072
s_add_u32 s75,s77,640
buffer_load_dwordx4 v67,s[24:27],s75 offen  lds
s_mov_b32 m0,132096
s_add_u32 s75,s77,9856
buffer_load_dwordx4 v67,s[24:27],s75 offen  lds
s_mov_b32 m0,139264
s_add_u32 s75,s77,74368
buffer_load_dwordx4 v67,s[24:27],s75 offen  lds
s_mov_b32 m0,140288
s_add_u32 s75,s77,83584
buffer_load_dwordx4 v67,s[24:27],s75 offen  lds
v_add_u32 v63,147456,v60
ds_read_b64_tr_b16 v[96:97],v63 offset:0
ds_read_b64_tr_b16 v[98:99],v63 offset:512
ds_read_b64_tr_b16 v[100:101],v63 offset:8192
ds_read_b64_tr_b16 v[102:103],v63 offset:8704
v_add_u32 v63,147456,v61
ds_read_b64_tr_b16 v[104:105],v63 offset:0
ds_read_b64_tr_b16 v[106:107],v63 offset:512
ds_read_b64_tr_b16 v[108:109],v63 offset:8192
ds_read_b64_tr_b16 v[110:111],v63 offset:8704
s_waitcnt vmcnt(28)
s_waitcnt lgkmcnt(0)
s_barrier
s_mov_b32 m0,147456
s_add_u32 s75,s77,768
buffer_load_dwordx4 v67,s[24:27],s75 offen  lds
s_mov_b32 m0,148480
s_add_u32 s75,s77,9984
buffer_load_dwordx4 v67,s[24:27],s75 offen  lds
s_mov_b32 m0,155648
s_add_u32 s75,s77,74496
buffer_load_dwordx4 v67,s[24:27],s75 offen  lds
s_mov_b32 m0,156672
s_add_u32 s75,s77,83712
buffer_load_dwordx4 v67,s[24:27],s75 offen  lds
v_add_u32 v63,16384,v60
ds_read_b64_tr_b16 v[112:113],v63 offset:0
ds_read_b64_tr_b16 v[114:115],v63 offset:512
ds_read_b64_tr_b16 v[116:117],v63 offset:8192
ds_read_b64_tr_b16 v[118:119],v63 offset:8704
v_add_u32 v63,16384,v61
ds_read_b64_tr_b16 v[120:121],v63 offset:0
ds_read_b64_tr_b16 v[122:123],v63 offset:512
ds_read_b64_tr_b16 v[124:125],v63 offset:8192
ds_read_b64_tr_b16 v[126:127],v63 offset:8704
s_waitcnt vmcnt(28)
s_waitcnt lgkmcnt(0)
s_barrier
s_mov_b32 m0,16384
s_add_u32 s75,s76,4194304
buffer_load_dwordx4 v66,s[12:15],s75 offen  lds
s_mov_b32 m0,20480
s_add_u32 s75,s76,4325376
buffer_load_dwordx4 v66,s[12:15],s75 offen  lds
s_mov_b32 m0,24576
s_add_u32 s75,s76,4456448
buffer_load_dwordx4 v66,s[12:15],s75 offen  lds
s_mov_b32 m0,28672
s_add_u32 s75,s76,4587520
buffer_load_dwordx4 v66,s[12:15],s75 offen  lds
v_add_u32 v63,32768,v60
ds_read_b64_tr_b16 v[128:129],v63 offset:0
ds_read_b64_tr_b16 v[130:131],v63 offset:512
ds_read_b64_tr_b16 v[132:133],v63 offset:8192
ds_read_b64_tr_b16 v[134:135],v63 offset:8704
v_add_u32 v63,32768,v61
ds_read_b64_tr_b16 v[136:137],v63 offset:0
ds_read_b64_tr_b16 v[138:139],v63 offset:512
ds_read_b64_tr_b16 v[140:141],v63 offset:8192
ds_read_b64_tr_b16 v[142:143],v63 offset:8704
s_waitcnt vmcnt(28)
s_waitcnt lgkmcnt(0)
s_barrier
s_mov_b32 m0,32768
s_add_u32 s75,s76,0
buffer_load_dwordx4 v66,s[20:23],s75 offen  lds
s_mov_b32 m0,36864
s_add_u32 s75,s76,131072
buffer_load_dwordx4 v66,s[20:23],s75 offen  lds
s_mov_b32 m0,40960
s_add_u32 s75,s76,262144
buffer_load_dwordx4 v66,s[20:23],s75 offen  lds
s_mov_b32 m0,45056
s_add_u32 s75,s76,393216
buffer_load_dwordx4 v66,s[20:23],s75 offen  lds
v_add_u32 v63,49152,v62
ds_read_b64_tr_b16 v[144:145],v63 offset:0
ds_read_b64_tr_b16 v[146:147],v63 offset:256
ds_read_b64_tr_b16 v[148:149],v63 offset:1024
ds_read_b64_tr_b16 v[150:151],v63 offset:1280
v_add_u32 v63,49152,v62
ds_read_b64_tr_b16 v[152:153],v63 offset:8192
ds_read_b64_tr_b16 v[154:155],v63 offset:8448
ds_read_b64_tr_b16 v[156:157],v63 offset:9216
ds_read_b64_tr_b16 v[158:159],v63 offset:9472
s_waitcnt vmcnt(28)
s_waitcnt lgkmcnt(0)
s_barrier
s_mov_b32 m0,49152
s_add_u32 s75,s76,524288
buffer_load_dwordx4 v66,s[20:23],s75 offen  lds
s_mov_b32 m0,53248
s_add_u32 s75,s76,655360
buffer_load_dwordx4 v66,s[20:23],s75 offen  lds
s_mov_b32 m0,57344
s_add_u32 s75,s76,786432
buffer_load_dwordx4 v66,s[20:23],s75 offen  lds
s_mov_b32 m0,61440
s_add_u32 s75,s76,917504
buffer_load_dwordx4 v66,s[20:23],s75 offen  lds
v_add_u32 v63,65536,v62
ds_read_b64_tr_b16 v[160:161],v63 offset:0
ds_read_b64_tr_b16 v[162:163],v63 offset:256
ds_read_b64_tr_b16 v[164:165],v63 offset:1024
ds_read_b64_tr_b16 v[166:167],v63 offset:1280
v_add_u32 v63,65536,v62
ds_read_b64_tr_b16 v[168:169],v63 offset:8192
ds_read_b64_tr_b16 v[170:171],v63 offset:8448
ds_read_b64_tr_b16 v[172:173],v63 offset:9216
ds_read_b64_tr_b16 v[174:175],v63 offset:9472
s_waitcnt vmcnt(28)
s_waitcnt lgkmcnt(0)
s_barrier
s_mov_b32 m0,65536
s_add_u32 s75,s76,524288
buffer_load_dwordx4 v66,s[16:19],s75 offen  lds
s_mov_b32 m0,69632
s_add_u32 s75,s76,655360
buffer_load_dwordx4 v66,s[16:19],s75 offen  lds
s_mov_b32 m0,73728
s_add_u32 s75,s76,786432
buffer_load_dwordx4 v66,s[16:19],s75 offen  lds
s_mov_b32 m0,77824
s_add_u32 s75,s76,917504
buffer_load_dwordx4 v66,s[16:19],s75 offen  lds
v_add_u32 v63,81920,v62
ds_read_b64_tr_b16 v[176:177],v63 offset:0
ds_read_b64_tr_b16 v[178:179],v63 offset:256
ds_read_b64_tr_b16 v[180:181],v63 offset:1024
ds_read_b64_tr_b16 v[182:183],v63 offset:1280
v_add_u32 v63,81920,v62
ds_read_b64_tr_b16 v[184:185],v63 offset:8192
ds_read_b64_tr_b16 v[186:187],v63 offset:8448
ds_read_b64_tr_b16 v[188:189],v63 offset:9216
ds_read_b64_tr_b16 v[190:191],v63 offset:9472
s_waitcnt vmcnt(28)
s_waitcnt lgkmcnt(0)
s_barrier
s_mov_b32 m0,81920
s_add_u32 s75,s76,1572864
buffer_load_dwordx4 v66,s[16:19],s75 offen  lds
s_mov_b32 m0,86016
s_add_u32 s75,s76,1703936
buffer_load_dwordx4 v66,s[16:19],s75 offen  lds
s_mov_b32 m0,90112
s_add_u32 s75,s76,1835008
buffer_load_dwordx4 v66,s[16:19],s75 offen  lds
s_mov_b32 m0,94208
s_add_u32 s75,s76,1966080
buffer_load_dwordx4 v66,s[16:19],s75 offen  lds
v_add_u32 v63,98304,v62
ds_read_b64_tr_b16 v[192:193],v63 offset:0
ds_read_b64_tr_b16 v[194:195],v63 offset:256
ds_read_b64_tr_b16 v[196:197],v63 offset:1024
ds_read_b64_tr_b16 v[198:199],v63 offset:1280
v_add_u32 v63,98304,v62
ds_read_b64_tr_b16 v[200:201],v63 offset:8192
ds_read_b64_tr_b16 v[202:203],v63 offset:8448
ds_read_b64_tr_b16 v[204:205],v63 offset:9216
ds_read_b64_tr_b16 v[206:207],v63 offset:9472
s_waitcnt vmcnt(28)
s_waitcnt lgkmcnt(0)
s_barrier
s_mov_b32 m0,98304
s_add_u32 s75,s76,2621440
buffer_load_dwordx4 v66,s[16:19],s75 offen  lds
s_mov_b32 m0,102400
s_add_u32 s75,s76,2752512
buffer_load_dwordx4 v66,s[16:19],s75 offen  lds
s_mov_b32 m0,106496
s_add_u32 s75,s76,2883584
buffer_load_dwordx4 v66,s[16:19],s75 offen  lds
s_mov_b32 m0,110592
s_add_u32 s75,s76,3014656
buffer_load_dwordx4 v66,s[16:19],s75 offen  lds
v_add_u32 v63,114688,v62
ds_read_b64_tr_b16 v[208:209],v63 offset:0
ds_read_b64_tr_b16 v[210:211],v63 offset:256
ds_read_b64_tr_b16 v[212:213],v63 offset:1024
ds_read_b64_tr_b16 v[214:215],v63 offset:1280
v_add_u32 v63,114688,v62
ds_read_b64_tr_b16 v[216:217],v63 offset:8192
ds_read_b64_tr_b16 v[218:219],v63 offset:8448
ds_read_b64_tr_b16 v[220:221],v63 offset:9216
ds_read_b64_tr_b16 v[222:223],v63 offset:9472
s_waitcnt vmcnt(28)
s_waitcnt lgkmcnt(0)
s_barrier
s_mov_b32 m0,114688
s_add_u32 s75,s76,3670016
buffer_load_dwordx4 v66,s[16:19],s75 offen  lds
s_mov_b32 m0,118784
s_add_u32 s75,s76,3801088
buffer_load_dwordx4 v66,s[16:19],s75 offen  lds
s_mov_b32 m0,122880
s_add_u32 s75,s76,3932160
buffer_load_dwordx4 v66,s[16:19],s75 offen  lds
s_mov_b32 m0,126976
s_add_u32 s75,s76,4063232
buffer_load_dwordx4 v66,s[16:19],s75 offen  lds
v_add_u32 v63,131072,v62
ds_read_b64_tr_b16 v[224:225],v63 offset:0
ds_read_b64_tr_b16 v[226:227],v63 offset:256
ds_read_b64_tr_b16 v[228:229],v63 offset:1024
ds_read_b64_tr_b16 v[230:231],v63 offset:1280
v_add_u32 v63,131072,v62
ds_read_b64_tr_b16 v[232:233],v63 offset:8192
ds_read_b64_tr_b16 v[234:235],v63 offset:8448
ds_read_b64_tr_b16 v[236:237],v63 offset:9216
ds_read_b64_tr_b16 v[238:239],v63 offset:9472
s_waitcnt vmcnt(28)
s_waitcnt lgkmcnt(0)
s_barrier
s_mov_b32 m0,131072
s_add_u32 s75,s77,896
buffer_load_dwordx4 v67,s[24:27],s75 offen  lds
s_mov_b32 m0,132096
s_add_u32 s75,s77,10112
buffer_load_dwordx4 v67,s[24:27],s75 offen  lds
s_mov_b32 m0,139264
s_add_u32 s75,s77,74624
buffer_load_dwordx4 v67,s[24:27],s75 offen  lds
s_mov_b32 m0,140288
s_add_u32 s75,s77,83840
buffer_load_dwordx4 v67,s[24:27],s75 offen  lds
v_add_u32 v63,147456,v62
ds_read_b64_tr_b16 v[240:241],v63 offset:0
ds_read_b64_tr_b16 v[242:243],v63 offset:256
ds_read_b64_tr_b16 v[244:245],v63 offset:1024
ds_read_b64_tr_b16 v[246:247],v63 offset:1280
v_add_u32 v63,147456,v62
ds_read_b64_tr_b16 v[248:249],v63 offset:8192
ds_read_b64_tr_b16 v[250:251],v63 offset:8448
ds_read_b64_tr_b16 v[252:253],v63 offset:9216
ds_read_b64_tr_b16 v[254:255],v63 offset:9472
s_waitcnt vmcnt(28)
s_waitcnt lgkmcnt(0)
s_barrier
s_mov_b32 m0,147456
s_add_u32 s75,s77,1024
buffer_load_dwordx4 v67,s[24:27],s75 offen  lds
s_mov_b32 m0,148480
s_add_u32 s75,s77,10240
buffer_load_dwordx4 v67,s[24:27],s75 offen  lds
s_mov_b32 m0,155648
s_add_u32 s75,s77,74752
buffer_load_dwordx4 v67,s[24:27],s75 offen  lds
s_mov_b32 m0,156672
s_add_u32 s75,s77,83968
buffer_load_dwordx4 v67,s[24:27],s75 offen  lds
v_add_u32 v63,16384,v60
ds_read_b64_tr_b16 v[28:29],v63 offset:0
ds_read_b64_tr_b16 v[30:31],v63 offset:512
ds_read_b64_tr_b16 v[32:33],v63 offset:8192
ds_read_b64_tr_b16 v[34:35],v63 offset:8704
v_add_u32 v63,16384,v61
ds_read_b64_tr_b16 v[36:37],v63 offset:0
ds_read_b64_tr_b16 v[38:39],v63 offset:512
ds_read_b64_tr_b16 v[40:41],v63 offset:8192
ds_read_b64_tr_b16 v[42:43],v63 offset:8704
s_waitcnt vmcnt(28)
s_waitcnt lgkmcnt(0)
s_barrier
v_add_u32 v63,0,v2
ds_write_b128 v63,v[28:31] offset:0
ds_write_b128 v63,v[32:35] offset:1024
ds_write_b128 v63,v[36:39] offset:2048
ds_write_b128 v63,v[40:43] offset:3072
v_add_u32 v63,32768,v60
ds_read_b64_tr_b16 v[12:13],v63 offset:0
ds_read_b64_tr_b16 v[14:15],v63 offset:512
ds_read_b64_tr_b16 v[16:17],v63 offset:8192
ds_read_b64_tr_b16 v[18:19],v63 offset:8704
v_add_u32 v63,32768,v61
ds_read_b64_tr_b16 v[20:21],v63 offset:0
ds_read_b64_tr_b16 v[22:23],v63 offset:512
ds_read_b64_tr_b16 v[24:25],v63 offset:8192
ds_read_b64_tr_b16 v[26:27],v63 offset:8704
s_waitcnt vmcnt(24)
s_waitcnt lgkmcnt(0)
s_barrier
v_bfe_u32 v64,v0,4,5
buffer_load_ubyte v68,v64,s[32:35],0 offen offset:128 sc1
v_mov_b32 v64,0
buffer_load_dword v69,v64,s[32:35],0 offen offset:160 sc1
v_add_u32 v63,16384,v2
ds_write_b128 v63,v[12:15] offset:0
ds_write_b128 v63,v[16:19] offset:1024
ds_write_b128 v63,v[20:23] offset:2048
ds_write_b128 v63,v[24:27] offset:3072
v_add_u32 v63,49152,v60
ds_read_b64_tr_b16 v[28:29],v63 offset:0
ds_read_b64_tr_b16 v[30:31],v63 offset:512
ds_read_b64_tr_b16 v[32:33],v63 offset:8192
ds_read_b64_tr_b16 v[34:35],v63 offset:8704
v_add_u32 v63,49152,v61
ds_read_b64_tr_b16 v[36:37],v63 offset:0
ds_read_b64_tr_b16 v[38:39],v63 offset:512
ds_read_b64_tr_b16 v[40:41],v63 offset:8192
ds_read_b64_tr_b16 v[42:43],v63 offset:8704
s_waitcnt vmcnt(22)
s_waitcnt lgkmcnt(0)
s_barrier
v_add_u32 v63,32768,v2
ds_write_b128 v63,v[28:31] offset:0
ds_write_b128 v63,v[32:35] offset:1024
ds_write_b128 v63,v[36:39] offset:2048
ds_write_b128 v63,v[40:43] offset:3072
v_add_u32 v63,65536,v60
ds_read_b64_tr_b16 v[12:13],v63 offset:0
ds_read_b64_tr_b16 v[14:15],v63 offset:512
ds_read_b64_tr_b16 v[16:17],v63 offset:8192
ds_read_b64_tr_b16 v[18:19],v63 offset:8704
v_add_u32 v63,65536,v61
ds_read_b64_tr_b16 v[20:21],v63 offset:0
ds_read_b64_tr_b16 v[22:23],v63 offset:512
ds_read_b64_tr_b16 v[24:25],v63 offset:8192
ds_read_b64_tr_b16 v[26:27],v63 offset:8704
s_waitcnt vmcnt(18)
s_waitcnt lgkmcnt(0)
s_barrier
v_add_u32 v63,49152,v2
ds_write_b128 v63,v[12:15] offset:0
ds_write_b128 v63,v[16:19] offset:1024
ds_write_b128 v63,v[20:23] offset:2048
ds_write_b128 v63,v[24:27] offset:3072
v_add_u32 v63,81920,v60
ds_read_b64_tr_b16 v[28:29],v63 offset:0
ds_read_b64_tr_b16 v[30:31],v63 offset:512
ds_read_b64_tr_b16 v[32:33],v63 offset:8192
ds_read_b64_tr_b16 v[34:35],v63 offset:8704
v_add_u32 v63,81920,v61
ds_read_b64_tr_b16 v[36:37],v63 offset:0
ds_read_b64_tr_b16 v[38:39],v63 offset:512
ds_read_b64_tr_b16 v[40:41],v63 offset:8192
ds_read_b64_tr_b16 v[42:43],v63 offset:8704
s_waitcnt vmcnt(14)
s_waitcnt lgkmcnt(0)
s_barrier
v_add_u32 v63,65536,v2
ds_write_b128 v63,v[28:31] offset:0
ds_write_b128 v63,v[32:35] offset:1024
ds_write_b128 v63,v[36:39] offset:2048
ds_write_b128 v63,v[40:43] offset:3072
v_add_u32 v63,98304,v60
ds_read_b64_tr_b16 v[12:13],v63 offset:0
ds_read_b64_tr_b16 v[14:15],v63 offset:512
ds_read_b64_tr_b16 v[16:17],v63 offset:8192
ds_read_b64_tr_b16 v[18:19],v63 offset:8704
v_add_u32 v63,98304,v61
ds_read_b64_tr_b16 v[20:21],v63 offset:0
ds_read_b64_tr_b16 v[22:23],v63 offset:512
ds_read_b64_tr_b16 v[24:25],v63 offset:8192
ds_read_b64_tr_b16 v[26:27],v63 offset:8704
s_waitcnt vmcnt(10)
s_waitcnt lgkmcnt(0)
s_barrier
v_add_u32 v63,81920,v2
ds_write_b128 v63,v[12:15] offset:0
ds_write_b128 v63,v[16:19] offset:1024
ds_write_b128 v63,v[20:23] offset:2048
ds_write_b128 v63,v[24:27] offset:3072
v_add_u32 v63,114688,v60
ds_read_b64_tr_b16 v[28:29],v63 offset:0
ds_read_b64_tr_b16 v[30:31],v63 offset:512
ds_read_b64_tr_b16 v[32:33],v63 offset:8192
ds_read_b64_tr_b16 v[34:35],v63 offset:8704
v_add_u32 v63,114688,v61
ds_read_b64_tr_b16 v[36:37],v63 offset:0
ds_read_b64_tr_b16 v[38:39],v63 offset:512
ds_read_b64_tr_b16 v[40:41],v63 offset:8192
ds_read_b64_tr_b16 v[42:43],v63 offset:8704
s_waitcnt vmcnt(6)
s_waitcnt lgkmcnt(0)
s_barrier
v_add_u32 v63,98304,v2
ds_write_b128 v63,v[28:31] offset:0
ds_write_b128 v63,v[32:35] offset:1024
ds_write_b128 v63,v[36:39] offset:2048
ds_write_b128 v63,v[40:43] offset:3072
v_add_u32 v63,131072,v62
ds_read_b64_tr_b16 v[12:13],v63 offset:0
ds_read_b64_tr_b16 v[14:15],v63 offset:256
ds_read_b64_tr_b16 v[16:17],v63 offset:1024
ds_read_b64_tr_b16 v[18:19],v63 offset:1280
v_add_u32 v63,131072,v62
ds_read_b64_tr_b16 v[20:21],v63 offset:8192
ds_read_b64_tr_b16 v[22:23],v63 offset:8448
ds_read_b64_tr_b16 v[24:25],v63 offset:9216
ds_read_b64_tr_b16 v[26:27],v63 offset:9472
s_waitcnt vmcnt(2)
s_waitcnt lgkmcnt(0)
s_barrier
v_add_u32 v63,114688,v2
ds_write_b128 v63,v[12:15] offset:0
ds_write_b128 v63,v[16:19] offset:1024
ds_write_b128 v63,v[20:23] offset:2048
ds_write_b128 v63,v[24:27] offset:3072
v_add_u32 v63,147456,v62
ds_read_b64_tr_b16 v[28:29],v63 offset:0
ds_read_b64_tr_b16 v[30:31],v63 offset:256
ds_read_b64_tr_b16 v[32:33],v63 offset:1024
ds_read_b64_tr_b16 v[34:35],v63 offset:1280
v_add_u32 v63,147456,v62
ds_read_b64_tr_b16 v[36:37],v63 offset:8192
ds_read_b64_tr_b16 v[38:39],v63 offset:8448
ds_read_b64_tr_b16 v[40:41],v63 offset:9216
ds_read_b64_tr_b16 v[42:43],v63 offset:9472
s_waitcnt lgkmcnt(0)
s_barrier
v_add_u32 v63,131072,v2
ds_write_b128 v63,v[28:31] offset:0
ds_write_b128 v63,v[32:35] offset:1024
ds_write_b128 v63,v[36:39] offset:2048
ds_write_b128 v63,v[40:43] offset:3072
s_waitcnt lgkmcnt(0)
s_barrier
s_branch Lr_prodone
Lr_pro1:
v_lshrrev_b32 v12,4,v0
v_lshrrev_b32 v13,4,v12
v_and_b32 v14,1,v13
v_or_b32 v14,2,v14
v_lshlrev_b32 v14,1,v14
v_and_b32 v15,15,v12
v_xor_b32 v15,v15,v14
v_lshlrev_b32 v15,4,v15
v_add_u32 v13,4,v13
v_lshl_add_u32 v66,v13,13,v15
v_lshrrev_b32 v13,3,v12
v_mul_u32_u24 v13,1152,v13
v_and_b32 v15,7,v12
v_xor_b32 v15,2,v15
v_lshl_add_u32 v67,v15,4,v13
v_lshrrev_b32 v13,4,v12
v_bfe_u32 v14,v12,2,2
v_and_b32 v15,3,v12
v_lshrrev_b32 v16,1,v13
v_and_b32 v17,1,v13
v_and_b32 v18,1,v14
v_lshrrev_b32 v19,1,v14
v_lshlrev_b32 v20,4,v16
v_lshl_add_u32 v20,v17,2,v20
v_add_u32 v20,v20,v18
v_lshl_add_u32 v20,v19,3,v20
v_lshl_add_u32 v21,v17,1,v18
v_lshl_add_u32 v21,v19,2,v21
v_lshlrev_b32 v20,8,v20
v_lshl_add_u32 v20,v15,3,v20
v_xor_b32 v22,2,v21
v_lshl_add_u32 v60,v22,5,v20
v_xor_b32 v22,3,v21
v_lshl_add_u32 v61,v22,5,v20
v_lshlrev_b32 v20,5,v17
v_lshl_add_u32 v20,v16,2,v20
v_add_u32 v20,v20,v18
v_lshl_add_u32 v20,v19,4,v20
v_lshlrev_b32 v20,7,v20
v_lshl_add_u32 v20,v15,3,v20
v_lshl_add_u32 v21,v17,1,v19
v_xor_b32 v21,1,v21
v_lshl_add_u32 v62,v21,5,v20
s_lshl_b32 s76,s61,8
s_mul_i32 s77,s61,147456
s_mov_b32 m0,17408
s_add_u32 s75,s76,0
buffer_load_dwordx4 v66,s[12:15],s75 offen  lds
s_mov_b32 m0,21504
s_add_u32 s75,s76,131072
buffer_load_dwordx4 v66,s[12:15],s75 offen  lds
s_mov_b32 m0,25600
s_add_u32 s75,s76,262144
buffer_load_dwordx4 v66,s[12:15],s75 offen  lds
s_mov_b32 m0,29696
s_add_u32 s75,s76,393216
buffer_load_dwordx4 v66,s[12:15],s75 offen  lds
s_mov_b32 m0,33792
s_add_u32 s75,s76,524288
buffer_load_dwordx4 v66,s[12:15],s75 offen  lds
s_mov_b32 m0,37888
s_add_u32 s75,s76,655360
buffer_load_dwordx4 v66,s[12:15],s75 offen  lds
s_mov_b32 m0,41984
s_add_u32 s75,s76,786432
buffer_load_dwordx4 v66,s[12:15],s75 offen  lds
s_mov_b32 m0,46080
s_add_u32 s75,s76,917504
buffer_load_dwordx4 v66,s[12:15],s75 offen  lds
s_mov_b32 m0,50176
s_add_u32 s75,s76,1048576
buffer_load_dwordx4 v66,s[12:15],s75 offen  lds
s_mov_b32 m0,54272
s_add_u32 s75,s76,1179648
buffer_load_dwordx4 v66,s[12:15],s75 offen  lds
s_mov_b32 m0,58368
s_add_u32 s75,s76,1310720
buffer_load_dwordx4 v66,s[12:15],s75 offen  lds
s_mov_b32 m0,62464
s_add_u32 s75,s76,1441792
buffer_load_dwordx4 v66,s[12:15],s75 offen  lds
s_mov_b32 m0,66560
s_add_u32 s75,s76,1572864
buffer_load_dwordx4 v66,s[12:15],s75 offen  lds
s_mov_b32 m0,70656
s_add_u32 s75,s76,1703936
buffer_load_dwordx4 v66,s[12:15],s75 offen  lds
s_mov_b32 m0,74752
s_add_u32 s75,s76,1835008
buffer_load_dwordx4 v66,s[12:15],s75 offen  lds
s_mov_b32 m0,78848
s_add_u32 s75,s76,1966080
buffer_load_dwordx4 v66,s[12:15],s75 offen  lds
s_mov_b32 m0,82944
s_add_u32 s75,s76,2097152
buffer_load_dwordx4 v66,s[12:15],s75 offen  lds
s_mov_b32 m0,87040
s_add_u32 s75,s76,2228224
buffer_load_dwordx4 v66,s[12:15],s75 offen  lds
s_mov_b32 m0,91136
s_add_u32 s75,s76,2359296
buffer_load_dwordx4 v66,s[12:15],s75 offen  lds
s_mov_b32 m0,95232
s_add_u32 s75,s76,2490368
buffer_load_dwordx4 v66,s[12:15],s75 offen  lds
s_mov_b32 m0,99328
s_add_u32 s75,s76,2621440
buffer_load_dwordx4 v66,s[12:15],s75 offen  lds
s_mov_b32 m0,103424
s_add_u32 s75,s76,2752512
buffer_load_dwordx4 v66,s[12:15],s75 offen  lds
s_mov_b32 m0,107520
s_add_u32 s75,s76,2883584
buffer_load_dwordx4 v66,s[12:15],s75 offen  lds
s_mov_b32 m0,111616
s_add_u32 s75,s76,3014656
buffer_load_dwordx4 v66,s[12:15],s75 offen  lds
s_mov_b32 m0,115712
s_add_u32 s75,s76,3145728
buffer_load_dwordx4 v66,s[12:15],s75 offen  lds
s_mov_b32 m0,119808
s_add_u32 s75,s76,3276800
buffer_load_dwordx4 v66,s[12:15],s75 offen  lds
s_mov_b32 m0,123904
s_add_u32 s75,s76,3407872
buffer_load_dwordx4 v66,s[12:15],s75 offen  lds
s_mov_b32 m0,128000
s_add_u32 s75,s76,3538944
buffer_load_dwordx4 v66,s[12:15],s75 offen  lds
s_mov_b32 m0,132096
s_add_u32 s75,s76,3670016
buffer_load_dwordx4 v66,s[12:15],s75 offen  lds
s_mov_b32 m0,136192
s_add_u32 s75,s76,3801088
buffer_load_dwordx4 v66,s[12:15],s75 offen  lds
s_mov_b32 m0,140288
s_add_u32 s75,s76,3932160
buffer_load_dwordx4 v66,s[12:15],s75 offen  lds
s_mov_b32 m0,144384
s_add_u32 s75,s76,4063232
buffer_load_dwordx4 v66,s[12:15],s75 offen  lds
s_mov_b32 m0,148480
s_add_u32 s75,s76,0
buffer_load_dwordx4 v66,s[16:19],s75 offen  lds
s_mov_b32 m0,152576
s_add_u32 s75,s76,131072
buffer_load_dwordx4 v66,s[16:19],s75 offen  lds
s_mov_b32 m0,156672
s_add_u32 s75,s76,262144
buffer_load_dwordx4 v66,s[16:19],s75 offen  lds
s_mov_b32 m0,160768
s_add_u32 s75,s76,393216
buffer_load_dwordx4 v66,s[16:19],s75 offen  lds
s_branch Lr_mid
Lr_pro2_1:
s_lshl_b32 s76,s61,8
s_mul_i32 s77,s61,147456
s_waitcnt vmcnt(32)
s_waitcnt lgkmcnt(0)
s_barrier
v_add_u32 v63,16384,v60
ds_read_b64_tr_b16 a[32:33],v63 offset:0
ds_read_b64_tr_b16 a[34:35],v63 offset:512
ds_read_b64_tr_b16 a[36:37],v63 offset:8192
ds_read_b64_tr_b16 a[38:39],v63 offset:8704
v_add_u32 v63,16384,v61
ds_read_b64_tr_b16 a[40:41],v63 offset:0
ds_read_b64_tr_b16 a[42:43],v63 offset:512
ds_read_b64_tr_b16 a[44:45],v63 offset:8192
ds_read_b64_tr_b16 a[46:47],v63 offset:8704
s_waitcnt vmcnt(28)
s_waitcnt lgkmcnt(0)
s_barrier
s_mov_b32 m0,17408
s_add_u32 s75,s76,1048576
buffer_load_dwordx4 v66,s[16:19],s75 offen  lds
s_mov_b32 m0,21504
s_add_u32 s75,s76,1179648
buffer_load_dwordx4 v66,s[16:19],s75 offen  lds
s_mov_b32 m0,25600
s_add_u32 s75,s76,1310720
buffer_load_dwordx4 v66,s[16:19],s75 offen  lds
s_mov_b32 m0,29696
s_add_u32 s75,s76,1441792
buffer_load_dwordx4 v66,s[16:19],s75 offen  lds
v_add_u32 v63,32768,v60
ds_read_b64_tr_b16 a[48:49],v63 offset:0
ds_read_b64_tr_b16 a[50:51],v63 offset:512
ds_read_b64_tr_b16 a[52:53],v63 offset:8192
ds_read_b64_tr_b16 a[54:55],v63 offset:8704
v_add_u32 v63,32768,v61
ds_read_b64_tr_b16 a[56:57],v63 offset:0
ds_read_b64_tr_b16 a[58:59],v63 offset:512
ds_read_b64_tr_b16 a[60:61],v63 offset:8192
ds_read_b64_tr_b16 a[62:63],v63 offset:8704
s_waitcnt vmcnt(28)
s_waitcnt lgkmcnt(0)
s_barrier
s_mov_b32 m0,33792
s_add_u32 s75,s76,2097152
buffer_load_dwordx4 v66,s[16:19],s75 offen  lds
s_mov_b32 m0,37888
s_add_u32 s75,s76,2228224
buffer_load_dwordx4 v66,s[16:19],s75 offen  lds
s_mov_b32 m0,41984
s_add_u32 s75,s76,2359296
buffer_load_dwordx4 v66,s[16:19],s75 offen  lds
s_mov_b32 m0,46080
s_add_u32 s75,s76,2490368
buffer_load_dwordx4 v66,s[16:19],s75 offen  lds
v_add_u32 v63,49152,v60
ds_read_b64_tr_b16 a[0:1],v63 offset:0
ds_read_b64_tr_b16 a[2:3],v63 offset:512
ds_read_b64_tr_b16 a[4:5],v63 offset:8192
ds_read_b64_tr_b16 a[6:7],v63 offset:8704
v_add_u32 v63,49152,v61
ds_read_b64_tr_b16 a[8:9],v63 offset:0
ds_read_b64_tr_b16 a[10:11],v63 offset:512
ds_read_b64_tr_b16 a[12:13],v63 offset:8192
ds_read_b64_tr_b16 a[14:15],v63 offset:8704
s_waitcnt vmcnt(28)
s_waitcnt lgkmcnt(0)
s_barrier
s_mov_b32 m0,50176
s_add_u32 s75,s76,3145728
buffer_load_dwordx4 v66,s[16:19],s75 offen  lds
s_mov_b32 m0,54272
s_add_u32 s75,s76,3276800
buffer_load_dwordx4 v66,s[16:19],s75 offen  lds
s_mov_b32 m0,58368
s_add_u32 s75,s76,3407872
buffer_load_dwordx4 v66,s[16:19],s75 offen  lds
s_mov_b32 m0,62464
s_add_u32 s75,s76,3538944
buffer_load_dwordx4 v66,s[16:19],s75 offen  lds
v_add_u32 v63,65536,v60
ds_read_b64_tr_b16 a[16:17],v63 offset:0
ds_read_b64_tr_b16 a[18:19],v63 offset:512
ds_read_b64_tr_b16 a[20:21],v63 offset:8192
ds_read_b64_tr_b16 a[22:23],v63 offset:8704
v_add_u32 v63,65536,v61
ds_read_b64_tr_b16 a[24:25],v63 offset:0
ds_read_b64_tr_b16 a[26:27],v63 offset:512
ds_read_b64_tr_b16 a[28:29],v63 offset:8192
ds_read_b64_tr_b16 a[30:31],v63 offset:8704
s_waitcnt vmcnt(28)
s_waitcnt lgkmcnt(0)
s_barrier
s_mov_b32 m0,66560
s_add_u32 s75,s76,4194304
buffer_load_dwordx4 v66,s[16:19],s75 offen  lds
s_mov_b32 m0,70656
s_add_u32 s75,s76,4325376
buffer_load_dwordx4 v66,s[16:19],s75 offen  lds
s_mov_b32 m0,74752
s_add_u32 s75,s76,4456448
buffer_load_dwordx4 v66,s[16:19],s75 offen  lds
s_mov_b32 m0,78848
s_add_u32 s75,s76,4587520
buffer_load_dwordx4 v66,s[16:19],s75 offen  lds
v_add_u32 v63,81920,v60
ds_read_b64_tr_b16 a[96:97],v63 offset:0
ds_read_b64_tr_b16 a[98:99],v63 offset:512
ds_read_b64_tr_b16 a[100:101],v63 offset:8192
ds_read_b64_tr_b16 a[102:103],v63 offset:8704
v_add_u32 v63,81920,v61
ds_read_b64_tr_b16 a[104:105],v63 offset:0
ds_read_b64_tr_b16 a[106:107],v63 offset:512
ds_read_b64_tr_b16 a[108:109],v63 offset:8192
ds_read_b64_tr_b16 a[110:111],v63 offset:8704
s_waitcnt vmcnt(28)
s_waitcnt lgkmcnt(0)
s_barrier
s_mov_b32 m0,82944
s_add_u32 s75,s76,1048576
buffer_load_dwordx4 v66,s[20:23],s75 offen  lds
s_mov_b32 m0,87040
s_add_u32 s75,s76,1179648
buffer_load_dwordx4 v66,s[20:23],s75 offen  lds
s_mov_b32 m0,91136
s_add_u32 s75,s76,1310720
buffer_load_dwordx4 v66,s[20:23],s75 offen  lds
s_mov_b32 m0,95232
s_add_u32 s75,s76,1441792
buffer_load_dwordx4 v66,s[20:23],s75 offen  lds
v_add_u32 v63,98304,v60
ds_read_b64_tr_b16 a[112:113],v63 offset:0
ds_read_b64_tr_b16 a[114:115],v63 offset:512
ds_read_b64_tr_b16 a[116:117],v63 offset:8192
ds_read_b64_tr_b16 a[118:119],v63 offset:8704
v_add_u32 v63,98304,v61
ds_read_b64_tr_b16 a[120:121],v63 offset:0
ds_read_b64_tr_b16 a[122:123],v63 offset:512
ds_read_b64_tr_b16 a[124:125],v63 offset:8192
ds_read_b64_tr_b16 a[126:127],v63 offset:8704
s_waitcnt vmcnt(28)
s_waitcnt lgkmcnt(0)
s_barrier
s_mov_b32 m0,99328
s_add_u32 s75,s76,1572864
buffer_load_dwordx4 v66,s[20:23],s75 offen  lds
s_mov_b32 m0,103424
s_add_u32 s75,s76,1703936
buffer_load_dwordx4 v66,s[20:23],s75 offen  lds
s_mov_b32 m0,107520
s_add_u32 s75,s76,1835008
buffer_load_dwordx4 v66,s[20:23],s75 offen  lds
s_mov_b32 m0,111616
s_add_u32 s75,s76,1966080
buffer_load_dwordx4 v66,s[20:23],s75 offen  lds
v_add_u32 v63,114688,v60
ds_read_b64_tr_b16 a[64:65],v63 offset:0
ds_read_b64_tr_b16 a[66:67],v63 offset:512
ds_read_b64_tr_b16 a[68:69],v63 offset:8192
ds_read_b64_tr_b16 a[70:71],v63 offset:8704
v_add_u32 v63,114688,v61
ds_read_b64_tr_b16 a[72:73],v63 offset:0
ds_read_b64_tr_b16 a[74:75],v63 offset:512
ds_read_b64_tr_b16 a[76:77],v63 offset:8192
ds_read_b64_tr_b16 a[78:79],v63 offset:8704
s_waitcnt vmcnt(28)
s_waitcnt lgkmcnt(0)
s_barrier
s_mov_b32 m0,115712
s_add_u32 s75,s76,2097152
buffer_load_dwordx4 v66,s[20:23],s75 offen  lds
s_mov_b32 m0,119808
s_add_u32 s75,s76,2228224
buffer_load_dwordx4 v66,s[20:23],s75 offen  lds
s_mov_b32 m0,123904
s_add_u32 s75,s76,2359296
buffer_load_dwordx4 v66,s[20:23],s75 offen  lds
s_mov_b32 m0,128000
s_add_u32 s75,s76,2490368
buffer_load_dwordx4 v66,s[20:23],s75 offen  lds
v_add_u32 v63,131072,v60
ds_read_b64_tr_b16 a[80:81],v63 offset:0
ds_read_b64_tr_b16 a[82:83],v63 offset:512
ds_read_b64_tr_b16 a[84:85],v63 offset:8192
ds_read_b64_tr_b16 a[86:87],v63 offset:8704
v_add_u32 v63,131072,v61
ds_read_b64_tr_b16 a[88:89],v63 offset:0
ds_read_b64_tr_b16 a[90:91],v63 offset:512
ds_read_b64_tr_b16 a[92:93],v63 offset:8192
ds_read_b64_tr_b16 a[94:95],v63 offset:8704
s_waitcnt vmcnt(28)
s_waitcnt lgkmcnt(0)
s_barrier
s_mov_b32 m0,132096
s_add_u32 s75,s76,2621440
buffer_load_dwordx4 v66,s[20:23],s75 offen  lds
s_mov_b32 m0,136192
s_add_u32 s75,s76,2752512
buffer_load_dwordx4 v66,s[20:23],s75 offen  lds
s_mov_b32 m0,140288
s_add_u32 s75,s76,2883584
buffer_load_dwordx4 v66,s[20:23],s75 offen  lds
s_mov_b32 m0,144384
s_add_u32 s75,s76,3014656
buffer_load_dwordx4 v66,s[20:23],s75 offen  lds
v_add_u32 v63,147456,v60
ds_read_b64_tr_b16 a[144:145],v63 offset:0
ds_read_b64_tr_b16 a[146:147],v63 offset:512
ds_read_b64_tr_b16 a[148:149],v63 offset:8192
ds_read_b64_tr_b16 a[150:151],v63 offset:8704
v_add_u32 v63,147456,v61
ds_read_b64_tr_b16 a[152:153],v63 offset:0
ds_read_b64_tr_b16 a[154:155],v63 offset:512
ds_read_b64_tr_b16 a[156:157],v63 offset:8192
ds_read_b64_tr_b16 a[158:159],v63 offset:8704
s_waitcnt vmcnt(28)
s_waitcnt lgkmcnt(0)
s_barrier
s_mov_b32 m0,148480
s_add_u32 s75,s76,3145728
buffer_load_dwordx4 v66,s[20:23],s75 offen  lds
s_mov_b32 m0,152576
s_add_u32 s75,s76,3276800
buffer_load_dwordx4 v66,s[20:23],s75 offen  lds
s_mov_b32 m0,156672
s_add_u32 s75,s76,3407872
buffer_load_dwordx4 v66,s[20:23],s75 offen  lds
s_mov_b32 m0,160768
s_add_u32 s75,s76,3538944
buffer_load_dwordx4 v66,s[20:23],s75 offen  lds
v_add_u32 v63,16384,v60
ds_read_b64_tr_b16 a[128:129],v63 offset:0
ds_read_b64_tr_b16 a[130:131],v63 offset:512
ds_read_b64_tr_b16 a[132:133],v63 offset:8192
ds_read_b64_tr_b16 a[134:135],v63 offset:8704
v_add_u32 v63,16384,v61
ds_read_b64_tr_b16 a[136:137],v63 offset:0
ds_read_b64_tr_b16 a[138:139],v63 offset:512
ds_read_b64_tr_b16 a[140:141],v63 offset:8192
ds_read_b64_tr_b16 a[142:143],v63 offset:8704
s_waitcnt vmcnt(28)
s_waitcnt lgkmcnt(0)
s_barrier
s_mov_b32 m0,17408
s_add_u32 s75,s76,3670016
buffer_load_dwordx4 v66,s[20:23],s75 offen  lds
s_mov_b32 m0,21504
s_add_u32 s75,s76,3801088
buffer_load_dwordx4 v66,s[20:23],s75 offen  lds
s_mov_b32 m0,25600
s_add_u32 s75,s76,3932160
buffer_load_dwordx4 v66,s[20:23],s75 offen  lds
s_mov_b32 m0,29696
s_add_u32 s75,s76,4063232
buffer_load_dwordx4 v66,s[20:23],s75 offen  lds
v_add_u32 v63,32768,v60
ds_read_b64_tr_b16 a[176:177],v63 offset:0
ds_read_b64_tr_b16 a[178:179],v63 offset:512
ds_read_b64_tr_b16 a[180:181],v63 offset:8192
ds_read_b64_tr_b16 a[182:183],v63 offset:8704
v_add_u32 v63,32768,v61
ds_read_b64_tr_b16 a[184:185],v63 offset:0
ds_read_b64_tr_b16 a[186:187],v63 offset:512
ds_read_b64_tr_b16 a[188:189],v63 offset:8192
ds_read_b64_tr_b16 a[190:191],v63 offset:8704
s_waitcnt vmcnt(28)
s_waitcnt lgkmcnt(0)
s_barrier
s_mov_b32 m0,33792
s_add_u32 s75,s76,4194304
buffer_load_dwordx4 v66,s[20:23],s75 offen  lds
s_mov_b32 m0,37888
s_add_u32 s75,s76,4325376
buffer_load_dwordx4 v66,s[20:23],s75 offen  lds
s_mov_b32 m0,41984
s_add_u32 s75,s76,4456448
buffer_load_dwordx4 v66,s[20:23],s75 offen  lds
s_mov_b32 m0,46080
s_add_u32 s75,s76,4587520
buffer_load_dwordx4 v66,s[20:23],s75 offen  lds
v_add_u32 v63,49152,v60
ds_read_b64_tr_b16 a[160:161],v63 offset:0
ds_read_b64_tr_b16 a[162:163],v63 offset:512
ds_read_b64_tr_b16 a[164:165],v63 offset:8192
ds_read_b64_tr_b16 a[166:167],v63 offset:8704
v_add_u32 v63,49152,v61
ds_read_b64_tr_b16 a[168:169],v63 offset:0
ds_read_b64_tr_b16 a[170:171],v63 offset:512
ds_read_b64_tr_b16 a[172:173],v63 offset:8192
ds_read_b64_tr_b16 a[174:175],v63 offset:8704
s_waitcnt vmcnt(28)
s_waitcnt lgkmcnt(0)
s_barrier
s_mov_b32 m0,51200
s_add_u32 s75,s77,18432
buffer_load_dwordx4 v67,s[24:27],s75 offen  lds
s_mov_b32 m0,52224
s_add_u32 s75,s77,27648
buffer_load_dwordx4 v67,s[24:27],s75 offen  lds
s_mov_b32 m0,59392
s_add_u32 s75,s77,92160
buffer_load_dwordx4 v67,s[24:27],s75 offen  lds
s_mov_b32 m0,60416
s_add_u32 s75,s77,101376
buffer_load_dwordx4 v67,s[24:27],s75 offen  lds
v_add_u32 v63,65536,v60
ds_read_b64_tr_b16 a[192:193],v63 offset:0
ds_read_b64_tr_b16 a[194:195],v63 offset:512
ds_read_b64_tr_b16 a[196:197],v63 offset:8192
ds_read_b64_tr_b16 a[198:199],v63 offset:8704
v_add_u32 v63,65536,v61
ds_read_b64_tr_b16 a[200:201],v63 offset:0
ds_read_b64_tr_b16 a[202:203],v63 offset:512
ds_read_b64_tr_b16 a[204:205],v63 offset:8192
ds_read_b64_tr_b16 a[206:207],v63 offset:8704
s_waitcnt vmcnt(28)
s_waitcnt lgkmcnt(0)
s_barrier
s_mov_b32 m0,67584
s_add_u32 s75,s77,18560
buffer_load_dwordx4 v67,s[24:27],s75 offen  lds
s_mov_b32 m0,68608
s_add_u32 s75,s77,27776
buffer_load_dwordx4 v67,s[24:27],s75 offen  lds
s_mov_b32 m0,75776
s_add_u32 s75,s77,92288
buffer_load_dwordx4 v67,s[24:27],s75 offen  lds
s_mov_b32 m0,76800
s_add_u32 s75,s77,101504
buffer_load_dwordx4 v67,s[24:27],s75 offen  lds
v_add_u32 v63,81920,v60
ds_read_b64_tr_b16 a[208:209],v63 offset:0
ds_read_b64_tr_b16 a[210:211],v63 offset:512
ds_read_b64_tr_b16 a[212:213],v63 offset:8192
ds_read_b64_tr_b16 a[214:215],v63 offset:8704
v_add_u32 v63,81920,v61
ds_read_b64_tr_b16 a[216:217],v63 offset:0
ds_read_b64_tr_b16 a[218:219],v63 offset:512
ds_read_b64_tr_b16 a[220:221],v63 offset:8192
ds_read_b64_tr_b16 a[222:223],v63 offset:8704
s_waitcnt vmcnt(28)
s_waitcnt lgkmcnt(0)
s_barrier
s_mov_b32 m0,83968
s_add_u32 s75,s77,18688
buffer_load_dwordx4 v67,s[24:27],s75 offen  lds
s_mov_b32 m0,84992
s_add_u32 s75,s77,27904
buffer_load_dwordx4 v67,s[24:27],s75 offen  lds
s_mov_b32 m0,92160
s_add_u32 s75,s77,92416
buffer_load_dwordx4 v67,s[24:27],s75 offen  lds
s_mov_b32 m0,93184
s_add_u32 s75,s77,101632
buffer_load_dwordx4 v67,s[24:27],s75 offen  lds
v_add_u32 v63,98304,v60
ds_read_b64_tr_b16 a[224:225],v63 offset:0
ds_read_b64_tr_b16 a[226:227],v63 offset:512
ds_read_b64_tr_b16 a[228:229],v63 offset:8192
ds_read_b64_tr_b16 a[230:231],v63 offset:8704
v_add_u32 v63,98304,v61
ds_read_b64_tr_b16 a[232:233],v63 offset:0
ds_read_b64_tr_b16 a[234:235],v63 offset:512
ds_read_b64_tr_b16 a[236:237],v63 offset:8192
ds_read_b64_tr_b16 a[238:239],v63 offset:8704
s_waitcnt vmcnt(28)
s_waitcnt lgkmcnt(0)
s_barrier
s_mov_b32 m0,100352
s_add_u32 s75,s77,18816
buffer_load_dwordx4 v67,s[24:27],s75 offen  lds
s_mov_b32 m0,101376
s_add_u32 s75,s77,28032
buffer_load_dwordx4 v67,s[24:27],s75 offen  lds
s_mov_b32 m0,108544
s_add_u32 s75,s77,92544
buffer_load_dwordx4 v67,s[24:27],s75 offen  lds
s_mov_b32 m0,109568
s_add_u32 s75,s77,101760
buffer_load_dwordx4 v67,s[24:27],s75 offen  lds
v_add_u32 v63,114688,v60
ds_read_b64_tr_b16 a[240:241],v63 offset:0
ds_read_b64_tr_b16 a[242:243],v63 offset:512
ds_read_b64_tr_b16 a[244:245],v63 offset:8192
ds_read_b64_tr_b16 a[246:247],v63 offset:8704
v_add_u32 v63,114688,v61
ds_read_b64_tr_b16 a[248:249],v63 offset:0
ds_read_b64_tr_b16 a[250:251],v63 offset:512
ds_read_b64_tr_b16 a[252:253],v63 offset:8192
ds_read_b64_tr_b16 a[254:255],v63 offset:8704
s_waitcnt vmcnt(28)
s_waitcnt lgkmcnt(0)
s_barrier
s_mov_b32 m0,116736
s_add_u32 s75,s77,18944
buffer_load_dwordx4 v67,s[24:27],s75 offen  lds
s_mov_b32 m0,117760
s_add_u32 s75,s77,28160
buffer_load_dwordx4 v67,s[24:27],s75 offen  lds
s_mov_b32 m0,124928
s_add_u32 s75,s77,92672
buffer_load_dwordx4 v67,s[24:27],s75 offen  lds
s_mov_b32 m0,125952
s_add_u32 s75,s77,101888
buffer_load_dwordx4 v67,s[24:27],s75 offen  lds
v_add_u32 v63,131072,v60
ds_read_b64_tr_b16 v[80:81],v63 offset:0
ds_read_b64_tr_b16 v[82:83],v63 offset:512
ds_read_b64_tr_b16 v[84:85],v63 offset:8192
ds_read_b64_tr_b16 v[86:87],v63 offset:8704
v_add_u32 v63,131072,v61
ds_read_b64_tr_b16 v[88:89],v63 offset:0
ds_read_b64_tr_b16 v[90:91],v63 offset:512
ds_read_b64_tr_b16 v[92:93],v63 offset:8192
ds_read_b64_tr_b16 v[94:95],v63 offset:8704
s_waitcnt vmcnt(28)
s_waitcnt lgkmcnt(0)
s_barrier
s_mov_b32 m0,133120
s_add_u32 s75,s77,19072
buffer_load_dwordx4 v67,s[24:27],s75 offen  lds
s_mov_b32 m0,134144
s_add_u32 s75,s77,28288
buffer_load_dwordx4 v67,s[24:27],s75 offen  lds
s_mov_b32 m0,141312
s_add_u32 s75,s77,92800
buffer_load_dwordx4 v67,s[24:27],s75 offen  lds
s_mov_b32 m0,142336
s_add_u32 s75,s77,102016
buffer_load_dwordx4 v67,s[24:27],s75 offen  lds
v_add_u32 v63,147456,v60
ds_read_b64_tr_b16 v[96:97],v63 offset:0
ds_read_b64_tr_b16 v[98:99],v63 offset:512
ds_read_b64_tr_b16 v[100:101],v63 offset:8192
ds_read_b64_tr_b16 v[102:103],v63 offset:8704
v_add_u32 v63,147456,v61
ds_read_b64_tr_b16 v[104:105],v63 offset:0
ds_read_b64_tr_b16 v[106:107],v63 offset:512
ds_read_b64_tr_b16 v[108:109],v63 offset:8192
ds_read_b64_tr_b16 v[110:111],v63 offset:8704
s_waitcnt vmcnt(28)
s_waitcnt lgkmcnt(0)
s_barrier
s_mov_b32 m0,149504
s_add_u32 s75,s77,19200
buffer_load_dwordx4 v67,s[24:27],s75 offen  lds
s_mov_b32 m0,150528
s_add_u32 s75,s77,28416
buffer_load_dwordx4 v67,s[24:27],s75 offen  lds
s_mov_b32 m0,157696
s_add_u32 s75,s77,92928
buffer_load_dwordx4 v67,s[24:27],s75 offen  lds
s_mov_b32 m0,158720
s_add_u32 s75,s77,102144
buffer_load_dwordx4 v67,s[24:27],s75 offen  lds
v_add_u32 v63,16384,v60
ds_read_b64_tr_b16 v[112:113],v63 offset:0
ds_read_b64_tr_b16 v[114:115],v63 offset:512
ds_read_b64_tr_b16 v[116:117],v63 offset:8192
ds_read_b64_tr_b16 v[118:119],v63 offset:8704
v_add_u32 v63,16384,v61
ds_read_b64_tr_b16 v[120:121],v63 offset:0
ds_read_b64_tr_b16 v[122:123],v63 offset:512
ds_read_b64_tr_b16 v[124:125],v63 offset:8192
ds_read_b64_tr_b16 v[126:127],v63 offset:8704
s_waitcnt vmcnt(28)
s_waitcnt lgkmcnt(0)
s_barrier
s_mov_b32 m0,17408
s_add_u32 s75,s76,4194304
buffer_load_dwordx4 v66,s[12:15],s75 offen  lds
s_mov_b32 m0,21504
s_add_u32 s75,s76,4325376
buffer_load_dwordx4 v66,s[12:15],s75 offen  lds
s_mov_b32 m0,25600
s_add_u32 s75,s76,4456448
buffer_load_dwordx4 v66,s[12:15],s75 offen  lds
s_mov_b32 m0,29696
s_add_u32 s75,s76,4587520
buffer_load_dwordx4 v66,s[12:15],s75 offen  lds
v_add_u32 v63,32768,v60
ds_read_b64_tr_b16 v[128:129],v63 offset:0
ds_read_b64_tr_b16 v[130:131],v63 offset:512
ds_read_b64_tr_b16 v[132:133],v63 offset:8192
ds_read_b64_tr_b16 v[134:135],v63 offset:8704
v_add_u32 v63,32768,v61
ds_read_b64_tr_b16 v[136:137],v63 offset:0
ds_read_b64_tr_b16 v[138:139],v63 offset:512
ds_read_b64_tr_b16 v[140:141],v63 offset:8192
ds_read_b64_tr_b16 v[142:143],v63 offset:8704
s_waitcnt vmcnt(28)
s_waitcnt lgkmcnt(0)
s_barrier
s_mov_b32 m0,33792
s_add_u32 s75,s76,0
buffer_load_dwordx4 v66,s[20:23],s75 offen  lds
s_mov_b32 m0,37888
s_add_u32 s75,s76,131072
buffer_load_dwordx4 v66,s[20:23],s75 offen  lds
s_mov_b32 m0,41984
s_add_u32 s75,s76,262144
buffer_load_dwordx4 v66,s[20:23],s75 offen  lds
s_mov_b32 m0,46080
s_add_u32 s75,s76,393216
buffer_load_dwordx4 v66,s[20:23],s75 offen  lds
v_add_u32 v63,49152,v62
ds_read_b64_tr_b16 v[144:145],v63 offset:0
ds_read_b64_tr_b16 v[146:147],v63 offset:256
ds_read_b64_tr_b16 v[148:149],v63 offset:1024
ds_read_b64_tr_b16 v[150:151],v63 offset:1280
v_add_u32 v63,49152,v62
ds_read_b64_tr_b16 v[152:153],v63 offset:8192
ds_read_b64_tr_b16 v[154:155],v63 offset:8448
ds_read_b64_tr_b16 v[156:157],v63 offset:9216
ds_read_b64_tr_b16 v[158:159],v63 offset:9472
s_waitcnt vmcnt(28)
s_waitcnt lgkmcnt(0)
s_barrier
s_mov_b32 m0,50176
s_add_u32 s75,s76,524288
buffer_load_dwordx4 v66,s[20:23],s75 offen  lds
s_mov_b32 m0,54272
s_add_u32 s75,s76,655360
buffer_load_dwordx4 v66,s[20:23],s75 offen  lds
s_mov_b32 m0,58368
s_add_u32 s75,s76,786432
buffer_load_dwordx4 v66,s[20:23],s75 offen  lds
s_mov_b32 m0,62464
s_add_u32 s75,s76,917504
buffer_load_dwordx4 v66,s[20:23],s75 offen  lds
v_add_u32 v63,65536,v62
ds_read_b64_tr_b16 v[160:161],v63 offset:0
ds_read_b64_tr_b16 v[162:163],v63 offset:256
ds_read_b64_tr_b16 v[164:165],v63 offset:1024
ds_read_b64_tr_b16 v[166:167],v63 offset:1280
v_add_u32 v63,65536,v62
ds_read_b64_tr_b16 v[168:169],v63 offset:8192
ds_read_b64_tr_b16 v[170:171],v63 offset:8448
ds_read_b64_tr_b16 v[172:173],v63 offset:9216
ds_read_b64_tr_b16 v[174:175],v63 offset:9472
s_waitcnt vmcnt(28)
s_waitcnt lgkmcnt(0)
s_barrier
s_mov_b32 m0,66560
s_add_u32 s75,s76,524288
buffer_load_dwordx4 v66,s[16:19],s75 offen  lds
s_mov_b32 m0,70656
s_add_u32 s75,s76,655360
buffer_load_dwordx4 v66,s[16:19],s75 offen  lds
s_mov_b32 m0,74752
s_add_u32 s75,s76,786432
buffer_load_dwordx4 v66,s[16:19],s75 offen  lds
s_mov_b32 m0,78848
s_add_u32 s75,s76,917504
buffer_load_dwordx4 v66,s[16:19],s75 offen  lds
v_add_u32 v63,81920,v62
ds_read_b64_tr_b16 v[176:177],v63 offset:0
ds_read_b64_tr_b16 v[178:179],v63 offset:256
ds_read_b64_tr_b16 v[180:181],v63 offset:1024
ds_read_b64_tr_b16 v[182:183],v63 offset:1280
v_add_u32 v63,81920,v62
ds_read_b64_tr_b16 v[184:185],v63 offset:8192
ds_read_b64_tr_b16 v[186:187],v63 offset:8448
ds_read_b64_tr_b16 v[188:189],v63 offset:9216
ds_read_b64_tr_b16 v[190:191],v63 offset:9472
s_waitcnt vmcnt(28)
s_waitcnt lgkmcnt(0)
s_barrier
s_mov_b32 m0,82944
s_add_u32 s75,s76,1572864
buffer_load_dwordx4 v66,s[16:19],s75 offen  lds
s_mov_b32 m0,87040
s_add_u32 s75,s76,1703936
buffer_load_dwordx4 v66,s[16:19],s75 offen  lds
s_mov_b32 m0,91136
s_add_u32 s75,s76,1835008
buffer_load_dwordx4 v66,s[16:19],s75 offen  lds
s_mov_b32 m0,95232
s_add_u32 s75,s76,1966080
buffer_load_dwordx4 v66,s[16:19],s75 offen  lds
v_add_u32 v63,98304,v62
ds_read_b64_tr_b16 v[192:193],v63 offset:0
ds_read_b64_tr_b16 v[194:195],v63 offset:256
ds_read_b64_tr_b16 v[196:197],v63 offset:1024
ds_read_b64_tr_b16 v[198:199],v63 offset:1280
v_add_u32 v63,98304,v62
ds_read_b64_tr_b16 v[200:201],v63 offset:8192
ds_read_b64_tr_b16 v[202:203],v63 offset:8448
ds_read_b64_tr_b16 v[204:205],v63 offset:9216
ds_read_b64_tr_b16 v[206:207],v63 offset:9472
s_waitcnt vmcnt(28)
s_waitcnt lgkmcnt(0)
s_barrier
s_mov_b32 m0,99328
s_add_u32 s75,s76,2621440
buffer_load_dwordx4 v66,s[16:19],s75 offen  lds
s_mov_b32 m0,103424
s_add_u32 s75,s76,2752512
buffer_load_dwordx4 v66,s[16:19],s75 offen  lds
s_mov_b32 m0,107520
s_add_u32 s75,s76,2883584
buffer_load_dwordx4 v66,s[16:19],s75 offen  lds
s_mov_b32 m0,111616
s_add_u32 s75,s76,3014656
buffer_load_dwordx4 v66,s[16:19],s75 offen  lds
v_add_u32 v63,114688,v62
ds_read_b64_tr_b16 v[208:209],v63 offset:0
ds_read_b64_tr_b16 v[210:211],v63 offset:256
ds_read_b64_tr_b16 v[212:213],v63 offset:1024
ds_read_b64_tr_b16 v[214:215],v63 offset:1280
v_add_u32 v63,114688,v62
ds_read_b64_tr_b16 v[216:217],v63 offset:8192
ds_read_b64_tr_b16 v[218:219],v63 offset:8448
ds_read_b64_tr_b16 v[220:221],v63 offset:9216
ds_read_b64_tr_b16 v[222:223],v63 offset:9472
s_waitcnt vmcnt(28)
s_waitcnt lgkmcnt(0)
s_barrier
s_mov_b32 m0,115712
s_add_u32 s75,s76,3670016
buffer_load_dwordx4 v66,s[16:19],s75 offen  lds
s_mov_b32 m0,119808
s_add_u32 s75,s76,3801088
buffer_load_dwordx4 v66,s[16:19],s75 offen  lds
s_mov_b32 m0,123904
s_add_u32 s75,s76,3932160
buffer_load_dwordx4 v66,s[16:19],s75 offen  lds
s_mov_b32 m0,128000
s_add_u32 s75,s76,4063232
buffer_load_dwordx4 v66,s[16:19],s75 offen  lds
v_add_u32 v63,131072,v62
ds_read_b64_tr_b16 v[224:225],v63 offset:0
ds_read_b64_tr_b16 v[226:227],v63 offset:256
ds_read_b64_tr_b16 v[228:229],v63 offset:1024
ds_read_b64_tr_b16 v[230:231],v63 offset:1280
v_add_u32 v63,131072,v62
ds_read_b64_tr_b16 v[232:233],v63 offset:8192
ds_read_b64_tr_b16 v[234:235],v63 offset:8448
ds_read_b64_tr_b16 v[236:237],v63 offset:9216
ds_read_b64_tr_b16 v[238:239],v63 offset:9472
s_waitcnt vmcnt(28)
s_waitcnt lgkmcnt(0)
s_barrier
s_mov_b32 m0,133120
s_add_u32 s75,s77,19328
buffer_load_dwordx4 v67,s[24:27],s75 offen  lds
s_mov_b32 m0,134144
s_add_u32 s75,s77,28544
buffer_load_dwordx4 v67,s[24:27],s75 offen  lds
s_mov_b32 m0,141312
s_add_u32 s75,s77,93056
buffer_load_dwordx4 v67,s[24:27],s75 offen  lds
s_mov_b32 m0,142336
s_add_u32 s75,s77,102272
buffer_load_dwordx4 v67,s[24:27],s75 offen  lds
v_add_u32 v63,147456,v62
ds_read_b64_tr_b16 v[240:241],v63 offset:0
ds_read_b64_tr_b16 v[242:243],v63 offset:256
ds_read_b64_tr_b16 v[244:245],v63 offset:1024
ds_read_b64_tr_b16 v[246:247],v63 offset:1280
v_add_u32 v63,147456,v62
ds_read_b64_tr_b16 v[248:249],v63 offset:8192
ds_read_b64_tr_b16 v[250:251],v63 offset:8448
ds_read_b64_tr_b16 v[252:253],v63 offset:9216
ds_read_b64_tr_b16 v[254:255],v63 offset:9472
s_waitcnt vmcnt(28)
s_waitcnt lgkmcnt(0)
s_barrier
s_mov_b32 m0,149504
s_add_u32 s75,s77,19456
buffer_load_dwordx4 v67,s[24:27],s75 offen  lds
s_mov_b32 m0,150528
s_add_u32 s75,s77,28672
buffer_load_dwordx4 v67,s[24:27],s75 offen  lds
s_mov_b32 m0,157696
s_add_u32 s75,s77,93184
buffer_load_dwordx4 v67,s[24:27],s75 offen  lds
s_mov_b32 m0,158720
s_add_u32 s75,s77,102400
buffer_load_dwordx4 v67,s[24:27],s75 offen  lds
v_add_u32 v63,16384,v60
ds_read_b64_tr_b16 v[28:29],v63 offset:0
ds_read_b64_tr_b16 v[30:31],v63 offset:512
ds_read_b64_tr_b16 v[32:33],v63 offset:8192
ds_read_b64_tr_b16 v[34:35],v63 offset:8704
v_add_u32 v63,16384,v61
ds_read_b64_tr_b16 v[36:37],v63 offset:0
ds_read_b64_tr_b16 v[38:39],v63 offset:512
ds_read_b64_tr_b16 v[40:41],v63 offset:8192
ds_read_b64_tr_b16 v[42:43],v63 offset:8704
s_waitcnt vmcnt(28)
s_waitcnt lgkmcnt(0)
s_barrier
v_add_u32 v63,0,v2
ds_write_b128 v63,v[28:31] offset:0
ds_write_b128 v63,v[32:35] offset:1024
ds_write_b128 v63,v[36:39] offset:2048
ds_write_b128 v63,v[40:43] offset:3072
v_add_u32 v63,32768,v60
ds_read_b64_tr_b16 v[12:13],v63 offset:0
ds_read_b64_tr_b16 v[14:15],v63 offset:512
ds_read_b64_tr_b16 v[16:17],v63 offset:8192
ds_read_b64_tr_b16 v[18:19],v63 offset:8704
v_add_u32 v63,32768,v61
ds_read_b64_tr_b16 v[20:21],v63 offset:0
ds_read_b64_tr_b16 v[22:23],v63 offset:512
ds_read_b64_tr_b16 v[24:25],v63 offset:8192
ds_read_b64_tr_b16 v[26:27],v63 offset:8704
s_waitcnt vmcnt(24)
s_waitcnt lgkmcnt(0)
s_barrier
v_bfe_u32 v64,v0,4,5
buffer_load_ubyte v68,v64,s[32:35],0 offen offset:128 sc1
v_mov_b32 v64,0
buffer_load_dword v69,v64,s[32:35],0 offen offset:160 sc1
v_add_u32 v63,16384,v2
ds_write_b128 v63,v[12:15] offset:0
ds_write_b128 v63,v[16:19] offset:1024
ds_write_b128 v63,v[20:23] offset:2048
ds_write_b128 v63,v[24:27] offset:3072
v_add_u32 v63,49152,v60
ds_read_b64_tr_b16 v[28:29],v63 offset:0
ds_read_b64_tr_b16 v[30:31],v63 offset:512
ds_read_b64_tr_b16 v[32:33],v63 offset:8192
ds_read_b64_tr_b16 v[34:35],v63 offset:8704
v_add_u32 v63,49152,v61
ds_read_b64_tr_b16 v[36:37],v63 offset:0
ds_read_b64_tr_b16 v[38:39],v63 offset:512
ds_read_b64_tr_b16 v[40:41],v63 offset:8192
ds_read_b64_tr_b16 v[42:43],v63 offset:8704
s_waitcnt vmcnt(22)
s_waitcnt lgkmcnt(0)
s_barrier
v_add_u32 v63,32768,v2
ds_write_b128 v63,v[28:31] offset:0
ds_write_b128 v63,v[32:35] offset:1024
ds_write_b128 v63,v[36:39] offset:2048
ds_write_b128 v63,v[40:43] offset:3072
v_add_u32 v63,65536,v60
ds_read_b64_tr_b16 v[12:13],v63 offset:0
ds_read_b64_tr_b16 v[14:15],v63 offset:512
ds_read_b64_tr_b16 v[16:17],v63 offset:8192
ds_read_b64_tr_b16 v[18:19],v63 offset:8704
v_add_u32 v63,65536,v61
ds_read_b64_tr_b16 v[20:21],v63 offset:0
ds_read_b64_tr_b16 v[22:23],v63 offset:512
ds_read_b64_tr_b16 v[24:25],v63 offset:8192
ds_read_b64_tr_b16 v[26:27],v63 offset:8704
s_waitcnt vmcnt(18)
s_waitcnt lgkmcnt(0)
s_barrier
v_add_u32 v63,49152,v2
ds_write_b128 v63,v[12:15] offset:0
ds_write_b128 v63,v[16:19] offset:1024
ds_write_b128 v63,v[20:23] offset:2048
ds_write_b128 v63,v[24:27] offset:3072
v_add_u32 v63,81920,v60
ds_read_b64_tr_b16 v[28:29],v63 offset:0
ds_read_b64_tr_b16 v[30:31],v63 offset:512
ds_read_b64_tr_b16 v[32:33],v63 offset:8192
ds_read_b64_tr_b16 v[34:35],v63 offset:8704
v_add_u32 v63,81920,v61
ds_read_b64_tr_b16 v[36:37],v63 offset:0
ds_read_b64_tr_b16 v[38:39],v63 offset:512
ds_read_b64_tr_b16 v[40:41],v63 offset:8192
ds_read_b64_tr_b16 v[42:43],v63 offset:8704
s_waitcnt vmcnt(14)
s_waitcnt lgkmcnt(0)
s_barrier
v_add_u32 v63,65536,v2
ds_write_b128 v63,v[28:31] offset:0
ds_write_b128 v63,v[32:35] offset:1024
ds_write_b128 v63,v[36:39] offset:2048
ds_write_b128 v63,v[40:43] offset:3072
v_add_u32 v63,98304,v60
ds_read_b64_tr_b16 v[12:13],v63 offset:0
ds_read_b64_tr_b16 v[14:15],v63 offset:512
ds_read_b64_tr_b16 v[16:17],v63 offset:8192
ds_read_b64_tr_b16 v[18:19],v63 offset:8704
v_add_u32 v63,98304,v61
ds_read_b64_tr_b16 v[20:21],v63 offset:0
ds_read_b64_tr_b16 v[22:23],v63 offset:512
ds_read_b64_tr_b16 v[24:25],v63 offset:8192
ds_read_b64_tr_b16 v[26:27],v63 offset:8704
s_waitcnt vmcnt(10)
s_waitcnt lgkmcnt(0)
s_barrier
v_add_u32 v63,81920,v2
ds_write_b128 v63,v[12:15] offset:0
ds_write_b128 v63,v[16:19] offset:1024
ds_write_b128 v63,v[20:23] offset:2048
ds_write_b128 v63,v[24:27] offset:3072
v_add_u32 v63,114688,v60
ds_read_b64_tr_b16 v[28:29],v63 offset:0
ds_read_b64_tr_b16 v[30:31],v63 offset:512
ds_read_b64_tr_b16 v[32:33],v63 offset:8192
ds_read_b64_tr_b16 v[34:35],v63 offset:8704
v_add_u32 v63,114688,v61
ds_read_b64_tr_b16 v[36:37],v63 offset:0
ds_read_b64_tr_b16 v[38:39],v63 offset:512
ds_read_b64_tr_b16 v[40:41],v63 offset:8192
ds_read_b64_tr_b16 v[42:43],v63 offset:8704
s_waitcnt vmcnt(6)
s_waitcnt lgkmcnt(0)
s_barrier
v_add_u32 v63,98304,v2
ds_write_b128 v63,v[28:31] offset:0
ds_write_b128 v63,v[32:35] offset:1024
ds_write_b128 v63,v[36:39] offset:2048
ds_write_b128 v63,v[40:43] offset:3072
v_add_u32 v63,131072,v62
ds_read_b64_tr_b16 v[12:13],v63 offset:0
ds_read_b64_tr_b16 v[14:15],v63 offset:256
ds_read_b64_tr_b16 v[16:17],v63 offset:1024
ds_read_b64_tr_b16 v[18:19],v63 offset:1280
v_add_u32 v63,131072,v62
ds_read_b64_tr_b16 v[20:21],v63 offset:8192
ds_read_b64_tr_b16 v[22:23],v63 offset:8448
ds_read_b64_tr_b16 v[24:25],v63 offset:9216
ds_read_b64_tr_b16 v[26:27],v63 offset:9472
s_waitcnt vmcnt(2)
s_waitcnt lgkmcnt(0)
s_barrier
v_add_u32 v63,114688,v2
ds_write_b128 v63,v[12:15] offset:0
ds_write_b128 v63,v[16:19] offset:1024
ds_write_b128 v63,v[20:23] offset:2048
ds_write_b128 v63,v[24:27] offset:3072
v_add_u32 v63,147456,v62
ds_read_b64_tr_b16 v[28:29],v63 offset:0
ds_read_b64_tr_b16 v[30:31],v63 offset:256
ds_read_b64_tr_b16 v[32:33],v63 offset:1024
ds_read_b64_tr_b16 v[34:35],v63 offset:1280
v_add_u32 v63,147456,v62
ds_read_b64_tr_b16 v[36:37],v63 offset:8192
ds_read_b64_tr_b16 v[38:39],v63 offset:8448
ds_read_b64_tr_b16 v[40:41],v63 offset:9216
ds_read_b64_tr_b16 v[42:43],v63 offset:9472
s_waitcnt lgkmcnt(0)
s_barrier
v_add_u32 v63,131072,v2
ds_write_b128 v63,v[28:31] offset:0
ds_write_b128 v63,v[32:35] offset:1024
ds_write_b128 v63,v[36:39] offset:2048
ds_write_b128 v63,v[40:43] offset:3072
s_waitcnt lgkmcnt(0)
s_barrier
s_branch Lr_prodone
Lr_pro2:
v_lshrrev_b32 v12,4,v0
v_lshrrev_b32 v13,4,v12
v_and_b32 v14,1,v13
v_or_b32 v14,4,v14
v_lshlrev_b32 v14,1,v14
v_and_b32 v15,15,v12
v_xor_b32 v15,v15,v14
v_lshlrev_b32 v15,4,v15
v_add_u32 v13,8,v13
v_lshl_add_u32 v66,v13,13,v15
v_lshrrev_b32 v13,3,v12
v_mul_u32_u24 v13,1152,v13
v_and_b32 v15,7,v12
v_xor_b32 v15,4,v15
v_lshl_add_u32 v67,v15,4,v13
v_lshrrev_b32 v13,4,v12
v_bfe_u32 v14,v12,2,2
v_and_b32 v15,3,v12
v_lshrrev_b32 v16,1,v13
v_and_b32 v17,1,v13
v_and_b32 v18,1,v14
v_lshrrev_b32 v19,1,v14
v_lshlrev_b32 v20,4,v16
v_lshl_add_u32 v20,v17,2,v20
v_add_u32 v20,v20,v18
v_lshl_add_u32 v20,v19,3,v20
v_lshl_add_u32 v21,v17,1,v18
v_lshl_add_u32 v21,v19,2,v21
v_lshlrev_b32 v20,8,v20
v_lshl_add_u32 v20,v15,3,v20
v_xor_b32 v22,4,v21
v_lshl_add_u32 v60,v22,5,v20
v_xor_b32 v22,5,v21
v_lshl_add_u32 v61,v22,5,v20
v_lshlrev_b32 v20,5,v17
v_lshl_add_u32 v20,v16,2,v20
v_add_u32 v20,v20,v18
v_lshl_add_u32 v20,v19,4,v20
v_lshlrev_b32 v20,7,v20
v_lshl_add_u32 v20,v15,3,v20
v_lshl_add_u32 v21,v17,1,v19
v_xor_b32 v21,2,v21
v_lshl_add_u32 v62,v21,5,v20
s_lshl_b32 s76,s61,8
s_mul_i32 s77,s61,147456
s_mov_b32 m0,18432
s_add_u32 s75,s76,0
buffer_load_dwordx4 v66,s[12:15],s75 offen  lds
s_mov_b32 m0,22528
s_add_u32 s75,s76,131072
buffer_load_dwordx4 v66,s[12:15],s75 offen  lds
s_mov_b32 m0,26624
s_add_u32 s75,s76,262144
buffer_load_dwordx4 v66,s[12:15],s75 offen  lds
s_mov_b32 m0,30720
s_add_u32 s75,s76,393216
buffer_load_dwordx4 v66,s[12:15],s75 offen  lds
s_mov_b32 m0,34816
s_add_u32 s75,s76,524288
buffer_load_dwordx4 v66,s[12:15],s75 offen  lds
s_mov_b32 m0,38912
s_add_u32 s75,s76,655360
buffer_load_dwordx4 v66,s[12:15],s75 offen  lds
s_mov_b32 m0,43008
s_add_u32 s75,s76,786432
buffer_load_dwordx4 v66,s[12:15],s75 offen  lds
s_mov_b32 m0,47104
s_add_u32 s75,s76,917504
buffer_load_dwordx4 v66,s[12:15],s75 offen  lds
s_mov_b32 m0,51200
s_add_u32 s75,s76,1048576
buffer_load_dwordx4 v66,s[12:15],s75 offen  lds
s_mov_b32 m0,55296
s_add_u32 s75,s76,1179648
buffer_load_dwordx4 v66,s[12:15],s75 offen  lds
s_mov_b32 m0,59392
s_add_u32 s75,s76,1310720
buffer_load_dwordx4 v66,s[12:15],s75 offen  lds
s_mov_b32 m0,63488
s_add_u32 s75,s76,1441792
buffer_load_dwordx4 v66,s[12:15],s75 offen  lds
s_mov_b32 m0,67584
s_add_u32 s75,s76,1572864
buffer_load_dwordx4 v66,s[12:15],s75 offen  lds
s_mov_b32 m0,71680
s_add_u32 s75,s76,1703936
buffer_load_dwordx4 v66,s[12:15],s75 offen  lds
s_mov_b32 m0,75776
s_add_u32 s75,s76,1835008
buffer_load_dwordx4 v66,s[12:15],s75 offen  lds
s_mov_b32 m0,79872
s_add_u32 s75,s76,1966080
buffer_load_dwordx4 v66,s[12:15],s75 offen  lds
s_mov_b32 m0,83968
s_add_u32 s75,s76,2097152
buffer_load_dwordx4 v66,s[12:15],s75 offen  lds
s_mov_b32 m0,88064
s_add_u32 s75,s76,2228224
buffer_load_dwordx4 v66,s[12:15],s75 offen  lds
s_mov_b32 m0,92160
s_add_u32 s75,s76,2359296
buffer_load_dwordx4 v66,s[12:15],s75 offen  lds
s_mov_b32 m0,96256
s_add_u32 s75,s76,2490368
buffer_load_dwordx4 v66,s[12:15],s75 offen  lds
s_mov_b32 m0,100352
s_add_u32 s75,s76,2621440
buffer_load_dwordx4 v66,s[12:15],s75 offen  lds
s_mov_b32 m0,104448
s_add_u32 s75,s76,2752512
buffer_load_dwordx4 v66,s[12:15],s75 offen  lds
s_mov_b32 m0,108544
s_add_u32 s75,s76,2883584
buffer_load_dwordx4 v66,s[12:15],s75 offen  lds
s_mov_b32 m0,112640
s_add_u32 s75,s76,3014656
buffer_load_dwordx4 v66,s[12:15],s75 offen  lds
s_mov_b32 m0,116736
s_add_u32 s75,s76,3145728
buffer_load_dwordx4 v66,s[12:15],s75 offen  lds
s_mov_b32 m0,120832
s_add_u32 s75,s76,3276800
buffer_load_dwordx4 v66,s[12:15],s75 offen  lds
s_mov_b32 m0,124928
s_add_u32 s75,s76,3407872
buffer_load_dwordx4 v66,s[12:15],s75 offen  lds
s_mov_b32 m0,129024
s_add_u32 s75,s76,3538944
buffer_load_dwordx4 v66,s[12:15],s75 offen  lds
s_mov_b32 m0,133120
s_add_u32 s75,s76,3670016
buffer_load_dwordx4 v66,s[12:15],s75 offen  lds
s_mov_b32 m0,137216
s_add_u32 s75,s76,3801088
buffer_load_dwordx4 v66,s[12:15],s75 offen  lds
s_mov_b32 m0,141312
s_add_u32 s75,s76,3932160
buffer_load_dwordx4 v66,s[12:15],s75 offen  lds
s_mov_b32 m0,145408
s_add_u32 s75,s76,4063232
buffer_load_dwordx4 v66,s[12:15],s75 offen  lds
s_mov_b32 m0,149504
s_add_u32 s75,s76,0
buffer_load_dwordx4 v66,s[16:19],s75 offen  lds
s_mov_b32 m0,153600
s_add_u32 s75,s76,131072
buffer_load_dwordx4 v66,s[16:19],s75 offen  lds
s_mov_b32 m0,157696
s_add_u32 s75,s76,262144
buffer_load_dwordx4 v66,s[16:19],s75 offen  lds
s_mov_b32 m0,161792
s_add_u32 s75,s76,393216
buffer_load_dwordx4 v66,s[16:19],s75 offen  lds
s_branch Lr_mid
Lr_pro2_2:
s_lshl_b32 s76,s61,8
s_mul_i32 s77,s61,147456
s_waitcnt vmcnt(32)
s_waitcnt lgkmcnt(0)
s_barrier
v_add_u32 v63,16384,v60
ds_read_b64_tr_b16 a[64:65],v63 offset:0
ds_read_b64_tr_b16 a[66:67],v63 offset:512
ds_read_b64_tr_b16 a[68:69],v63 offset:8192
ds_read_b64_tr_b16 a[70:71],v63 offset:8704
v_add_u32 v63,16384,v61
ds_read_b64_tr_b16 a[72:73],v63 offset:0
ds_read_b64_tr_b16 a[74:75],v63 offset:512
ds_read_b64_tr_b16 a[76:77],v63 offset:8192
ds_read_b64_tr_b16 a[78:79],v63 offset:8704
s_waitcnt vmcnt(28)
s_waitcnt lgkmcnt(0)
s_barrier
s_mov_b32 m0,18432
s_add_u32 s75,s76,1048576
buffer_load_dwordx4 v66,s[16:19],s75 offen  lds
s_mov_b32 m0,22528
s_add_u32 s75,s76,1179648
buffer_load_dwordx4 v66,s[16:19],s75 offen  lds
s_mov_b32 m0,26624
s_add_u32 s75,s76,1310720
buffer_load_dwordx4 v66,s[16:19],s75 offen  lds
s_mov_b32 m0,30720
s_add_u32 s75,s76,1441792
buffer_load_dwordx4 v66,s[16:19],s75 offen  lds
v_add_u32 v63,32768,v60
ds_read_b64_tr_b16 a[80:81],v63 offset:0
ds_read_b64_tr_b16 a[82:83],v63 offset:512
ds_read_b64_tr_b16 a[84:85],v63 offset:8192
ds_read_b64_tr_b16 a[86:87],v63 offset:8704
v_add_u32 v63,32768,v61
ds_read_b64_tr_b16 a[88:89],v63 offset:0
ds_read_b64_tr_b16 a[90:91],v63 offset:512
ds_read_b64_tr_b16 a[92:93],v63 offset:8192
ds_read_b64_tr_b16 a[94:95],v63 offset:8704
s_waitcnt vmcnt(28)
s_waitcnt lgkmcnt(0)
s_barrier
s_mov_b32 m0,34816
s_add_u32 s75,s76,2097152
buffer_load_dwordx4 v66,s[16:19],s75 offen  lds
s_mov_b32 m0,38912
s_add_u32 s75,s76,2228224
buffer_load_dwordx4 v66,s[16:19],s75 offen  lds
s_mov_b32 m0,43008
s_add_u32 s75,s76,2359296
buffer_load_dwordx4 v66,s[16:19],s75 offen  lds
s_mov_b32 m0,47104
s_add_u32 s75,s76,2490368
buffer_load_dwordx4 v66,s[16:19],s75 offen  lds
v_add_u32 v63,49152,v60
ds_read_b64_tr_b16 a[96:97],v63 offset:0
ds_read_b64_tr_b16 a[98:99],v63 offset:512
ds_read_b64_tr_b16 a[100:101],v63 offset:8192
ds_read_b64_tr_b16 a[102:103],v63 offset:8704
v_add_u32 v63,49152,v61
ds_read_b64_tr_b16 a[104:105],v63 offset:0
ds_read_b64_tr_b16 a[106:107],v63 offset:512
ds_read_b64_tr_b16 a[108:109],v63 offset:8192
ds_read_b64_tr_b16 a[110:111],v63 offset:8704
s_waitcnt vmcnt(28)
s_waitcnt lgkmcnt(0)
s_barrier
s_mov_b32 m0,51200
s_add_u32 s75,s76,3145728
buffer_load_dwordx4 v66,s[16:19],s75 offen  lds
s_mov_b32 m0,55296
s_add_u32 s75,s76,3276800
buffer_load_dwordx4 v66,s[16:19],s75 offen  lds
s_mov_b32 m0,59392
s_add_u32 s75,s76,3407872
buffer_load_dwordx4 v66,s[16:19],s75 offen  lds
s_mov_b32 m0,63488
s_add_u32 s75,s76,3538944
buffer_load_dwordx4 v66,s[16:19],s75 offen  lds
v_add_u32 v63,65536,v60
ds_read_b64_tr_b16 a[112:113],v63 offset:0
ds_read_b64_tr_b16 a[114:115],v63 offset:512
ds_read_b64_tr_b16 a[116:117],v63 offset:8192
ds_read_b64_tr_b16 a[118:119],v63 offset:8704
v_add_u32 v63,65536,v61
ds_read_b64_tr_b16 a[120:121],v63 offset:0
ds_read_b64_tr_b16 a[122:123],v63 offset:512
ds_read_b64_tr_b16 a[124:125],v63 offset:8192
ds_read_b64_tr_b16 a[126:127],v63 offset:8704
s_waitcnt vmcnt(28)
s_waitcnt lgkmcnt(0)
s_barrier
s_mov_b32 m0,67584
s_add_u32 s75,s76,4194304
buffer_load_dwordx4 v66,s[16:19],s75 offen  lds
s_mov_b32 m0,71680
s_add_u32 s75,s76,4325376
buffer_load_dwordx4 v66,s[16:19],s75 offen  lds
s_mov_b32 m0,75776
s_add_u32 s75,s76,4456448
buffer_load_dwordx4 v66,s[16:19],s75 offen  lds
s_mov_b32 m0,79872
s_add_u32 s75,s76,4587520
buffer_load_dwordx4 v66,s[16:19],s75 offen  lds
v_add_u32 v63,81920,v60
ds_read_b64_tr_b16 a[0:1],v63 offset:0
ds_read_b64_tr_b16 a[2:3],v63 offset:512
ds_read_b64_tr_b16 a[4:5],v63 offset:8192
ds_read_b64_tr_b16 a[6:7],v63 offset:8704
v_add_u32 v63,81920,v61
ds_read_b64_tr_b16 a[8:9],v63 offset:0
ds_read_b64_tr_b16 a[10:11],v63 offset:512
ds_read_b64_tr_b16 a[12:13],v63 offset:8192
ds_read_b64_tr_b16 a[14:15],v63 offset:8704
s_waitcnt vmcnt(28)
s_waitcnt lgkmcnt(0)
s_barrier
s_mov_b32 m0,83968
s_add_u32 s75,s76,1048576
buffer_load_dwordx4 v66,s[20:23],s75 offen  lds
s_mov_b32 m0,88064
s_add_u32 s75,s76,1179648
buffer_load_dwordx4 v66,s[20:23],s75 offen  lds
s_mov_b32 m0,92160
s_add_u32 s75,s76,1310720
buffer_load_dwordx4 v66,s[20:23],s75 offen  lds
s_mov_b32 m0,96256
s_add_u32 s75,s76,1441792
buffer_load_dwordx4 v66,s[20:23],s75 offen  lds
v_add_u32 v63,98304,v60
ds_read_b64_tr_b16 a[16:17],v63 offset:0
ds_read_b64_tr_b16 a[18:19],v63 offset:512
ds_read_b64_tr_b16 a[20:21],v63 offset:8192
ds_read_b64_tr_b16 a[22:23],v63 offset:8704
v_add_u32 v63,98304,v61
ds_read_b64_tr_b16 a[24:25],v63 offset:0
ds_read_b64_tr_b16 a[26:27],v63 offset:512
ds_read_b64_tr_b16 a[28:29],v63 offset:8192
ds_read_b64_tr_b16 a[30:31],v63 offset:8704
s_waitcnt vmcnt(28)
s_waitcnt lgkmcnt(0)
s_barrier
s_mov_b32 m0,100352
s_add_u32 s75,s76,1572864
buffer_load_dwordx4 v66,s[20:23],s75 offen  lds
s_mov_b32 m0,104448
s_add_u32 s75,s76,1703936
buffer_load_dwordx4 v66,s[20:23],s75 offen  lds
s_mov_b32 m0,108544
s_add_u32 s75,s76,1835008
buffer_load_dwordx4 v66,s[20:23],s75 offen  lds
s_mov_b32 m0,112640
s_add_u32 s75,s76,1966080
buffer_load_dwordx4 v66,s[20:23],s75 offen  lds
v_add_u32 v63,114688,v60
ds_read_b64_tr_b16 a[32:33],v63 offset:0
ds_read_b64_tr_b16 a[34:35],v63 offset:512
ds_read_b64_tr_b16 a[36:37],v63 offset:8192
ds_read_b64_tr_b16 a[38:39],v63 offset:8704
v_add_u32 v63,114688,v61
ds_read_b64_tr_b16 a[40:41],v63 offset:0
ds_read_b64_tr_b16 a[42:43],v63 offset:512
ds_read_b64_tr_b16 a[44:45],v63 offset:8192
ds_read_b64_tr_b16 a[46:47],v63 offset:8704
s_waitcnt vmcnt(28)
s_waitcnt lgkmcnt(0)
s_barrier
s_mov_b32 m0,116736
s_add_u32 s75,s76,2097152
buffer_load_dwordx4 v66,s[20:23],s75 offen  lds
s_mov_b32 m0,120832
s_add_u32 s75,s76,2228224
buffer_load_dwordx4 v66,s[20:23],s75 offen  lds
s_mov_b32 m0,124928
s_add_u32 s75,s76,2359296
buffer_load_dwordx4 v66,s[20:23],s75 offen  lds
s_mov_b32 m0,129024
s_add_u32 s75,s76,2490368
buffer_load_dwordx4 v66,s[20:23],s75 offen  lds
v_add_u32 v63,131072,v60
ds_read_b64_tr_b16 a[48:49],v63 offset:0
ds_read_b64_tr_b16 a[50:51],v63 offset:512
ds_read_b64_tr_b16 a[52:53],v63 offset:8192
ds_read_b64_tr_b16 a[54:55],v63 offset:8704
v_add_u32 v63,131072,v61
ds_read_b64_tr_b16 a[56:57],v63 offset:0
ds_read_b64_tr_b16 a[58:59],v63 offset:512
ds_read_b64_tr_b16 a[60:61],v63 offset:8192
ds_read_b64_tr_b16 a[62:63],v63 offset:8704
s_waitcnt vmcnt(28)
s_waitcnt lgkmcnt(0)
s_barrier
s_mov_b32 m0,133120
s_add_u32 s75,s76,2621440
buffer_load_dwordx4 v66,s[20:23],s75 offen  lds
s_mov_b32 m0,137216
s_add_u32 s75,s76,2752512
buffer_load_dwordx4 v66,s[20:23],s75 offen  lds
s_mov_b32 m0,141312
s_add_u32 s75,s76,2883584
buffer_load_dwordx4 v66,s[20:23],s75 offen  lds
s_mov_b32 m0,145408
s_add_u32 s75,s76,3014656
buffer_load_dwordx4 v66,s[20:23],s75 offen  lds
v_add_u32 v63,147456,v60
ds_read_b64_tr_b16 a[160:161],v63 offset:0
ds_read_b64_tr_b16 a[162:163],v63 offset:512
ds_read_b64_tr_b16 a[164:165],v63 offset:8192
ds_read_b64_tr_b16 a[166:167],v63 offset:8704
v_add_u32 v63,147456,v61
ds_read_b64_tr_b16 a[168:169],v63 offset:0
ds_read_b64_tr_b16 a[170:171],v63 offset:512
ds_read_b64_tr_b16 a[172:173],v63 offset:8192
ds_read_b64_tr_b16 a[174:175],v63 offset:8704
s_waitcnt vmcnt(28)
s_waitcnt lgkmcnt(0)
s_barrier
s_mov_b32 m0,149504
s_add_u32 s75,s76,3145728
buffer_load_dwordx4 v66,s[20:23],s75 offen  lds
s_mov_b32 m0,153600
s_add_u32 s75,s76,3276800
buffer_load_dwordx4 v66,s[20:23],s75 offen  lds
s_mov_b32 m0,157696
s_add_u32 s75,s76,3407872
buffer_load_dwordx4 v66,s[20:23],s75 offen  lds
s_mov_b32 m0,161792
s_add_u32 s75,s76,3538944
buffer_load_dwordx4 v66,s[20:23],s75 offen  lds
v_add_u32 v63,16384,v60
ds_read_b64_tr_b16 a[176:177],v63 offset:0
ds_read_b64_tr_b16 a[178:179],v63 offset:512
ds_read_b64_tr_b16 a[180:181],v63 offset:8192
ds_read_b64_tr_b16 a[182:183],v63 offset:8704
v_add_u32 v63,16384,v61
ds_read_b64_tr_b16 a[184:185],v63 offset:0
ds_read_b64_tr_b16 a[186:187],v63 offset:512
ds_read_b64_tr_b16 a[188:189],v63 offset:8192
ds_read_b64_tr_b16 a[190:191],v63 offset:8704
s_waitcnt vmcnt(28)
s_waitcnt lgkmcnt(0)
s_barrier
s_mov_b32 m0,18432
s_add_u32 s75,s76,3670016
buffer_load_dwordx4 v66,s[20:23],s75 offen  lds
s_mov_b32 m0,22528
s_add_u32 s75,s76,3801088
buffer_load_dwordx4 v66,s[20:23],s75 offen  lds
s_mov_b32 m0,26624
s_add_u32 s75,s76,3932160
buffer_load_dwordx4 v66,s[20:23],s75 offen  lds
s_mov_b32 m0,30720
s_add_u32 s75,s76,4063232
buffer_load_dwordx4 v66,s[20:23],s75 offen  lds
v_add_u32 v63,32768,v60
ds_read_b64_tr_b16 a[128:129],v63 offset:0
ds_read_b64_tr_b16 a[130:131],v63 offset:512
ds_read_b64_tr_b16 a[132:133],v63 offset:8192
ds_read_b64_tr_b16 a[134:135],v63 offset:8704
v_add_u32 v63,32768,v61
ds_read_b64_tr_b16 a[136:137],v63 offset:0
ds_read_b64_tr_b16 a[138:139],v63 offset:512
ds_read_b64_tr_b16 a[140:141],v63 offset:8192
ds_read_b64_tr_b16 a[142:143],v63 offset:8704
s_waitcnt vmcnt(28)
s_waitcnt lgkmcnt(0)
s_barrier
s_mov_b32 m0,34816
s_add_u32 s75,s76,4194304
buffer_load_dwordx4 v66,s[20:23],s75 offen  lds
s_mov_b32 m0,38912
s_add_u32 s75,s76,4325376
buffer_load_dwordx4 v66,s[20:23],s75 offen  lds
s_mov_b32 m0,43008
s_add_u32 s75,s76,4456448
buffer_load_dwordx4 v66,s[20:23],s75 offen  lds
s_mov_b32 m0,47104
s_add_u32 s75,s76,4587520
buffer_load_dwordx4 v66,s[20:23],s75 offen  lds
v_add_u32 v63,49152,v60
ds_read_b64_tr_b16 a[144:145],v63 offset:0
ds_read_b64_tr_b16 a[146:147],v63 offset:512
ds_read_b64_tr_b16 a[148:149],v63 offset:8192
ds_read_b64_tr_b16 a[150:151],v63 offset:8704
v_add_u32 v63,49152,v61
ds_read_b64_tr_b16 a[152:153],v63 offset:0
ds_read_b64_tr_b16 a[154:155],v63 offset:512
ds_read_b64_tr_b16 a[156:157],v63 offset:8192
ds_read_b64_tr_b16 a[158:159],v63 offset:8704
s_waitcnt vmcnt(28)
s_waitcnt lgkmcnt(0)
s_barrier
s_mov_b32 m0,53248
s_add_u32 s75,s77,36864
buffer_load_dwordx4 v67,s[24:27],s75 offen  lds
s_mov_b32 m0,54272
s_add_u32 s75,s77,46080
buffer_load_dwordx4 v67,s[24:27],s75 offen  lds
s_mov_b32 m0,61440
s_add_u32 s75,s77,110592
buffer_load_dwordx4 v67,s[24:27],s75 offen  lds
s_mov_b32 m0,62464
s_add_u32 s75,s77,119808
buffer_load_dwordx4 v67,s[24:27],s75 offen  lds
v_add_u32 v63,65536,v60
ds_read_b64_tr_b16 a[192:193],v63 offset:0
ds_read_b64_tr_b16 a[194:195],v63 offset:512
ds_read_b64_tr_b16 a[196:197],v63 offset:8192
ds_read_b64_tr_b16 a[198:199],v63 offset:8704
v_add_u32 v63,65536,v61
ds_read_b64_tr_b16 a[200:201],v63 offset:0
ds_read_b64_tr_b16 a[202:203],v63 offset:512
ds_read_b64_tr_b16 a[204:205],v63 offset:8192
ds_read_b64_tr_b16 a[206:207],v63 offset:8704
s_waitcnt vmcnt(28)
s_waitcnt lgkmcnt(0)
s_barrier
s_mov_b32 m0,69632
s_add_u32 s75,s77,36992
buffer_load_dwordx4 v67,s[24:27],s75 offen  lds
s_mov_b32 m0,70656
s_add_u32 s75,s77,46208
buffer_load_dwordx4 v67,s[24:27],s75 offen  lds
s_mov_b32 m0,77824
s_add_u32 s75,s77,110720
buffer_load_dwordx4 v67,s[24:27],s75 offen  lds
s_mov_b32 m0,78848
s_add_u32 s75,s77,119936
buffer_load_dwordx4 v67,s[24:27],s75 offen  lds
v_add_u32 v63,81920,v60
ds_read_b64_tr_b16 a[208:209],v63 offset:0
ds_read_b64_tr_b16 a[210:211],v63 offset:512
ds_read_b64_tr_b16 a[212:213],v63 offset:8192
ds_read_b64_tr_b16 a[214:215],v63 offset:8704
v_add_u32 v63,81920,v61
ds_read_b64_tr_b16 a[216:217],v63 offset:0
ds_read_b64_tr_b16 a[218:219],v63 offset:512
ds_read_b64_tr_b16 a[220:221],v63 offset:8192
ds_read_b64_tr_b16 a[222:223],v63 offset:8704
s_waitcnt vmcnt(28)
s_waitcnt lgkmcnt(0)
s_barrier
s_mov_b32 m0,86016
s_add_u32 s75,s77,37120
buffer_load_dwordx4 v67,s[24:27],s75 offen  lds
s_mov_b32 m0,87040
s_add_u32 s75,s77,46336
buffer_load_dwordx4 v67,s[24:27],s75 offen  lds
s_mov_b32 m0,94208
s_add_u32 s75,s77,110848
buffer_load_dwordx4 v67,s[24:27],s75 offen  lds
s_mov_b32 m0,95232
s_add_u32 s75,s77,120064
buffer_load_dwordx4 v67,s[24:27],s75 offen  lds
v_add_u32 v63,98304,v60
ds_read_b64_tr_b16 a[224:225],v63 offset:0
ds_read_b64_tr_b16 a[226:227],v63 offset:512
ds_read_b64_tr_b16 a[228:229],v63 offset:8192
ds_read_b64_tr_b16 a[230:231],v63 offset:8704
v_add_u32 v63,98304,v61
ds_read_b64_tr_b16 a[232:233],v63 offset:0
ds_read_b64_tr_b16 a[234:235],v63 offset:512
ds_read_b64_tr_b16 a[236:237],v63 offset:8192
ds_read_b64_tr_b16 a[238:239],v63 offset:8704
s_waitcnt vmcnt(28)
s_waitcnt lgkmcnt(0)
s_barrier
s_mov_b32 m0,102400
s_add_u32 s75,s77,37248
buffer_load_dwordx4 v67,s[24:27],s75 offen  lds
s_mov_b32 m0,103424
s_add_u32 s75,s77,46464
buffer_load_dwordx4 v67,s[24:27],s75 offen  lds
s_mov_b32 m0,110592
s_add_u32 s75,s77,110976
buffer_load_dwordx4 v67,s[24:27],s75 offen  lds
s_mov_b32 m0,111616
s_add_u32 s75,s77,120192
buffer_load_dwordx4 v67,s[24:27],s75 offen  lds
v_add_u32 v63,114688,v60
ds_read_b64_tr_b16 a[240:241],v63 offset:0
ds_read_b64_tr_b16 a[242:243],v63 offset:512
ds_read_b64_tr_b16 a[244:245],v63 offset:8192
ds_read_b64_tr_b16 a[246:247],v63 offset:8704
v_add_u32 v63,114688,v61
ds_read_b64_tr_b16 a[248:249],v63 offset:0
ds_read_b64_tr_b16 a[250:251],v63 offset:512
ds_read_b64_tr_b16 a[252:253],v63 offset:8192
ds_read_b64_tr_b16 a[254:255],v63 offset:8704
s_waitcnt vmcnt(28)
s_waitcnt lgkmcnt(0)
s_barrier
s_mov_b32 m0,118784
s_add_u32 s75,s77,37376
buffer_load_dwordx4 v67,s[24:27],s75 offen  lds
s_mov_b32 m0,119808
s_add_u32 s75,s77,46592
buffer_load_dwordx4 v67,s[24:27],s75 offen  lds
s_mov_b32 m0,126976
s_add_u32 s75,s77,111104
buffer_load_dwordx4 v67,s[24:27],s75 offen  lds
s_mov_b32 m0,128000
s_add_u32 s75,s77,120320
buffer_load_dwordx4 v67,s[24:27],s75 offen  lds
v_add_u32 v63,131072,v60
ds_read_b64_tr_b16 v[80:81],v63 offset:0
ds_read_b64_tr_b16 v[82:83],v63 offset:512
ds_read_b64_tr_b16 v[84:85],v63 offset:8192
ds_read_b64_tr_b16 v[86:87],v63 offset:8704
v_add_u32 v63,131072,v61
ds_read_b64_tr_b16 v[88:89],v63 offset:0
ds_read_b64_tr_b16 v[90:91],v63 offset:512
ds_read_b64_tr_b16 v[92:93],v63 offset:8192
ds_read_b64_tr_b16 v[94:95],v63 offset:8704
s_waitcnt vmcnt(28)
s_waitcnt lgkmcnt(0)
s_barrier
s_mov_b32 m0,135168
s_add_u32 s75,s77,37504
buffer_load_dwordx4 v67,s[24:27],s75 offen  lds
s_mov_b32 m0,136192
s_add_u32 s75,s77,46720
buffer_load_dwordx4 v67,s[24:27],s75 offen  lds
s_mov_b32 m0,143360
s_add_u32 s75,s77,111232
buffer_load_dwordx4 v67,s[24:27],s75 offen  lds
s_mov_b32 m0,144384
s_add_u32 s75,s77,120448
buffer_load_dwordx4 v67,s[24:27],s75 offen  lds
v_add_u32 v63,147456,v60
ds_read_b64_tr_b16 v[96:97],v63 offset:0
ds_read_b64_tr_b16 v[98:99],v63 offset:512
ds_read_b64_tr_b16 v[100:101],v63 offset:8192
ds_read_b64_tr_b16 v[102:103],v63 offset:8704
v_add_u32 v63,147456,v61
ds_read_b64_tr_b16 v[104:105],v63 offset:0
ds_read_b64_tr_b16 v[106:107],v63 offset:512
ds_read_b64_tr_b16 v[108:109],v63 offset:8192
ds_read_b64_tr_b16 v[110:111],v63 offset:8704
s_waitcnt vmcnt(28)
s_waitcnt lgkmcnt(0)
s_barrier
s_mov_b32 m0,151552
s_add_u32 s75,s77,37632
buffer_load_dwordx4 v67,s[24:27],s75 offen  lds
s_mov_b32 m0,152576
s_add_u32 s75,s77,46848
buffer_load_dwordx4 v67,s[24:27],s75 offen  lds
s_mov_b32 m0,159744
s_add_u32 s75,s77,111360
buffer_load_dwordx4 v67,s[24:27],s75 offen  lds
s_mov_b32 m0,160768
s_add_u32 s75,s77,120576
buffer_load_dwordx4 v67,s[24:27],s75 offen  lds
v_add_u32 v63,16384,v60
ds_read_b64_tr_b16 v[112:113],v63 offset:0
ds_read_b64_tr_b16 v[114:115],v63 offset:512
ds_read_b64_tr_b16 v[116:117],v63 offset:8192
ds_read_b64_tr_b16 v[118:119],v63 offset:8704
v_add_u32 v63,16384,v61
ds_read_b64_tr_b16 v[120:121],v63 offset:0
ds_read_b64_tr_b16 v[122:123],v63 offset:512
ds_read_b64_tr_b16 v[124:125],v63 offset:8192
ds_read_b64_tr_b16 v[126:127],v63 offset:8704
s_waitcnt vmcnt(28)
s_waitcnt lgkmcnt(0)
s_barrier
s_mov_b32 m0,18432
s_add_u32 s75,s76,4194304
buffer_load_dwordx4 v66,s[12:15],s75 offen  lds
s_mov_b32 m0,22528
s_add_u32 s75,s76,4325376
buffer_load_dwordx4 v66,s[12:15],s75 offen  lds
s_mov_b32 m0,26624
s_add_u32 s75,s76,4456448
buffer_load_dwordx4 v66,s[12:15],s75 offen  lds
s_mov_b32 m0,30720
s_add_u32 s75,s76,4587520
buffer_load_dwordx4 v66,s[12:15],s75 offen  lds
v_add_u32 v63,32768,v60
ds_read_b64_tr_b16 v[128:129],v63 offset:0
ds_read_b64_tr_b16 v[130:131],v63 offset:512
ds_read_b64_tr_b16 v[132:133],v63 offset:8192
ds_read_b64_tr_b16 v[134:135],v63 offset:8704
v_add_u32 v63,32768,v61
ds_read_b64_tr_b16 v[136:137],v63 offset:0
ds_read_b64_tr_b16 v[138:139],v63 offset:512
ds_read_b64_tr_b16 v[140:141],v63 offset:8192
ds_read_b64_tr_b16 v[142:143],v63 offset:8704
s_waitcnt vmcnt(28)
s_waitcnt lgkmcnt(0)
s_barrier
s_mov_b32 m0,34816
s_add_u32 s75,s76,0
buffer_load_dwordx4 v66,s[20:23],s75 offen  lds
s_mov_b32 m0,38912
s_add_u32 s75,s76,131072
buffer_load_dwordx4 v66,s[20:23],s75 offen  lds
s_mov_b32 m0,43008
s_add_u32 s75,s76,262144
buffer_load_dwordx4 v66,s[20:23],s75 offen  lds
s_mov_b32 m0,47104
s_add_u32 s75,s76,393216
buffer_load_dwordx4 v66,s[20:23],s75 offen  lds
v_add_u32 v63,49152,v62
ds_read_b64_tr_b16 v[144:145],v63 offset:0
ds_read_b64_tr_b16 v[146:147],v63 offset:256
ds_read_b64_tr_b16 v[148:149],v63 offset:1024
ds_read_b64_tr_b16 v[150:151],v63 offset:1280
v_add_u32 v63,49152,v62
ds_read_b64_tr_b16 v[152:153],v63 offset:8192
ds_read_b64_tr_b16 v[154:155],v63 offset:8448
ds_read_b64_tr_b16 v[156:157],v63 offset:9216
ds_read_b64_tr_b16 v[158:159],v63 offset:9472
s_waitcnt vmcnt(28)
s_waitcnt lgkmcnt(0)
s_barrier
s_mov_b32 m0,51200
s_add_u32 s75,s76,524288
buffer_load_dwordx4 v66,s[20:23],s75 offen  lds
s_mov_b32 m0,55296
s_add_u32 s75,s76,655360
buffer_load_dwordx4 v66,s[20:23],s75 offen  lds
s_mov_b32 m0,59392
s_add_u32 s75,s76,786432
buffer_load_dwordx4 v66,s[20:23],s75 offen  lds
s_mov_b32 m0,63488
s_add_u32 s75,s76,917504
buffer_load_dwordx4 v66,s[20:23],s75 offen  lds
v_add_u32 v63,65536,v62
ds_read_b64_tr_b16 v[160:161],v63 offset:0
ds_read_b64_tr_b16 v[162:163],v63 offset:256
ds_read_b64_tr_b16 v[164:165],v63 offset:1024
ds_read_b64_tr_b16 v[166:167],v63 offset:1280
v_add_u32 v63,65536,v62
ds_read_b64_tr_b16 v[168:169],v63 offset:8192
ds_read_b64_tr_b16 v[170:171],v63 offset:8448
ds_read_b64_tr_b16 v[172:173],v63 offset:9216
ds_read_b64_tr_b16 v[174:175],v63 offset:9472
s_waitcnt vmcnt(28)
s_waitcnt lgkmcnt(0)
s_barrier
s_mov_b32 m0,67584
s_add_u32 s75,s76,524288
buffer_load_dwordx4 v66,s[16:19],s75 offen  lds
s_mov_b32 m0,71680
s_add_u32 s75,s76,655360
buffer_load_dwordx4 v66,s[16:19],s75 offen  lds
s_mov_b32 m0,75776
s_add_u32 s75,s76,786432
buffer_load_dwordx4 v66,s[16:19],s75 offen  lds
s_mov_b32 m0,79872
s_add_u32 s75,s76,917504
buffer_load_dwordx4 v66,s[16:19],s75 offen  lds
v_add_u32 v63,81920,v62
ds_read_b64_tr_b16 v[176:177],v63 offset:0
ds_read_b64_tr_b16 v[178:179],v63 offset:256
ds_read_b64_tr_b16 v[180:181],v63 offset:1024
ds_read_b64_tr_b16 v[182:183],v63 offset:1280
v_add_u32 v63,81920,v62
ds_read_b64_tr_b16 v[184:185],v63 offset:8192
ds_read_b64_tr_b16 v[186:187],v63 offset:8448
ds_read_b64_tr_b16 v[188:189],v63 offset:9216
ds_read_b64_tr_b16 v[190:191],v63 offset:9472
s_waitcnt vmcnt(28)
s_waitcnt lgkmcnt(0)
s_barrier
s_mov_b32 m0,83968
s_add_u32 s75,s76,1572864
buffer_load_dwordx4 v66,s[16:19],s75 offen  lds
s_mov_b32 m0,88064
s_add_u32 s75,s76,1703936
buffer_load_dwordx4 v66,s[16:19],s75 offen  lds
s_mov_b32 m0,92160
s_add_u32 s75,s76,1835008
buffer_load_dwordx4 v66,s[16:19],s75 offen  lds
s_mov_b32 m0,96256
s_add_u32 s75,s76,1966080
buffer_load_dwordx4 v66,s[16:19],s75 offen  lds
v_add_u32 v63,98304,v62
ds_read_b64_tr_b16 v[192:193],v63 offset:0
ds_read_b64_tr_b16 v[194:195],v63 offset:256
ds_read_b64_tr_b16 v[196:197],v63 offset:1024
ds_read_b64_tr_b16 v[198:199],v63 offset:1280
v_add_u32 v63,98304,v62
ds_read_b64_tr_b16 v[200:201],v63 offset:8192
ds_read_b64_tr_b16 v[202:203],v63 offset:8448
ds_read_b64_tr_b16 v[204:205],v63 offset:9216
ds_read_b64_tr_b16 v[206:207],v63 offset:9472
s_waitcnt vmcnt(28)
s_waitcnt lgkmcnt(0)
s_barrier
s_mov_b32 m0,100352
s_add_u32 s75,s76,2621440
buffer_load_dwordx4 v66,s[16:19],s75 offen  lds
s_mov_b32 m0,104448
s_add_u32 s75,s76,2752512
buffer_load_dwordx4 v66,s[16:19],s75 offen  lds
s_mov_b32 m0,108544
s_add_u32 s75,s76,2883584
buffer_load_dwordx4 v66,s[16:19],s75 offen  lds
s_mov_b32 m0,112640
s_add_u32 s75,s76,3014656
buffer_load_dwordx4 v66,s[16:19],s75 offen  lds
v_add_u32 v63,114688,v62
ds_read_b64_tr_b16 v[208:209],v63 offset:0
ds_read_b64_tr_b16 v[210:211],v63 offset:256
ds_read_b64_tr_b16 v[212:213],v63 offset:1024
ds_read_b64_tr_b16 v[214:215],v63 offset:1280
v_add_u32 v63,114688,v62
ds_read_b64_tr_b16 v[216:217],v63 offset:8192
ds_read_b64_tr_b16 v[218:219],v63 offset:8448
ds_read_b64_tr_b16 v[220:221],v63 offset:9216
ds_read_b64_tr_b16 v[222:223],v63 offset:9472
s_waitcnt vmcnt(28)
s_waitcnt lgkmcnt(0)
s_barrier
s_mov_b32 m0,116736
s_add_u32 s75,s76,3670016
buffer_load_dwordx4 v66,s[16:19],s75 offen  lds
s_mov_b32 m0,120832
s_add_u32 s75,s76,3801088
buffer_load_dwordx4 v66,s[16:19],s75 offen  lds
s_mov_b32 m0,124928
s_add_u32 s75,s76,3932160
buffer_load_dwordx4 v66,s[16:19],s75 offen  lds
s_mov_b32 m0,129024
s_add_u32 s75,s76,4063232
buffer_load_dwordx4 v66,s[16:19],s75 offen  lds
v_add_u32 v63,131072,v62
ds_read_b64_tr_b16 v[224:225],v63 offset:0
ds_read_b64_tr_b16 v[226:227],v63 offset:256
ds_read_b64_tr_b16 v[228:229],v63 offset:1024
ds_read_b64_tr_b16 v[230:231],v63 offset:1280
v_add_u32 v63,131072,v62
ds_read_b64_tr_b16 v[232:233],v63 offset:8192
ds_read_b64_tr_b16 v[234:235],v63 offset:8448
ds_read_b64_tr_b16 v[236:237],v63 offset:9216
ds_read_b64_tr_b16 v[238:239],v63 offset:9472
s_waitcnt vmcnt(28)
s_waitcnt lgkmcnt(0)
s_barrier
s_mov_b32 m0,135168
s_add_u32 s75,s77,37760
buffer_load_dwordx4 v67,s[24:27],s75 offen  lds
s_mov_b32 m0,136192
s_add_u32 s75,s77,46976
buffer_load_dwordx4 v67,s[24:27],s75 offen  lds
s_mov_b32 m0,143360
s_add_u32 s75,s77,111488
buffer_load_dwordx4 v67,s[24:27],s75 offen  lds
s_mov_b32 m0,144384
s_add_u32 s75,s77,120704
buffer_load_dwordx4 v67,s[24:27],s75 offen  lds
v_add_u32 v63,147456,v62
ds_read_b64_tr_b16 v[240:241],v63 offset:0
ds_read_b64_tr_b16 v[242:243],v63 offset:256
ds_read_b64_tr_b16 v[244:245],v63 offset:1024
ds_read_b64_tr_b16 v[246:247],v63 offset:1280
v_add_u32 v63,147456,v62
ds_read_b64_tr_b16 v[248:249],v63 offset:8192
ds_read_b64_tr_b16 v[250:251],v63 offset:8448
ds_read_b64_tr_b16 v[252:253],v63 offset:9216
ds_read_b64_tr_b16 v[254:255],v63 offset:9472
s_waitcnt vmcnt(28)
s_waitcnt lgkmcnt(0)
s_barrier
s_mov_b32 m0,151552
s_add_u32 s75,s77,37888
buffer_load_dwordx4 v67,s[24:27],s75 offen  lds
s_mov_b32 m0,152576
s_add_u32 s75,s77,47104
buffer_load_dwordx4 v67,s[24:27],s75 offen  lds
s_mov_b32 m0,159744
s_add_u32 s75,s77,111616
buffer_load_dwordx4 v67,s[24:27],s75 offen  lds
s_mov_b32 m0,160768
s_add_u32 s75,s77,120832
buffer_load_dwordx4 v67,s[24:27],s75 offen  lds
v_add_u32 v63,16384,v60
ds_read_b64_tr_b16 v[28:29],v63 offset:0
ds_read_b64_tr_b16 v[30:31],v63 offset:512
ds_read_b64_tr_b16 v[32:33],v63 offset:8192
ds_read_b64_tr_b16 v[34:35],v63 offset:8704
v_add_u32 v63,16384,v61
ds_read_b64_tr_b16 v[36:37],v63 offset:0
ds_read_b64_tr_b16 v[38:39],v63 offset:512
ds_read_b64_tr_b16 v[40:41],v63 offset:8192
ds_read_b64_tr_b16 v[42:43],v63 offset:8704
s_waitcnt vmcnt(28)
s_waitcnt lgkmcnt(0)
s_barrier
v_add_u32 v63,0,v2
ds_write_b128 v63,v[28:31] offset:0
ds_write_b128 v63,v[32:35] offset:1024
ds_write_b128 v63,v[36:39] offset:2048
ds_write_b128 v63,v[40:43] offset:3072
v_add_u32 v63,32768,v60
ds_read_b64_tr_b16 v[12:13],v63 offset:0
ds_read_b64_tr_b16 v[14:15],v63 offset:512
ds_read_b64_tr_b16 v[16:17],v63 offset:8192
ds_read_b64_tr_b16 v[18:19],v63 offset:8704
v_add_u32 v63,32768,v61
ds_read_b64_tr_b16 v[20:21],v63 offset:0
ds_read_b64_tr_b16 v[22:23],v63 offset:512
ds_read_b64_tr_b16 v[24:25],v63 offset:8192
ds_read_b64_tr_b16 v[26:27],v63 offset:8704
s_waitcnt vmcnt(24)
s_waitcnt lgkmcnt(0)
s_barrier
v_bfe_u32 v64,v0,4,5
buffer_load_ubyte v68,v64,s[32:35],0 offen offset:128 sc1
v_mov_b32 v64,0
buffer_load_dword v69,v64,s[32:35],0 offen offset:160 sc1
v_add_u32 v63,16384,v2
ds_write_b128 v63,v[12:15] offset:0
ds_write_b128 v63,v[16:19] offset:1024
ds_write_b128 v63,v[20:23] offset:2048
ds_write_b128 v63,v[24:27] offset:3072
v_add_u32 v63,49152,v60
ds_read_b64_tr_b16 v[28:29],v63 offset:0
ds_read_b64_tr_b16 v[30:31],v63 offset:512
ds_read_b64_tr_b16 v[32:33],v63 offset:8192
ds_read_b64_tr_b16 v[34:35],v63 offset:8704
v_add_u32 v63,49152,v61
ds_read_b64_tr_b16 v[36:37],v63 offset:0
ds_read_b64_tr_b16 v[38:39],v63 offset:512
ds_read_b64_tr_b16 v[40:41],v63 offset:8192
ds_read_b64_tr_b16 v[42:43],v63 offset:8704
s_waitcnt vmcnt(22)
s_waitcnt lgkmcnt(0)
s_barrier
v_add_u32 v63,32768,v2
ds_write_b128 v63,v[28:31] offset:0
ds_write_b128 v63,v[32:35] offset:1024
ds_write_b128 v63,v[36:39] offset:2048
ds_write_b128 v63,v[40:43] offset:3072
v_add_u32 v63,65536,v60
ds_read_b64_tr_b16 v[12:13],v63 offset:0
ds_read_b64_tr_b16 v[14:15],v63 offset:512
ds_read_b64_tr_b16 v[16:17],v63 offset:8192
ds_read_b64_tr_b16 v[18:19],v63 offset:8704
v_add_u32 v63,65536,v61
ds_read_b64_tr_b16 v[20:21],v63 offset:0
ds_read_b64_tr_b16 v[22:23],v63 offset:512
ds_read_b64_tr_b16 v[24:25],v63 offset:8192
ds_read_b64_tr_b16 v[26:27],v63 offset:8704
s_waitcnt vmcnt(18)
s_waitcnt lgkmcnt(0)
s_barrier
v_add_u32 v63,49152,v2
ds_write_b128 v63,v[12:15] offset:0
ds_write_b128 v63,v[16:19] offset:1024
ds_write_b128 v63,v[20:23] offset:2048
ds_write_b128 v63,v[24:27] offset:3072
v_add_u32 v63,81920,v60
ds_read_b64_tr_b16 v[28:29],v63 offset:0
ds_read_b64_tr_b16 v[30:31],v63 offset:512
ds_read_b64_tr_b16 v[32:33],v63 offset:8192
ds_read_b64_tr_b16 v[34:35],v63 offset:8704
v_add_u32 v63,81920,v61
ds_read_b64_tr_b16 v[36:37],v63 offset:0
ds_read_b64_tr_b16 v[38:39],v63 offset:512
ds_read_b64_tr_b16 v[40:41],v63 offset:8192
ds_read_b64_tr_b16 v[42:43],v63 offset:8704
s_waitcnt vmcnt(14)
s_waitcnt lgkmcnt(0)
s_barrier
v_add_u32 v63,65536,v2
ds_write_b128 v63,v[28:31] offset:0
ds_write_b128 v63,v[32:35] offset:1024
ds_write_b128 v63,v[36:39] offset:2048
ds_write_b128 v63,v[40:43] offset:3072
v_add_u32 v63,98304,v60
ds_read_b64_tr_b16 v[12:13],v63 offset:0
ds_read_b64_tr_b16 v[14:15],v63 offset:512
ds_read_b64_tr_b16 v[16:17],v63 offset:8192
ds_read_b64_tr_b16 v[18:19],v63 offset:8704
v_add_u32 v63,98304,v61
ds_read_b64_tr_b16 v[20:21],v63 offset:0
ds_read_b64_tr_b16 v[22:23],v63 offset:512
ds_read_b64_tr_b16 v[24:25],v63 offset:8192
ds_read_b64_tr_b16 v[26:27],v63 offset:8704
s_waitcnt vmcnt(10)
s_waitcnt lgkmcnt(0)
s_barrier
v_add_u32 v63,81920,v2
ds_write_b128 v63,v[12:15] offset:0
ds_write_b128 v63,v[16:19] offset:1024
ds_write_b128 v63,v[20:23] offset:2048
ds_write_b128 v63,v[24:27] offset:3072
v_add_u32 v63,114688,v60
ds_read_b64_tr_b16 v[28:29],v63 offset:0
ds_read_b64_tr_b16 v[30:31],v63 offset:512
ds_read_b64_tr_b16 v[32:33],v63 offset:8192
ds_read_b64_tr_b16 v[34:35],v63 offset:8704
v_add_u32 v63,114688,v61
ds_read_b64_tr_b16 v[36:37],v63 offset:0
ds_read_b64_tr_b16 v[38:39],v63 offset:512
ds_read_b64_tr_b16 v[40:41],v63 offset:8192
ds_read_b64_tr_b16 v[42:43],v63 offset:8704
s_waitcnt vmcnt(6)
s_waitcnt lgkmcnt(0)
s_barrier
v_add_u32 v63,98304,v2
ds_write_b128 v63,v[28:31] offset:0
ds_write_b128 v63,v[32:35] offset:1024
ds_write_b128 v63,v[36:39] offset:2048
ds_write_b128 v63,v[40:43] offset:3072
v_add_u32 v63,131072,v62
ds_read_b64_tr_b16 v[12:13],v63 offset:0
ds_read_b64_tr_b16 v[14:15],v63 offset:256
ds_read_b64_tr_b16 v[16:17],v63 offset:1024
ds_read_b64_tr_b16 v[18:19],v63 offset:1280
v_add_u32 v63,131072,v62
ds_read_b64_tr_b16 v[20:21],v63 offset:8192
ds_read_b64_tr_b16 v[22:23],v63 offset:8448
ds_read_b64_tr_b16 v[24:25],v63 offset:9216
ds_read_b64_tr_b16 v[26:27],v63 offset:9472
s_waitcnt vmcnt(2)
s_waitcnt lgkmcnt(0)
s_barrier
v_add_u32 v63,114688,v2
ds_write_b128 v63,v[12:15] offset:0
ds_write_b128 v63,v[16:19] offset:1024
ds_write_b128 v63,v[20:23] offset:2048
ds_write_b128 v63,v[24:27] offset:3072
v_add_u32 v63,147456,v62
ds_read_b64_tr_b16 v[28:29],v63 offset:0
ds_read_b64_tr_b16 v[30:31],v63 offset:256
ds_read_b64_tr_b16 v[32:33],v63 offset:1024
ds_read_b64_tr_b16 v[34:35],v63 offset:1280
v_add_u32 v63,147456,v62
ds_read_b64_tr_b16 v[36:37],v63 offset:8192
ds_read_b64_tr_b16 v[38:39],v63 offset:8448
ds_read_b64_tr_b16 v[40:41],v63 offset:9216
ds_read_b64_tr_b16 v[42:43],v63 offset:9472
s_waitcnt lgkmcnt(0)
s_barrier
v_add_u32 v63,131072,v2
ds_write_b128 v63,v[28:31] offset:0
ds_write_b128 v63,v[32:35] offset:1024
ds_write_b128 v63,v[36:39] offset:2048
ds_write_b128 v63,v[40:43] offset:3072
s_waitcnt lgkmcnt(0)
s_barrier
s_branch Lr_prodone
Lr_pro3:
v_lshrrev_b32 v12,4,v0
v_lshrrev_b32 v13,4,v12
v_and_b32 v14,1,v13
v_or_b32 v14,6,v14
v_lshlrev_b32 v14,1,v14
v_and_b32 v15,15,v12
v_xor_b32 v15,v15,v14
v_lshlrev_b32 v15,4,v15
v_add_u32 v13,12,v13
v_lshl_add_u32 v66,v13,13,v15
v_lshrrev_b32 v13,3,v12
v_mul_u32_u24 v13,1152,v13
v_and_b32 v15,7,v12
v_xor_b32 v15,6,v15
v_lshl_add_u32 v67,v15,4,v13
v_lshrrev_b32 v13,4,v12
v_bfe_u32 v14,v12,2,2
v_and_b32 v15,3,v12
v_lshrrev_b32 v16,1,v13
v_and_b32 v17,1,v13
v_and_b32 v18,1,v14
v_lshrrev_b32 v19,1,v14
v_lshlrev_b32 v20,4,v16
v_lshl_add_u32 v20,v17,2,v20
v_add_u32 v20,v20,v18
v_lshl_add_u32 v20,v19,3,v20
v_lshl_add_u32 v21,v17,1,v18
v_lshl_add_u32 v21,v19,2,v21
v_lshlrev_b32 v20,8,v20
v_lshl_add_u32 v20,v15,3,v20
v_xor_b32 v22,6,v21
v_lshl_add_u32 v60,v22,5,v20
v_xor_b32 v22,7,v21
v_lshl_add_u32 v61,v22,5,v20
v_lshlrev_b32 v20,5,v17
v_lshl_add_u32 v20,v16,2,v20
v_add_u32 v20,v20,v18
v_lshl_add_u32 v20,v19,4,v20
v_lshlrev_b32 v20,7,v20
v_lshl_add_u32 v20,v15,3,v20
v_lshl_add_u32 v21,v17,1,v19
v_xor_b32 v21,3,v21
v_lshl_add_u32 v62,v21,5,v20
s_lshl_b32 s76,s61,8
s_mul_i32 s77,s61,147456
s_mov_b32 m0,19456
s_add_u32 s75,s76,0
buffer_load_dwordx4 v66,s[12:15],s75 offen  lds
s_mov_b32 m0,23552
s_add_u32 s75,s76,131072
buffer_load_dwordx4 v66,s[12:15],s75 offen  lds
s_mov_b32 m0,27648
s_add_u32 s75,s76,262144
buffer_load_dwordx4 v66,s[12:15],s75 offen  lds
s_mov_b32 m0,31744
s_add_u32 s75,s76,393216
buffer_load_dwordx4 v66,s[12:15],s75 offen  lds
s_mov_b32 m0,35840
s_add_u32 s75,s76,524288
buffer_load_dwordx4 v66,s[12:15],s75 offen  lds
s_mov_b32 m0,39936
s_add_u32 s75,s76,655360
buffer_load_dwordx4 v66,s[12:15],s75 offen  lds
s_mov_b32 m0,44032
s_add_u32 s75,s76,786432
buffer_load_dwordx4 v66,s[12:15],s75 offen  lds
s_mov_b32 m0,48128
s_add_u32 s75,s76,917504
buffer_load_dwordx4 v66,s[12:15],s75 offen  lds
s_mov_b32 m0,52224
s_add_u32 s75,s76,1048576
buffer_load_dwordx4 v66,s[12:15],s75 offen  lds
s_mov_b32 m0,56320
s_add_u32 s75,s76,1179648
buffer_load_dwordx4 v66,s[12:15],s75 offen  lds
s_mov_b32 m0,60416
s_add_u32 s75,s76,1310720
buffer_load_dwordx4 v66,s[12:15],s75 offen  lds
s_mov_b32 m0,64512
s_add_u32 s75,s76,1441792
buffer_load_dwordx4 v66,s[12:15],s75 offen  lds
s_mov_b32 m0,68608
s_add_u32 s75,s76,1572864
buffer_load_dwordx4 v66,s[12:15],s75 offen  lds
s_mov_b32 m0,72704
s_add_u32 s75,s76,1703936
buffer_load_dwordx4 v66,s[12:15],s75 offen  lds
s_mov_b32 m0,76800
s_add_u32 s75,s76,1835008
buffer_load_dwordx4 v66,s[12:15],s75 offen  lds
s_mov_b32 m0,80896
s_add_u32 s75,s76,1966080
buffer_load_dwordx4 v66,s[12:15],s75 offen  lds
s_mov_b32 m0,84992
s_add_u32 s75,s76,2097152
buffer_load_dwordx4 v66,s[12:15],s75 offen  lds
s_mov_b32 m0,89088
s_add_u32 s75,s76,2228224
buffer_load_dwordx4 v66,s[12:15],s75 offen  lds
s_mov_b32 m0,93184
s_add_u32 s75,s76,2359296
buffer_load_dwordx4 v66,s[12:15],s75 offen  lds
s_mov_b32 m0,97280
s_add_u32 s75,s76,2490368
buffer_load_dwordx4 v66,s[12:15],s75 offen  lds
s_mov_b32 m0,101376
s_add_u32 s75,s76,2621440
buffer_load_dwordx4 v66,s[12:15],s75 offen  lds
s_mov_b32 m0,105472
s_add_u32 s75,s76,2752512
buffer_load_dwordx4 v66,s[12:15],s75 offen  lds
s_mov_b32 m0,109568
s_add_u32 s75,s76,2883584
buffer_load_dwordx4 v66,s[12:15],s75 offen  lds
s_mov_b32 m0,113664
s_add_u32 s75,s76,3014656
buffer_load_dwordx4 v66,s[12:15],s75 offen  lds
s_mov_b32 m0,117760
s_add_u32 s75,s76,3145728
buffer_load_dwordx4 v66,s[12:15],s75 offen  lds
s_mov_b32 m0,121856
s_add_u32 s75,s76,3276800
buffer_load_dwordx4 v66,s[12:15],s75 offen  lds
s_mov_b32 m0,125952
s_add_u32 s75,s76,3407872
buffer_load_dwordx4 v66,s[12:15],s75 offen  lds
s_mov_b32 m0,130048
s_add_u32 s75,s76,3538944
buffer_load_dwordx4 v66,s[12:15],s75 offen  lds
s_mov_b32 m0,134144
s_add_u32 s75,s76,3670016
buffer_load_dwordx4 v66,s[12:15],s75 offen  lds
s_mov_b32 m0,138240
s_add_u32 s75,s76,3801088
buffer_load_dwordx4 v66,s[12:15],s75 offen  lds
s_mov_b32 m0,142336
s_add_u32 s75,s76,3932160
buffer_load_dwordx4 v66,s[12:15],s75 offen  lds
s_mov_b32 m0,146432
s_add_u32 s75,s76,4063232
buffer_load_dwordx4 v66,s[12:15],s75 offen  lds
s_mov_b32 m0,150528
s_add_u32 s75,s76,0
buffer_load_dwordx4 v66,s[16:19],s75 offen  lds
s_mov_b32 m0,154624
s_add_u32 s75,s76,131072
buffer_load_dwordx4 v66,s[16:19],s75 offen  lds
s_mov_b32 m0,158720
s_add_u32 s75,s76,262144
buffer_load_dwordx4 v66,s[16:19],s75 offen  lds
s_mov_b32 m0,162816
s_add_u32 s75,s76,393216
buffer_load_dwordx4 v66,s[16:19],s75 offen  lds
s_branch Lr_mid
Lr_pro2_3:
s_lshl_b32 s76,s61,8
s_mul_i32 s77,s61,147456
s_waitcnt vmcnt(32)
s_waitcnt lgkmcnt(0)
s_barrier
v_add_u32 v63,16384,v60
ds_read_b64_tr_b16 a[96:97],v63 offset:0
ds_read_b64_tr_b16 a[98:99],v63 offset:512
ds_read_b64_tr_b16 a[100:101],v63 offset:8192
ds_read_b64_tr_b16 a[102:103],v63 offset:8704
v_add_u32 v63,16384,v61
ds_read_b64_tr_b16 a[104:105],v63 offset:0
ds_read_b64_tr_b16 a[106:107],v63 offset:512
ds_read_b64_tr_b16 a[108:109],v63 offset:8192
ds_read_b64_tr_b16 a[110:111],v63 offset:8704
s_waitcnt vmcnt(28)
s_waitcnt lgkmcnt(0)
s_barrier
s_mov_b32 m0,19456
s_add_u32 s75,s76,1048576
buffer_load_dwordx4 v66,s[16:19],s75 offen  lds
s_mov_b32 m0,23552
s_add_u32 s75,s76,1179648
buffer_load_dwordx4 v66,s[16:19],s75 offen  lds
s_mov_b32 m0,27648
s_add_u32 s75,s76,1310720
buffer_load_dwordx4 v66,s[16:19],s75 offen  lds
s_mov_b32 m0,31744
s_add_u32 s75,s76,1441792
buffer_load_dwordx4 v66,s[16:19],s75 offen  lds
v_add_u32 v63,32768,v60
ds_read_b64_tr_b16 a[112:113],v63 offset:0
ds_read_b64_tr_b16 a[114:115],v63 offset:512
ds_read_b64_tr_b16 a[116:117],v63 offset:8192
ds_read_b64_tr_b16 a[118:119],v63 offset:8704
v_add_u32 v63,32768,v61
ds_read_b64_tr_b16 a[120:121],v63 offset:0
ds_read_b64_tr_b16 a[122:123],v63 offset:512
ds_read_b64_tr_b16 a[124:125],v63 offset:8192
ds_read_b64_tr_b16 a[126:127],v63 offset:8704
s_waitcnt vmcnt(28)
s_waitcnt lgkmcnt(0)
s_barrier
s_mov_b32 m0,35840
s_add_u32 s75,s76,2097152
buffer_load_dwordx4 v66,s[16:19],s75 offen  lds
s_mov_b32 m0,39936
s_add_u32 s75,s76,2228224
buffer_load_dwordx4 v66,s[16:19],s75 offen  lds
s_mov_b32 m0,44032
s_add_u32 s75,s76,2359296
buffer_load_dwordx4 v66,s[16:19],s75 offen  lds
s_mov_b32 m0,48128
s_add_u32 s75,s76,2490368
buffer_load_dwordx4 v66,s[16:19],s75 offen  lds
v_add_u32 v63,49152,v60
ds_read_b64_tr_b16 a[64:65],v63 offset:0
ds_read_b64_tr_b16 a[66:67],v63 offset:512
ds_read_b64_tr_b16 a[68:69],v63 offset:8192
ds_read_b64_tr_b16 a[70:71],v63 offset:8704
v_add_u32 v63,49152,v61
ds_read_b64_tr_b16 a[72:73],v63 offset:0
ds_read_b64_tr_b16 a[74:75],v63 offset:512
ds_read_b64_tr_b16 a[76:77],v63 offset:8192
ds_read_b64_tr_b16 a[78:79],v63 offset:8704
s_waitcnt vmcnt(28)
s_waitcnt lgkmcnt(0)
s_barrier
s_mov_b32 m0,52224
s_add_u32 s75,s76,3145728
buffer_load_dwordx4 v66,s[16:19],s75 offen  lds
s_mov_b32 m0,56320
s_add_u32 s75,s76,3276800
buffer_load_dwordx4 v66,s[16:19],s75 offen  lds
s_mov_b32 m0,60416
s_add_u32 s75,s76,3407872
buffer_load_dwordx4 v66,s[16:19],s75 offen  lds
s_mov_b32 m0,64512
s_add_u32 s75,s76,3538944
buffer_load_dwordx4 v66,s[16:19],s75 offen  lds
v_add_u32 v63,65536,v60
ds_read_b64_tr_b16 a[80:81],v63 offset:0
ds_read_b64_tr_b16 a[82:83],v63 offset:512
ds_read_b64_tr_b16 a[84:85],v63 offset:8192
ds_read_b64_tr_b16 a[86:87],v63 offset:8704
v_add_u32 v63,65536,v61
ds_read_b64_tr_b16 a[88:89],v63 offset:0
ds_read_b64_tr_b16 a[90:91],v63 offset:512
ds_read_b64_tr_b16 a[92:93],v63 offset:8192
ds_read_b64_tr_b16 a[94:95],v63 offset:8704
s_waitcnt vmcnt(28)
s_waitcnt lgkmcnt(0)
s_barrier
s_mov_b32 m0,68608
s_add_u32 s75,s76,4194304
buffer_load_dwordx4 v66,s[16:19],s75 offen  lds
s_mov_b32 m0,72704
s_add_u32 s75,s76,4325376
buffer_load_dwordx4 v66,s[16:19],s75 offen  lds
s_mov_b32 m0,76800
s_add_u32 s75,s76,4456448
buffer_load_dwordx4 v66,s[16:19],s75 offen  lds
s_mov_b32 m0,80896
s_add_u32 s75,s76,4587520
buffer_load_dwordx4 v66,s[16:19],s75 offen  lds
v_add_u32 v63,81920,v60
ds_read_b64_tr_b16 a[32:33],v63 offset:0
ds_read_b64_tr_b16 a[34:35],v63 offset:512
ds_read_b64_tr_b16 a[36:37],v63 offset:8192
ds_read_b64_tr_b16 a[38:39],v63 offset:8704
v_add_u32 v63,81920,v61
ds_read_b64_tr_b16 a[40:41],v63 offset:0
ds_read_b64_tr_b16 a[42:43],v63 offset:512
ds_read_b64_tr_b16 a[44:45],v63 offset:8192
ds_read_b64_tr_b16 a[46:47],v63 offset:8704
s_waitcnt vmcnt(28)
s_waitcnt lgkmcnt(0)
s_barrier
s_mov_b32 m0,84992
s_add_u32 s75,s76,1048576
buffer_load_dwordx4 v66,s[20:23],s75 offen  lds
s_mov_b32 m0,89088
s_add_u32 s75,s76,1179648
buffer_load_dwordx4 v66,s[20:23],s75 offen  lds
s_mov_b32 m0,93184
s_add_u32 s75,s76,1310720
buffer_load_dwordx4 v66,s[20:23],s75 offen  lds
s_mov_b32 m0,97280
s_add_u32 s75,s76,1441792
buffer_load_dwordx4 v66,s[20:23],s75 offen  lds
v_add_u32 v63,98304,v60
ds_read_b64_tr_b16 a[48:49],v63 offset:0
ds_read_b64_tr_b16 a[50:51],v63 offset:512
ds_read_b64_tr_b16 a[52:53],v63 offset:8192
ds_read_b64_tr_b16 a[54:55],v63 offset:8704
v_add_u32 v63,98304,v61
ds_read_b64_tr_b16 a[56:57],v63 offset:0
ds_read_b64_tr_b16 a[58:59],v63 offset:512
ds_read_b64_tr_b16 a[60:61],v63 offset:8192
ds_read_b64_tr_b16 a[62:63],v63 offset:8704
s_waitcnt vmcnt(28)
s_waitcnt lgkmcnt(0)
s_barrier
s_mov_b32 m0,101376
s_add_u32 s75,s76,1572864
buffer_load_dwordx4 v66,s[20:23],s75 offen  lds
s_mov_b32 m0,105472
s_add_u32 s75,s76,1703936
buffer_load_dwordx4 v66,s[20:23],s75 offen  lds
s_mov_b32 m0,109568
s_add_u32 s75,s76,1835008
buffer_load_dwordx4 v66,s[20:23],s75 offen  lds
s_mov_b32 m0,113664
s_add_u32 s75,s76,1966080
buffer_load_dwordx4 v66,s[20:23],s75 offen  lds
v_add_u32 v63,114688,v60
ds_read_b64_tr_b16 a[0:1],v63 offset:0
ds_read_b64_tr_b16 a[2:3],v63 offset:512
ds_read_b64_tr_b16 a[4:5],v63 offset:8192
ds_read_b64_tr_b16 a[6:7],v63 offset:8704
v_add_u32 v63,114688,v61
ds_read_b64_tr_b16 a[8:9],v63 offset:0
ds_read_b64_tr_b16 a[10:11],v63 offset:512
ds_read_b64_tr_b16 a[12:13],v63 offset:8192
ds_read_b64_tr_b16 a[14:15],v63 offset:8704
s_waitcnt vmcnt(28)
s_waitcnt lgkmcnt(0)
s_barrier
s_mov_b32 m0,117760
s_add_u32 s75,s76,2097152
buffer_load_dwordx4 v66,s[20:23],s75 offen  lds
s_mov_b32 m0,121856
s_add_u32 s75,s76,2228224
buffer_load_dwordx4 v66,s[20:23],s75 offen  lds
s_mov_b32 m0,125952
s_add_u32 s75,s76,2359296
buffer_load_dwordx4 v66,s[20:23],s75 offen  lds
s_mov_b32 m0,130048
s_add_u32 s75,s76,2490368
buffer_load_dwordx4 v66,s[20:23],s75 offen  lds
v_add_u32 v63,131072,v60
ds_read_b64_tr_b16 a[16:17],v63 offset:0
ds_read_b64_tr_b16 a[18:19],v63 offset:512
ds_read_b64_tr_b16 a[20:21],v63 offset:8192
ds_read_b64_tr_b16 a[22:23],v63 offset:8704
v_add_u32 v63,131072,v61
ds_read_b64_tr_b16 a[24:25],v63 offset:0
ds_read_b64_tr_b16 a[26:27],v63 offset:512
ds_read_b64_tr_b16 a[28:29],v63 offset:8192
ds_read_b64_tr_b16 a[30:31],v63 offset:8704
s_waitcnt vmcnt(28)
s_waitcnt lgkmcnt(0)
s_barrier
s_mov_b32 m0,134144
s_add_u32 s75,s76,2621440
buffer_load_dwordx4 v66,s[20:23],s75 offen  lds
s_mov_b32 m0,138240
s_add_u32 s75,s76,2752512
buffer_load_dwordx4 v66,s[20:23],s75 offen  lds
s_mov_b32 m0,142336
s_add_u32 s75,s76,2883584
buffer_load_dwordx4 v66,s[20:23],s75 offen  lds
s_mov_b32 m0,146432
s_add_u32 s75,s76,3014656
buffer_load_dwordx4 v66,s[20:23],s75 offen  lds
v_add_u32 v63,147456,v60
ds_read_b64_tr_b16 a[176:177],v63 offset:0
ds_read_b64_tr_b16 a[178:179],v63 offset:512
ds_read_b64_tr_b16 a[180:181],v63 offset:8192
ds_read_b64_tr_b16 a[182:183],v63 offset:8704
v_add_u32 v63,147456,v61
ds_read_b64_tr_b16 a[184:185],v63 offset:0
ds_read_b64_tr_b16 a[186:187],v63 offset:512
ds_read_b64_tr_b16 a[188:189],v63 offset:8192
ds_read_b64_tr_b16 a[190:191],v63 offset:8704
s_waitcnt vmcnt(28)
s_waitcnt lgkmcnt(0)
s_barrier
s_mov_b32 m0,150528
s_add_u32 s75,s76,3145728
buffer_load_dwordx4 v66,s[20:23],s75 offen  lds
s_mov_b32 m0,154624
s_add_u32 s75,s76,3276800
buffer_load_dwordx4 v66,s[20:23],s75 offen  lds
s_mov_b32 m0,158720
s_add_u32 s75,s76,3407872
buffer_load_dwordx4 v66,s[20:23],s75 offen  lds
s_mov_b32 m0,162816
s_add_u32 s75,s76,3538944
buffer_load_dwordx4 v66,s[20:23],s75 offen  lds
v_add_u32 v63,16384,v60
ds_read_b64_tr_b16 a[160:161],v63 offset:0
ds_read_b64_tr_b16 a[162:163],v63 offset:512
ds_read_b64_tr_b16 a[164:165],v63 offset:8192
ds_read_b64_tr_b16 a[166:167],v63 offset:8704
v_add_u32 v63,16384,v61
ds_read_b64_tr_b16 a[168:169],v63 offset:0
ds_read_b64_tr_b16 a[170:171],v63 offset:512
ds_read_b64_tr_b16 a[172:173],v63 offset:8192
ds_read_b64_tr_b16 a[174:175],v63 offset:8704
s_waitcnt vmcnt(28)
s_waitcnt lgkmcnt(0)
s_barrier
s_mov_b32 m0,19456
s_add_u32 s75,s76,3670016
buffer_load_dwordx4 v66,s[20:23],s75 offen  lds
s_mov_b32 m0,23552
s_add_u32 s75,s76,3801088
buffer_load_dwordx4 v66,s[20:23],s75 offen  lds
s_mov_b32 m0,27648
s_add_u32 s75,s76,3932160
buffer_load_dwordx4 v66,s[20:23],s75 offen  lds
s_mov_b32 m0,31744
s_add_u32 s75,s76,4063232
buffer_load_dwordx4 v66,s[20:23],s75 offen  lds
v_add_u32 v63,32768,v60
ds_read_b64_tr_b16 a[144:145],v63 offset:0
ds_read_b64_tr_b16 a[146:147],v63 offset:512
ds_read_b64_tr_b16 a[148:149],v63 offset:8192
ds_read_b64_tr_b16 a[150:151],v63 offset:8704
v_add_u32 v63,32768,v61
ds_read_b64_tr_b16 a[152:153],v63 offset:0
ds_read_b64_tr_b16 a[154:155],v63 offset:512
ds_read_b64_tr_b16 a[156:157],v63 offset:8192
ds_read_b64_tr_b16 a[158:159],v63 offset:8704
s_waitcnt vmcnt(28)
s_waitcnt lgkmcnt(0)
s_barrier
s_mov_b32 m0,35840
s_add_u32 s75,s76,4194304
buffer_load_dwordx4 v66,s[20:23],s75 offen  lds
s_mov_b32 m0,39936
s_add_u32 s75,s76,4325376
buffer_load_dwordx4 v66,s[20:23],s75 offen  lds
s_mov_b32 m0,44032
s_add_u32 s75,s76,4456448
buffer_load_dwordx4 v66,s[20:23],s75 offen  lds
s_mov_b32 m0,48128
s_add_u32 s75,s76,4587520
buffer_load_dwordx4 v66,s[20:23],s75 offen  lds
v_add_u32 v63,49152,v60
ds_read_b64_tr_b16 a[128:129],v63 offset:0
ds_read_b64_tr_b16 a[130:131],v63 offset:512
ds_read_b64_tr_b16 a[132:133],v63 offset:8192
ds_read_b64_tr_b16 a[134:135],v63 offset:8704
v_add_u32 v63,49152,v61
ds_read_b64_tr_b16 a[136:137],v63 offset:0
ds_read_b64_tr_b16 a[138:139],v63 offset:512
ds_read_b64_tr_b16 a[140:141],v63 offset:8192
ds_read_b64_tr_b16 a[142:143],v63 offset:8704
s_waitcnt vmcnt(28)
s_waitcnt lgkmcnt(0)
s_barrier
s_mov_b32 m0,55296
s_add_u32 s75,s77,55296
buffer_load_dwordx4 v67,s[24:27],s75 offen  lds
s_mov_b32 m0,56320
s_add_u32 s75,s77,64512
buffer_load_dwordx4 v67,s[24:27],s75 offen  lds
s_mov_b32 m0,63488
s_add_u32 s75,s77,129024
buffer_load_dwordx4 v67,s[24:27],s75 offen  lds
s_mov_b32 m0,64512
s_add_u32 s75,s77,138240
buffer_load_dwordx4 v67,s[24:27],s75 offen  lds
v_add_u32 v63,65536,v60
ds_read_b64_tr_b16 a[192:193],v63 offset:0
ds_read_b64_tr_b16 a[194:195],v63 offset:512
ds_read_b64_tr_b16 a[196:197],v63 offset:8192
ds_read_b64_tr_b16 a[198:199],v63 offset:8704
v_add_u32 v63,65536,v61
ds_read_b64_tr_b16 a[200:201],v63 offset:0
ds_read_b64_tr_b16 a[202:203],v63 offset:512
ds_read_b64_tr_b16 a[204:205],v63 offset:8192
ds_read_b64_tr_b16 a[206:207],v63 offset:8704
s_waitcnt vmcnt(28)
s_waitcnt lgkmcnt(0)
s_barrier
s_mov_b32 m0,71680
s_add_u32 s75,s77,55424
buffer_load_dwordx4 v67,s[24:27],s75 offen  lds
s_mov_b32 m0,72704
s_add_u32 s75,s77,64640
buffer_load_dwordx4 v67,s[24:27],s75 offen  lds
s_mov_b32 m0,79872
s_add_u32 s75,s77,129152
buffer_load_dwordx4 v67,s[24:27],s75 offen  lds
s_mov_b32 m0,80896
s_add_u32 s75,s77,138368
buffer_load_dwordx4 v67,s[24:27],s75 offen  lds
v_add_u32 v63,81920,v60
ds_read_b64_tr_b16 a[208:209],v63 offset:0
ds_read_b64_tr_b16 a[210:211],v63 offset:512
ds_read_b64_tr_b16 a[212:213],v63 offset:8192
ds_read_b64_tr_b16 a[214:215],v63 offset:8704
v_add_u32 v63,81920,v61
ds_read_b64_tr_b16 a[216:217],v63 offset:0
ds_read_b64_tr_b16 a[218:219],v63 offset:512
ds_read_b64_tr_b16 a[220:221],v63 offset:8192
ds_read_b64_tr_b16 a[222:223],v63 offset:8704
s_waitcnt vmcnt(28)
s_waitcnt lgkmcnt(0)
s_barrier
s_mov_b32 m0,88064
s_add_u32 s75,s77,55552
buffer_load_dwordx4 v67,s[24:27],s75 offen  lds
s_mov_b32 m0,89088
s_add_u32 s75,s77,64768
buffer_load_dwordx4 v67,s[24:27],s75 offen  lds
s_mov_b32 m0,96256
s_add_u32 s75,s77,129280
buffer_load_dwordx4 v67,s[24:27],s75 offen  lds
s_mov_b32 m0,97280
s_add_u32 s75,s77,138496
buffer_load_dwordx4 v67,s[24:27],s75 offen  lds
v_add_u32 v63,98304,v60
ds_read_b64_tr_b16 a[224:225],v63 offset:0
ds_read_b64_tr_b16 a[226:227],v63 offset:512
ds_read_b64_tr_b16 a[228:229],v63 offset:8192
ds_read_b64_tr_b16 a[230:231],v63 offset:8704
v_add_u32 v63,98304,v61
ds_read_b64_tr_b16 a[232:233],v63 offset:0
ds_read_b64_tr_b16 a[234:235],v63 offset:512
ds_read_b64_tr_b16 a[236:237],v63 offset:8192
ds_read_b64_tr_b16 a[238:239],v63 offset:8704
s_waitcnt vmcnt(28)
s_waitcnt lgkmcnt(0)
s_barrier
s_mov_b32 m0,104448
s_add_u32 s75,s77,55680
buffer_load_dwordx4 v67,s[24:27],s75 offen  lds
s_mov_b32 m0,105472
s_add_u32 s75,s77,64896
buffer_load_dwordx4 v67,s[24:27],s75 offen  lds
s_mov_b32 m0,112640
s_add_u32 s75,s77,129408
buffer_load_dwordx4 v67,s[24:27],s75 offen  lds
s_mov_b32 m0,113664
s_add_u32 s75,s77,138624
buffer_load_dwordx4 v67,s[24:27],s75 offen  lds
v_add_u32 v63,114688,v60
ds_read_b64_tr_b16 a[240:241],v63 offset:0
ds_read_b64_tr_b16 a[242:243],v63 offset:512
ds_read_b64_tr_b16 a[244:245],v63 offset:8192
ds_read_b64_tr_b16 a[246:247],v63 offset:8704
v_add_u32 v63,114688,v61
ds_read_b64_tr_b16 a[248:249],v63 offset:0
ds_read_b64_tr_b16 a[250:251],v63 offset:512
ds_read_b64_tr_b16 a[252:253],v63 offset:8192
ds_read_b64_tr_b16 a[254:255],v63 offset:8704
s_waitcnt vmcnt(28)
s_waitcnt lgkmcnt(0)
s_barrier
s_mov_b32 m0,120832
s_add_u32 s75,s77,55808
buffer_load_dwordx4 v67,s[24:27],s75 offen  lds
s_mov_b32 m0,121856
s_add_u32 s75,s77,65024
buffer_load_dwordx4 v67,s[24:27],s75 offen  lds
s_mov_b32 m0,129024
s_add_u32 s75,s77,129536
buffer_load_dwordx4 v67,s[24:27],s75 offen  lds
s_mov_b32 m0,130048
s_add_u32 s75,s77,138752
buffer_load_dwordx4 v67,s[24:27],s75 offen  lds
v_add_u32 v63,131072,v60
ds_read_b64_tr_b16 v[80:81],v63 offset:0
ds_read_b64_tr_b16 v[82:83],v63 offset:512
ds_read_b64_tr_b16 v[84:85],v63 offset:8192
ds_read_b64_tr_b16 v[86:87],v63 offset:8704
v_add_u32 v63,131072,v61
ds_read_b64_tr_b16 v[88:89],v63 offset:0
ds_read_b64_tr_b16 v[90:91],v63 offset:512
ds_read_b64_tr_b16 v[92:93],v63 offset:8192
ds_read_b64_tr_b16 v[94:95],v63 offset:8704
s_waitcnt vmcnt(28)
s_waitcnt lgkmcnt(0)
s_barrier
s_mov_b32 m0,137216
s_add_u32 s75,s77,55936
buffer_load_dwordx4 v67,s[24:27],s75 offen  lds
s_mov_b32 m0,138240
s_add_u32 s75,s77,65152
buffer_load_dwordx4 v67,s[24:27],s75 offen  lds
s_mov_b32 m0,145408
s_add_u32 s75,s77,129664
buffer_load_dwordx4 v67,s[24:27],s75 offen  lds
s_mov_b32 m0,146432
s_add_u32 s75,s77,138880
buffer_load_dwordx4 v67,s[24:27],s75 offen  lds
v_add_u32 v63,147456,v60
ds_read_b64_tr_b16 v[96:97],v63 offset:0
ds_read_b64_tr_b16 v[98:99],v63 offset:512
ds_read_b64_tr_b16 v[100:101],v63 offset:8192
ds_read_b64_tr_b16 v[102:103],v63 offset:8704
v_add_u32 v63,147456,v61
ds_read_b64_tr_b16 v[104:105],v63 offset:0
ds_read_b64_tr_b16 v[106:107],v63 offset:512
ds_read_b64_tr_b16 v[108:109],v63 offset:8192
ds_read_b64_tr_b16 v[110:111],v63 offset:8704
s_waitcnt vmcnt(28)
s_waitcnt lgkmcnt(0)
s_barrier
s_mov_b32 m0,153600
s_add_u32 s75,s77,56064
buffer_load_dwordx4 v67,s[24:27],s75 offen  lds
s_mov_b32 m0,154624
s_add_u32 s75,s77,65280
buffer_load_dwordx4 v67,s[24:27],s75 offen  lds
s_mov_b32 m0,161792
s_add_u32 s75,s77,129792
buffer_load_dwordx4 v67,s[24:27],s75 offen  lds
s_mov_b32 m0,162816
s_add_u32 s75,s77,139008
buffer_load_dwordx4 v67,s[24:27],s75 offen  lds
v_add_u32 v63,16384,v60
ds_read_b64_tr_b16 v[112:113],v63 offset:0
ds_read_b64_tr_b16 v[114:115],v63 offset:512
ds_read_b64_tr_b16 v[116:117],v63 offset:8192
ds_read_b64_tr_b16 v[118:119],v63 offset:8704
v_add_u32 v63,16384,v61
ds_read_b64_tr_b16 v[120:121],v63 offset:0
ds_read_b64_tr_b16 v[122:123],v63 offset:512
ds_read_b64_tr_b16 v[124:125],v63 offset:8192
ds_read_b64_tr_b16 v[126:127],v63 offset:8704
s_waitcnt vmcnt(28)
s_waitcnt lgkmcnt(0)
s_barrier
s_mov_b32 m0,19456
s_add_u32 s75,s76,4194304
buffer_load_dwordx4 v66,s[12:15],s75 offen  lds
s_mov_b32 m0,23552
s_add_u32 s75,s76,4325376
buffer_load_dwordx4 v66,s[12:15],s75 offen  lds
s_mov_b32 m0,27648
s_add_u32 s75,s76,4456448
buffer_load_dwordx4 v66,s[12:15],s75 offen  lds
s_mov_b32 m0,31744
s_add_u32 s75,s76,4587520
buffer_load_dwordx4 v66,s[12:15],s75 offen  lds
v_add_u32 v63,32768,v60
ds_read_b64_tr_b16 v[128:129],v63 offset:0
ds_read_b64_tr_b16 v[130:131],v63 offset:512
ds_read_b64_tr_b16 v[132:133],v63 offset:8192
ds_read_b64_tr_b16 v[134:135],v63 offset:8704
v_add_u32 v63,32768,v61
ds_read_b64_tr_b16 v[136:137],v63 offset:0
ds_read_b64_tr_b16 v[138:139],v63 offset:512
ds_read_b64_tr_b16 v[140:141],v63 offset:8192
ds_read_b64_tr_b16 v[142:143],v63 offset:8704
s_waitcnt vmcnt(28)
s_waitcnt lgkmcnt(0)
s_barrier
s_mov_b32 m0,35840
s_add_u32 s75,s76,0
buffer_load_dwordx4 v66,s[20:23],s75 offen  lds
s_mov_b32 m0,39936
s_add_u32 s75,s76,131072
buffer_load_dwordx4 v66,s[20:23],s75 offen  lds
s_mov_b32 m0,44032
s_add_u32 s75,s76,262144
buffer_load_dwordx4 v66,s[20:23],s75 offen  lds
s_mov_b32 m0,48128
s_add_u32 s75,s76,393216
buffer_load_dwordx4 v66,s[20:23],s75 offen  lds
v_add_u32 v63,49152,v62
ds_read_b64_tr_b16 v[144:145],v63 offset:0
ds_read_b64_tr_b16 v[146:147],v63 offset:256
ds_read_b64_tr_b16 v[148:149],v63 offset:1024
ds_read_b64_tr_b16 v[150:151],v63 offset:1280
v_add_u32 v63,49152,v62
ds_read_b64_tr_b16 v[152:153],v63 offset:8192
ds_read_b64_tr_b16 v[154:155],v63 offset:8448
ds_read_b64_tr_b16 v[156:157],v63 offset:9216
ds_read_b64_tr_b16 v[158:159],v63 offset:9472
s_waitcnt vmcnt(28)
s_waitcnt lgkmcnt(0)
s_barrier
s_mov_b32 m0,52224
s_add_u32 s75,s76,524288
buffer_load_dwordx4 v66,s[20:23],s75 offen  lds
s_mov_b32 m0,56320
s_add_u32 s75,s76,655360
buffer_load_dwordx4 v66,s[20:23],s75 offen  lds
s_mov_b32 m0,60416
s_add_u32 s75,s76,786432
buffer_load_dwordx4 v66,s[20:23],s75 offen  lds
s_mov_b32 m0,64512
s_add_u32 s75,s76,917504
buffer_load_dwordx4 v66,s[20:23],s75 offen  lds
v_add_u32 v63,65536,v62
ds_read_b64_tr_b16 v[160:161],v63 offset:0
ds_read_b64_tr_b16 v[162:163],v63 offset:256
ds_read_b64_tr_b16 v[164:165],v63 offset:1024
ds_read_b64_tr_b16 v[166:167],v63 offset:1280
v_add_u32 v63,65536,v62
ds_read_b64_tr_b16 v[168:169],v63 offset:8192
ds_read_b64_tr_b16 v[170:171],v63 offset:8448
ds_read_b64_tr_b16 v[172:173],v63 offset:9216
ds_read_b64_tr_b16 v[174:175],v63 offset:9472
s_waitcnt vmcnt(28)
s_waitcnt lgkmcnt(0)
s_barrier
s_mov_b32 m0,68608
s_add_u32 s75,s76,524288
buffer_load_dwordx4 v66,s[16:19],s75 offen  lds
s_mov_b32 m0,72704
s_add_u32 s75,s76,655360
buffer_load_dwordx4 v66,s[16:19],s75 offen  lds
s_mov_b32 m0,76800
s_add_u32 s75,s76,786432
buffer_load_dwordx4 v66,s[16:19],s75 offen  lds
s_mov_b32 m0,80896
s_add_u32 s75,s76,917504
buffer_load_dwordx4 v66,s[16:19],s75 offen  lds
v_add_u32 v63,81920,v62
ds_read_b64_tr_b16 v[176:177],v63 offset:0
ds_read_b64_tr_b16 v[178:179],v63 offset:256
ds_read_b64_tr_b16 v[180:181],v63 offset:1024
ds_read_b64_tr_b16 v[182:183],v63 offset:1280
v_add_u32 v63,81920,v62
ds_read_b64_tr_b16 v[184:185],v63 offset:8192
ds_read_b64_tr_b16 v[186:187],v63 offset:8448
ds_read_b64_tr_b16 v[188:189],v63 offset:9216
ds_read_b64_tr_b16 v[190:191],v63 offset:9472
s_waitcnt vmcnt(28)
s_waitcnt lgkmcnt(0)
s_barrier
s_mov_b32 m0,84992
s_add_u32 s75,s76,1572864
buffer_load_dwordx4 v66,s[16:19],s75 offen  lds
s_mov_b32 m0,89088
s_add_u32 s75,s76,1703936
buffer_load_dwordx4 v66,s[16:19],s75 offen  lds
s_mov_b32 m0,93184
s_add_u32 s75,s76,1835008
buffer_load_dwordx4 v66,s[16:19],s75 offen  lds
s_mov_b32 m0,97280
s_add_u32 s75,s76,1966080
buffer_load_dwordx4 v66,s[16:19],s75 offen  lds
v_add_u32 v63,98304,v62
ds_read_b64_tr_b16 v[192:193],v63 offset:0
ds_read_b64_tr_b16 v[194:195],v63 offset:256
ds_read_b64_tr_b16 v[196:197],v63 offset:1024
ds_read_b64_tr_b16 v[198:199],v63 offset:1280
v_add_u32 v63,98304,v62
ds_read_b64_tr_b16 v[200:201],v63 offset:8192
ds_read_b64_tr_b16 v[202:203],v63 offset:8448
ds_read_b64_tr_b16 v[204:205],v63 offset:9216
ds_read_b64_tr_b16 v[206:207],v63 offset:9472
s_waitcnt vmcnt(28)
s_waitcnt lgkmcnt(0)
s_barrier
s_mov_b32 m0,101376
s_add_u32 s75,s76,2621440
buffer_load_dwordx4 v66,s[16:19],s75 offen  lds
s_mov_b32 m0,105472
s_add_u32 s75,s76,2752512
buffer_load_dwordx4 v66,s[16:19],s75 offen  lds
s_mov_b32 m0,109568
s_add_u32 s75,s76,2883584
buffer_load_dwordx4 v66,s[16:19],s75 offen  lds
s_mov_b32 m0,113664
s_add_u32 s75,s76,3014656
buffer_load_dwordx4 v66,s[16:19],s75 offen  lds
v_add_u32 v63,114688,v62
ds_read_b64_tr_b16 v[208:209],v63 offset:0
ds_read_b64_tr_b16 v[210:211],v63 offset:256
ds_read_b64_tr_b16 v[212:213],v63 offset:1024
ds_read_b64_tr_b16 v[214:215],v63 offset:1280
v_add_u32 v63,114688,v62
ds_read_b64_tr_b16 v[216:217],v63 offset:8192
ds_read_b64_tr_b16 v[218:219],v63 offset:8448
ds_read_b64_tr_b16 v[220:221],v63 offset:9216
ds_read_b64_tr_b16 v[222:223],v63 offset:9472
s_waitcnt vmcnt(28)
s_waitcnt lgkmcnt(0)
s_barrier
s_mov_b32 m0,117760
s_add_u32 s75,s76,3670016
buffer_load_dwordx4 v66,s[16:19],s75 offen  lds
s_mov_b32 m0,121856
s_add_u32 s75,s76,3801088
buffer_load_dwordx4 v66,s[16:19],s75 offen  lds
s_mov_b32 m0,125952
s_add_u32 s75,s76,3932160
buffer_load_dwordx4 v66,s[16:19],s75 offen  lds
s_mov_b32 m0,130048
s_add_u32 s75,s76,4063232
buffer_load_dwordx4 v66,s[16:19],s75 offen  lds
v_add_u32 v63,131072,v62
ds_read_b64_tr_b16 v[224:225],v63 offset:0
ds_read_b64_tr_b16 v[226:227],v63 offset:256
ds_read_b64_tr_b16 v[228:229],v63 offset:1024
ds_read_b64_tr_b16 v[230:231],v63 offset:1280
v_add_u32 v63,131072,v62
ds_read_b64_tr_b16 v[232:233],v63 offset:8192
ds_read_b64_tr_b16 v[234:235],v63 offset:8448
ds_read_b64_tr_b16 v[236:237],v63 offset:9216
ds_read_b64_tr_b16 v[238:239],v63 offset:9472
s_waitcnt vmcnt(28)
s_waitcnt lgkmcnt(0)
s_barrier
s_mov_b32 m0,137216
s_add_u32 s75,s77,56192
buffer_load_dwordx4 v67,s[24:27],s75 offen  lds
s_mov_b32 m0,138240
s_add_u32 s75,s77,65408
buffer_load_dwordx4 v67,s[24:27],s75 offen  lds
s_mov_b32 m0,145408
s_add_u32 s75,s77,129920
buffer_load_dwordx4 v67,s[24:27],s75 offen  lds
s_mov_b32 m0,146432
s_add_u32 s75,s77,139136
buffer_load_dwordx4 v67,s[24:27],s75 offen  lds
v_add_u32 v63,147456,v62
ds_read_b64_tr_b16 v[240:241],v63 offset:0
ds_read_b64_tr_b16 v[242:243],v63 offset:256
ds_read_b64_tr_b16 v[244:245],v63 offset:1024
ds_read_b64_tr_b16 v[246:247],v63 offset:1280
v_add_u32 v63,147456,v62
ds_read_b64_tr_b16 v[248:249],v63 offset:8192
ds_read_b64_tr_b16 v[250:251],v63 offset:8448
ds_read_b64_tr_b16 v[252:253],v63 offset:9216
ds_read_b64_tr_b16 v[254:255],v63 offset:9472
s_waitcnt vmcnt(28)
s_waitcnt lgkmcnt(0)
s_barrier
s_mov_b32 m0,153600
s_add_u32 s75,s77,56320
buffer_load_dwordx4 v67,s[24:27],s75 offen  lds
s_mov_b32 m0,154624
s_add_u32 s75,s77,65536
buffer_load_dwordx4 v67,s[24:27],s75 offen  lds
s_mov_b32 m0,161792
s_add_u32 s75,s77,130048
buffer_load_dwordx4 v67,s[24:27],s75 offen  lds
s_mov_b32 m0,162816
s_add_u32 s75,s77,139264
buffer_load_dwordx4 v67,s[24:27],s75 offen  lds
v_add_u32 v63,16384,v60
ds_read_b64_tr_b16 v[28:29],v63 offset:0
ds_read_b64_tr_b16 v[30:31],v63 offset:512
ds_read_b64_tr_b16 v[32:33],v63 offset:8192
ds_read_b64_tr_b16 v[34:35],v63 offset:8704
v_add_u32 v63,16384,v61
ds_read_b64_tr_b16 v[36:37],v63 offset:0
ds_read_b64_tr_b16 v[38:39],v63 offset:512
ds_read_b64_tr_b16 v[40:41],v63 offset:8192
ds_read_b64_tr_b16 v[42:43],v63 offset:8704
s_waitcnt vmcnt(28)
s_waitcnt lgkmcnt(0)
s_barrier
v_add_u32 v63,0,v2
ds_write_b128 v63,v[28:31] offset:0
ds_write_b128 v63,v[32:35] offset:1024
ds_write_b128 v63,v[36:39] offset:2048
ds_write_b128 v63,v[40:43] offset:3072
v_add_u32 v63,32768,v60
ds_read_b64_tr_b16 v[12:13],v63 offset:0
ds_read_b64_tr_b16 v[14:15],v63 offset:512
ds_read_b64_tr_b16 v[16:17],v63 offset:8192
ds_read_b64_tr_b16 v[18:19],v63 offset:8704
v_add_u32 v63,32768,v61
ds_read_b64_tr_b16 v[20:21],v63 offset:0
ds_read_b64_tr_b16 v[22:23],v63 offset:512
ds_read_b64_tr_b16 v[24:25],v63 offset:8192
ds_read_b64_tr_b16 v[26:27],v63 offset:8704
s_waitcnt vmcnt(24)
s_waitcnt lgkmcnt(0)
s_barrier
v_bfe_u32 v64,v0,4,5
buffer_load_ubyte v68,v64,s[32:35],0 offen offset:128 sc1
v_mov_b32 v64,0
buffer_load_dword v69,v64,s[32:35],0 offen offset:160 sc1
v_add_u32 v63,16384,v2
ds_write_b128 v63,v[12:15] offset:0
ds_write_b128 v63,v[16:19] offset:1024
ds_write_b128 v63,v[20:23] offset:2048
ds_write_b128 v63,v[24:27] offset:3072
v_add_u32 v63,49152,v60
ds_read_b64_tr_b16 v[28:29],v63 offset:0
ds_read_b64_tr_b16 v[30:31],v63 offset:512
ds_read_b64_tr_b16 v[32:33],v63 offset:8192
ds_read_b64_tr_b16 v[34:35],v63 offset:8704
v_add_u32 v63,49152,v61
ds_read_b64_tr_b16 v[36:37],v63 offset:0
ds_read_b64_tr_b16 v[38:39],v63 offset:512
ds_read_b64_tr_b16 v[40:41],v63 offset:8192
ds_read_b64_tr_b16 v[42:43],v63 offset:8704
s_waitcnt vmcnt(22)
s_waitcnt lgkmcnt(0)
s_barrier
v_add_u32 v63,32768,v2
ds_write_b128 v63,v[28:31] offset:0
ds_write_b128 v63,v[32:35] offset:1024
ds_write_b128 v63,v[36:39] offset:2048
ds_write_b128 v63,v[40:43] offset:3072
v_add_u32 v63,65536,v60
ds_read_b64_tr_b16 v[12:13],v63 offset:0
ds_read_b64_tr_b16 v[14:15],v63 offset:512
ds_read_b64_tr_b16 v[16:17],v63 offset:8192
ds_read_b64_tr_b16 v[18:19],v63 offset:8704
v_add_u32 v63,65536,v61
ds_read_b64_tr_b16 v[20:21],v63 offset:0
ds_read_b64_tr_b16 v[22:23],v63 offset:512
ds_read_b64_tr_b16 v[24:25],v63 offset:8192
ds_read_b64_tr_b16 v[26:27],v63 offset:8704
s_waitcnt vmcnt(18)
s_waitcnt lgkmcnt(0)
s_barrier
v_add_u32 v63,49152,v2
ds_write_b128 v63,v[12:15] offset:0
ds_write_b128 v63,v[16:19] offset:1024
ds_write_b128 v63,v[20:23] offset:2048
ds_write_b128 v63,v[24:27] offset:3072
v_add_u32 v63,81920,v60
ds_read_b64_tr_b16 v[28:29],v63 offset:0
ds_read_b64_tr_b16 v[30:31],v63 offset:512
ds_read_b64_tr_b16 v[32:33],v63 offset:8192
ds_read_b64_tr_b16 v[34:35],v63 offset:8704
v_add_u32 v63,81920,v61
ds_read_b64_tr_b16 v[36:37],v63 offset:0
ds_read_b64_tr_b16 v[38:39],v63 offset:512
ds_read_b64_tr_b16 v[40:41],v63 offset:8192
ds_read_b64_tr_b16 v[42:43],v63 offset:8704
s_waitcnt vmcnt(14)
s_waitcnt lgkmcnt(0)
s_barrier
v_add_u32 v63,65536,v2
ds_write_b128 v63,v[28:31] offset:0
ds_write_b128 v63,v[32:35] offset:1024
ds_write_b128 v63,v[36:39] offset:2048
ds_write_b128 v63,v[40:43] offset:3072
v_add_u32 v63,98304,v60
ds_read_b64_tr_b16 v[12:13],v63 offset:0
ds_read_b64_tr_b16 v[14:15],v63 offset:512
ds_read_b64_tr_b16 v[16:17],v63 offset:8192
ds_read_b64_tr_b16 v[18:19],v63 offset:8704
v_add_u32 v63,98304,v61
ds_read_b64_tr_b16 v[20:21],v63 offset:0
ds_read_b64_tr_b16 v[22:23],v63 offset:512
ds_read_b64_tr_b16 v[24:25],v63 offset:8192
ds_read_b64_tr_b16 v[26:27],v63 offset:8704
s_waitcnt vmcnt(10)
s_waitcnt lgkmcnt(0)
s_barrier
v_add_u32 v63,81920,v2
ds_write_b128 v63,v[12:15] offset:0
ds_write_b128 v63,v[16:19] offset:1024
ds_write_b128 v63,v[20:23] offset:2048
ds_write_b128 v63,v[24:27] offset:3072
v_add_u32 v63,114688,v60
ds_read_b64_tr_b16 v[28:29],v63 offset:0
ds_read_b64_tr_b16 v[30:31],v63 offset:512
ds_read_b64_tr_b16 v[32:33],v63 offset:8192
ds_read_b64_tr_b16 v[34:35],v63 offset:8704
v_add_u32 v63,114688,v61
ds_read_b64_tr_b16 v[36:37],v63 offset:0
ds_read_b64_tr_b16 v[38:39],v63 offset:512
ds_read_b64_tr_b16 v[40:41],v63 offset:8192
ds_read_b64_tr_b16 v[42:43],v63 offset:8704
s_waitcnt vmcnt(6)
s_waitcnt lgkmcnt(0)
s_barrier
v_add_u32 v63,98304,v2
ds_write_b128 v63,v[28:31] offset:0
ds_write_b128 v63,v[32:35] offset:1024
ds_write_b128 v63,v[36:39] offset:2048
ds_write_b128 v63,v[40:43] offset:3072
v_add_u32 v63,131072,v62
ds_read_b64_tr_b16 v[12:13],v63 offset:0
ds_read_b64_tr_b16 v[14:15],v63 offset:256
ds_read_b64_tr_b16 v[16:17],v63 offset:1024
ds_read_b64_tr_b16 v[18:19],v63 offset:1280
v_add_u32 v63,131072,v62
ds_read_b64_tr_b16 v[20:21],v63 offset:8192
ds_read_b64_tr_b16 v[22:23],v63 offset:8448
ds_read_b64_tr_b16 v[24:25],v63 offset:9216
ds_read_b64_tr_b16 v[26:27],v63 offset:9472
s_waitcnt vmcnt(2)
s_waitcnt lgkmcnt(0)
s_barrier
v_add_u32 v63,114688,v2
ds_write_b128 v63,v[12:15] offset:0
ds_write_b128 v63,v[16:19] offset:1024
ds_write_b128 v63,v[20:23] offset:2048
ds_write_b128 v63,v[24:27] offset:3072
v_add_u32 v63,147456,v62
ds_read_b64_tr_b16 v[28:29],v63 offset:0
ds_read_b64_tr_b16 v[30:31],v63 offset:256
ds_read_b64_tr_b16 v[32:33],v63 offset:1024
ds_read_b64_tr_b16 v[34:35],v63 offset:1280
v_add_u32 v63,147456,v62
ds_read_b64_tr_b16 v[36:37],v63 offset:8192
ds_read_b64_tr_b16 v[38:39],v63 offset:8448
ds_read_b64_tr_b16 v[40:41],v63 offset:9216
ds_read_b64_tr_b16 v[42:43],v63 offset:9472
s_waitcnt lgkmcnt(0)
s_barrier
v_add_u32 v63,131072,v2
ds_write_b128 v63,v[28:31] offset:0
ds_write_b128 v63,v[32:35] offset:1024
ds_write_b128 v63,v[36:39] offset:2048
ds_write_b128 v63,v[40:43] offset:3072
s_waitcnt lgkmcnt(0)
s_barrier
s_branch Lr_prodone
Lr_mid:
s_cmp_lg_u32 s60,0
s_cbranch_scc1 Lr_c1
s_waitcnt vmcnt(36)
s_mov_b64 exec,1
ds_write_b32 v65,v64
s_mov_b64 exec,-1
s_waitcnt lgkmcnt(0)
Lr_c1:
s_barrier
ds_read_b32 v64,v65
s_waitcnt lgkmcnt(0)
v_readfirstlane_b32 s75,v64
s_barrier
s_bitcmp0_b32 s75,s61
s_cbranch_scc1 Lr_mine

s_waitcnt vmcnt(0)
s_barrier
v_lshrrev_b32 v11,4,v0
s_cmp_eq_u32 s75,-1
s_cbranch_scc1 Lr_none
s_ff0_i32_b32 s61,s75
s_branch Lr_try
Lr_none:
s_lshl_b32 s75,s60,6
v_add_u32 v0,s75,v11
s_cmp_eq_u32 s3,0
s_cbranch_scc1 L_par
s_branch L_p23
Lr_mine:
v_lshrrev_b32 v11,4,v0
s_mov_b32 s80,0x33333333
s_mov_b32 s81,0x33333333
v_mov_b32 v12,0xeeee
v_mov_b32 v13,0x4444
v_cndmask_b32 v1,v12,v13,s[80:81]
s_lshl_b32 s75,s60,12
s_add_u32 s75,s75,16384
v_add_u32 v2,s75,v0
s_lshl_b32 s75,s60,14
s_add_u32 s75,s75,49152
v_add_u32 v3,s75,v2
v_bfe_u32 v12,v11,2,2
v_and_b32 v13,1,v11
v_lshl_add_u32 v14,v12,1,v13
s_lshl_b32 s75,s60,11
v_add_u32 v4,s75,v0
s_lshl_b32 s75,s60,8
s_add_u32 s75,s75,8192
v_lshlrev_b32 v12,2,v11
v_add_u32 v9,s75,v12

v_and_b32 v12,31,v11
v_lshlrev_b32 v12,6,v12
v_lshrrev_b32 v13,5,v11
v_lshl_add_u32 v6,v13,24,v12

v_bfe_u32 v12,v11,3,1
v_lshrrev_b32 v13,4,v11
v_lshl_add_u32 v12,v12,4,v13
v_mul_u32_u24 v12,9216,v12
v_and_b32 v13,7,v11
v_lshl_add_u32 v5,v13,4,v12

v_bfe_u32 v12,v11,1,2
v_lshlrev_b32 v12,5,v12
v_and_b32 v13,1,v11
v_lshl_add_u32 v12,v13,3,v12
v_bfe_u32 v13,v11,5,1
v_lshl_add_u32 v12,v13,4,v12
v_bfe_u32 v13,v11,4,1
v_lshl_add_u32 v12,v13,2,v12
v_mov_b32 v13,0x7ff00000
v_bfe_u32 v16,v11,3,1
v_cmp_eq_u32 vcc,0,v16
s_nop 1
v_cndmask_b32 v7,v13,v12,vcc
s_mul_i32 s78,s61,9216
s_sub_u32 s78,s78,8192
s_mul_i32 s75,s60,40
s_add_u32 s73,s75,s61
s_cmp_lt_u32 s60,2
s_cbranch_scc1 Lr_red_done
s_mov_b32 s73,-1
s_cmp_lg_u32 s60,2
s_cbranch_scc1 Lr_red_done
s_cmp_ge_u32 s61,8
s_cbranch_scc1 Lr_red_done
s_add_u32 s73,s61,32
Lr_red_done:
s_lshl_b32 s83,s73,7
s_cmp_eq_u32 s73,-1
s_cselect_b32 s83,0x40000000,s83
s_lshl_b32 s84,s60,10
s_add_u32 s84,s84,12288
s_lshl_b32 s85,s60,8
s_add_u32 s85,s85,10240
s_lshr_b32 s86,s60,1
s_lshl_b32 s86,s86,13
s_and_b32 s75,s60,1
s_lshl_b32 s75,s75,3
s_add_u32 s86,s86,s75
s_lshl_b32 s75,s61,13
s_lshl_b32 s76,s60,11
s_add_u32 s75,s75,s76
s_add_u32 s69,s75,16777216
s_add_u32 s70,s75,33554432
s_lshr_b32 s75,s75,1
s_add_u32 s71,s75,67108864
s_lshr_b32 s75,s75,1
s_add_u32 s72,s75,75497472
s_lshl_b32 s79,s61,7
s_add_u32 s79,s79,0
s_mov_b32 s64,983040
s_mov_b32 s65,999424
s_mov_b32 s66,1032192
s_mov_b32 s67,65536
s_mov_b32 s68,360448
s_mov_b32 s59,1
s_mov_b32 s91,0
s_mov_b32 s74,0x100000
s_mov_b32 s63,0
s_mov_b32 s87,0x3e0293ee
v_lshrrev_b32 v12,1,v14
v_lshrrev_b32 v13,4,v11
v_and_b32 v16,1,v14
v_lshlrev_b32 v16,4,v16
v_mov_b32 v17,0x3f80
v_lshlrev_b32 v16,v16,v17
v_cmp_eq_u32 vcc,v12,v13
v_mov_b32 v21,0
v_mov_b32 v22,0
v_cndmask_b32 v20,0,v16,vcc
v_mov_b32 v23,v20
ds_write_b128 v0,v[20:23] offset:9216
v_bfe_u32 v12,v11,3,1
v_lshlrev_b32 v12,4,v12
v_lshlrev_b32 v16,v12,v17
v_bfe_u32 v12,v11,2,1
v_and_b32 v13,3,v11
v_lshl_add_u32 v12,v12,1,v13
v_and_b32 v13,2,v13
v_lshl_add_u32 v12,v13,2,v12
v_cmp_eq_u32 vcc,0,v12
s_nop 1
v_cndmask_b32 v24,0,v16,vcc
v_cmp_eq_u32 vcc,1,v12
s_nop 1
v_cndmask_b32 v25,0,v16,vcc
v_cmp_eq_u32 vcc,2,v12
s_nop 1
v_cndmask_b32 v26,0,v16,vcc
v_cmp_eq_u32 vcc,3,v12
s_nop 1
v_cndmask_b32 v27,0,v16,vcc
ds_write_b128 v0,v[24:27] offset:11264
s_cmp_eq_u32 s60,3
s_cselect_b64 s[94:95],1,0
s_cmp_lg_u32 s61,0
s_cbranch_scc1 Lr_nomem0
s_lshl_b32 s75,s60,11
s_add_u32 s75,s75,s64
s_add_u32 s76,s64,8192
s_waitcnt vmcnt(36)
buffer_store_dwordx4 v[68:71],v0,s[8:11],s75 offen sc1
buffer_store_dwordx4 v[72:75],v0,s[8:11],s75 offen offset:1024 sc1
buffer_store_dwordx4 v[76:79],v0,s[8:11],s76 offen sc1
Lr_nomem0:
v_mov_b32 v12,-1
v_mov_b32 v13,-1
v_mov_b32 v14,-1
v_mov_b32 v15,-1
v_mov_b64 v[16:17],0
v_mov_b64 v[18:19],0
s_mov_b64 exec,s[94:95]
buffer_store_dword v16,v0,s[8:11],s79 offen sc1
s_mov_b64 exec,-1
s_cmp_eq_u32 s73,-1
s_cbranch_scc1 Lr_noarm
s_add_u32 s75,s83,s67
s_add_u32 s75,s75,0
buffer_store_dwordx4 v[16:19],v5,s[8:11],s75 offen sc1
s_add_u32 s75,s83,s67
s_add_u32 s75,s75,36864
buffer_store_dwordx4 v[16:19],v5,s[8:11],s75 offen sc1
s_add_u32 s75,s83,s67
s_add_u32 s75,s75,73728
buffer_store_dwordx4 v[16:19],v5,s[8:11],s75 offen sc1
s_add_u32 s75,s83,s67
s_add_u32 s75,s75,110592
buffer_store_dwordx4 v[16:19],v5,s[8:11],s75 offen sc1
s_add_u32 s75,s83,s68
s_add_u32 s75,s75,0
buffer_store_dwordx4 v[16:19],v5,s[8:11],s75 offen sc1
s_add_u32 s75,s83,s68
s_add_u32 s75,s75,36864
buffer_store_dwordx4 v[16:19],v5,s[8:11],s75 offen sc1
s_add_u32 s75,s83,s68
s_add_u32 s75,s75,73728
buffer_store_dwordx4 v[16:19],v5,s[8:11],s75 offen sc1
s_add_u32 s75,s83,s68
s_add_u32 s75,s75,110592
buffer_store_dwordx4 v[16:19],v5,s[8:11],s75 offen sc1
s_add_u32 s75,s83,s65
s_add_u32 s76,s75,16384
s_add_u32 s77,s75,32768
buffer_store_dword v12,v7,s[8:11],s75 offen sc1
buffer_store_dword v12,v7,s[8:11],s76 offen sc1
buffer_store_dword v12,v7,s[8:11],s77 offen sc1
Lr_noarm:
s_cmp_eq_u32 s60,1
s_cbranch_scc1 Lr_pro2_1
s_cmp_eq_u32 s60,2
s_cbranch_scc1 Lr_pro2_2
s_cmp_eq_u32 s60,3
s_cbranch_scc1 Lr_pro2_3
s_branch Lr_pro2_0
Lr_prodone:
v_bfe_u32 v10,v0,4,5
v_mov_b32 v12,0
s_mov_b32 s76,0x4000000
s_branch Lr_wchk
Lr_wbar:
buffer_load_ubyte v68,v10,s[32:35],0 offen offset:128 sc1
buffer_load_dword v69,v12,s[32:35],0 offen offset:160 sc1
s_sub_u32 s76,s76,1
s_cmp_eq_u32 s76,0
s_cbranch_scc1 Lr_exit
Lr_wchk:
s_waitcnt vmcnt(0)
v_min_u32 v11,v68,v69
v_cmp_eq_u32 vcc,0,v11
s_cbranch_vccnz Lr_wbar
s_add_u32 s75,s62,1
v_cmp_ne_u32 vcc,s75,v68
s_cbranch_vccnz Lr_slow
s_memrealtime s[96:97]
v_xor_b32 v11,16384,v3
ds_read_b128 v[44:47],v3 offset:0
ds_read_b128 v[48:51],v3 offset:1024
ds_read_b128 v[52:55],v3 offset:2048
ds_read_b128 v[56:59],v3 offset:3072
ds_read_b128 v[60:63],v11 offset:0
ds_read_b128 v[64:67],v11 offset:1024
ds_read_b128 v[68:71],v11 offset:2048
ds_read_b128 v[72:75],v11 offset:3072
ds_read_b128 v[76:79],v0 offset:9216
v_mov_b64 v[12:13],0
v_mov_b64 v[14:15],0
v_mov_b64 v[16:17],0
v_mov_b64 v[18:19],0
v_mov_b64 v[20:21],0
v_mov_b64 v[22:23],0
v_mov_b64 v[24:25],0
v_mov_b64 v[26:27],0
Lrf_pollB:
s_add_u32 s75,s63,1
s_mov_b32 s58,0
s_cmp_ge_u32 s75,s91
s_cbranch_scc1 Lrf_kvwait
Lrf_kvok:
buffer_load_dwordx4 v[28:31],v4,s[8:11],s64 offen sc1
buffer_load_dwordx4 v[32:35],v4,s[8:11],s64 offen offset:1024 sc1
buffer_load_dword v8,v9,s[8:11],s64 offen sc1
Lrf_top:
s_waitcnt vmcnt(2)
v_max3_u32 v10,v28,v29,v30
v_max_u32 v10,v10,v31
v_smfmac_f32_16x16x64_bf16 v[12:15],v[28:31],a[0:7],v1
s_waitcnt vmcnt(1)
v_max3_u32 v10,v10,v32,v33
v_smfmac_f32_16x16x64_bf16 v[16:19],v[28:31],a[8:15],v1
s_waitcnt vmcnt(0)
v_max3_u32 v11,v34,v35,v8
v_max_u32 v10,v10,v11
v_cmp_eq_u32 vcc,-1,v10
v_smfmac_f32_16x16x64_bf16 v[20:23],v[28:31],a[128:135],v1
s_cbranch_vccnz Lrf_retryB
Lrf_gotB:
v_smfmac_f32_16x16x64_bf16 v[24:27],v[28:31],a[136:143],v1
ds_write_b128 v4,v[28:31]
v_xor_b32 v10,2048,v4
v_smfmac_f32_16x16x64_bf16 v[12:15],v[32:35],a[16:23],v1
ds_write_b128 v4,v[32:35] offset:1024
v_xor_b32 v11,4096,v4
v_smfmac_f32_16x16x64_bf16 v[16:19],v[32:35],a[24:31],v1
ds_write_b32 v9,v8
s_waitcnt vmcnt(0) lgkmcnt(0)
s_barrier
ds_read_b128 v[36:39],v10 offset:0
v_smfmac_f32_16x16x64_bf16 v[20:23],v[32:35],v[44:51],v1
ds_read_b128 v[40:43],v10 offset:1024
v_smfmac_f32_16x16x64_bf16 v[24:27],v[32:35],v[52:59],v1
ds_read_b128 v[28:31],v0 offset:8192
s_waitcnt lgkmcnt(2)
v_smfmac_f32_16x16x64_bf16 v[12:15],v[36:39],a[32:39],v1
ds_read_b128 v[32:35],v11 offset:0
v_smfmac_f32_16x16x64_bf16 v[16:19],v[36:39],a[40:47],v1
ds_read_b128 v[44:47],v2 offset:0
s_waitcnt lgkmcnt(3)
v_smfmac_f32_16x16x64_bf16 v[12:15],v[40:43],a[48:55],v1
ds_read_b128 v[48:51],v2 offset:1024
v_smfmac_f32_16x16x64_bf16 v[16:19],v[40:43],a[56:63],v1
ds_read_b128 v[52:55],v2 offset:2048
v_smfmac_f32_16x16x64_bf16 v[20:23],v[36:39],a[144:151],v1
ds_read_b128 v[56:59],v2 offset:3072
v_smfmac_f32_16x16x64_bf16 v[24:27],v[36:39],a[152:159],v1
ds_read_b128 v[36:39],v11 offset:1024
v_xor_b32 v11,6144,v4
v_smfmac_f32_16x16x64_bf16 v[20:23],v[40:43],v[60:67],v1
buffer_load_dwordx4 v[60:63],v0,s[8:11],s69 offen sc1
v_smfmac_f32_16x16x64_bf16 v[24:27],v[40:43],v[68:75],v1
ds_read_b128 v[40:43],v11 offset:0
v_xor_b32 v10,32768,v3
s_waitcnt lgkmcnt(2)
v_smfmac_f32_16x16x64_bf16 v[12:15],v[28:31],v[44:51],v1
buffer_load_dwordx4 v[64:67],v0,s[8:11],s69 offen offset:1024 sc1
v_smfmac_f32_16x16x64_bf16 v[16:19],v[28:31],v[52:59],v1
ds_read_b128 v[44:47],v10 offset:0
v_smfmac_f32_16x16x64_bf16 v[12:15],v[32:35],a[64:71],v1
ds_read_b128 v[48:51],v10 offset:1024
v_smfmac_f32_16x16x64_bf16 v[16:19],v[32:35],a[72:79],v1
ds_read_b128 v[52:55],v10 offset:2048
s_waitcnt lgkmcnt(4)
v_smfmac_f32_16x16x64_bf16 v[12:15],v[36:39],a[80:87],v1
ds_read_b128 v[56:59],v10 offset:3072
v_xor_b32 v10,49152,v3
v_smfmac_f32_16x16x64_bf16 v[16:19],v[36:39],a[88:95],v1
buffer_load_dwordx4 v[68:71],v0,s[8:11],s70 offen sc1
v_smfmac_f32_16x16x64_bf16 v[20:23],v[32:35],a[160:167],v1
buffer_load_dwordx4 v[72:75],v0,s[8:11],s70 offen offset:1024 sc1
v_smfmac_f32_16x16x64_bf16 v[24:27],v[32:35],a[168:175],v1
ds_read_b128 v[32:35],v11 offset:1024
s_waitcnt lgkmcnt(5)
v_smfmac_f32_16x16x64_bf16 v[12:15],v[40:43],a[96:103],v1
s_add_u32 s69,s69,0x40000
s_add_u32 s70,s70,0x40000
v_smfmac_f32_16x16x64_bf16 v[16:19],v[40:43],a[104:111],v1
s_or_b32 s58,s58,s69
buffer_load_dword v8,v6,s[8:11],s58 offen sc1
s_waitcnt lgkmcnt(1)
v_smfmac_f32_16x16x64_bf16 v[20:23],v[36:39],v[44:51],v1
ds_read_b128 v[44:47],v10 offset:0
s_waitcnt lgkmcnt(1)
v_smfmac_f32_16x16x64_bf16 v[12:15],v[32:35],a[112:119],v1
ds_read_b128 v[48:51],v10 offset:1024
v_smfmac_f32_16x16x64_bf16 v[16:19],v[32:35],a[120:127],v1
v_add_u32 v11,s84,v0
v_smfmac_f32_16x16x64_bf16 v[24:27],v[36:39],v[52:59],v1
ds_read_b128 v[52:55],v10 offset:2048
v_smfmac_f32_16x16x64_bf16 v[20:23],v[40:43],a[176:183],v1
ds_read_b128 v[56:59],v10 offset:3072
v_smfmac_f32_16x16x64_bf16 v[24:27],v[40:43],a[184:191],v1
v_lshrrev_b32 v10,2,v0
v_mov_b64 v[40:41],0
v_mov_b32 v42,s63
v_smfmac_f32_16x16x64_bf16 v[20:23],v[28:31],a[192:199],v1
v_add_f32 v12,v12,v14
v_add_f32 v13,v13,v15
v_smfmac_f32_16x16x64_bf16 v[24:27],v[28:31],a[200:207],v1
v_add_f32 v16,v16,v18
v_add_f32 v17,v17,v19
s_waitcnt lgkmcnt(2)
v_smfmac_f32_16x16x64_bf16 v[20:23],v[32:35],v[44:51],v1
s_mov_b64 exec,s[94:95]
buffer_store_dword v42,v0,s[8:11],s79 offen sc1
s_mov_b64 exec,-1
v_cvt_pk_bf16_f32 v14,v12,v13
v_cvt_pk_bf16_f32 v15,v16,v17
s_waitcnt lgkmcnt(0)
v_smfmac_f32_16x16x64_bf16 v[24:27],v[32:35],v[52:59],v1
ds_read_b128 v[44:47],v2 offset:16384
v_mov_b64 v[42:43],0
v_mfma_f32_16x16x16_bf16 v[16:19],v[14:15],v[76:77],0
ds_read_b128 v[48:51],v2 offset:17408
v_mov_b64 v[32:33],0
v_mfma_f32_16x16x16_bf16 v[36:39],v[14:15],v[78:79],0
ds_read_b128 v[52:55],v2 offset:18432
v_mov_b64 v[34:35],0
v_add_f32 v20,v20,v22
v_add_f32 v21,v21,v23
v_add_f32 v24,v24,v26
v_add_f32 v25,v25,v27
v_cvt_pk_bf16_f32 v22,v20,v21
v_cvt_pk_bf16_f32 v23,v24,v25
v_cvt_pk_bf16_f32 v12,v16,v17
v_cvt_pk_bf16_f32 v13,v18,v19
v_mfma_f32_16x16x16_bf16 v[24:27],v[22:23],v[76:77],0
ds_read_b128 v[56:59],v2 offset:19456
v_cvt_pk_bf16_f32 v14,v36,v37
v_mfma_f32_16x16x16_bf16 v[76:79],v[22:23],v[78:79],0
v_cvt_pk_bf16_f32 v15,v38,v39
v_smfmac_f32_16x16x64_bf16 v[40:43],v[28:31],v[128:135],v1
s_waitcnt vmcnt(4)
v_mfma_f32_16x16x32_bf16 v[36:39],v[60:63],v[12:15],0
v_mfma_f32_16x16x32_bf16 v[16:19],v[64:67],v[12:15],0
v_add_u32 v65,s85,v10
v_cvt_pk_bf16_f32 v20,v24,v25
v_cvt_pk_bf16_f32 v21,v26,v27
v_cvt_pk_bf16_f32 v22,v76,v77
v_cvt_pk_bf16_f32 v23,v78,v79
v_smfmac_f32_16x16x64_bf16 v[32:35],v[28:31],v[136:143],v1
ds_read_b128 v[76:79],v0 offset:0
v_mfma_f32_16x16x32_bf16 v[24:27],v[20:23],v[12:15],0
ds_read_b128 v[28:31],v0 offset:2048
v_cndmask_b32 v60,v16,v36,s[80:81]
v_cndmask_b32 v61,v17,v37,s[80:81]
v_cndmask_b32 v62,v18,v38,s[80:81]
v_cndmask_b32 v63,v19,v39,s[80:81]
s_waitcnt lgkmcnt(1)
v_smfmac_f32_16x16x64_bf16 v[40:43],v[76:79],v[44:51],v1
ds_write_b128 v11,v[60:63]
v_cndmask_b32 v64,v25,v24,s[80:81]
v_smfmac_f32_16x16x64_bf16 v[32:35],v[76:79],v[52:59],v1
ds_write_b32 v65,v64
s_waitcnt lgkmcnt(2)
v_smfmac_f32_16x16x64_bf16 v[40:43],v[28:31],a[208:215],v1
ds_read_b128 v[36:39],v0 offset:3072
v_xor_b32 v11,1024,v11
v_smfmac_f32_16x16x64_bf16 v[32:35],v[28:31],a[216:223],v1
buffer_store_dwordx4 v[20:23],v0,s[8:11],s71 offen sc1
s_waitcnt lgkmcnt(1)
s_barrier
ds_read_b128 v[12:15],v11 offset:0
v_xor_b32 v11,3072,v11
s_waitcnt lgkmcnt(1)
v_smfmac_f32_16x16x64_bf16 v[40:43],v[36:39],a[224:231],v1
ds_read_b128 v[16:19],v11 offset:0
v_xor_b32 v11,1024,v11
v_smfmac_f32_16x16x64_bf16 v[32:35],v[36:39],a[232:239],v1
ds_read_b128 v[20:23],v11 offset:0
ds_read2st64_b32 v[24:25],v10 offset0:40 offset1:41
ds_read2st64_b32 v[26:27],v10 offset0:42 offset1:43
ds_read_b128 v[76:79],v0 offset:4096
ds_read_b128 v[28:31],v0 offset:5120
ds_read_b128 v[36:39],v0 offset:6144
s_waitcnt lgkmcnt(7)
v_add_f32 v60,v60,v12
v_add_f32 v61,v61,v13
v_add_f32 v62,v62,v14
v_add_f32 v63,v63,v15
s_waitcnt lgkmcnt(5)
v_add_f32 v16,v16,v20
v_add_f32 v17,v17,v21
v_add_f32 v18,v18,v22
v_add_f32 v19,v19,v23
s_waitcnt lgkmcnt(3)
v_add_f32 v24,v24,v25
v_add_f32 v26,v26,v27
v_add_f32 v12,v60,v16
v_add_f32 v13,v61,v17
v_add_f32 v14,v62,v18
v_add_f32 v15,v63,v19
v_add_f32 v60,v24,v26
v_max3_f32 v66,v12,v13,v14
v_max3_f32 v66,v66,v15,v60
s_waitcnt lgkmcnt(2)
v_smfmac_f32_16x16x64_bf16 v[40:43],v[76:79],a[240:247],v1
ds_read_b128 v[44:47],v2 offset:32768
v_max_f32_dpp v66,v66,v66 quad_perm:[2,3,0,1] row_mask:0xf bank_mask:0xf
v_mov_b32 v67,v66
v_smfmac_f32_16x16x64_bf16 v[32:35],v[76:79],a[248:255],v1
ds_read_b128 v[48:51],v2 offset:33792
v_permlane16_swap_b32 v66,v67
v_max_f32 v66,v66,v67
v_mov_b32 v67,v66
s_waitcnt lgkmcnt(3)
v_smfmac_f32_16x16x64_bf16 v[40:43],v[28:31],v[80:87],v1
ds_read_b128 v[76:79],v0 offset:7168
v_permlane32_swap_b32 v66,v67
v_max_f32 v66,v66,v67
v_smfmac_f32_16x16x64_bf16 v[32:35],v[28:31],v[88:95],v1
ds_read_b128 v[52:55],v2 offset:34816
v_mul_f32 v66,s87,v66
v_fma_f32 v12,v12,s87,-v66
v_fma_f32 v13,v13,s87,-v66
v_fma_f32 v14,v14,s87,-v66
v_fma_f32 v15,v15,s87,-v66
s_waitcnt lgkmcnt(4)
v_smfmac_f32_16x16x64_bf16 v[40:43],v[36:39],v[96:103],v1
ds_read_b128 v[56:59],v2 offset:35840
v_exp_f32 v12,v12
v_exp_f32 v13,v13
v_smfmac_f32_16x16x64_bf16 v[32:35],v[36:39],v[104:111],v1
ds_read_b128 v[28:31],v0 offset:1024
v_exp_f32 v14,v14
v_exp_f32 v15,v15
s_waitcnt lgkmcnt(3)
v_smfmac_f32_16x16x64_bf16 v[40:43],v[76:79],v[112:119],v1
v_cvt_pk_bf16_f32 v62,v12,v13
v_cvt_pk_bf16_f32 v63,v14,v15
v_smfmac_f32_16x16x64_bf16 v[32:35],v[76:79],v[120:127],v1
v_cndmask_b32 v20,0,v62,s[80:81]
v_cndmask_b32 v21,0,v63,s[80:81]
v_cndmask_b32 v26,v62,0,s[80:81]
v_cndmask_b32 v27,v63,0,s[80:81]
s_waitcnt lgkmcnt(0)
v_smfmac_f32_16x16x64_bf16 v[40:43],v[28:31],v[44:51],v1
v_mov_b32_dpp v24,v20 quad_perm:[2,3,0,1] row_mask:0xf bank_mask:0xf
v_smfmac_f32_16x16x64_bf16 v[32:35],v[28:31],v[52:59],v1
v_mov_b32_dpp v25,v21 quad_perm:[2,3,0,1] row_mask:0xf bank_mask:0xf
v_mov_b32_dpp v22,v26 quad_perm:[2,3,0,1] row_mask:0xf bank_mask:0xf
v_mov_b32_dpp v23,v27 quad_perm:[2,3,0,1] row_mask:0xf bank_mask:0xf
v_fma_f32 v60,v60,s87,-v66
s_waitcnt vmcnt(3)
v_mfma_f32_16x16x32_bf16 v[16:19],v[72:75],v[24:27],0
v_exp_f32 v60,v60
v_mfma_f32_16x16x32_bf16 v[16:19],v[68:71],v[20:23],v[16:19]
v_add_f32 v66,v12,v13
v_add_f32 v67,v14,v15
v_cvt_pk_bf16_f32 v61,v60,0
v_add_f32 v40,v40,v42
v_add_f32 v41,v41,v43
v_lshlrev_b32 v62,16,v61
v_add_f32 v32,v32,v34
v_add_f32 v33,v33,v35
v_cndmask_b32 v64,v62,v61,s[80:81]
v_add_f32 v66,v66,v67
v_mov_b64 v[14:15],0
v_or_b32_dpp v64,v64,v64 quad_perm:[2,3,0,1] row_mask:0xf bank_mask:0xf
v_add_f32 v66,v66,v60
v_cvt_pk_bf16_f32 v60,v40,v41
v_cvt_pk_bf16_f32 v61,v32,v33
v_cndmask_b32 v12,0,v64,s[80:81]
v_cndmask_b32 v13,v64,0,s[80:81]
v_add_f32_dpp v66,v66,v66 quad_perm:[2,3,0,1] row_mask:0xf bank_mask:0xf
v_lshrrev_b32 v10,1,v0
v_mfma_f32_16x16x32_bf16 v[16:19],v[60:63],v[12:15],v[16:19]
buffer_store_dwordx2 v[60:61],v10,s[8:11],s72 offen sc1
v_mov_b32 v67,v66
v_add_u32 v10,s86,v0
v_add_u32 v11,114688,v2
v_permlane16_swap_b32 v66,v67
v_add_f32 v66,v66,v67
v_mov_b32 v67,v66
s_cmp_eq_u32 s63,63
s_cbranch_scc1 Lrf_done
v_permlane32_swap_b32 v66,v67
v_add_f32 v66,v66,v67
v_rcp_f32 v66,v66
v_mov_b64 v[76:77],0
v_mul_f32 v16,v16,v66
v_mul_f32 v17,v17,v66
v_mul_f32 v18,v18,v66
v_mul_f32 v19,v19,v66
v_cvt_pk_bf16_f32 v62,v16,v17
v_cvt_pk_bf16_f32 v63,v18,v19
ds_write_b64 v10,v[62:63]
v_mov_b64 v[78:79],0
v_mov_b64 v[12:13],0
v_mov_b64 v[14:15],0
v_mov_b64 v[16:17],0
v_mov_b64 v[18:19],0
v_mov_b64 v[20:21],0
v_mov_b64 v[22:23],0
v_mov_b64 v[24:25],0
v_mov_b64 v[26:27],0
v_mov_b64 v[68:69],0
v_mov_b64 v[70:71],0
v_mov_b64 v[72:73],0
v_mov_b64 v[74:75],0
s_waitcnt lgkmcnt(0)
s_barrier
ds_read_b128 v[60:63],v0 offset:0
ds_read_b128 v[64:67],v0 offset:8192
ds_read_b128 v[44:47],v11 offset:0
ds_read_b128 v[48:51],v11 offset:1024
s_waitcnt lgkmcnt(3)
v_smfmac_f32_16x16x64_bf16 v[76:79],v[60:63],v[144:151],v1
s_add_u32 s75,s67,s78
s_add_u32 s71,s71,0x20000
ds_read_b128 v[52:55],v11 offset:2048
s_waitcnt lgkmcnt(3)
v_smfmac_f32_16x16x64_bf16 v[76:79],v[64:67],v[152:159],v1
s_add_u32 s76,s75,4096
s_add_u32 s72,s72,0x10000
ds_read_b128 v[56:59],v11 offset:3072
v_smfmac_f32_16x16x64_bf16 v[12:15],v[60:63],v[160:167],v1
s_add_u32 s77,s75,8192
s_add_u32 s98,s83,s67
ds_read_b128 v[28:31],v11 offset:16384
v_smfmac_f32_16x16x64_bf16 v[12:15],v[64:67],v[168:175],v1
s_add_u32 s99,s98,36864
s_add_u32 s100,s98,73728
ds_read_b128 v[32:35],v11 offset:17408
v_smfmac_f32_16x16x64_bf16 v[16:19],v[60:63],v[176:183],v1
s_add_u32 s101,s98,110592
s_add_u32 s82,s83,s65
ds_read_b128 v[36:39],v11 offset:18432
v_add_f32 v76,v76,v78
v_add_f32 v77,v77,v79
v_cvt_pk_bf16_f32 v76,v76,v77
v_smfmac_f32_16x16x64_bf16 v[16:19],v[64:67],v[184:191],v1
ds_read_b128 v[40:43],v11 offset:19456
v_bfi_b32 v76,1,s59,v76
v_add_f32 v12,v12,v14
v_add_f32 v13,v13,v15
v_smfmac_f32_16x16x64_bf16 v[20:23],v[60:63],v[192:199],v1
buffer_store_dword v76,v9,s[8:11],s75 offen offset:0
v_cvt_pk_bf16_f32 v12,v12,v13
v_bfi_b32 v12,1,s59,v12
v_smfmac_f32_16x16x64_bf16 v[20:23],v[64:67],v[200:207],v1
buffer_store_dword v12,v9,s[8:11],s75 offen offset:1024
v_mov_b64 v[76:77],0
v_mov_b64 v[78:79],0
v_add_f32 v16,v16,v18
v_smfmac_f32_16x16x64_bf16 v[24:27],v[60:63],v[208:215],v1
v_add_f32 v17,v17,v19
v_cvt_pk_bf16_f32 v16,v16,v17
v_bfi_b32 v16,1,s59,v16
v_smfmac_f32_16x16x64_bf16 v[24:27],v[64:67],v[216:223],v1
buffer_store_dword v16,v9,s[8:11],s75 offen offset:2048
v_mov_b64 v[12:13],0
v_mov_b64 v[14:15],0
v_add_f32 v20,v20,v22
v_smfmac_f32_16x16x64_bf16 v[68:71],v[60:63],v[224:231],v1
v_add_f32 v21,v21,v23
v_cvt_pk_bf16_f32 v20,v20,v21
v_bfi_b32 v20,1,s59,v20
v_smfmac_f32_16x16x64_bf16 v[68:71],v[64:67],v[232:239],v1
buffer_store_dword v20,v9,s[8:11],s75 offen offset:3072
v_add_f32 v24,v24,v26
v_add_f32 v25,v25,v27
v_smfmac_f32_16x16x64_bf16 v[72:75],v[60:63],v[240:247],v1
v_cvt_pk_bf16_f32 v24,v24,v25
v_bfi_b32 v24,1,s59,v24
v_smfmac_f32_16x16x64_bf16 v[72:75],v[64:67],v[248:255],v1
buffer_store_dword v24,v9,s[8:11],s76 offen offset:0
v_add_f32 v68,v68,v70
v_add_f32 v69,v69,v71
v_cvt_pk_bf16_f32 v68,v68,v69
s_waitcnt lgkmcnt(4)
v_smfmac_f32_16x16x64_bf16 v[76:79],v[60:63],v[44:51],v1
v_bfi_b32 v68,1,s59,v68
v_smfmac_f32_16x16x64_bf16 v[76:79],v[64:67],v[52:59],v1
buffer_store_dword v68,v9,s[8:11],s76 offen offset:1024
v_add_f32 v72,v72,v74
v_add_f32 v73,v73,v75
v_cvt_pk_bf16_f32 v72,v72,v73
v_bfi_b32 v72,1,s59,v72
s_waitcnt lgkmcnt(0)
v_smfmac_f32_16x16x64_bf16 v[12:15],v[60:63],v[28:35],v1
buffer_store_dword v72,v9,s[8:11],s76 offen offset:2048
v_smfmac_f32_16x16x64_bf16 v[12:15],v[64:67],v[36:43],v1
v_add_f32 v76,v76,v78
v_add_f32 v77,v77,v79
v_cvt_pk_bf16_f32 v76,v76,v77
v_bfi_b32 v76,1,s59,v76
buffer_store_dword v76,v9,s[8:11],s76 offen offset:3072
s_nop 2
v_add_f32 v12,v12,v14
v_add_f32 v13,v13,v15
v_cvt_pk_bf16_f32 v12,v12,v13
v_bfi_b32 v12,1,s59,v12
buffer_store_dword v12,v9,s[8:11],s77 offen offset:0
s_cmp_eq_u32 s73,-1
s_cbranch_scc1 Lrf_nored
ds_read_b128 v[68:71],v0 offset:11264
s_cmp_lg_u32 s60,1
s_cbranch_scc1 Lrf_pollA
s_sleep 4
Lrf_pollA:
buffer_load_dwordx4 v[28:31],v5,s[8:11],s98 offen sc1
buffer_load_dwordx4 v[32:35],v5,s[8:11],s99 offen sc1
buffer_load_dwordx4 v[36:39],v5,s[8:11],s100 offen sc1
buffer_load_dwordx4 v[40:43],v5,s[8:11],s101 offen sc1
s_mov_b32 s66,s64
s_mov_b32 s64,s65
s_add_u32 s65,s65,16384
s_and_b32 s65,s65,0xffff
s_or_b32 s65,s65,983040
s_mov_b32 s88,s67
s_mov_b32 s67,s68
s_mov_b32 s68,s88
s_mov_b32 s89,s59
s_add_u32 s63,s63,1
s_bfe_u32 s59,s63,0x10001
s_xor_b32 s59,s59,1
v_xor_b32 v11,16384,v3
ds_read_b128 v[44:47],v3 offset:0
ds_read_b128 v[48:51],v3 offset:1024
ds_read_b128 v[52:55],v3 offset:2048
ds_read_b128 v[56:59],v3 offset:3072
ds_read_b128 v[60:63],v11 offset:0
ds_read_b128 v[64:67],v11 offset:1024
ds_read_b128 v[76:79],v0 offset:9216
v_mov_b64 v[12:13],0
v_mov_b64 v[14:15],0
v_mov_b64 v[16:17],0
v_mov_b64 v[18:19],0
v_mov_b64 v[20:21],0
v_mov_b64 v[22:23],0
v_mov_b64 v[24:25],0
v_mov_b64 v[26:27],0
s_waitcnt lgkmcnt(7)
Lrf_chkA:
s_cmp_eq_u32 s89,0
s_cbranch_scc1 Lrf_chkA0
s_waitcnt vmcnt(3)
v_mfma_f32_16x16x32_bf16 v[72:75],v[68:71],v[28:31],0
v_bitop3_b32 v10,v28,v29,v30 bitop3:128
v_bitop3_b32 v10,v10,v31,1 bitop3:128
s_waitcnt vmcnt(2)
v_mfma_f32_16x16x32_bf16 v[72:75],v[68:71],v[32:35],v[72:75]
v_bitop3_b32 v10,v10,v32,v33 bitop3:128
v_bitop3_b32 v10,v10,v34,v35 bitop3:128
s_waitcnt vmcnt(1)
v_mfma_f32_16x16x32_bf16 v[72:75],v[68:71],v[36:39],v[72:75]
v_bitop3_b32 v10,v10,v36,v37 bitop3:128
v_bitop3_b32 v10,v10,v38,v39 bitop3:128
s_waitcnt vmcnt(0)
v_mfma_f32_16x16x32_bf16 v[72:75],v[68:71],v[40:43],v[72:75]
v_bitop3_b32 v10,v10,v40,v41 bitop3:128
v_bitop3_b32 v10,v10,v42,v43 bitop3:128
v_cmp_ne_u32 vcc,1,v10
s_cbranch_vccnz Lrf_failA1
Lrf_gotA:
s_nop 3
v_add_f32_dpp v72,v72,v72 row_ror:8 row_mask:0xf bank_mask:0xf
v_add_f32_dpp v73,v73,v73 row_ror:8 row_mask:0xf bank_mask:0xf
v_cvt_pk_bf16_f32 v72,v72,v73
buffer_store_dword v72,v7,s[8:11],s82 offen
s_add_u32 s75,s83,s66
v_mov_b32 v10,-1
buffer_store_dword v10,v7,s[8:11],s75 offen
ds_read_b128 v[68:71],v11 offset:2048
ds_read_b128 v[72:75],v11 offset:3072
s_cmp_eq_u32 s60,1
s_cbranch_scc1 Lrf_lateB
s_sleep 3
Lrf_lateB:
s_sleep 2
s_branch Lrf_pollB
Lrf_chkA0:
s_waitcnt vmcnt(3)
v_mfma_f32_16x16x32_bf16 v[72:75],v[68:71],v[28:31],0
v_bitop3_b32 v10,v28,v29,v30 bitop3:254
v_bitop3_b32 v10,v10,v31,1 bitop3:252
s_waitcnt vmcnt(2)
v_mfma_f32_16x16x32_bf16 v[72:75],v[68:71],v[32:35],v[72:75]
v_bitop3_b32 v10,v10,v32,v33 bitop3:254
v_bitop3_b32 v10,v10,v34,v35 bitop3:254
s_waitcnt vmcnt(1)
v_mfma_f32_16x16x32_bf16 v[72:75],v[68:71],v[36:39],v[72:75]
v_bitop3_b32 v10,v10,v36,v37 bitop3:254
v_bitop3_b32 v10,v10,v38,v39 bitop3:254
s_waitcnt vmcnt(0)
v_mfma_f32_16x16x32_bf16 v[72:75],v[68:71],v[40:43],v[72:75]
v_bitop3_b32 v10,v10,v40,v41 bitop3:254
v_bitop3_b32 v10,v10,v42,v43 bitop3:254
v_and_b32 v10,1,v10
v_cmp_ne_u32 vcc,0,v10
s_cbranch_vccz Lrf_gotA
Lrf_failA1:
Lrf_failA:
buffer_load_dwordx4 v[28:31],v5,s[8:11],s98 offen sc1
buffer_load_dwordx4 v[32:35],v5,s[8:11],s99 offen sc1
buffer_load_dwordx4 v[36:39],v5,s[8:11],s100 offen sc1
buffer_load_dwordx4 v[40:43],v5,s[8:11],s101 offen sc1
s_sub_u32 s74,s74,1
s_cbranch_scc0 Lrf_chkA
s_mov_b32 s74,0
s_branch Lrf_gotA
Lrf_retryB:
buffer_load_dwordx4 v[28:31],v4,s[8:11],s64 offen sc1
buffer_load_dwordx4 v[32:35],v4,s[8:11],s64 offen offset:1024 sc1
buffer_load_dword v8,v9,s[8:11],s64 offen sc1
s_nop 7
v_mov_b64 v[12:13],0
v_mov_b64 v[14:15],0
v_mov_b64 v[16:17],0
v_mov_b64 v[18:19],0
v_mov_b64 v[20:21],0
v_mov_b64 v[22:23],0
s_sub_u32 s74,s74,1
s_cbranch_scc0 Lrf_top
s_mov_b32 s74,0
s_waitcnt vmcnt(0)
s_branch Lrf_gotB
Lrf_kvwait:
s_waitcnt vmcnt(0)
v_lshlrev_b32 v36,3,v0
s_mov_b32 s76,5120
s_mov_b64 exec,0x1ff
buffer_load_dword v40,v36,s[8:11],s76 offen sc1
s_waitcnt vmcnt(0)
v_cmp_le_u32 vcc,32,v40
s_mov_b64 exec,-1
s_ff0_i32_b32 s76,vcc_lo
s_lshl_b32 s91,s76,3
s_sub_u32 s91,s91,8
s_cmp_lt_u32 s76,2
s_cbranch_scc0 Lrf_kvn
s_lshl_b32 s91,s76,2
Lrf_kvn:
s_cmp_eq_u32 s91,64
s_cselect_b32 s91,1000,s91
s_cmp_lt_u32 s75,s91
s_cbranch_scc1 Lrf_kvok
s_mov_b32 s58,0x40000000
s_cmp_lt_u32 s63,s91
s_cbranch_scc1 Lrf_kvok
s_sleep 1
s_sub_u32 s74,s74,1
s_cbranch_scc0 Lrf_kvwait
s_mov_b32 s74,0
s_branch Lrf_kvok
Lrf_nored:
v_xor_b32 v11,16384,v3
ds_read_b128 v[44:47],v3 offset:0
ds_read_b128 v[48:51],v3 offset:1024
ds_read_b128 v[52:55],v3 offset:2048
ds_read_b128 v[56:59],v3 offset:3072
ds_read_b128 v[60:63],v11 offset:0
ds_read_b128 v[64:67],v11 offset:1024
ds_read_b128 v[68:71],v11 offset:2048
ds_read_b128 v[72:75],v11 offset:3072
ds_read_b128 v[76:79],v0 offset:9216
v_mov_b64 v[12:13],0
v_mov_b64 v[14:15],0
v_mov_b64 v[16:17],0
v_mov_b64 v[18:19],0
v_mov_b64 v[20:21],0
v_mov_b64 v[22:23],0
v_mov_b64 v[24:25],0
v_mov_b64 v[26:27],0
s_mov_b32 s66,s64
s_mov_b32 s64,s65
s_add_u32 s65,s65,16384
s_and_b32 s65,s65,0xffff
s_or_b32 s65,s65,983040
s_mov_b32 s88,s67
s_mov_b32 s67,s68
s_mov_b32 s68,s88
s_mov_b32 s89,s59
s_add_u32 s63,s63,1
s_bfe_u32 s59,s63,0x10001
s_xor_b32 s59,s59,1
s_sleep 8
s_sleep 4
s_nop 7
s_branch Lrf_pollB
Lrf_done:
s_waitcnt vmcnt(0) lgkmcnt(0)
s_barrier
s_mov_b64 exec,s[94:95]
v_mov_b32 v76,64
buffer_store_dword v76,v0,s[8:11],s79 offen sc1
s_mov_b64 exec,-1
Lrf_exit:
s_branch Lr_exit
Lr_slow:
v_xor_b32 v11,16384,v3
ds_read_b128 v[44:47],v3 offset:0
ds_read_b128 v[48:51],v3 offset:1024
ds_read_b128 v[52:55],v3 offset:2048
ds_read_b128 v[56:59],v3 offset:3072
ds_read_b128 v[60:63],v11 offset:0
ds_read_b128 v[64:67],v11 offset:1024
ds_read_b128 v[68:71],v11 offset:2048
ds_read_b128 v[72:75],v11 offset:3072
ds_read_b128 v[76:79],v0 offset:9216
v_mov_b64 v[12:13],0
v_mov_b64 v[14:15],0
v_mov_b64 v[16:17],0
v_mov_b64 v[18:19],0
v_mov_b64 v[20:21],0
v_mov_b64 v[22:23],0
v_mov_b64 v[24:25],0
v_mov_b64 v[26:27],0
Lrs_pollB:
s_add_u32 s75,s63,1
s_mov_b32 s58,0
s_cmp_ge_u32 s75,s91
s_cbranch_scc1 Lrs_kvwait
Lrs_kvok:
buffer_load_dwordx4 v[28:31],v4,s[8:11],s64 offen sc1
buffer_load_dwordx4 v[32:35],v4,s[8:11],s64 offen offset:1024 sc1
buffer_load_dword v8,v9,s[8:11],s64 offen sc1
Lrs_top:
s_waitcnt vmcnt(2)
v_max3_u32 v10,v28,v29,v30
v_max_u32 v10,v10,v31
v_smfmac_f32_16x16x64_bf16 v[12:15],v[28:31],a[0:7],v1
s_waitcnt vmcnt(1)
v_max3_u32 v10,v10,v32,v33
v_smfmac_f32_16x16x64_bf16 v[16:19],v[28:31],a[8:15],v1
s_waitcnt vmcnt(0)
v_max3_u32 v11,v34,v35,v8
v_max_u32 v10,v10,v11
v_cmp_eq_u32 vcc,-1,v10
v_smfmac_f32_16x16x64_bf16 v[20:23],v[28:31],a[128:135],v1
s_cbranch_vccnz Lrs_retryB
Lrs_gotB:
v_smfmac_f32_16x16x64_bf16 v[24:27],v[28:31],a[136:143],v1
ds_write_b128 v4,v[28:31]
v_xor_b32 v10,2048,v4
v_smfmac_f32_16x16x64_bf16 v[12:15],v[32:35],a[16:23],v1
ds_write_b128 v4,v[32:35] offset:1024
v_xor_b32 v11,4096,v4
v_smfmac_f32_16x16x64_bf16 v[16:19],v[32:35],a[24:31],v1
ds_write_b32 v9,v8
s_waitcnt vmcnt(0) lgkmcnt(0)
s_barrier
ds_read_b128 v[36:39],v10 offset:0
v_smfmac_f32_16x16x64_bf16 v[20:23],v[32:35],v[44:51],v1
ds_read_b128 v[40:43],v10 offset:1024
v_smfmac_f32_16x16x64_bf16 v[24:27],v[32:35],v[52:59],v1
ds_read_b128 v[28:31],v0 offset:8192
s_waitcnt lgkmcnt(2)
v_smfmac_f32_16x16x64_bf16 v[12:15],v[36:39],a[32:39],v1
ds_read_b128 v[32:35],v11 offset:0
v_smfmac_f32_16x16x64_bf16 v[16:19],v[36:39],a[40:47],v1
ds_read_b128 v[44:47],v2 offset:0
s_waitcnt lgkmcnt(3)
v_smfmac_f32_16x16x64_bf16 v[12:15],v[40:43],a[48:55],v1
ds_read_b128 v[48:51],v2 offset:1024
v_smfmac_f32_16x16x64_bf16 v[16:19],v[40:43],a[56:63],v1
ds_read_b128 v[52:55],v2 offset:2048
v_smfmac_f32_16x16x64_bf16 v[20:23],v[36:39],a[144:151],v1
ds_read_b128 v[56:59],v2 offset:3072
v_smfmac_f32_16x16x64_bf16 v[24:27],v[36:39],a[152:159],v1
ds_read_b128 v[36:39],v11 offset:1024
v_xor_b32 v11,6144,v4
v_smfmac_f32_16x16x64_bf16 v[20:23],v[40:43],v[60:67],v1
buffer_load_dwordx4 v[60:63],v0,s[8:11],s69 offen sc1
v_smfmac_f32_16x16x64_bf16 v[24:27],v[40:43],v[68:75],v1
ds_read_b128 v[40:43],v11 offset:0
v_xor_b32 v10,32768,v3
s_waitcnt lgkmcnt(2)
v_smfmac_f32_16x16x64_bf16 v[12:15],v[28:31],v[44:51],v1
buffer_load_dwordx4 v[64:67],v0,s[8:11],s69 offen offset:1024 sc1
v_smfmac_f32_16x16x64_bf16 v[16:19],v[28:31],v[52:59],v1
ds_read_b128 v[44:47],v10 offset:0
v_smfmac_f32_16x16x64_bf16 v[12:15],v[32:35],a[64:71],v1
ds_read_b128 v[48:51],v10 offset:1024
v_smfmac_f32_16x16x64_bf16 v[16:19],v[32:35],a[72:79],v1
ds_read_b128 v[52:55],v10 offset:2048
s_waitcnt lgkmcnt(4)
v_smfmac_f32_16x16x64_bf16 v[12:15],v[36:39],a[80:87],v1
ds_read_b128 v[56:59],v10 offset:3072
v_xor_b32 v10,49152,v3
v_smfmac_f32_16x16x64_bf16 v[16:19],v[36:39],a[88:95],v1
buffer_load_dwordx4 v[68:71],v0,s[8:11],s70 offen sc1
v_smfmac_f32_16x16x64_bf16 v[20:23],v[32:35],a[160:167],v1
buffer_load_dwordx4 v[72:75],v0,s[8:11],s70 offen offset:1024 sc1
v_smfmac_f32_16x16x64_bf16 v[24:27],v[32:35],a[168:175],v1
ds_read_b128 v[32:35],v11 offset:1024
s_waitcnt lgkmcnt(5)
v_smfmac_f32_16x16x64_bf16 v[12:15],v[40:43],a[96:103],v1
s_add_u32 s69,s69,0x40000
s_add_u32 s70,s70,0x40000
v_smfmac_f32_16x16x64_bf16 v[16:19],v[40:43],a[104:111],v1
s_or_b32 s58,s58,s69
buffer_load_dword v8,v6,s[8:11],s58 offen sc1
s_waitcnt lgkmcnt(1)
v_smfmac_f32_16x16x64_bf16 v[20:23],v[36:39],v[44:51],v1
ds_read_b128 v[44:47],v10 offset:0
s_waitcnt lgkmcnt(1)
v_smfmac_f32_16x16x64_bf16 v[12:15],v[32:35],a[112:119],v1
ds_read_b128 v[48:51],v10 offset:1024
v_smfmac_f32_16x16x64_bf16 v[16:19],v[32:35],a[120:127],v1
v_add_u32 v11,s84,v0
v_smfmac_f32_16x16x64_bf16 v[24:27],v[36:39],v[52:59],v1
ds_read_b128 v[52:55],v10 offset:2048
v_smfmac_f32_16x16x64_bf16 v[20:23],v[40:43],a[176:183],v1
ds_read_b128 v[56:59],v10 offset:3072
v_smfmac_f32_16x16x64_bf16 v[24:27],v[40:43],a[184:191],v1
v_lshrrev_b32 v10,2,v0
v_mov_b64 v[40:41],0
v_mov_b32 v42,s63
v_smfmac_f32_16x16x64_bf16 v[20:23],v[28:31],a[192:199],v1
v_add_f32 v12,v12,v14
v_add_f32 v13,v13,v15
v_smfmac_f32_16x16x64_bf16 v[24:27],v[28:31],a[200:207],v1
v_add_f32 v16,v16,v18
v_add_f32 v17,v17,v19
s_waitcnt lgkmcnt(2)
v_smfmac_f32_16x16x64_bf16 v[20:23],v[32:35],v[44:51],v1
s_mov_b64 exec,s[94:95]
buffer_store_dword v42,v0,s[8:11],s79 offen sc1
s_mov_b64 exec,-1
v_cvt_pk_bf16_f32 v14,v12,v13
v_cvt_pk_bf16_f32 v15,v16,v17
s_waitcnt lgkmcnt(0)
v_smfmac_f32_16x16x64_bf16 v[24:27],v[32:35],v[52:59],v1
ds_read_b128 v[44:47],v2 offset:16384
v_mov_b64 v[42:43],0
v_mfma_f32_16x16x16_bf16 v[16:19],v[14:15],v[76:77],0
ds_read_b128 v[48:51],v2 offset:17408
v_mov_b64 v[32:33],0
v_mfma_f32_16x16x16_bf16 v[36:39],v[14:15],v[78:79],0
ds_read_b128 v[52:55],v2 offset:18432
v_mov_b64 v[34:35],0
v_add_f32 v20,v20,v22
v_add_f32 v21,v21,v23
v_add_f32 v24,v24,v26
v_add_f32 v25,v25,v27
v_cvt_pk_bf16_f32 v22,v20,v21
v_cvt_pk_bf16_f32 v23,v24,v25
v_cvt_pk_bf16_f32 v12,v16,v17
v_cvt_pk_bf16_f32 v13,v18,v19
v_mfma_f32_16x16x16_bf16 v[24:27],v[22:23],v[76:77],0
ds_read_b128 v[56:59],v2 offset:19456
v_cvt_pk_bf16_f32 v14,v36,v37
v_mfma_f32_16x16x16_bf16 v[76:79],v[22:23],v[78:79],0
v_cvt_pk_bf16_f32 v15,v38,v39
v_smfmac_f32_16x16x64_bf16 v[40:43],v[28:31],v[128:135],v1
s_waitcnt vmcnt(4)
v_mfma_f32_16x16x32_bf16 v[36:39],v[60:63],v[12:15],0
v_mfma_f32_16x16x32_bf16 v[16:19],v[64:67],v[12:15],0
v_add_u32 v65,s85,v10
v_cvt_pk_bf16_f32 v20,v24,v25
v_cvt_pk_bf16_f32 v21,v26,v27
v_cvt_pk_bf16_f32 v22,v76,v77
v_cvt_pk_bf16_f32 v23,v78,v79
v_smfmac_f32_16x16x64_bf16 v[32:35],v[28:31],v[136:143],v1
ds_read_b128 v[76:79],v0 offset:0
v_mfma_f32_16x16x32_bf16 v[24:27],v[20:23],v[12:15],0
ds_read_b128 v[28:31],v0 offset:2048
v_cndmask_b32 v60,v16,v36,s[80:81]
v_cndmask_b32 v61,v17,v37,s[80:81]
v_cndmask_b32 v62,v18,v38,s[80:81]
v_cndmask_b32 v63,v19,v39,s[80:81]
s_waitcnt lgkmcnt(1)
v_smfmac_f32_16x16x64_bf16 v[40:43],v[76:79],v[44:51],v1
ds_write_b128 v11,v[60:63]
v_cndmask_b32 v64,v25,v24,s[80:81]
v_smfmac_f32_16x16x64_bf16 v[32:35],v[76:79],v[52:59],v1
ds_write_b32 v65,v64
s_waitcnt lgkmcnt(2)
v_smfmac_f32_16x16x64_bf16 v[40:43],v[28:31],a[208:215],v1
ds_read_b128 v[36:39],v0 offset:3072
v_xor_b32 v11,1024,v11
v_smfmac_f32_16x16x64_bf16 v[32:35],v[28:31],a[216:223],v1
buffer_store_dwordx4 v[20:23],v0,s[8:11],s71 offen sc1
s_waitcnt lgkmcnt(1)
s_barrier
ds_read_b128 v[12:15],v11 offset:0
v_xor_b32 v11,3072,v11
s_waitcnt lgkmcnt(1)
v_smfmac_f32_16x16x64_bf16 v[40:43],v[36:39],a[224:231],v1
ds_read_b128 v[16:19],v11 offset:0
v_xor_b32 v11,1024,v11
v_smfmac_f32_16x16x64_bf16 v[32:35],v[36:39],a[232:239],v1
ds_read_b128 v[20:23],v11 offset:0
ds_read2st64_b32 v[24:25],v10 offset0:40 offset1:41
ds_read2st64_b32 v[26:27],v10 offset0:42 offset1:43
ds_read_b128 v[76:79],v0 offset:4096
ds_read_b128 v[28:31],v0 offset:5120
ds_read_b128 v[36:39],v0 offset:6144
s_waitcnt lgkmcnt(7)
v_add_f32 v60,v60,v12
v_add_f32 v61,v61,v13
v_add_f32 v62,v62,v14
v_add_f32 v63,v63,v15
s_waitcnt lgkmcnt(5)
v_add_f32 v16,v16,v20
v_add_f32 v17,v17,v21
v_add_f32 v18,v18,v22
v_add_f32 v19,v19,v23
s_waitcnt lgkmcnt(3)
v_add_f32 v24,v24,v25
v_add_f32 v26,v26,v27
v_add_f32 v12,v60,v16
v_add_f32 v13,v61,v17
v_add_f32 v14,v62,v18
v_add_f32 v15,v63,v19
v_add_f32 v60,v24,v26
v_max3_f32 v66,v12,v13,v14
v_max3_f32 v66,v66,v15,v60
s_waitcnt lgkmcnt(2)
v_smfmac_f32_16x16x64_bf16 v[40:43],v[76:79],a[240:247],v1
ds_read_b128 v[44:47],v2 offset:32768
v_max_f32_dpp v66,v66,v66 quad_perm:[2,3,0,1] row_mask:0xf bank_mask:0xf
v_mov_b32 v67,v66
v_smfmac_f32_16x16x64_bf16 v[32:35],v[76:79],a[248:255],v1
ds_read_b128 v[48:51],v2 offset:33792
v_permlane16_swap_b32 v66,v67
v_max_f32 v66,v66,v67
v_mov_b32 v67,v66
s_waitcnt lgkmcnt(3)
v_smfmac_f32_16x16x64_bf16 v[40:43],v[28:31],v[80:87],v1
ds_read_b128 v[76:79],v0 offset:7168
v_permlane32_swap_b32 v66,v67
v_max_f32 v66,v66,v67
v_smfmac_f32_16x16x64_bf16 v[32:35],v[28:31],v[88:95],v1
ds_read_b128 v[52:55],v2 offset:34816
v_mul_f32 v66,s87,v66
v_fma_f32 v12,v12,s87,-v66
v_fma_f32 v13,v13,s87,-v66
v_fma_f32 v14,v14,s87,-v66
v_fma_f32 v15,v15,s87,-v66
s_waitcnt lgkmcnt(4)
v_smfmac_f32_16x16x64_bf16 v[40:43],v[36:39],v[96:103],v1
ds_read_b128 v[56:59],v2 offset:35840
v_exp_f32 v12,v12
v_exp_f32 v13,v13
v_smfmac_f32_16x16x64_bf16 v[32:35],v[36:39],v[104:111],v1
ds_read_b128 v[28:31],v0 offset:1024
v_exp_f32 v14,v14
v_exp_f32 v15,v15
s_waitcnt lgkmcnt(3)
v_smfmac_f32_16x16x64_bf16 v[40:43],v[76:79],v[112:119],v1
v_cvt_pk_bf16_f32 v62,v12,v13
v_cvt_pk_bf16_f32 v63,v14,v15
v_smfmac_f32_16x16x64_bf16 v[32:35],v[76:79],v[120:127],v1
v_cndmask_b32 v20,0,v62,s[80:81]
v_cndmask_b32 v21,0,v63,s[80:81]
v_cndmask_b32 v26,v62,0,s[80:81]
v_cndmask_b32 v27,v63,0,s[80:81]
s_waitcnt lgkmcnt(0)
v_smfmac_f32_16x16x64_bf16 v[40:43],v[28:31],v[44:51],v1
v_mov_b32_dpp v24,v20 quad_perm:[2,3,0,1] row_mask:0xf bank_mask:0xf
v_smfmac_f32_16x16x64_bf16 v[32:35],v[28:31],v[52:59],v1
v_mov_b32_dpp v25,v21 quad_perm:[2,3,0,1] row_mask:0xf bank_mask:0xf
v_mov_b32_dpp v22,v26 quad_perm:[2,3,0,1] row_mask:0xf bank_mask:0xf
v_mov_b32_dpp v23,v27 quad_perm:[2,3,0,1] row_mask:0xf bank_mask:0xf
v_fma_f32 v60,v60,s87,-v66
s_waitcnt vmcnt(3)
v_mfma_f32_16x16x32_bf16 v[16:19],v[72:75],v[24:27],0
v_exp_f32 v60,v60
v_mfma_f32_16x16x32_bf16 v[16:19],v[68:71],v[20:23],v[16:19]
v_add_f32 v66,v12,v13
v_add_f32 v67,v14,v15
v_cvt_pk_bf16_f32 v61,v60,0
v_add_f32 v40,v40,v42
v_add_f32 v41,v41,v43
v_lshlrev_b32 v62,16,v61
v_add_f32 v32,v32,v34
v_add_f32 v33,v33,v35
v_cndmask_b32 v64,v62,v61,s[80:81]
v_add_f32 v66,v66,v67
v_mov_b64 v[14:15],0
v_or_b32_dpp v64,v64,v64 quad_perm:[2,3,0,1] row_mask:0xf bank_mask:0xf
v_add_f32 v66,v66,v60
v_cvt_pk_bf16_f32 v60,v40,v41
v_cvt_pk_bf16_f32 v61,v32,v33
v_cndmask_b32 v12,0,v64,s[80:81]
v_cndmask_b32 v13,v64,0,s[80:81]
v_add_f32_dpp v66,v66,v66 quad_perm:[2,3,0,1] row_mask:0xf bank_mask:0xf
v_lshrrev_b32 v10,1,v0
v_mfma_f32_16x16x32_bf16 v[16:19],v[60:63],v[12:15],v[16:19]
buffer_store_dwordx2 v[60:61],v10,s[8:11],s72 offen sc1
v_mov_b32 v67,v66
v_add_u32 v10,s86,v0
v_add_u32 v11,114688,v2
v_permlane16_swap_b32 v66,v67
v_add_f32 v66,v66,v67
v_mov_b32 v67,v66
s_cmp_eq_u32 s63,63
s_cbranch_scc1 Lrs_done
v_permlane32_swap_b32 v66,v67
v_add_f32 v66,v66,v67
v_rcp_f32 v66,v66
v_mov_b64 v[76:77],0
v_mul_f32 v16,v16,v66
v_mul_f32 v17,v17,v66
v_mul_f32 v18,v18,v66
v_mul_f32 v19,v19,v66
v_cvt_pk_bf16_f32 v62,v16,v17
v_cvt_pk_bf16_f32 v63,v18,v19
ds_write_b64 v10,v[62:63]
v_mov_b64 v[78:79],0
v_mov_b64 v[12:13],0
v_mov_b64 v[14:15],0
v_mov_b64 v[16:17],0
v_mov_b64 v[18:19],0
v_mov_b64 v[20:21],0
v_mov_b64 v[22:23],0
v_mov_b64 v[24:25],0
v_mov_b64 v[26:27],0
v_mov_b64 v[68:69],0
v_mov_b64 v[70:71],0
v_mov_b64 v[72:73],0
v_mov_b64 v[74:75],0
s_waitcnt lgkmcnt(0)
s_barrier
ds_read_b128 v[60:63],v0 offset:0
ds_read_b128 v[64:67],v0 offset:8192
ds_read_b128 v[44:47],v11 offset:0
ds_read_b128 v[48:51],v11 offset:1024
s_waitcnt lgkmcnt(3)
v_smfmac_f32_16x16x64_bf16 v[76:79],v[60:63],v[144:151],v1
s_add_u32 s75,s67,s78
s_add_u32 s71,s71,0x20000
ds_read_b128 v[52:55],v11 offset:2048
s_waitcnt lgkmcnt(3)
v_smfmac_f32_16x16x64_bf16 v[76:79],v[64:67],v[152:159],v1
s_add_u32 s76,s75,4096
s_add_u32 s72,s72,0x10000
ds_read_b128 v[56:59],v11 offset:3072
v_smfmac_f32_16x16x64_bf16 v[12:15],v[60:63],v[160:167],v1
s_add_u32 s77,s75,8192
s_add_u32 s98,s83,s67
ds_read_b128 v[28:31],v11 offset:16384
v_smfmac_f32_16x16x64_bf16 v[12:15],v[64:67],v[168:175],v1
s_add_u32 s99,s98,36864
s_add_u32 s100,s98,73728
ds_read_b128 v[32:35],v11 offset:17408
v_smfmac_f32_16x16x64_bf16 v[16:19],v[60:63],v[176:183],v1
s_add_u32 s101,s98,110592
s_add_u32 s82,s83,s65
ds_read_b128 v[36:39],v11 offset:18432
v_add_f32 v76,v76,v78
v_add_f32 v77,v77,v79
v_cvt_pk_bf16_f32 v76,v76,v77
v_smfmac_f32_16x16x64_bf16 v[16:19],v[64:67],v[184:191],v1
ds_read_b128 v[40:43],v11 offset:19456
v_bfi_b32 v76,1,s59,v76
v_add_f32 v12,v12,v14
v_add_f32 v13,v13,v15
v_smfmac_f32_16x16x64_bf16 v[20:23],v[60:63],v[192:199],v1
buffer_store_dword v76,v9,s[8:11],s75 offen offset:0 sc1
v_cvt_pk_bf16_f32 v12,v12,v13
v_bfi_b32 v12,1,s59,v12
v_smfmac_f32_16x16x64_bf16 v[20:23],v[64:67],v[200:207],v1
buffer_store_dword v12,v9,s[8:11],s75 offen offset:1024 sc1
v_mov_b64 v[76:77],0
v_mov_b64 v[78:79],0
v_add_f32 v16,v16,v18
v_smfmac_f32_16x16x64_bf16 v[24:27],v[60:63],v[208:215],v1
v_add_f32 v17,v17,v19
v_cvt_pk_bf16_f32 v16,v16,v17
v_bfi_b32 v16,1,s59,v16
v_smfmac_f32_16x16x64_bf16 v[24:27],v[64:67],v[216:223],v1
buffer_store_dword v16,v9,s[8:11],s75 offen offset:2048 sc1
v_mov_b64 v[12:13],0
v_mov_b64 v[14:15],0
v_add_f32 v20,v20,v22
v_smfmac_f32_16x16x64_bf16 v[68:71],v[60:63],v[224:231],v1
v_add_f32 v21,v21,v23
v_cvt_pk_bf16_f32 v20,v20,v21
v_bfi_b32 v20,1,s59,v20
v_smfmac_f32_16x16x64_bf16 v[68:71],v[64:67],v[232:239],v1
buffer_store_dword v20,v9,s[8:11],s75 offen offset:3072 sc1
v_add_f32 v24,v24,v26
v_add_f32 v25,v25,v27
v_smfmac_f32_16x16x64_bf16 v[72:75],v[60:63],v[240:247],v1
v_cvt_pk_bf16_f32 v24,v24,v25
v_bfi_b32 v24,1,s59,v24
v_smfmac_f32_16x16x64_bf16 v[72:75],v[64:67],v[248:255],v1
buffer_store_dword v24,v9,s[8:11],s76 offen offset:0 sc1
v_add_f32 v68,v68,v70
v_add_f32 v69,v69,v71
v_cvt_pk_bf16_f32 v68,v68,v69
s_waitcnt lgkmcnt(4)
v_smfmac_f32_16x16x64_bf16 v[76:79],v[60:63],v[44:51],v1
v_bfi_b32 v68,1,s59,v68
v_smfmac_f32_16x16x64_bf16 v[76:79],v[64:67],v[52:59],v1
buffer_store_dword v68,v9,s[8:11],s76 offen offset:1024 sc1
v_add_f32 v72,v72,v74
v_add_f32 v73,v73,v75
v_cvt_pk_bf16_f32 v72,v72,v73
v_bfi_b32 v72,1,s59,v72
s_waitcnt lgkmcnt(0)
v_smfmac_f32_16x16x64_bf16 v[12:15],v[60:63],v[28:35],v1
buffer_store_dword v72,v9,s[8:11],s76 offen offset:2048 sc1
v_smfmac_f32_16x16x64_bf16 v[12:15],v[64:67],v[36:43],v1
v_add_f32 v76,v76,v78
v_add_f32 v77,v77,v79
v_cvt_pk_bf16_f32 v76,v76,v77
v_bfi_b32 v76,1,s59,v76
buffer_store_dword v76,v9,s[8:11],s76 offen offset:3072 sc1
s_nop 2
v_add_f32 v12,v12,v14
v_add_f32 v13,v13,v15
v_cvt_pk_bf16_f32 v12,v12,v13
v_bfi_b32 v12,1,s59,v12
buffer_store_dword v12,v9,s[8:11],s77 offen offset:0 sc1
s_cmp_eq_u32 s73,-1
s_cbranch_scc1 Lrs_nored
ds_read_b128 v[68:71],v0 offset:11264
s_cmp_lg_u32 s60,1
s_cbranch_scc1 Lrs_pollA
s_sleep 4
Lrs_pollA:
buffer_load_dwordx4 v[28:31],v5,s[8:11],s98 offen sc1
buffer_load_dwordx4 v[32:35],v5,s[8:11],s99 offen sc1
buffer_load_dwordx4 v[36:39],v5,s[8:11],s100 offen sc1
buffer_load_dwordx4 v[40:43],v5,s[8:11],s101 offen sc1
s_mov_b32 s66,s64
s_mov_b32 s64,s65
s_add_u32 s65,s65,16384
s_and_b32 s65,s65,0xffff
s_or_b32 s65,s65,983040
s_mov_b32 s88,s67
s_mov_b32 s67,s68
s_mov_b32 s68,s88
s_mov_b32 s89,s59
s_add_u32 s63,s63,1
s_bfe_u32 s59,s63,0x10001
s_xor_b32 s59,s59,1
v_xor_b32 v11,16384,v3
ds_read_b128 v[44:47],v3 offset:0
ds_read_b128 v[48:51],v3 offset:1024
ds_read_b128 v[52:55],v3 offset:2048
ds_read_b128 v[56:59],v3 offset:3072
ds_read_b128 v[60:63],v11 offset:0
ds_read_b128 v[64:67],v11 offset:1024
ds_read_b128 v[76:79],v0 offset:9216
v_mov_b64 v[12:13],0
v_mov_b64 v[14:15],0
v_mov_b64 v[16:17],0
v_mov_b64 v[18:19],0
v_mov_b64 v[20:21],0
v_mov_b64 v[22:23],0
v_mov_b64 v[24:25],0
v_mov_b64 v[26:27],0
s_waitcnt lgkmcnt(7)
Lrs_chkA:
s_cmp_eq_u32 s89,0
s_cbranch_scc1 Lrs_chkA0
s_waitcnt vmcnt(3)
v_mfma_f32_16x16x32_bf16 v[72:75],v[68:71],v[28:31],0
v_bitop3_b32 v10,v28,v29,v30 bitop3:128
v_bitop3_b32 v10,v10,v31,1 bitop3:128
s_waitcnt vmcnt(2)
v_mfma_f32_16x16x32_bf16 v[72:75],v[68:71],v[32:35],v[72:75]
v_bitop3_b32 v10,v10,v32,v33 bitop3:128
v_bitop3_b32 v10,v10,v34,v35 bitop3:128
s_waitcnt vmcnt(1)
v_mfma_f32_16x16x32_bf16 v[72:75],v[68:71],v[36:39],v[72:75]
v_bitop3_b32 v10,v10,v36,v37 bitop3:128
v_bitop3_b32 v10,v10,v38,v39 bitop3:128
s_waitcnt vmcnt(0)
v_mfma_f32_16x16x32_bf16 v[72:75],v[68:71],v[40:43],v[72:75]
v_bitop3_b32 v10,v10,v40,v41 bitop3:128
v_bitop3_b32 v10,v10,v42,v43 bitop3:128
v_cmp_ne_u32 vcc,1,v10
s_cbranch_vccnz Lrs_failA1
Lrs_gotA:
s_nop 3
v_add_f32_dpp v72,v72,v72 row_ror:8 row_mask:0xf bank_mask:0xf
v_add_f32_dpp v73,v73,v73 row_ror:8 row_mask:0xf bank_mask:0xf
v_cvt_pk_bf16_f32 v72,v72,v73
buffer_store_dword v72,v7,s[8:11],s82 offen sc1
s_add_u32 s75,s83,s66
v_mov_b32 v10,-1
buffer_store_dword v10,v7,s[8:11],s75 offen sc1
ds_read_b128 v[68:71],v11 offset:2048
ds_read_b128 v[72:75],v11 offset:3072
s_cmp_eq_u32 s60,1
s_cbranch_scc1 Lrs_lateB
s_sleep 3
Lrs_lateB:
s_sleep 2
s_branch Lrs_pollB
Lrs_chkA0:
s_waitcnt vmcnt(3)
v_mfma_f32_16x16x32_bf16 v[72:75],v[68:71],v[28:31],0
v_bitop3_b32 v10,v28,v29,v30 bitop3:254
v_bitop3_b32 v10,v10,v31,1 bitop3:252
s_waitcnt vmcnt(2)
v_mfma_f32_16x16x32_bf16 v[72:75],v[68:71],v[32:35],v[72:75]
v_bitop3_b32 v10,v10,v32,v33 bitop3:254
v_bitop3_b32 v10,v10,v34,v35 bitop3:254
s_waitcnt vmcnt(1)
v_mfma_f32_16x16x32_bf16 v[72:75],v[68:71],v[36:39],v[72:75]
v_bitop3_b32 v10,v10,v36,v37 bitop3:254
v_bitop3_b32 v10,v10,v38,v39 bitop3:254
s_waitcnt vmcnt(0)
v_mfma_f32_16x16x32_bf16 v[72:75],v[68:71],v[40:43],v[72:75]
v_bitop3_b32 v10,v10,v40,v41 bitop3:254
v_bitop3_b32 v10,v10,v42,v43 bitop3:254
v_and_b32 v10,1,v10
v_cmp_ne_u32 vcc,0,v10
s_cbranch_vccz Lrs_gotA
Lrs_failA1:
Lrs_failA:
buffer_load_dwordx4 v[28:31],v5,s[8:11],s98 offen sc1
buffer_load_dwordx4 v[32:35],v5,s[8:11],s99 offen sc1
buffer_load_dwordx4 v[36:39],v5,s[8:11],s100 offen sc1
buffer_load_dwordx4 v[40:43],v5,s[8:11],s101 offen sc1
s_sub_u32 s74,s74,1
s_cbranch_scc0 Lrs_chkA
s_mov_b32 s74,0
s_branch Lrs_gotA
Lrs_retryB:
buffer_load_dwordx4 v[28:31],v4,s[8:11],s64 offen sc1
buffer_load_dwordx4 v[32:35],v4,s[8:11],s64 offen offset:1024 sc1
buffer_load_dword v8,v9,s[8:11],s64 offen sc1
s_nop 7
v_mov_b64 v[12:13],0
v_mov_b64 v[14:15],0
v_mov_b64 v[16:17],0
v_mov_b64 v[18:19],0
v_mov_b64 v[20:21],0
v_mov_b64 v[22:23],0
s_sub_u32 s74,s74,1
s_cbranch_scc0 Lrs_top
s_mov_b32 s74,0
s_waitcnt vmcnt(0)
s_branch Lrs_gotB
Lrs_kvwait:
s_waitcnt vmcnt(0)
v_lshlrev_b32 v36,3,v0
s_mov_b32 s76,5120
s_mov_b64 exec,0x1ff
buffer_load_dword v40,v36,s[8:11],s76 offen sc1
s_waitcnt vmcnt(0)
v_cmp_le_u32 vcc,32,v40
s_mov_b64 exec,-1
s_ff0_i32_b32 s76,vcc_lo
s_lshl_b32 s91,s76,3
s_sub_u32 s91,s91,8
s_cmp_lt_u32 s76,2
s_cbranch_scc0 Lrs_kvn
s_lshl_b32 s91,s76,2
Lrs_kvn:
s_cmp_eq_u32 s91,64
s_cselect_b32 s91,1000,s91
s_cmp_lt_u32 s75,s91
s_cbranch_scc1 Lrs_kvok
s_mov_b32 s58,0x40000000
s_cmp_lt_u32 s63,s91
s_cbranch_scc1 Lrs_kvok
s_sleep 1
s_sub_u32 s74,s74,1
s_cbranch_scc0 Lrs_kvwait
s_mov_b32 s74,0
s_branch Lrs_kvok
Lrs_nored:
v_xor_b32 v11,16384,v3
ds_read_b128 v[44:47],v3 offset:0
ds_read_b128 v[48:51],v3 offset:1024
ds_read_b128 v[52:55],v3 offset:2048
ds_read_b128 v[56:59],v3 offset:3072
ds_read_b128 v[60:63],v11 offset:0
ds_read_b128 v[64:67],v11 offset:1024
ds_read_b128 v[68:71],v11 offset:2048
ds_read_b128 v[72:75],v11 offset:3072
ds_read_b128 v[76:79],v0 offset:9216
v_mov_b64 v[12:13],0
v_mov_b64 v[14:15],0
v_mov_b64 v[16:17],0
v_mov_b64 v[18:19],0
v_mov_b64 v[20:21],0
v_mov_b64 v[22:23],0
v_mov_b64 v[24:25],0
v_mov_b64 v[26:27],0
s_mov_b32 s66,s64
s_mov_b32 s64,s65
s_add_u32 s65,s65,16384
s_and_b32 s65,s65,0xffff
s_or_b32 s65,s65,983040
s_mov_b32 s88,s67
s_mov_b32 s67,s68
s_mov_b32 s68,s88
s_mov_b32 s89,s59
s_add_u32 s63,s63,1
s_bfe_u32 s59,s63,0x10001
s_xor_b32 s59,s59,1
s_sleep 8
s_sleep 4
s_nop 7
s_branch Lrs_pollB
Lrs_done:
s_waitcnt vmcnt(0) lgkmcnt(0)
s_barrier
s_mov_b64 exec,s[94:95]
v_mov_b32 v76,64
buffer_store_dword v76,v0,s[8:11],s79 offen sc1
s_mov_b64 exec,-1
Lrs_exit:
Lr_exit:
s_branch L_fin
L_par:
s_add_u32 s84,s62,6
s_mul_hi_u32 s64,s84,613566757
s_mul_i32 s64,s64,7
s_sub_u32 s84,s84,s64
s_lshl_b32 s86,s84,2
s_barrier
s_cmp_lg_u32 s60,0
s_cbranch_scc1 Lat_g1q0
v_mov_b32 v1,1
v_mov_b32 v2,0
s_mov_b64 exec,1
buffer_atomic_add v1,v2,s[32:35],s86 offen offset:32 sc0
s_waitcnt vmcnt(0)
ds_write_b32 v2,v1
s_mov_b64 exec,-1
s_waitcnt lgkmcnt(0)
Lat_g1q0:
s_barrier
v_mov_b32 v2,0
ds_read_b32 v1,v2
s_waitcnt lgkmcnt(0)
v_readfirstlane_b32 s87,v1
s_barrier
s_mov_b32 s65,160
s_cmp_lg_u32 s60,0
s_cbranch_scc1 Lwd_init2
s_mov_b32 s71,0x800000
v_mov_b32 v2,0
s_mov_b64 exec,1
Lw_init2:
buffer_load_dword v1,v2,s[32:35],s65 offen sc1
s_sub_u32 s71,s71,1
s_cbranch_scc1 Lwe_init2
s_waitcnt vmcnt(0)
v_cmp_gt_u32 vcc,1,v1
s_cbranch_vccz Lwe_init2
s_sleep 1
s_branch Lw_init2
Lwe_init2:
s_waitcnt vmcnt(0)
s_mov_b64 exec,-1
Lwd_init2:
s_barrier
s_mov_b32 s66,s87
v_and_b32 v11,63,v0
v_lshlrev_b32 v3,4,v11
v_lshrrev_b32 v12,4,v11
v_bfe_u32 v13,v11,2,2
v_and_b32 v14,3,v11
v_lshl_add_u32 v15,v12,3,v13
v_lshlrev_b32 v15,8,v15
v_lshl_add_u32 v15,v14,3,v15
v_and_b32 v12,1,v12
v_lshl_add_u32 v13,v12,2,v13
v_lshl_add_u32 v10,v13,5,v15
s_lshr_b32 s64,s60,1
s_lshl_b32 s81,s64,13
v_add_u32 v5,s81,v3
s_lshl_b32 s79,s60,12
s_and_b32 s65,s60,1
s_lshl_b32 s80,s65,11
s_add_u32 s80,s80,s81
s_add_u32 s80,s80,16384
s_mov_b32 s85,0
Lg1_fresh:
s_cmp_lt_u32 s84,4
s_cselect_b32 s65,5,4
s_cmp_lt_u32 s66,s65
s_cselect_b32 s61,0,2
s_cselect_b32 s67,0,s65
s_sub_u32 s66,s66,s67
s_cmp_lt_u32 s66,s67
s_cselect_b32 s61,1,s61
Lg1_fresh2:
s_cmp_lt_u32 s66,96
s_cbranch_scc1 Lg1_first
s_cmp_lg_u32 s60,0
s_cbranch_scc1 Lst_g1
v_and_b32 v1,7,v0
v_lshlrev_b32 v1,2,v1
buffer_load_dword v2,v1,s[32:35],0 offen offset:32 sc1
s_waitcnt vmcnt(0)
v_cmp_gt_u32 vcc,16,v1
v_mov_b32 v1,100
s_nop 0
v_addc_co_u32 v1,vcc,0,v1,vcc
s_waitcnt vmcnt(0)
v_cmp_gt_u32 vcc,v1,v2
s_and_b32 s67,vcc_lo,0x7f
v_mov_b32 v2,s67
v_mov_b32 v1,0
ds_write_b32 v1,v2
s_waitcnt lgkmcnt(0)
Lst_g1:
s_barrier
v_mov_b32 v1,0
ds_read_b32 v2,v1
s_waitcnt lgkmcnt(0)
v_readfirstlane_b32 s67,v2
s_barrier
s_cmp_eq_u32 s67,0
s_cbranch_scc1 Lg1_done
s_ff1_i32_b32 s84,s67
s_lshl_b32 s81,s84,2
s_barrier
s_cmp_lg_u32 s60,0
s_cbranch_scc1 Lat_g1q
v_mov_b32 v1,1
v_mov_b32 v2,0
s_mov_b64 exec,1
buffer_atomic_add v1,v2,s[32:35],s81 offen offset:32 sc0
s_waitcnt vmcnt(0)
ds_write_b32 v2,v1
s_mov_b64 exec,-1
s_waitcnt lgkmcnt(0)
Lat_g1q:
s_barrier
v_mov_b32 v2,0
ds_read_b32 v1,v2
s_waitcnt lgkmcnt(0)
v_readfirstlane_b32 s66,v1
s_barrier
s_branch Lg1_fresh
Lg1_first:
s_mul_hi_u32 s72,s66,357913942
s_mul_i32 s65,s72,12
s_sub_u32 s65,s66,s65
s_mul_i32 s65,s65,7
s_add_u32 s65,s65,s84
s_lshr_b32 s66,s60,1
s_and_b32 s67,s60,1
s_cmp_ge_u32 s65,48
s_cbranch_scc1 Lg1_gu_a
s_mov_b32 s77,8192
s_cmp_ge_u32 s65,32
s_cbranch_scc1 Lg1_q_a
s_and_b32 s74,s65,1
s_lshr_b32 s68,s65,1
s_cmp_eq_u32 s74,0
s_cselect_b32 s56,s16,s20
s_cselect_b32 s57,s17,s21
s_add_u32 s78,s74,1
s_lshl_b32 s78,s78,24
s_mov_b32 s82,5248
s_branch Lg1_kvq_a
Lg1_q_a:
s_mov_b32 s74,2
s_sub_u32 s68,s65,32
s_mov_b32 s56,s12
s_mov_b32 s57,s13
s_mov_b32 s78,50331648
s_mov_b32 s82,6272
Lg1_kvq_a:
s_mov_b32 s58,4718592
s_lshl_b32 s76,s68,9
s_lshl_b32 s69,s66,8
s_add_u32 s76,s76,s69
s_lshl_b32 s69,s68,1
s_add_u32 s69,s69,s67
s_lshl_b32 s69,s69,13
s_add_u32 s78,s78,s69
s_lshl_b32 s69,s72,1
s_add_u32 s69,s69,s66
s_lshl_b32 s69,s69,20
s_add_u32 s78,s78,s69
s_lshl_b32 s69,s67,13
s_add_u32 s70,s69,128
s_branch Lg1_dec_a
Lg1_gu_a:
s_mov_b32 s74,3
s_mov_b32 s77,9216
s_sub_u32 s68,s65,48
s_cmp_eq_u32 s66,0
s_cselect_b32 s56,s40,s44
s_cselect_b32 s57,s41,s45
s_mov_b32 s58,5308416
s_lshl_b32 s76,s68,8
s_mov_b32 s82,7296
s_lshl_b32 s69,s72,1
s_add_u32 s69,s69,s66
s_mul_i32 s78,s69,1179648
s_lshl_b32 s69,s68,1
s_add_u32 s69,s69,s67
s_lshl_b32 s69,s69,11
s_add_u32 s78,s78,s69
s_add_u32 s78,s78,83886080
s_lshl_b32 s69,s67,7
s_add_u32 s70,s69,8192
Lg1_dec_a:
s_mov_b32 s59,0x20000
s_lshl_b32 s81,s72,7
s_add_u32 s82,s82,s81
v_and_b32 v11,63,v0
v_lshrrev_b32 v12,4,v11
s_lshl_b32 s81,s67,2
v_or_b32 v13,s81,v12
v_lshlrev_b32 v13,1,v13
v_and_b32 v14,15,v11
v_xor_b32 v13,v13,v14
s_lshl_b32 s81,s67,3
v_add_u32 v12,s81,v12
v_mul_lo_u32 v12,v12,s77
v_lshl_add_u32 v4,v13,4,v12
v_xor_b32 v6,s69,v10
v_xor_b32 v7,s70,v10
s_lshl_b32 s75,s72,4
s_lshl_b32 s81,s60,2
s_add_u32 s75,s75,s81
s_mul_i32 s75,s75,18432
s_add_u32 s75,s75,1048576
s_lshl_b32 s68,s77,2
s_lshl_b32 s69,s77,4
s_lshl_b32 s70,s77,5
s_bitcmp1_b32 s85,s72
s_cbranch_scc1 Lg1_lnok_a
s_add_u32 m0,s80,0
s_mov_b32 s81,s76
buffer_load_dwordx4 v4,s[56:59],s81 offen lds
s_add_u32 m0,s80,1024
s_add_u32 s81,s76,s68
buffer_load_dwordx4 v4,s[56:59],s81 offen lds
s_add_u32 m0,s80,4096
s_add_u32 s81,s76,s69
buffer_load_dwordx4 v4,s[56:59],s81 offen lds
s_add_u32 m0,s80,5120
s_add_u32 s81,s81,s68
buffer_load_dwordx4 v4,s[56:59],s81 offen lds
s_add_u32 s76,s76,s70
s_add_u32 m0,s80,32768
s_mov_b32 s81,s76
buffer_load_dwordx4 v4,s[56:59],s81 offen lds
s_add_u32 m0,s80,33792
s_add_u32 s81,s76,s68
buffer_load_dwordx4 v4,s[56:59],s81 offen lds
s_add_u32 m0,s80,36864
s_add_u32 s81,s76,s69
buffer_load_dwordx4 v4,s[56:59],s81 offen lds
s_add_u32 m0,s80,37888
s_add_u32 s81,s81,s68
buffer_load_dwordx4 v4,s[56:59],s81 offen lds
s_add_u32 s76,s76,s70
s_add_u32 m0,s80,65536
s_mov_b32 s81,s76
buffer_load_dwordx4 v4,s[56:59],s81 offen lds
s_add_u32 m0,s80,66560
s_add_u32 s81,s76,s68
buffer_load_dwordx4 v4,s[56:59],s81 offen lds
s_add_u32 m0,s80,69632
s_add_u32 s81,s76,s69
buffer_load_dwordx4 v4,s[56:59],s81 offen lds
s_add_u32 m0,s80,70656
s_add_u32 s81,s81,s68
buffer_load_dwordx4 v4,s[56:59],s81 offen lds
s_add_u32 s76,s76,s70
s_add_u32 m0,s80,98304
s_mov_b32 s81,s76
buffer_load_dwordx4 v4,s[56:59],s81 offen lds
s_add_u32 m0,s80,99328
s_add_u32 s81,s76,s68
buffer_load_dwordx4 v4,s[56:59],s81 offen lds
s_add_u32 m0,s80,102400
s_add_u32 s81,s76,s69
buffer_load_dwordx4 v4,s[56:59],s81 offen lds
s_add_u32 m0,s80,103424
s_add_u32 s81,s81,s68
buffer_load_dwordx4 v4,s[56:59],s81 offen lds
s_add_u32 s76,s76,s70
s_lshl_b32 s81,s72,7
s_add_u32 s67,s81,4096
s_cmp_lg_u32 s60,0
s_cbranch_scc1 Lwd_lna
s_mov_b32 s71,0x800000
v_mov_b32 v2,0
s_mov_b64 exec,1
Lw_lna:
buffer_load_dword v1,v2,s[8:11],s67 offen sc1
s_sub_u32 s71,s71,1
s_cbranch_scc1 Lwe_lna
s_waitcnt vmcnt(0)
v_cmp_gt_u32 vcc,16,v1
s_cbranch_vccz Lwe_lna
s_sleep 1
s_branch Lw_lna
Lwe_lna:
s_waitcnt vmcnt(0)
s_mov_b64 exec,-1
Lwd_lna:
s_barrier
s_bitset1_b32 s85,s72
s_add_u32 m0,s79,0
s_add_u32 s81,s75,0
buffer_load_dwordx4 v3,s[8:11],s81 offen sc1 lds
s_add_u32 m0,s79,1024
s_add_u32 s81,s75,18432
buffer_load_dwordx4 v3,s[8:11],s81 offen sc1 lds
s_add_u32 m0,s79,2048
s_add_u32 s81,s75,36864
buffer_load_dwordx4 v3,s[8:11],s81 offen sc1 lds
s_add_u32 m0,s79,3072
s_add_u32 s81,s75,55296
buffer_load_dwordx4 v3,s[8:11],s81 offen sc1 lds
s_add_u32 m0,s79,32768
s_add_u32 s81,s75,1024
buffer_load_dwordx4 v3,s[8:11],s81 offen sc1 lds
s_add_u32 m0,s79,33792
s_add_u32 s81,s75,19456
buffer_load_dwordx4 v3,s[8:11],s81 offen sc1 lds
s_add_u32 m0,s79,34816
s_add_u32 s81,s75,37888
buffer_load_dwordx4 v3,s[8:11],s81 offen sc1 lds
s_add_u32 m0,s79,35840
s_add_u32 s81,s75,56320
buffer_load_dwordx4 v3,s[8:11],s81 offen sc1 lds
s_add_u32 m0,s79,65536
s_add_u32 s81,s75,2048
buffer_load_dwordx4 v3,s[8:11],s81 offen sc1 lds
s_add_u32 m0,s79,66560
s_add_u32 s81,s75,20480
buffer_load_dwordx4 v3,s[8:11],s81 offen sc1 lds
s_add_u32 m0,s79,67584
s_add_u32 s81,s75,38912
buffer_load_dwordx4 v3,s[8:11],s81 offen sc1 lds
s_add_u32 m0,s79,68608
s_add_u32 s81,s75,57344
buffer_load_dwordx4 v3,s[8:11],s81 offen sc1 lds
s_add_u32 m0,s79,98304
s_add_u32 s81,s75,3072
buffer_load_dwordx4 v3,s[8:11],s81 offen sc1 lds
s_add_u32 m0,s79,99328
s_add_u32 s81,s75,21504
buffer_load_dwordx4 v3,s[8:11],s81 offen sc1 lds
s_add_u32 m0,s79,100352
s_add_u32 s81,s75,39936
buffer_load_dwordx4 v3,s[8:11],s81 offen sc1 lds
s_add_u32 m0,s79,101376
s_add_u32 s81,s75,58368
buffer_load_dwordx4 v3,s[8:11],s81 offen sc1 lds
s_waitcnt vmcnt(0)
s_branch Lg1_started_a
Lg1_lnok_a:
s_add_u32 m0,s80,0
s_mov_b32 s81,s76
buffer_load_dwordx4 v4,s[56:59],s81 offen lds
s_add_u32 m0,s80,1024
s_add_u32 s81,s76,s68
buffer_load_dwordx4 v4,s[56:59],s81 offen lds
s_add_u32 m0,s80,4096
s_add_u32 s81,s76,s69
buffer_load_dwordx4 v4,s[56:59],s81 offen lds
s_add_u32 m0,s80,5120
s_add_u32 s81,s81,s68
buffer_load_dwordx4 v4,s[56:59],s81 offen lds
s_add_u32 s76,s76,s70
s_add_u32 m0,s79,0
s_add_u32 s81,s75,0
buffer_load_dwordx4 v3,s[8:11],s81 offen sc1 lds
s_add_u32 m0,s79,1024
s_add_u32 s81,s75,18432
buffer_load_dwordx4 v3,s[8:11],s81 offen sc1 lds
s_add_u32 m0,s79,2048
s_add_u32 s81,s75,36864
buffer_load_dwordx4 v3,s[8:11],s81 offen sc1 lds
s_add_u32 m0,s79,3072
s_add_u32 s81,s75,55296
buffer_load_dwordx4 v3,s[8:11],s81 offen sc1 lds
s_add_u32 m0,s80,32768
s_mov_b32 s81,s76
buffer_load_dwordx4 v4,s[56:59],s81 offen lds
s_add_u32 m0,s80,33792
s_add_u32 s81,s76,s68
buffer_load_dwordx4 v4,s[56:59],s81 offen lds
s_add_u32 m0,s80,36864
s_add_u32 s81,s76,s69
buffer_load_dwordx4 v4,s[56:59],s81 offen lds
s_add_u32 m0,s80,37888
s_add_u32 s81,s81,s68
buffer_load_dwordx4 v4,s[56:59],s81 offen lds
s_add_u32 s76,s76,s70
s_add_u32 m0,s79,32768
s_add_u32 s81,s75,1024
buffer_load_dwordx4 v3,s[8:11],s81 offen sc1 lds
s_add_u32 m0,s79,33792
s_add_u32 s81,s75,19456
buffer_load_dwordx4 v3,s[8:11],s81 offen sc1 lds
s_add_u32 m0,s79,34816
s_add_u32 s81,s75,37888
buffer_load_dwordx4 v3,s[8:11],s81 offen sc1 lds
s_add_u32 m0,s79,35840
s_add_u32 s81,s75,56320
buffer_load_dwordx4 v3,s[8:11],s81 offen sc1 lds
s_add_u32 m0,s80,65536
s_mov_b32 s81,s76
buffer_load_dwordx4 v4,s[56:59],s81 offen lds
s_add_u32 m0,s80,66560
s_add_u32 s81,s76,s68
buffer_load_dwordx4 v4,s[56:59],s81 offen lds
s_add_u32 m0,s80,69632
s_add_u32 s81,s76,s69
buffer_load_dwordx4 v4,s[56:59],s81 offen lds
s_add_u32 m0,s80,70656
s_add_u32 s81,s81,s68
buffer_load_dwordx4 v4,s[56:59],s81 offen lds
s_add_u32 s76,s76,s70
s_add_u32 m0,s79,65536
s_add_u32 s81,s75,2048
buffer_load_dwordx4 v3,s[8:11],s81 offen sc1 lds
s_add_u32 m0,s79,66560
s_add_u32 s81,s75,20480
buffer_load_dwordx4 v3,s[8:11],s81 offen sc1 lds
s_add_u32 m0,s79,67584
s_add_u32 s81,s75,38912
buffer_load_dwordx4 v3,s[8:11],s81 offen sc1 lds
s_add_u32 m0,s79,68608
s_add_u32 s81,s75,57344
buffer_load_dwordx4 v3,s[8:11],s81 offen sc1 lds
s_add_u32 m0,s80,98304
s_mov_b32 s81,s76
buffer_load_dwordx4 v4,s[56:59],s81 offen lds
s_add_u32 m0,s80,99328
s_add_u32 s81,s76,s68
buffer_load_dwordx4 v4,s[56:59],s81 offen lds
s_add_u32 m0,s80,102400
s_add_u32 s81,s76,s69
buffer_load_dwordx4 v4,s[56:59],s81 offen lds
s_add_u32 m0,s80,103424
s_add_u32 s81,s81,s68
buffer_load_dwordx4 v4,s[56:59],s81 offen lds
s_add_u32 s76,s76,s70
s_add_u32 m0,s79,98304
s_add_u32 s81,s75,3072
buffer_load_dwordx4 v3,s[8:11],s81 offen sc1 lds
s_add_u32 m0,s79,99328
s_add_u32 s81,s75,21504
buffer_load_dwordx4 v3,s[8:11],s81 offen sc1 lds
s_add_u32 m0,s79,100352
s_add_u32 s81,s75,39936
buffer_load_dwordx4 v3,s[8:11],s81 offen sc1 lds
s_add_u32 m0,s79,101376
s_add_u32 s81,s75,58368
buffer_load_dwordx4 v3,s[8:11],s81 offen sc1 lds
Lg1_started_a:
v_xor_b32 v24,0,v6
v_xor_b32 v25,32,v6
v_xor_b32 v26,64,v6
v_xor_b32 v27,96,v6
v_xor_b32 v28,0,v7
v_xor_b32 v29,32,v7
v_xor_b32 v30,64,v7
v_xor_b32 v31,96,v7
s_waitcnt vmcnt(0)
s_mov_b32 s87,0x40000000
Lg1_task:
s_mov_b32 s73,s74
s_mov_b32 s83,s78
s_mov_b32 s86,s82
s_cmp_eq_u32 s60,0
s_cselect_b64 s[64:65],1,0
v_mov_b32 v1,1
v_mov_b32 v2,0
v_mov_b32 v9,1
v_mov_b32 v11,0x20000
s_lshl_b32 s81,s84,2
s_mov_b64 exec,s[64:65]
buffer_atomic_add v9,v2,s[32:35],s81 offen offset:32 sc0
s_mov_b64 exec,-1
s_cmp_lt_u32 s61,2
s_cbranch_scc1 Lg1_x
s_cmp_eq_u32 s73,1
s_cbranch_scc1 Lg1_vloop
s_waitcnt vmcnt(40)
s_barrier
v_add_u32 v8,0,v5
v_add_u32 v16,16384,v24
v_add_u32 v17,16384,v25
v_add_u32 v18,16384,v26
v_add_u32 v19,16384,v27
v_add_u32 v20,16384,v28
v_add_u32 v21,16384,v29
v_add_u32 v22,16384,v30
v_add_u32 v23,16384,v31
ds_read_b128 v[128:131],v8 offset:0
ds_read_b128 v[132:135],v8 offset:1024
ds_read_b128 v[136:139],v8 offset:2048
ds_read_b128 v[140:143],v8 offset:3072
ds_read_b128 v[144:147],v8 offset:4096
ds_read_b128 v[148:151],v8 offset:5120
ds_read_b128 v[152:155],v8 offset:6144
ds_read_b128 v[156:159],v8 offset:7168
ds_read_b64_tr_b16 v[160:161],v16 offset:0
ds_read_b64_tr_b16 v[162:163],v16 offset:1024
ds_read_b64_tr_b16 v[164:165],v17 offset:0
ds_read_b64_tr_b16 v[166:167],v17 offset:1024
ds_read_b64_tr_b16 v[168:169],v18 offset:0
ds_read_b64_tr_b16 v[170:171],v18 offset:1024
ds_read_b64_tr_b16 v[172:173],v19 offset:0
ds_read_b64_tr_b16 v[174:175],v19 offset:1024
ds_read_b64_tr_b16 v[176:177],v20 offset:0
ds_read_b64_tr_b16 v[178:179],v20 offset:1024
ds_read_b64_tr_b16 v[180:181],v21 offset:0
ds_read_b64_tr_b16 v[182:183],v21 offset:1024
ds_read_b64_tr_b16 v[184:185],v22 offset:0
ds_read_b64_tr_b16 v[186:187],v22 offset:1024
ds_read_b64_tr_b16 v[188:189],v23 offset:0
ds_read_b64_tr_b16 v[190:191],v23 offset:1024
s_waitcnt vmcnt(32) lgkmcnt(0)
s_barrier
v_mfma_f32_16x16x32_bf16 a[0:3],v[160:163],v[128:131],0
v_add_u32 v8,32768,v5
v_mfma_f32_16x16x32_bf16 a[4:7],v[160:163],v[132:135],0
v_mfma_f32_16x16x32_bf16 a[8:11],v[160:163],v[136:139],0
ds_read_b128 v[192:195],v8 offset:0
v_add_u32 v16,49152,v24
v_mfma_f32_16x16x32_bf16 a[12:15],v[160:163],v[140:143],0
s_add_u32 m0,s80,131072
s_mov_b32 s81,s76
buffer_load_dwordx4 v4,s[56:59],s81 offen lds
v_mfma_f32_16x16x32_bf16 a[16:19],v[160:163],v[144:147],0
ds_read_b128 v[196:199],v8 offset:1024
v_add_u32 v17,49152,v25
v_mfma_f32_16x16x32_bf16 a[20:23],v[160:163],v[148:151],0
v_mfma_f32_16x16x32_bf16 a[24:27],v[160:163],v[152:155],0
ds_read_b128 v[200:203],v8 offset:2048
v_add_u32 v18,49152,v26
v_mfma_f32_16x16x32_bf16 a[28:31],v[160:163],v[156:159],0
v_mfma_f32_16x16x32_bf16 a[32:35],v[164:167],v[128:131],0
ds_read_b128 v[204:207],v8 offset:3072
v_add_u32 v19,49152,v27
v_mfma_f32_16x16x32_bf16 a[36:39],v[164:167],v[132:135],0
v_mfma_f32_16x16x32_bf16 a[40:43],v[164:167],v[136:139],0
s_add_u32 m0,s80,132096
s_add_u32 s81,s76,s68
buffer_load_dwordx4 v4,s[56:59],s81 offen lds
v_mfma_f32_16x16x32_bf16 a[44:47],v[164:167],v[140:143],0
v_mfma_f32_16x16x32_bf16 a[48:51],v[164:167],v[144:147],0
ds_read_b128 v[208:211],v8 offset:4096
v_add_u32 v20,49152,v28
v_mfma_f32_16x16x32_bf16 a[52:55],v[164:167],v[148:151],0
v_mfma_f32_16x16x32_bf16 a[56:59],v[164:167],v[152:155],0
ds_read_b128 v[212:215],v8 offset:5120
v_add_u32 v21,49152,v29
v_mfma_f32_16x16x32_bf16 a[60:63],v[164:167],v[156:159],0
v_mfma_f32_16x16x32_bf16 a[64:67],v[168:171],v[128:131],0
ds_read_b128 v[216:219],v8 offset:6144
v_add_u32 v22,49152,v30
v_mfma_f32_16x16x32_bf16 a[68:71],v[168:171],v[132:135],0
s_add_u32 m0,s80,135168
s_add_u32 s81,s76,s69
buffer_load_dwordx4 v4,s[56:59],s81 offen lds
v_mfma_f32_16x16x32_bf16 a[72:75],v[168:171],v[136:139],0
ds_read_b128 v[220:223],v8 offset:7168
v_add_u32 v23,49152,v31
v_mfma_f32_16x16x32_bf16 a[76:79],v[168:171],v[140:143],0
v_mfma_f32_16x16x32_bf16 a[80:83],v[168:171],v[144:147],0
ds_read_b64_tr_b16 v[224:225],v16 offset:0
v_mfma_f32_16x16x32_bf16 a[84:87],v[168:171],v[148:151],0
v_mfma_f32_16x16x32_bf16 a[88:91],v[168:171],v[152:155],0
ds_read_b64_tr_b16 v[226:227],v16 offset:1024
v_mfma_f32_16x16x32_bf16 a[92:95],v[168:171],v[156:159],0
v_mfma_f32_16x16x32_bf16 a[96:99],v[172:175],v[128:131],0
s_add_u32 m0,s80,136192
s_add_u32 s81,s81,s68
buffer_load_dwordx4 v4,s[56:59],s81 offen lds
s_add_u32 s76,s76,s70
v_mfma_f32_16x16x32_bf16 a[100:103],v[172:175],v[132:135],0
v_mfma_f32_16x16x32_bf16 a[104:107],v[172:175],v[136:139],0
ds_read_b64_tr_b16 v[228:229],v17 offset:0
v_mfma_f32_16x16x32_bf16 a[108:111],v[172:175],v[140:143],0
v_mfma_f32_16x16x32_bf16 a[112:115],v[172:175],v[144:147],0
ds_read_b64_tr_b16 v[230:231],v17 offset:1024
v_mfma_f32_16x16x32_bf16 a[116:119],v[172:175],v[148:151],0
v_mfma_f32_16x16x32_bf16 a[120:123],v[172:175],v[152:155],0
ds_read_b64_tr_b16 v[232:233],v18 offset:0
v_mfma_f32_16x16x32_bf16 a[124:127],v[172:175],v[156:159],0
s_add_u32 m0,s79,131072
s_add_u32 s81,s75,4096
buffer_load_dwordx4 v3,s[8:11],s81 offen sc1 lds
v_mfma_f32_16x16x32_bf16 a[128:131],v[176:179],v[128:131],0
ds_read_b64_tr_b16 v[234:235],v18 offset:1024
v_mfma_f32_16x16x32_bf16 a[132:135],v[176:179],v[132:135],0
v_mfma_f32_16x16x32_bf16 a[136:139],v[176:179],v[136:139],0
ds_read_b64_tr_b16 v[236:237],v19 offset:0
v_mfma_f32_16x16x32_bf16 a[140:143],v[176:179],v[140:143],0
v_mfma_f32_16x16x32_bf16 a[144:147],v[176:179],v[144:147],0
ds_read_b64_tr_b16 v[238:239],v19 offset:1024
v_mfma_f32_16x16x32_bf16 a[148:151],v[176:179],v[148:151],0
v_mfma_f32_16x16x32_bf16 a[152:155],v[176:179],v[152:155],0
s_add_u32 m0,s79,132096
s_add_u32 s81,s75,22528
buffer_load_dwordx4 v3,s[8:11],s81 offen sc1 lds
v_mfma_f32_16x16x32_bf16 a[156:159],v[176:179],v[156:159],0
v_mfma_f32_16x16x32_bf16 a[160:163],v[180:183],v[128:131],0
ds_read_b64_tr_b16 v[240:241],v20 offset:0
v_mfma_f32_16x16x32_bf16 a[164:167],v[180:183],v[132:135],0
v_mfma_f32_16x16x32_bf16 a[168:171],v[180:183],v[136:139],0
ds_read_b64_tr_b16 v[242:243],v20 offset:1024
v_mfma_f32_16x16x32_bf16 a[172:175],v[180:183],v[140:143],0
v_mfma_f32_16x16x32_bf16 a[176:179],v[180:183],v[144:147],0
ds_read_b64_tr_b16 v[244:245],v21 offset:0
v_mfma_f32_16x16x32_bf16 a[180:183],v[180:183],v[148:151],0
s_add_u32 m0,s79,133120
s_add_u32 s81,s75,40960
buffer_load_dwordx4 v3,s[8:11],s81 offen sc1 lds
v_mfma_f32_16x16x32_bf16 a[184:187],v[180:183],v[152:155],0
ds_read_b64_tr_b16 v[246:247],v21 offset:1024
v_mfma_f32_16x16x32_bf16 a[188:191],v[180:183],v[156:159],0
v_mfma_f32_16x16x32_bf16 a[192:195],v[184:187],v[128:131],0
ds_read_b64_tr_b16 v[248:249],v22 offset:0
v_mfma_f32_16x16x32_bf16 a[196:199],v[184:187],v[132:135],0
v_mfma_f32_16x16x32_bf16 a[200:203],v[184:187],v[136:139],0
ds_read_b64_tr_b16 v[250:251],v22 offset:1024
v_mfma_f32_16x16x32_bf16 a[204:207],v[184:187],v[140:143],0
v_mfma_f32_16x16x32_bf16 a[208:211],v[184:187],v[144:147],0
s_add_u32 m0,s79,134144
s_add_u32 s81,s75,59392
buffer_load_dwordx4 v3,s[8:11],s81 offen sc1 lds
v_mfma_f32_16x16x32_bf16 a[212:215],v[184:187],v[148:151],0
v_mfma_f32_16x16x32_bf16 a[216:219],v[184:187],v[152:155],0
ds_read_b64_tr_b16 v[252:253],v23 offset:0
v_mfma_f32_16x16x32_bf16 a[220:223],v[184:187],v[156:159],0
v_mfma_f32_16x16x32_bf16 a[224:227],v[188:191],v[128:131],0
ds_read_b64_tr_b16 v[254:255],v23 offset:1024
v_mfma_f32_16x16x32_bf16 a[228:231],v[188:191],v[132:135],0
v_mfma_f32_16x16x32_bf16 a[232:235],v[188:191],v[136:139],0
v_mfma_f32_16x16x32_bf16 a[236:239],v[188:191],v[140:143],0
v_mfma_f32_16x16x32_bf16 a[240:243],v[188:191],v[144:147],0
v_mfma_f32_16x16x32_bf16 a[244:247],v[188:191],v[148:151],0
v_mfma_f32_16x16x32_bf16 a[248:251],v[188:191],v[152:155],0
v_mfma_f32_16x16x32_bf16 a[252:255],v[188:191],v[156:159],0
s_waitcnt vmcnt(32) lgkmcnt(0)
s_barrier
v_mfma_f32_16x16x32_bf16 a[0:3],v[224:227],v[192:195],a[0:3]
v_add_u32 v8,65536,v5
v_mfma_f32_16x16x32_bf16 a[4:7],v[224:227],v[196:199],a[4:7]
v_mfma_f32_16x16x32_bf16 a[8:11],v[224:227],v[200:203],a[8:11]
ds_read_b128 v[128:131],v8 offset:0
v_add_u32 v16,81920,v24
v_mfma_f32_16x16x32_bf16 a[12:15],v[224:227],v[204:207],a[12:15]
s_add_u32 m0,s80,0
s_mov_b32 s81,s76
buffer_load_dwordx4 v4,s[56:59],s81 offen lds
v_mfma_f32_16x16x32_bf16 a[16:19],v[224:227],v[208:211],a[16:19]
ds_read_b128 v[132:135],v8 offset:1024
v_add_u32 v17,81920,v25
v_mfma_f32_16x16x32_bf16 a[20:23],v[224:227],v[212:215],a[20:23]
v_mfma_f32_16x16x32_bf16 a[24:27],v[224:227],v[216:219],a[24:27]
ds_read_b128 v[136:139],v8 offset:2048
v_add_u32 v18,81920,v26
v_mfma_f32_16x16x32_bf16 a[28:31],v[224:227],v[220:223],a[28:31]
v_mfma_f32_16x16x32_bf16 a[32:35],v[228:231],v[192:195],a[32:35]
ds_read_b128 v[140:143],v8 offset:3072
v_add_u32 v19,81920,v27
v_mfma_f32_16x16x32_bf16 a[36:39],v[228:231],v[196:199],a[36:39]
v_mfma_f32_16x16x32_bf16 a[40:43],v[228:231],v[200:203],a[40:43]
s_add_u32 m0,s80,1024
s_add_u32 s81,s76,s68
buffer_load_dwordx4 v4,s[56:59],s81 offen lds
v_mfma_f32_16x16x32_bf16 a[44:47],v[228:231],v[204:207],a[44:47]
v_mfma_f32_16x16x32_bf16 a[48:51],v[228:231],v[208:211],a[48:51]
ds_read_b128 v[144:147],v8 offset:4096
v_add_u32 v20,81920,v28
v_mfma_f32_16x16x32_bf16 a[52:55],v[228:231],v[212:215],a[52:55]
v_mfma_f32_16x16x32_bf16 a[56:59],v[228:231],v[216:219],a[56:59]
ds_read_b128 v[148:151],v8 offset:5120
v_add_u32 v21,81920,v29
v_mfma_f32_16x16x32_bf16 a[60:63],v[228:231],v[220:223],a[60:63]
v_mfma_f32_16x16x32_bf16 a[64:67],v[232:235],v[192:195],a[64:67]
ds_read_b128 v[152:155],v8 offset:6144
v_add_u32 v22,81920,v30
v_mfma_f32_16x16x32_bf16 a[68:71],v[232:235],v[196:199],a[68:71]
s_add_u32 m0,s80,4096
s_add_u32 s81,s76,s69
buffer_load_dwordx4 v4,s[56:59],s81 offen lds
v_mfma_f32_16x16x32_bf16 a[72:75],v[232:235],v[200:203],a[72:75]
ds_read_b128 v[156:159],v8 offset:7168
v_add_u32 v23,81920,v31
v_mfma_f32_16x16x32_bf16 a[76:79],v[232:235],v[204:207],a[76:79]
v_mfma_f32_16x16x32_bf16 a[80:83],v[232:235],v[208:211],a[80:83]
ds_read_b64_tr_b16 v[160:161],v16 offset:0
v_mfma_f32_16x16x32_bf16 a[84:87],v[232:235],v[212:215],a[84:87]
v_mfma_f32_16x16x32_bf16 a[88:91],v[232:235],v[216:219],a[88:91]
ds_read_b64_tr_b16 v[162:163],v16 offset:1024
v_mfma_f32_16x16x32_bf16 a[92:95],v[232:235],v[220:223],a[92:95]
v_mfma_f32_16x16x32_bf16 a[96:99],v[236:239],v[192:195],a[96:99]
s_add_u32 m0,s80,5120
s_add_u32 s81,s81,s68
buffer_load_dwordx4 v4,s[56:59],s81 offen lds
s_add_u32 s76,s76,s70
v_mfma_f32_16x16x32_bf16 a[100:103],v[236:239],v[196:199],a[100:103]
v_mfma_f32_16x16x32_bf16 a[104:107],v[236:239],v[200:203],a[104:107]
ds_read_b64_tr_b16 v[164:165],v17 offset:0
v_mfma_f32_16x16x32_bf16 a[108:111],v[236:239],v[204:207],a[108:111]
v_mfma_f32_16x16x32_bf16 a[112:115],v[236:239],v[208:211],a[112:115]
ds_read_b64_tr_b16 v[166:167],v17 offset:1024
v_mfma_f32_16x16x32_bf16 a[116:119],v[236:239],v[212:215],a[116:119]
v_mfma_f32_16x16x32_bf16 a[120:123],v[236:239],v[216:219],a[120:123]
ds_read_b64_tr_b16 v[168:169],v18 offset:0
v_mfma_f32_16x16x32_bf16 a[124:127],v[236:239],v[220:223],a[124:127]
s_add_u32 m0,s79,0
s_add_u32 s81,s75,5120
buffer_load_dwordx4 v3,s[8:11],s81 offen sc1 lds
v_mfma_f32_16x16x32_bf16 a[128:131],v[240:243],v[192:195],a[128:131]
ds_read_b64_tr_b16 v[170:171],v18 offset:1024
v_mfma_f32_16x16x32_bf16 a[132:135],v[240:243],v[196:199],a[132:135]
v_mfma_f32_16x16x32_bf16 a[136:139],v[240:243],v[200:203],a[136:139]
ds_read_b64_tr_b16 v[172:173],v19 offset:0
v_mfma_f32_16x16x32_bf16 a[140:143],v[240:243],v[204:207],a[140:143]
v_mfma_f32_16x16x32_bf16 a[144:147],v[240:243],v[208:211],a[144:147]
ds_read_b64_tr_b16 v[174:175],v19 offset:1024
v_mfma_f32_16x16x32_bf16 a[148:151],v[240:243],v[212:215],a[148:151]
v_mfma_f32_16x16x32_bf16 a[152:155],v[240:243],v[216:219],a[152:155]
s_add_u32 m0,s79,1024
s_add_u32 s81,s75,23552
buffer_load_dwordx4 v3,s[8:11],s81 offen sc1 lds
v_mfma_f32_16x16x32_bf16 a[156:159],v[240:243],v[220:223],a[156:159]
v_mfma_f32_16x16x32_bf16 a[160:163],v[244:247],v[192:195],a[160:163]
ds_read_b64_tr_b16 v[176:177],v20 offset:0
v_mfma_f32_16x16x32_bf16 a[164:167],v[244:247],v[196:199],a[164:167]
v_mfma_f32_16x16x32_bf16 a[168:171],v[244:247],v[200:203],a[168:171]
ds_read_b64_tr_b16 v[178:179],v20 offset:1024
v_mfma_f32_16x16x32_bf16 a[172:175],v[244:247],v[204:207],a[172:175]
v_mfma_f32_16x16x32_bf16 a[176:179],v[244:247],v[208:211],a[176:179]
ds_read_b64_tr_b16 v[180:181],v21 offset:0
v_mfma_f32_16x16x32_bf16 a[180:183],v[244:247],v[212:215],a[180:183]
s_add_u32 m0,s79,2048
s_add_u32 s81,s75,41984
buffer_load_dwordx4 v3,s[8:11],s81 offen sc1 lds
v_mfma_f32_16x16x32_bf16 a[184:187],v[244:247],v[216:219],a[184:187]
ds_read_b64_tr_b16 v[182:183],v21 offset:1024
v_mfma_f32_16x16x32_bf16 a[188:191],v[244:247],v[220:223],a[188:191]
v_mfma_f32_16x16x32_bf16 a[192:195],v[248:251],v[192:195],a[192:195]
ds_read_b64_tr_b16 v[184:185],v22 offset:0
v_mfma_f32_16x16x32_bf16 a[196:199],v[248:251],v[196:199],a[196:199]
v_mfma_f32_16x16x32_bf16 a[200:203],v[248:251],v[200:203],a[200:203]
ds_read_b64_tr_b16 v[186:187],v22 offset:1024
v_mfma_f32_16x16x32_bf16 a[204:207],v[248:251],v[204:207],a[204:207]
v_mfma_f32_16x16x32_bf16 a[208:211],v[248:251],v[208:211],a[208:211]
s_add_u32 m0,s79,3072
s_add_u32 s81,s75,60416
buffer_load_dwordx4 v3,s[8:11],s81 offen sc1 lds
v_mfma_f32_16x16x32_bf16 a[212:215],v[248:251],v[212:215],a[212:215]
v_mfma_f32_16x16x32_bf16 a[216:219],v[248:251],v[216:219],a[216:219]
ds_read_b64_tr_b16 v[188:189],v23 offset:0
v_mfma_f32_16x16x32_bf16 a[220:223],v[248:251],v[220:223],a[220:223]
v_mfma_f32_16x16x32_bf16 a[224:227],v[252:255],v[192:195],a[224:227]
ds_read_b64_tr_b16 v[190:191],v23 offset:1024
v_mfma_f32_16x16x32_bf16 a[228:231],v[252:255],v[196:199],a[228:231]
v_mfma_f32_16x16x32_bf16 a[232:235],v[252:255],v[200:203],a[232:235]
v_mfma_f32_16x16x32_bf16 a[236:239],v[252:255],v[204:207],a[236:239]
v_mfma_f32_16x16x32_bf16 a[240:243],v[252:255],v[208:211],a[240:243]
v_mfma_f32_16x16x32_bf16 a[244:247],v[252:255],v[212:215],a[244:247]
v_mfma_f32_16x16x32_bf16 a[248:251],v[252:255],v[216:219],a[248:251]
v_mfma_f32_16x16x32_bf16 a[252:255],v[252:255],v[220:223],a[252:255]
s_waitcnt vmcnt(32) lgkmcnt(0)
s_barrier
v_mfma_f32_16x16x32_bf16 a[0:3],v[160:163],v[128:131],a[0:3]
v_add_u32 v8,98304,v5
v_mfma_f32_16x16x32_bf16 a[4:7],v[160:163],v[132:135],a[4:7]
v_mfma_f32_16x16x32_bf16 a[8:11],v[160:163],v[136:139],a[8:11]
ds_read_b128 v[192:195],v8 offset:0
v_add_u32 v16,114688,v24
v_mfma_f32_16x16x32_bf16 a[12:15],v[160:163],v[140:143],a[12:15]
s_add_u32 m0,s80,32768
s_mov_b32 s81,s76
buffer_load_dwordx4 v4,s[56:59],s81 offen lds
v_mfma_f32_16x16x32_bf16 a[16:19],v[160:163],v[144:147],a[16:19]
ds_read_b128 v[196:199],v8 offset:1024
v_add_u32 v17,114688,v25
v_mfma_f32_16x16x32_bf16 a[20:23],v[160:163],v[148:151],a[20:23]
v_mfma_f32_16x16x32_bf16 a[24:27],v[160:163],v[152:155],a[24:27]
ds_read_b128 v[200:203],v8 offset:2048
v_add_u32 v18,114688,v26
v_mfma_f32_16x16x32_bf16 a[28:31],v[160:163],v[156:159],a[28:31]
v_mfma_f32_16x16x32_bf16 a[32:35],v[164:167],v[128:131],a[32:35]
ds_read_b128 v[204:207],v8 offset:3072
v_add_u32 v19,114688,v27
v_mfma_f32_16x16x32_bf16 a[36:39],v[164:167],v[132:135],a[36:39]
v_mfma_f32_16x16x32_bf16 a[40:43],v[164:167],v[136:139],a[40:43]
s_add_u32 m0,s80,33792
s_add_u32 s81,s76,s68
buffer_load_dwordx4 v4,s[56:59],s81 offen lds
v_mfma_f32_16x16x32_bf16 a[44:47],v[164:167],v[140:143],a[44:47]
v_mfma_f32_16x16x32_bf16 a[48:51],v[164:167],v[144:147],a[48:51]
ds_read_b128 v[208:211],v8 offset:4096
v_add_u32 v20,114688,v28
v_mfma_f32_16x16x32_bf16 a[52:55],v[164:167],v[148:151],a[52:55]
v_mfma_f32_16x16x32_bf16 a[56:59],v[164:167],v[152:155],a[56:59]
ds_read_b128 v[212:215],v8 offset:5120
v_add_u32 v21,114688,v29
v_mfma_f32_16x16x32_bf16 a[60:63],v[164:167],v[156:159],a[60:63]
v_mfma_f32_16x16x32_bf16 a[64:67],v[168:171],v[128:131],a[64:67]
ds_read_b128 v[216:219],v8 offset:6144
v_add_u32 v22,114688,v30
v_mfma_f32_16x16x32_bf16 a[68:71],v[168:171],v[132:135],a[68:71]
s_add_u32 m0,s80,36864
s_add_u32 s81,s76,s69
buffer_load_dwordx4 v4,s[56:59],s81 offen lds
v_mfma_f32_16x16x32_bf16 a[72:75],v[168:171],v[136:139],a[72:75]
ds_read_b128 v[220:223],v8 offset:7168
v_add_u32 v23,114688,v31
v_mfma_f32_16x16x32_bf16 a[76:79],v[168:171],v[140:143],a[76:79]
v_mfma_f32_16x16x32_bf16 a[80:83],v[168:171],v[144:147],a[80:83]
ds_read_b64_tr_b16 v[224:225],v16 offset:0
v_mfma_f32_16x16x32_bf16 a[84:87],v[168:171],v[148:151],a[84:87]
v_mfma_f32_16x16x32_bf16 a[88:91],v[168:171],v[152:155],a[88:91]
ds_read_b64_tr_b16 v[226:227],v16 offset:1024
v_mfma_f32_16x16x32_bf16 a[92:95],v[168:171],v[156:159],a[92:95]
v_mfma_f32_16x16x32_bf16 a[96:99],v[172:175],v[128:131],a[96:99]
s_add_u32 m0,s80,37888
s_add_u32 s81,s81,s68
buffer_load_dwordx4 v4,s[56:59],s81 offen lds
s_add_u32 s76,s76,s70
v_mfma_f32_16x16x32_bf16 a[100:103],v[172:175],v[132:135],a[100:103]
v_mfma_f32_16x16x32_bf16 a[104:107],v[172:175],v[136:139],a[104:107]
ds_read_b64_tr_b16 v[228:229],v17 offset:0
v_mfma_f32_16x16x32_bf16 a[108:111],v[172:175],v[140:143],a[108:111]
v_mfma_f32_16x16x32_bf16 a[112:115],v[172:175],v[144:147],a[112:115]
ds_read_b64_tr_b16 v[230:231],v17 offset:1024
v_mfma_f32_16x16x32_bf16 a[116:119],v[172:175],v[148:151],a[116:119]
v_mfma_f32_16x16x32_bf16 a[120:123],v[172:175],v[152:155],a[120:123]
ds_read_b64_tr_b16 v[232:233],v18 offset:0
v_mfma_f32_16x16x32_bf16 a[124:127],v[172:175],v[156:159],a[124:127]
s_add_u32 m0,s79,32768
s_add_u32 s81,s75,6144
buffer_load_dwordx4 v3,s[8:11],s81 offen sc1 lds
v_mfma_f32_16x16x32_bf16 a[128:131],v[176:179],v[128:131],a[128:131]
ds_read_b64_tr_b16 v[234:235],v18 offset:1024
v_mfma_f32_16x16x32_bf16 a[132:135],v[176:179],v[132:135],a[132:135]
v_mfma_f32_16x16x32_bf16 a[136:139],v[176:179],v[136:139],a[136:139]
ds_read_b64_tr_b16 v[236:237],v19 offset:0
v_mfma_f32_16x16x32_bf16 a[140:143],v[176:179],v[140:143],a[140:143]
v_mfma_f32_16x16x32_bf16 a[144:147],v[176:179],v[144:147],a[144:147]
ds_read_b64_tr_b16 v[238:239],v19 offset:1024
v_mfma_f32_16x16x32_bf16 a[148:151],v[176:179],v[148:151],a[148:151]
v_mfma_f32_16x16x32_bf16 a[152:155],v[176:179],v[152:155],a[152:155]
s_add_u32 m0,s79,33792
s_add_u32 s81,s75,24576
buffer_load_dwordx4 v3,s[8:11],s81 offen sc1 lds
v_mfma_f32_16x16x32_bf16 a[156:159],v[176:179],v[156:159],a[156:159]
v_mfma_f32_16x16x32_bf16 a[160:163],v[180:183],v[128:131],a[160:163]
ds_read_b64_tr_b16 v[240:241],v20 offset:0
v_mfma_f32_16x16x32_bf16 a[164:167],v[180:183],v[132:135],a[164:167]
v_mfma_f32_16x16x32_bf16 a[168:171],v[180:183],v[136:139],a[168:171]
ds_read_b64_tr_b16 v[242:243],v20 offset:1024
v_mfma_f32_16x16x32_bf16 a[172:175],v[180:183],v[140:143],a[172:175]
v_mfma_f32_16x16x32_bf16 a[176:179],v[180:183],v[144:147],a[176:179]
ds_read_b64_tr_b16 v[244:245],v21 offset:0
v_mfma_f32_16x16x32_bf16 a[180:183],v[180:183],v[148:151],a[180:183]
s_add_u32 m0,s79,34816
s_add_u32 s81,s75,43008
buffer_load_dwordx4 v3,s[8:11],s81 offen sc1 lds
v_mfma_f32_16x16x32_bf16 a[184:187],v[180:183],v[152:155],a[184:187]
ds_read_b64_tr_b16 v[246:247],v21 offset:1024
v_mfma_f32_16x16x32_bf16 a[188:191],v[180:183],v[156:159],a[188:191]
v_mfma_f32_16x16x32_bf16 a[192:195],v[184:187],v[128:131],a[192:195]
ds_read_b64_tr_b16 v[248:249],v22 offset:0
v_mfma_f32_16x16x32_bf16 a[196:199],v[184:187],v[132:135],a[196:199]
v_mfma_f32_16x16x32_bf16 a[200:203],v[184:187],v[136:139],a[200:203]
ds_read_b64_tr_b16 v[250:251],v22 offset:1024
v_mfma_f32_16x16x32_bf16 a[204:207],v[184:187],v[140:143],a[204:207]
v_mfma_f32_16x16x32_bf16 a[208:211],v[184:187],v[144:147],a[208:211]
s_add_u32 m0,s79,35840
s_add_u32 s81,s75,61440
buffer_load_dwordx4 v3,s[8:11],s81 offen sc1 lds
v_mfma_f32_16x16x32_bf16 a[212:215],v[184:187],v[148:151],a[212:215]
v_mfma_f32_16x16x32_bf16 a[216:219],v[184:187],v[152:155],a[216:219]
ds_read_b64_tr_b16 v[252:253],v23 offset:0
v_mfma_f32_16x16x32_bf16 a[220:223],v[184:187],v[156:159],a[220:223]
v_mfma_f32_16x16x32_bf16 a[224:227],v[188:191],v[128:131],a[224:227]
ds_read_b64_tr_b16 v[254:255],v23 offset:1024
v_mfma_f32_16x16x32_bf16 a[228:231],v[188:191],v[132:135],a[228:231]
v_mfma_f32_16x16x32_bf16 a[232:235],v[188:191],v[136:139],a[232:235]
v_mfma_f32_16x16x32_bf16 a[236:239],v[188:191],v[140:143],a[236:239]
v_mfma_f32_16x16x32_bf16 a[240:243],v[188:191],v[144:147],a[240:243]
v_mfma_f32_16x16x32_bf16 a[244:247],v[188:191],v[148:151],a[244:247]
v_mfma_f32_16x16x32_bf16 a[248:251],v[188:191],v[152:155],a[248:251]
v_mfma_f32_16x16x32_bf16 a[252:255],v[188:191],v[156:159],a[252:255]
s_waitcnt vmcnt(16) lgkmcnt(0)
s_barrier
v_mfma_f32_16x16x32_bf16 a[0:3],v[224:227],v[192:195],a[0:3]
v_add_u32 v8,131072,v5
v_mfma_f32_16x16x32_bf16 a[4:7],v[224:227],v[196:199],a[4:7]
v_mfma_f32_16x16x32_bf16 a[8:11],v[224:227],v[200:203],a[8:11]
ds_read_b128 v[128:131],v8 offset:0
v_add_u32 v16,147456,v24
v_mfma_f32_16x16x32_bf16 a[12:15],v[224:227],v[204:207],a[12:15]
s_add_u32 m0,s80,65536
s_mov_b32 s81,s76
buffer_load_dwordx4 v4,s[56:59],s81 offen lds
v_mfma_f32_16x16x32_bf16 a[16:19],v[224:227],v[208:211],a[16:19]
ds_read_b128 v[132:135],v8 offset:1024
v_add_u32 v17,147456,v25
v_mfma_f32_16x16x32_bf16 a[20:23],v[224:227],v[212:215],a[20:23]
v_mfma_f32_16x16x32_bf16 a[24:27],v[224:227],v[216:219],a[24:27]
ds_read_b128 v[136:139],v8 offset:2048
v_add_u32 v18,147456,v26
v_mfma_f32_16x16x32_bf16 a[28:31],v[224:227],v[220:223],a[28:31]
v_mfma_f32_16x16x32_bf16 a[32:35],v[228:231],v[192:195],a[32:35]
ds_read_b128 v[140:143],v8 offset:3072
v_add_u32 v19,147456,v27
v_mfma_f32_16x16x32_bf16 a[36:39],v[228:231],v[196:199],a[36:39]
v_mfma_f32_16x16x32_bf16 a[40:43],v[228:231],v[200:203],a[40:43]
s_add_u32 m0,s80,66560
s_add_u32 s81,s76,s68
buffer_load_dwordx4 v4,s[56:59],s81 offen lds
v_mfma_f32_16x16x32_bf16 a[44:47],v[228:231],v[204:207],a[44:47]
v_mfma_f32_16x16x32_bf16 a[48:51],v[228:231],v[208:211],a[48:51]
ds_read_b128 v[144:147],v8 offset:4096
v_add_u32 v20,147456,v28
v_mfma_f32_16x16x32_bf16 a[52:55],v[228:231],v[212:215],a[52:55]
v_mfma_f32_16x16x32_bf16 a[56:59],v[228:231],v[216:219],a[56:59]
ds_read_b128 v[148:151],v8 offset:5120
v_add_u32 v21,147456,v29
v_mfma_f32_16x16x32_bf16 a[60:63],v[228:231],v[220:223],a[60:63]
v_mfma_f32_16x16x32_bf16 a[64:67],v[232:235],v[192:195],a[64:67]
ds_read_b128 v[152:155],v8 offset:6144
v_add_u32 v22,147456,v30
v_mfma_f32_16x16x32_bf16 a[68:71],v[232:235],v[196:199],a[68:71]
s_add_u32 m0,s80,69632
s_add_u32 s81,s76,s69
buffer_load_dwordx4 v4,s[56:59],s81 offen lds
v_mfma_f32_16x16x32_bf16 a[72:75],v[232:235],v[200:203],a[72:75]
ds_read_b128 v[156:159],v8 offset:7168
v_add_u32 v23,147456,v31
v_mfma_f32_16x16x32_bf16 a[76:79],v[232:235],v[204:207],a[76:79]
v_mfma_f32_16x16x32_bf16 a[80:83],v[232:235],v[208:211],a[80:83]
ds_read_b64_tr_b16 v[160:161],v16 offset:0
v_mfma_f32_16x16x32_bf16 a[84:87],v[232:235],v[212:215],a[84:87]
v_mfma_f32_16x16x32_bf16 a[88:91],v[232:235],v[216:219],a[88:91]
ds_read_b64_tr_b16 v[162:163],v16 offset:1024
v_mfma_f32_16x16x32_bf16 a[92:95],v[232:235],v[220:223],a[92:95]
v_mfma_f32_16x16x32_bf16 a[96:99],v[236:239],v[192:195],a[96:99]
s_add_u32 m0,s80,70656
s_add_u32 s81,s81,s68
buffer_load_dwordx4 v4,s[56:59],s81 offen lds
s_add_u32 s76,s76,s70
v_mfma_f32_16x16x32_bf16 a[100:103],v[236:239],v[196:199],a[100:103]
v_mfma_f32_16x16x32_bf16 a[104:107],v[236:239],v[200:203],a[104:107]
ds_read_b64_tr_b16 v[164:165],v17 offset:0
v_mfma_f32_16x16x32_bf16 a[108:111],v[236:239],v[204:207],a[108:111]
v_mfma_f32_16x16x32_bf16 a[112:115],v[236:239],v[208:211],a[112:115]
ds_read_b64_tr_b16 v[166:167],v17 offset:1024
v_mfma_f32_16x16x32_bf16 a[116:119],v[236:239],v[212:215],a[116:119]
v_mfma_f32_16x16x32_bf16 a[120:123],v[236:239],v[216:219],a[120:123]
ds_read_b64_tr_b16 v[168:169],v18 offset:0
v_mfma_f32_16x16x32_bf16 a[124:127],v[236:239],v[220:223],a[124:127]
s_add_u32 m0,s79,65536
s_add_u32 s81,s75,7168
buffer_load_dwordx4 v3,s[8:11],s81 offen sc1 lds
v_mfma_f32_16x16x32_bf16 a[128:131],v[240:243],v[192:195],a[128:131]
ds_read_b64_tr_b16 v[170:171],v18 offset:1024
v_mfma_f32_16x16x32_bf16 a[132:135],v[240:243],v[196:199],a[132:135]
v_mfma_f32_16x16x32_bf16 a[136:139],v[240:243],v[200:203],a[136:139]
ds_read_b64_tr_b16 v[172:173],v19 offset:0
v_mfma_f32_16x16x32_bf16 a[140:143],v[240:243],v[204:207],a[140:143]
v_mfma_f32_16x16x32_bf16 a[144:147],v[240:243],v[208:211],a[144:147]
ds_read_b64_tr_b16 v[174:175],v19 offset:1024
v_mfma_f32_16x16x32_bf16 a[148:151],v[240:243],v[212:215],a[148:151]
v_mfma_f32_16x16x32_bf16 a[152:155],v[240:243],v[216:219],a[152:155]
s_add_u32 m0,s79,66560
s_add_u32 s81,s75,25600
buffer_load_dwordx4 v3,s[8:11],s81 offen sc1 lds
v_mfma_f32_16x16x32_bf16 a[156:159],v[240:243],v[220:223],a[156:159]
v_mfma_f32_16x16x32_bf16 a[160:163],v[244:247],v[192:195],a[160:163]
ds_read_b64_tr_b16 v[176:177],v20 offset:0
v_mfma_f32_16x16x32_bf16 a[164:167],v[244:247],v[196:199],a[164:167]
v_mfma_f32_16x16x32_bf16 a[168:171],v[244:247],v[200:203],a[168:171]
ds_read_b64_tr_b16 v[178:179],v20 offset:1024
v_mfma_f32_16x16x32_bf16 a[172:175],v[244:247],v[204:207],a[172:175]
v_mfma_f32_16x16x32_bf16 a[176:179],v[244:247],v[208:211],a[176:179]
ds_read_b64_tr_b16 v[180:181],v21 offset:0
v_mfma_f32_16x16x32_bf16 a[180:183],v[244:247],v[212:215],a[180:183]
s_add_u32 m0,s79,67584
s_add_u32 s81,s75,44032
buffer_load_dwordx4 v3,s[8:11],s81 offen sc1 lds
v_mfma_f32_16x16x32_bf16 a[184:187],v[244:247],v[216:219],a[184:187]
ds_read_b64_tr_b16 v[182:183],v21 offset:1024
v_mfma_f32_16x16x32_bf16 a[188:191],v[244:247],v[220:223],a[188:191]
v_mfma_f32_16x16x32_bf16 a[192:195],v[248:251],v[192:195],a[192:195]
ds_read_b64_tr_b16 v[184:185],v22 offset:0
v_mfma_f32_16x16x32_bf16 a[196:199],v[248:251],v[196:199],a[196:199]
v_mfma_f32_16x16x32_bf16 a[200:203],v[248:251],v[200:203],a[200:203]
ds_read_b64_tr_b16 v[186:187],v22 offset:1024
v_mfma_f32_16x16x32_bf16 a[204:207],v[248:251],v[204:207],a[204:207]
v_mfma_f32_16x16x32_bf16 a[208:211],v[248:251],v[208:211],a[208:211]
s_add_u32 m0,s79,68608
s_add_u32 s81,s75,62464
buffer_load_dwordx4 v3,s[8:11],s81 offen sc1 lds
v_mfma_f32_16x16x32_bf16 a[212:215],v[248:251],v[212:215],a[212:215]
v_mfma_f32_16x16x32_bf16 a[216:219],v[248:251],v[216:219],a[216:219]
ds_read_b64_tr_b16 v[188:189],v23 offset:0
v_mfma_f32_16x16x32_bf16 a[220:223],v[248:251],v[220:223],a[220:223]
v_mfma_f32_16x16x32_bf16 a[224:227],v[252:255],v[192:195],a[224:227]
ds_read_b64_tr_b16 v[190:191],v23 offset:1024
v_mfma_f32_16x16x32_bf16 a[228:231],v[252:255],v[196:199],a[228:231]
v_mfma_f32_16x16x32_bf16 a[232:235],v[252:255],v[200:203],a[232:235]
v_mfma_f32_16x16x32_bf16 a[236:239],v[252:255],v[204:207],a[236:239]
v_mfma_f32_16x16x32_bf16 a[240:243],v[252:255],v[208:211],a[240:243]
v_mfma_f32_16x16x32_bf16 a[244:247],v[252:255],v[212:215],a[244:247]
v_mfma_f32_16x16x32_bf16 a[248:251],v[252:255],v[216:219],a[248:251]
v_mfma_f32_16x16x32_bf16 a[252:255],v[252:255],v[220:223],a[252:255]
s_waitcnt vmcnt(16) lgkmcnt(0)
s_barrier
v_mfma_f32_16x16x32_bf16 a[0:3],v[160:163],v[128:131],a[0:3]
v_add_u32 v8,0,v5
v_mfma_f32_16x16x32_bf16 a[4:7],v[160:163],v[132:135],a[4:7]
v_mfma_f32_16x16x32_bf16 a[8:11],v[160:163],v[136:139],a[8:11]
ds_read_b128 v[192:195],v8 offset:0
v_add_u32 v16,16384,v24
v_mfma_f32_16x16x32_bf16 a[12:15],v[160:163],v[140:143],a[12:15]
s_add_u32 m0,s80,98304
s_mov_b32 s81,s76
buffer_load_dwordx4 v4,s[56:59],s81 offen lds
v_mfma_f32_16x16x32_bf16 a[16:19],v[160:163],v[144:147],a[16:19]
ds_read_b128 v[196:199],v8 offset:1024
v_add_u32 v17,16384,v25
v_mfma_f32_16x16x32_bf16 a[20:23],v[160:163],v[148:151],a[20:23]
v_mfma_f32_16x16x32_bf16 a[24:27],v[160:163],v[152:155],a[24:27]
ds_read_b128 v[200:203],v8 offset:2048
v_add_u32 v18,16384,v26
v_mfma_f32_16x16x32_bf16 a[28:31],v[160:163],v[156:159],a[28:31]
v_mfma_f32_16x16x32_bf16 a[32:35],v[164:167],v[128:131],a[32:35]
ds_read_b128 v[204:207],v8 offset:3072
v_add_u32 v19,16384,v27
v_mfma_f32_16x16x32_bf16 a[36:39],v[164:167],v[132:135],a[36:39]
v_mfma_f32_16x16x32_bf16 a[40:43],v[164:167],v[136:139],a[40:43]
s_add_u32 m0,s80,99328
s_add_u32 s81,s76,s68
buffer_load_dwordx4 v4,s[56:59],s81 offen lds
v_mfma_f32_16x16x32_bf16 a[44:47],v[164:167],v[140:143],a[44:47]
v_mfma_f32_16x16x32_bf16 a[48:51],v[164:167],v[144:147],a[48:51]
ds_read_b128 v[208:211],v8 offset:4096
v_add_u32 v20,16384,v28
v_mfma_f32_16x16x32_bf16 a[52:55],v[164:167],v[148:151],a[52:55]
v_mfma_f32_16x16x32_bf16 a[56:59],v[164:167],v[152:155],a[56:59]
ds_read_b128 v[212:215],v8 offset:5120
v_add_u32 v21,16384,v29
v_mfma_f32_16x16x32_bf16 a[60:63],v[164:167],v[156:159],a[60:63]
v_mfma_f32_16x16x32_bf16 a[64:67],v[168:171],v[128:131],a[64:67]
ds_read_b128 v[216:219],v8 offset:6144
v_add_u32 v22,16384,v30
v_mfma_f32_16x16x32_bf16 a[68:71],v[168:171],v[132:135],a[68:71]
s_add_u32 m0,s80,102400
s_add_u32 s81,s76,s69
buffer_load_dwordx4 v4,s[56:59],s81 offen lds
v_mfma_f32_16x16x32_bf16 a[72:75],v[168:171],v[136:139],a[72:75]
ds_read_b128 v[220:223],v8 offset:7168
v_add_u32 v23,16384,v31
v_mfma_f32_16x16x32_bf16 a[76:79],v[168:171],v[140:143],a[76:79]
v_mfma_f32_16x16x32_bf16 a[80:83],v[168:171],v[144:147],a[80:83]
ds_read_b64_tr_b16 v[224:225],v16 offset:0
v_mfma_f32_16x16x32_bf16 a[84:87],v[168:171],v[148:151],a[84:87]
v_mfma_f32_16x16x32_bf16 a[88:91],v[168:171],v[152:155],a[88:91]
ds_read_b64_tr_b16 v[226:227],v16 offset:1024
v_mfma_f32_16x16x32_bf16 a[92:95],v[168:171],v[156:159],a[92:95]
v_mfma_f32_16x16x32_bf16 a[96:99],v[172:175],v[128:131],a[96:99]
s_add_u32 m0,s80,103424
s_add_u32 s81,s81,s68
buffer_load_dwordx4 v4,s[56:59],s81 offen lds
s_add_u32 s76,s76,s70
v_mfma_f32_16x16x32_bf16 a[100:103],v[172:175],v[132:135],a[100:103]
v_mfma_f32_16x16x32_bf16 a[104:107],v[172:175],v[136:139],a[104:107]
ds_read_b64_tr_b16 v[228:229],v17 offset:0
v_mfma_f32_16x16x32_bf16 a[108:111],v[172:175],v[140:143],a[108:111]
v_mfma_f32_16x16x32_bf16 a[112:115],v[172:175],v[144:147],a[112:115]
ds_read_b64_tr_b16 v[230:231],v17 offset:1024
v_mfma_f32_16x16x32_bf16 a[116:119],v[172:175],v[148:151],a[116:119]
v_mfma_f32_16x16x32_bf16 a[120:123],v[172:175],v[152:155],a[120:123]
ds_read_b64_tr_b16 v[232:233],v18 offset:0
v_mfma_f32_16x16x32_bf16 a[124:127],v[172:175],v[156:159],a[124:127]
s_add_u32 m0,s79,98304
s_add_u32 s81,s75,8192
buffer_load_dwordx4 v3,s[8:11],s81 offen sc1 lds
v_mfma_f32_16x16x32_bf16 a[128:131],v[176:179],v[128:131],a[128:131]
ds_read_b64_tr_b16 v[234:235],v18 offset:1024
v_mfma_f32_16x16x32_bf16 a[132:135],v[176:179],v[132:135],a[132:135]
v_mfma_f32_16x16x32_bf16 a[136:139],v[176:179],v[136:139],a[136:139]
ds_read_b64_tr_b16 v[236:237],v19 offset:0
v_mfma_f32_16x16x32_bf16 a[140:143],v[176:179],v[140:143],a[140:143]
v_mfma_f32_16x16x32_bf16 a[144:147],v[176:179],v[144:147],a[144:147]
ds_read_b64_tr_b16 v[238:239],v19 offset:1024
v_mfma_f32_16x16x32_bf16 a[148:151],v[176:179],v[148:151],a[148:151]
v_mfma_f32_16x16x32_bf16 a[152:155],v[176:179],v[152:155],a[152:155]
s_add_u32 m0,s79,99328
s_add_u32 s81,s75,26624
buffer_load_dwordx4 v3,s[8:11],s81 offen sc1 lds
v_mfma_f32_16x16x32_bf16 a[156:159],v[176:179],v[156:159],a[156:159]
v_mfma_f32_16x16x32_bf16 a[160:163],v[180:183],v[128:131],a[160:163]
ds_read_b64_tr_b16 v[240:241],v20 offset:0
v_mfma_f32_16x16x32_bf16 a[164:167],v[180:183],v[132:135],a[164:167]
v_mfma_f32_16x16x32_bf16 a[168:171],v[180:183],v[136:139],a[168:171]
ds_read_b64_tr_b16 v[242:243],v20 offset:1024
v_mfma_f32_16x16x32_bf16 a[172:175],v[180:183],v[140:143],a[172:175]
v_mfma_f32_16x16x32_bf16 a[176:179],v[180:183],v[144:147],a[176:179]
ds_read_b64_tr_b16 v[244:245],v21 offset:0
v_mfma_f32_16x16x32_bf16 a[180:183],v[180:183],v[148:151],a[180:183]
s_add_u32 m0,s79,100352
s_add_u32 s81,s75,45056
buffer_load_dwordx4 v3,s[8:11],s81 offen sc1 lds
v_mfma_f32_16x16x32_bf16 a[184:187],v[180:183],v[152:155],a[184:187]
ds_read_b64_tr_b16 v[246:247],v21 offset:1024
v_mfma_f32_16x16x32_bf16 a[188:191],v[180:183],v[156:159],a[188:191]
v_mfma_f32_16x16x32_bf16 a[192:195],v[184:187],v[128:131],a[192:195]
ds_read_b64_tr_b16 v[248:249],v22 offset:0
v_mfma_f32_16x16x32_bf16 a[196:199],v[184:187],v[132:135],a[196:199]
v_mfma_f32_16x16x32_bf16 a[200:203],v[184:187],v[136:139],a[200:203]
ds_read_b64_tr_b16 v[250:251],v22 offset:1024
v_mfma_f32_16x16x32_bf16 a[204:207],v[184:187],v[140:143],a[204:207]
v_mfma_f32_16x16x32_bf16 a[208:211],v[184:187],v[144:147],a[208:211]
s_add_u32 m0,s79,101376
s_add_u32 s81,s75,63488
buffer_load_dwordx4 v3,s[8:11],s81 offen sc1 lds
v_mfma_f32_16x16x32_bf16 a[212:215],v[184:187],v[148:151],a[212:215]
v_mfma_f32_16x16x32_bf16 a[216:219],v[184:187],v[152:155],a[216:219]
ds_read_b64_tr_b16 v[252:253],v23 offset:0
v_mfma_f32_16x16x32_bf16 a[220:223],v[184:187],v[156:159],a[220:223]
v_mfma_f32_16x16x32_bf16 a[224:227],v[188:191],v[128:131],a[224:227]
ds_read_b64_tr_b16 v[254:255],v23 offset:1024
v_mfma_f32_16x16x32_bf16 a[228:231],v[188:191],v[132:135],a[228:231]
v_mfma_f32_16x16x32_bf16 a[232:235],v[188:191],v[136:139],a[232:235]
v_mfma_f32_16x16x32_bf16 a[236:239],v[188:191],v[140:143],a[236:239]
s_mov_b64 exec,s[64:65]
buffer_atomic_add v1,v2,s[8:11],s87 offen
s_mov_b64 exec,-1
v_mfma_f32_16x16x32_bf16 a[240:243],v[188:191],v[144:147],a[240:243]
v_mfma_f32_16x16x32_bf16 a[244:247],v[188:191],v[148:151],a[244:247]
v_mfma_f32_16x16x32_bf16 a[248:251],v[188:191],v[152:155],a[248:251]
v_mfma_f32_16x16x32_bf16 a[252:255],v[188:191],v[156:159],a[252:255]
s_waitcnt vmcnt(16) lgkmcnt(0)
s_barrier
v_mfma_f32_16x16x32_bf16 a[0:3],v[224:227],v[192:195],a[0:3]
v_add_u32 v8,32768,v5
v_mfma_f32_16x16x32_bf16 a[4:7],v[224:227],v[196:199],a[4:7]
v_mfma_f32_16x16x32_bf16 a[8:11],v[224:227],v[200:203],a[8:11]
ds_read_b128 v[128:131],v8 offset:0
v_add_u32 v16,49152,v24
v_mfma_f32_16x16x32_bf16 a[12:15],v[224:227],v[204:207],a[12:15]
s_add_u32 m0,s80,131072
s_mov_b32 s81,s76
buffer_load_dwordx4 v4,s[56:59],s81 offen lds
v_mfma_f32_16x16x32_bf16 a[16:19],v[224:227],v[208:211],a[16:19]
ds_read_b128 v[132:135],v8 offset:1024
v_add_u32 v17,49152,v25
v_mfma_f32_16x16x32_bf16 a[20:23],v[224:227],v[212:215],a[20:23]
v_mfma_f32_16x16x32_bf16 a[24:27],v[224:227],v[216:219],a[24:27]
ds_read_b128 v[136:139],v8 offset:2048
v_add_u32 v18,49152,v26
v_mfma_f32_16x16x32_bf16 a[28:31],v[224:227],v[220:223],a[28:31]
v_mfma_f32_16x16x32_bf16 a[32:35],v[228:231],v[192:195],a[32:35]
ds_read_b128 v[140:143],v8 offset:3072
v_add_u32 v19,49152,v27
v_mfma_f32_16x16x32_bf16 a[36:39],v[228:231],v[196:199],a[36:39]
v_mfma_f32_16x16x32_bf16 a[40:43],v[228:231],v[200:203],a[40:43]
s_add_u32 m0,s80,132096
s_add_u32 s81,s76,s68
buffer_load_dwordx4 v4,s[56:59],s81 offen lds
v_mfma_f32_16x16x32_bf16 a[44:47],v[228:231],v[204:207],a[44:47]
v_mfma_f32_16x16x32_bf16 a[48:51],v[228:231],v[208:211],a[48:51]
ds_read_b128 v[144:147],v8 offset:4096
v_add_u32 v20,49152,v28
v_mfma_f32_16x16x32_bf16 a[52:55],v[228:231],v[212:215],a[52:55]
v_mfma_f32_16x16x32_bf16 a[56:59],v[228:231],v[216:219],a[56:59]
ds_read_b128 v[148:151],v8 offset:5120
v_add_u32 v21,49152,v29
v_mfma_f32_16x16x32_bf16 a[60:63],v[228:231],v[220:223],a[60:63]
v_mfma_f32_16x16x32_bf16 a[64:67],v[232:235],v[192:195],a[64:67]
ds_read_b128 v[152:155],v8 offset:6144
v_add_u32 v22,49152,v30
v_mfma_f32_16x16x32_bf16 a[68:71],v[232:235],v[196:199],a[68:71]
s_add_u32 m0,s80,135168
s_add_u32 s81,s76,s69
buffer_load_dwordx4 v4,s[56:59],s81 offen lds
v_mfma_f32_16x16x32_bf16 a[72:75],v[232:235],v[200:203],a[72:75]
ds_read_b128 v[156:159],v8 offset:7168
v_add_u32 v23,49152,v31
v_mfma_f32_16x16x32_bf16 a[76:79],v[232:235],v[204:207],a[76:79]
v_mfma_f32_16x16x32_bf16 a[80:83],v[232:235],v[208:211],a[80:83]
ds_read_b64_tr_b16 v[160:161],v16 offset:0
v_mfma_f32_16x16x32_bf16 a[84:87],v[232:235],v[212:215],a[84:87]
v_mfma_f32_16x16x32_bf16 a[88:91],v[232:235],v[216:219],a[88:91]
ds_read_b64_tr_b16 v[162:163],v16 offset:1024
v_mfma_f32_16x16x32_bf16 a[92:95],v[232:235],v[220:223],a[92:95]
v_mfma_f32_16x16x32_bf16 a[96:99],v[236:239],v[192:195],a[96:99]
s_add_u32 m0,s80,136192
s_add_u32 s81,s81,s68
buffer_load_dwordx4 v4,s[56:59],s81 offen lds
s_add_u32 s76,s76,s70
v_mfma_f32_16x16x32_bf16 a[100:103],v[236:239],v[196:199],a[100:103]
v_mfma_f32_16x16x32_bf16 a[104:107],v[236:239],v[200:203],a[104:107]
ds_read_b64_tr_b16 v[164:165],v17 offset:0
v_mfma_f32_16x16x32_bf16 a[108:111],v[236:239],v[204:207],a[108:111]
v_mfma_f32_16x16x32_bf16 a[112:115],v[236:239],v[208:211],a[112:115]
ds_read_b64_tr_b16 v[166:167],v17 offset:1024
v_mfma_f32_16x16x32_bf16 a[116:119],v[236:239],v[212:215],a[116:119]
v_mfma_f32_16x16x32_bf16 a[120:123],v[236:239],v[216:219],a[120:123]
ds_read_b64_tr_b16 v[168:169],v18 offset:0
v_mfma_f32_16x16x32_bf16 a[124:127],v[236:239],v[220:223],a[124:127]
s_add_u32 m0,s79,131072
s_add_u32 s81,s75,9216
buffer_load_dwordx4 v3,s[8:11],s81 offen sc1 lds
v_mfma_f32_16x16x32_bf16 a[128:131],v[240:243],v[192:195],a[128:131]
ds_read_b64_tr_b16 v[170:171],v18 offset:1024
v_mfma_f32_16x16x32_bf16 a[132:135],v[240:243],v[196:199],a[132:135]
v_mfma_f32_16x16x32_bf16 a[136:139],v[240:243],v[200:203],a[136:139]
ds_read_b64_tr_b16 v[172:173],v19 offset:0
v_mfma_f32_16x16x32_bf16 a[140:143],v[240:243],v[204:207],a[140:143]
v_mfma_f32_16x16x32_bf16 a[144:147],v[240:243],v[208:211],a[144:147]
ds_read_b64_tr_b16 v[174:175],v19 offset:1024
v_mfma_f32_16x16x32_bf16 a[148:151],v[240:243],v[212:215],a[148:151]
v_mfma_f32_16x16x32_bf16 a[152:155],v[240:243],v[216:219],a[152:155]
s_add_u32 m0,s79,132096
s_add_u32 s81,s75,27648
buffer_load_dwordx4 v3,s[8:11],s81 offen sc1 lds
v_mfma_f32_16x16x32_bf16 a[156:159],v[240:243],v[220:223],a[156:159]
v_mfma_f32_16x16x32_bf16 a[160:163],v[244:247],v[192:195],a[160:163]
ds_read_b64_tr_b16 v[176:177],v20 offset:0
v_mfma_f32_16x16x32_bf16 a[164:167],v[244:247],v[196:199],a[164:167]
v_mfma_f32_16x16x32_bf16 a[168:171],v[244:247],v[200:203],a[168:171]
ds_read_b64_tr_b16 v[178:179],v20 offset:1024
v_mfma_f32_16x16x32_bf16 a[172:175],v[244:247],v[204:207],a[172:175]
v_mfma_f32_16x16x32_bf16 a[176:179],v[244:247],v[208:211],a[176:179]
ds_read_b64_tr_b16 v[180:181],v21 offset:0
v_mfma_f32_16x16x32_bf16 a[180:183],v[244:247],v[212:215],a[180:183]
s_add_u32 m0,s79,133120
s_add_u32 s81,s75,46080
buffer_load_dwordx4 v3,s[8:11],s81 offen sc1 lds
v_mfma_f32_16x16x32_bf16 a[184:187],v[244:247],v[216:219],a[184:187]
ds_read_b64_tr_b16 v[182:183],v21 offset:1024
v_mfma_f32_16x16x32_bf16 a[188:191],v[244:247],v[220:223],a[188:191]
v_mfma_f32_16x16x32_bf16 a[192:195],v[248:251],v[192:195],a[192:195]
ds_read_b64_tr_b16 v[184:185],v22 offset:0
v_mfma_f32_16x16x32_bf16 a[196:199],v[248:251],v[196:199],a[196:199]
v_mfma_f32_16x16x32_bf16 a[200:203],v[248:251],v[200:203],a[200:203]
ds_read_b64_tr_b16 v[186:187],v22 offset:1024
v_mfma_f32_16x16x32_bf16 a[204:207],v[248:251],v[204:207],a[204:207]
v_mfma_f32_16x16x32_bf16 a[208:211],v[248:251],v[208:211],a[208:211]
s_add_u32 m0,s79,134144
s_add_u32 s81,s75,64512
buffer_load_dwordx4 v3,s[8:11],s81 offen sc1 lds
v_mfma_f32_16x16x32_bf16 a[212:215],v[248:251],v[212:215],a[212:215]
v_mfma_f32_16x16x32_bf16 a[216:219],v[248:251],v[216:219],a[216:219]
ds_read_b64_tr_b16 v[188:189],v23 offset:0
v_mfma_f32_16x16x32_bf16 a[220:223],v[248:251],v[220:223],a[220:223]
v_mfma_f32_16x16x32_bf16 a[224:227],v[252:255],v[192:195],a[224:227]
ds_read_b64_tr_b16 v[190:191],v23 offset:1024
v_mfma_f32_16x16x32_bf16 a[228:231],v[252:255],v[196:199],a[228:231]
v_mfma_f32_16x16x32_bf16 a[232:235],v[252:255],v[200:203],a[232:235]
v_mfma_f32_16x16x32_bf16 a[236:239],v[252:255],v[204:207],a[236:239]
v_mfma_f32_16x16x32_bf16 a[240:243],v[252:255],v[208:211],a[240:243]
v_mfma_f32_16x16x32_bf16 a[244:247],v[252:255],v[212:215],a[244:247]
v_mfma_f32_16x16x32_bf16 a[248:251],v[252:255],v[216:219],a[248:251]
v_mfma_f32_16x16x32_bf16 a[252:255],v[252:255],v[220:223],a[252:255]
s_waitcnt vmcnt(16) lgkmcnt(0)
s_barrier
v_mfma_f32_16x16x32_bf16 a[0:3],v[160:163],v[128:131],a[0:3]
v_add_u32 v8,65536,v5
v_mfma_f32_16x16x32_bf16 a[4:7],v[160:163],v[132:135],a[4:7]
v_mfma_f32_16x16x32_bf16 a[8:11],v[160:163],v[136:139],a[8:11]
ds_read_b128 v[192:195],v8 offset:0
v_add_u32 v16,81920,v24
v_mfma_f32_16x16x32_bf16 a[12:15],v[160:163],v[140:143],a[12:15]
s_add_u32 m0,s80,0
s_mov_b32 s81,s76
buffer_load_dwordx4 v4,s[56:59],s81 offen lds
v_mfma_f32_16x16x32_bf16 a[16:19],v[160:163],v[144:147],a[16:19]
ds_read_b128 v[196:199],v8 offset:1024
v_add_u32 v17,81920,v25
v_mfma_f32_16x16x32_bf16 a[20:23],v[160:163],v[148:151],a[20:23]
v_mfma_f32_16x16x32_bf16 a[24:27],v[160:163],v[152:155],a[24:27]
ds_read_b128 v[200:203],v8 offset:2048
v_add_u32 v18,81920,v26
v_mfma_f32_16x16x32_bf16 a[28:31],v[160:163],v[156:159],a[28:31]
v_mfma_f32_16x16x32_bf16 a[32:35],v[164:167],v[128:131],a[32:35]
ds_read_b128 v[204:207],v8 offset:3072
v_add_u32 v19,81920,v27
v_mfma_f32_16x16x32_bf16 a[36:39],v[164:167],v[132:135],a[36:39]
v_mfma_f32_16x16x32_bf16 a[40:43],v[164:167],v[136:139],a[40:43]
s_add_u32 m0,s80,1024
s_add_u32 s81,s76,s68
buffer_load_dwordx4 v4,s[56:59],s81 offen lds
v_mfma_f32_16x16x32_bf16 a[44:47],v[164:167],v[140:143],a[44:47]
v_mfma_f32_16x16x32_bf16 a[48:51],v[164:167],v[144:147],a[48:51]
ds_read_b128 v[208:211],v8 offset:4096
v_add_u32 v20,81920,v28
v_mfma_f32_16x16x32_bf16 a[52:55],v[164:167],v[148:151],a[52:55]
v_mfma_f32_16x16x32_bf16 a[56:59],v[164:167],v[152:155],a[56:59]
ds_read_b128 v[212:215],v8 offset:5120
v_add_u32 v21,81920,v29
v_mfma_f32_16x16x32_bf16 a[60:63],v[164:167],v[156:159],a[60:63]
v_mfma_f32_16x16x32_bf16 a[64:67],v[168:171],v[128:131],a[64:67]
ds_read_b128 v[216:219],v8 offset:6144
v_add_u32 v22,81920,v30
v_mfma_f32_16x16x32_bf16 a[68:71],v[168:171],v[132:135],a[68:71]
s_add_u32 m0,s80,4096
s_add_u32 s81,s76,s69
buffer_load_dwordx4 v4,s[56:59],s81 offen lds
v_mfma_f32_16x16x32_bf16 a[72:75],v[168:171],v[136:139],a[72:75]
ds_read_b128 v[220:223],v8 offset:7168
v_add_u32 v23,81920,v31
v_mfma_f32_16x16x32_bf16 a[76:79],v[168:171],v[140:143],a[76:79]
v_mfma_f32_16x16x32_bf16 a[80:83],v[168:171],v[144:147],a[80:83]
ds_read_b64_tr_b16 v[224:225],v16 offset:0
v_mfma_f32_16x16x32_bf16 a[84:87],v[168:171],v[148:151],a[84:87]
v_mfma_f32_16x16x32_bf16 a[88:91],v[168:171],v[152:155],a[88:91]
ds_read_b64_tr_b16 v[226:227],v16 offset:1024
v_mfma_f32_16x16x32_bf16 a[92:95],v[168:171],v[156:159],a[92:95]
v_mfma_f32_16x16x32_bf16 a[96:99],v[172:175],v[128:131],a[96:99]
s_add_u32 m0,s80,5120
s_add_u32 s81,s81,s68
buffer_load_dwordx4 v4,s[56:59],s81 offen lds
s_add_u32 s76,s76,s70
v_mfma_f32_16x16x32_bf16 a[100:103],v[172:175],v[132:135],a[100:103]
v_mfma_f32_16x16x32_bf16 a[104:107],v[172:175],v[136:139],a[104:107]
ds_read_b64_tr_b16 v[228:229],v17 offset:0
v_mfma_f32_16x16x32_bf16 a[108:111],v[172:175],v[140:143],a[108:111]
v_mfma_f32_16x16x32_bf16 a[112:115],v[172:175],v[144:147],a[112:115]
ds_read_b64_tr_b16 v[230:231],v17 offset:1024
v_mfma_f32_16x16x32_bf16 a[116:119],v[172:175],v[148:151],a[116:119]
v_mfma_f32_16x16x32_bf16 a[120:123],v[172:175],v[152:155],a[120:123]
ds_read_b64_tr_b16 v[232:233],v18 offset:0
v_mfma_f32_16x16x32_bf16 a[124:127],v[172:175],v[156:159],a[124:127]
s_add_u32 m0,s79,0
s_add_u32 s81,s75,10240
buffer_load_dwordx4 v3,s[8:11],s81 offen sc1 lds
v_mfma_f32_16x16x32_bf16 a[128:131],v[176:179],v[128:131],a[128:131]
ds_read_b64_tr_b16 v[234:235],v18 offset:1024
v_mfma_f32_16x16x32_bf16 a[132:135],v[176:179],v[132:135],a[132:135]
v_mfma_f32_16x16x32_bf16 a[136:139],v[176:179],v[136:139],a[136:139]
ds_read_b64_tr_b16 v[236:237],v19 offset:0
v_mfma_f32_16x16x32_bf16 a[140:143],v[176:179],v[140:143],a[140:143]
v_mfma_f32_16x16x32_bf16 a[144:147],v[176:179],v[144:147],a[144:147]
ds_read_b64_tr_b16 v[238:239],v19 offset:1024
v_mfma_f32_16x16x32_bf16 a[148:151],v[176:179],v[148:151],a[148:151]
v_mfma_f32_16x16x32_bf16 a[152:155],v[176:179],v[152:155],a[152:155]
s_add_u32 m0,s79,1024
s_add_u32 s81,s75,28672
buffer_load_dwordx4 v3,s[8:11],s81 offen sc1 lds
v_mfma_f32_16x16x32_bf16 a[156:159],v[176:179],v[156:159],a[156:159]
v_mfma_f32_16x16x32_bf16 a[160:163],v[180:183],v[128:131],a[160:163]
ds_read_b64_tr_b16 v[240:241],v20 offset:0
v_mfma_f32_16x16x32_bf16 a[164:167],v[180:183],v[132:135],a[164:167]
v_mfma_f32_16x16x32_bf16 a[168:171],v[180:183],v[136:139],a[168:171]
ds_read_b64_tr_b16 v[242:243],v20 offset:1024
v_mfma_f32_16x16x32_bf16 a[172:175],v[180:183],v[140:143],a[172:175]
v_mfma_f32_16x16x32_bf16 a[176:179],v[180:183],v[144:147],a[176:179]
ds_read_b64_tr_b16 v[244:245],v21 offset:0
v_mfma_f32_16x16x32_bf16 a[180:183],v[180:183],v[148:151],a[180:183]
s_add_u32 m0,s79,2048
s_add_u32 s81,s75,47104
buffer_load_dwordx4 v3,s[8:11],s81 offen sc1 lds
v_mfma_f32_16x16x32_bf16 a[184:187],v[180:183],v[152:155],a[184:187]
ds_read_b64_tr_b16 v[246:247],v21 offset:1024
v_mfma_f32_16x16x32_bf16 a[188:191],v[180:183],v[156:159],a[188:191]
v_mfma_f32_16x16x32_bf16 a[192:195],v[184:187],v[128:131],a[192:195]
ds_read_b64_tr_b16 v[248:249],v22 offset:0
v_mfma_f32_16x16x32_bf16 a[196:199],v[184:187],v[132:135],a[196:199]
v_mfma_f32_16x16x32_bf16 a[200:203],v[184:187],v[136:139],a[200:203]
ds_read_b64_tr_b16 v[250:251],v22 offset:1024
v_mfma_f32_16x16x32_bf16 a[204:207],v[184:187],v[140:143],a[204:207]
v_mfma_f32_16x16x32_bf16 a[208:211],v[184:187],v[144:147],a[208:211]
s_add_u32 m0,s79,3072
s_add_u32 s81,s75,65536
buffer_load_dwordx4 v3,s[8:11],s81 offen sc1 lds
v_mfma_f32_16x16x32_bf16 a[212:215],v[184:187],v[148:151],a[212:215]
v_mfma_f32_16x16x32_bf16 a[216:219],v[184:187],v[152:155],a[216:219]
ds_read_b64_tr_b16 v[252:253],v23 offset:0
v_mfma_f32_16x16x32_bf16 a[220:223],v[184:187],v[156:159],a[220:223]
v_mfma_f32_16x16x32_bf16 a[224:227],v[188:191],v[128:131],a[224:227]
ds_read_b64_tr_b16 v[254:255],v23 offset:1024
v_mfma_f32_16x16x32_bf16 a[228:231],v[188:191],v[132:135],a[228:231]
v_mfma_f32_16x16x32_bf16 a[232:235],v[188:191],v[136:139],a[232:235]
v_mfma_f32_16x16x32_bf16 a[236:239],v[188:191],v[140:143],a[236:239]
v_mfma_f32_16x16x32_bf16 a[240:243],v[188:191],v[144:147],a[240:243]
v_mfma_f32_16x16x32_bf16 a[244:247],v[188:191],v[148:151],a[244:247]
v_mfma_f32_16x16x32_bf16 a[248:251],v[188:191],v[152:155],a[248:251]
v_mfma_f32_16x16x32_bf16 a[252:255],v[188:191],v[156:159],a[252:255]
s_waitcnt vmcnt(16) lgkmcnt(0)
s_barrier
v_mfma_f32_16x16x32_bf16 a[0:3],v[224:227],v[192:195],a[0:3]
v_add_u32 v8,98304,v5
v_mfma_f32_16x16x32_bf16 a[4:7],v[224:227],v[196:199],a[4:7]
v_mfma_f32_16x16x32_bf16 a[8:11],v[224:227],v[200:203],a[8:11]
ds_read_b128 v[128:131],v8 offset:0
v_add_u32 v16,114688,v24
v_mfma_f32_16x16x32_bf16 a[12:15],v[224:227],v[204:207],a[12:15]
s_add_u32 m0,s80,32768
s_mov_b32 s81,s76
buffer_load_dwordx4 v4,s[56:59],s81 offen lds
v_mfma_f32_16x16x32_bf16 a[16:19],v[224:227],v[208:211],a[16:19]
ds_read_b128 v[132:135],v8 offset:1024
v_add_u32 v17,114688,v25
v_mfma_f32_16x16x32_bf16 a[20:23],v[224:227],v[212:215],a[20:23]
v_mfma_f32_16x16x32_bf16 a[24:27],v[224:227],v[216:219],a[24:27]
ds_read_b128 v[136:139],v8 offset:2048
v_add_u32 v18,114688,v26
v_mfma_f32_16x16x32_bf16 a[28:31],v[224:227],v[220:223],a[28:31]
v_mfma_f32_16x16x32_bf16 a[32:35],v[228:231],v[192:195],a[32:35]
ds_read_b128 v[140:143],v8 offset:3072
v_add_u32 v19,114688,v27
v_mfma_f32_16x16x32_bf16 a[36:39],v[228:231],v[196:199],a[36:39]
v_mfma_f32_16x16x32_bf16 a[40:43],v[228:231],v[200:203],a[40:43]
s_add_u32 m0,s80,33792
s_add_u32 s81,s76,s68
buffer_load_dwordx4 v4,s[56:59],s81 offen lds
v_mfma_f32_16x16x32_bf16 a[44:47],v[228:231],v[204:207],a[44:47]
v_mfma_f32_16x16x32_bf16 a[48:51],v[228:231],v[208:211],a[48:51]
ds_read_b128 v[144:147],v8 offset:4096
v_add_u32 v20,114688,v28
v_mfma_f32_16x16x32_bf16 a[52:55],v[228:231],v[212:215],a[52:55]
v_mfma_f32_16x16x32_bf16 a[56:59],v[228:231],v[216:219],a[56:59]
ds_read_b128 v[148:151],v8 offset:5120
v_add_u32 v21,114688,v29
v_mfma_f32_16x16x32_bf16 a[60:63],v[228:231],v[220:223],a[60:63]
v_mfma_f32_16x16x32_bf16 a[64:67],v[232:235],v[192:195],a[64:67]
ds_read_b128 v[152:155],v8 offset:6144
v_add_u32 v22,114688,v30
v_mfma_f32_16x16x32_bf16 a[68:71],v[232:235],v[196:199],a[68:71]
s_add_u32 m0,s80,36864
s_add_u32 s81,s76,s69
buffer_load_dwordx4 v4,s[56:59],s81 offen lds
v_mfma_f32_16x16x32_bf16 a[72:75],v[232:235],v[200:203],a[72:75]
ds_read_b128 v[156:159],v8 offset:7168
v_add_u32 v23,114688,v31
v_mfma_f32_16x16x32_bf16 a[76:79],v[232:235],v[204:207],a[76:79]
v_mfma_f32_16x16x32_bf16 a[80:83],v[232:235],v[208:211],a[80:83]
ds_read_b64_tr_b16 v[160:161],v16 offset:0
v_mfma_f32_16x16x32_bf16 a[84:87],v[232:235],v[212:215],a[84:87]
v_mfma_f32_16x16x32_bf16 a[88:91],v[232:235],v[216:219],a[88:91]
ds_read_b64_tr_b16 v[162:163],v16 offset:1024
v_mfma_f32_16x16x32_bf16 a[92:95],v[232:235],v[220:223],a[92:95]
v_mfma_f32_16x16x32_bf16 a[96:99],v[236:239],v[192:195],a[96:99]
s_add_u32 m0,s80,37888
s_add_u32 s81,s81,s68
buffer_load_dwordx4 v4,s[56:59],s81 offen lds
s_add_u32 s76,s76,s70
v_mfma_f32_16x16x32_bf16 a[100:103],v[236:239],v[196:199],a[100:103]
v_mfma_f32_16x16x32_bf16 a[104:107],v[236:239],v[200:203],a[104:107]
ds_read_b64_tr_b16 v[164:165],v17 offset:0
v_mfma_f32_16x16x32_bf16 a[108:111],v[236:239],v[204:207],a[108:111]
v_mfma_f32_16x16x32_bf16 a[112:115],v[236:239],v[208:211],a[112:115]
ds_read_b64_tr_b16 v[166:167],v17 offset:1024
v_mfma_f32_16x16x32_bf16 a[116:119],v[236:239],v[212:215],a[116:119]
v_mfma_f32_16x16x32_bf16 a[120:123],v[236:239],v[216:219],a[120:123]
ds_read_b64_tr_b16 v[168:169],v18 offset:0
v_mfma_f32_16x16x32_bf16 a[124:127],v[236:239],v[220:223],a[124:127]
s_add_u32 m0,s79,32768
s_add_u32 s81,s75,11264
buffer_load_dwordx4 v3,s[8:11],s81 offen sc1 lds
v_mfma_f32_16x16x32_bf16 a[128:131],v[240:243],v[192:195],a[128:131]
ds_read_b64_tr_b16 v[170:171],v18 offset:1024
v_mfma_f32_16x16x32_bf16 a[132:135],v[240:243],v[196:199],a[132:135]
v_mfma_f32_16x16x32_bf16 a[136:139],v[240:243],v[200:203],a[136:139]
ds_read_b64_tr_b16 v[172:173],v19 offset:0
v_mfma_f32_16x16x32_bf16 a[140:143],v[240:243],v[204:207],a[140:143]
v_mfma_f32_16x16x32_bf16 a[144:147],v[240:243],v[208:211],a[144:147]
ds_read_b64_tr_b16 v[174:175],v19 offset:1024
v_mfma_f32_16x16x32_bf16 a[148:151],v[240:243],v[212:215],a[148:151]
v_mfma_f32_16x16x32_bf16 a[152:155],v[240:243],v[216:219],a[152:155]
s_add_u32 m0,s79,33792
s_add_u32 s81,s75,29696
buffer_load_dwordx4 v3,s[8:11],s81 offen sc1 lds
v_mfma_f32_16x16x32_bf16 a[156:159],v[240:243],v[220:223],a[156:159]
v_mfma_f32_16x16x32_bf16 a[160:163],v[244:247],v[192:195],a[160:163]
ds_read_b64_tr_b16 v[176:177],v20 offset:0
v_mfma_f32_16x16x32_bf16 a[164:167],v[244:247],v[196:199],a[164:167]
v_mfma_f32_16x16x32_bf16 a[168:171],v[244:247],v[200:203],a[168:171]
ds_read_b64_tr_b16 v[178:179],v20 offset:1024
v_mfma_f32_16x16x32_bf16 a[172:175],v[244:247],v[204:207],a[172:175]
v_mfma_f32_16x16x32_bf16 a[176:179],v[244:247],v[208:211],a[176:179]
ds_read_b64_tr_b16 v[180:181],v21 offset:0
v_mfma_f32_16x16x32_bf16 a[180:183],v[244:247],v[212:215],a[180:183]
s_add_u32 m0,s79,34816
s_add_u32 s81,s75,48128
buffer_load_dwordx4 v3,s[8:11],s81 offen sc1 lds
v_mfma_f32_16x16x32_bf16 a[184:187],v[244:247],v[216:219],a[184:187]
ds_read_b64_tr_b16 v[182:183],v21 offset:1024
v_mfma_f32_16x16x32_bf16 a[188:191],v[244:247],v[220:223],a[188:191]
v_mfma_f32_16x16x32_bf16 a[192:195],v[248:251],v[192:195],a[192:195]
ds_read_b64_tr_b16 v[184:185],v22 offset:0
v_mfma_f32_16x16x32_bf16 a[196:199],v[248:251],v[196:199],a[196:199]
v_mfma_f32_16x16x32_bf16 a[200:203],v[248:251],v[200:203],a[200:203]
ds_read_b64_tr_b16 v[186:187],v22 offset:1024
v_mfma_f32_16x16x32_bf16 a[204:207],v[248:251],v[204:207],a[204:207]
v_mfma_f32_16x16x32_bf16 a[208:211],v[248:251],v[208:211],a[208:211]
s_add_u32 m0,s79,35840
s_add_u32 s81,s75,66560
buffer_load_dwordx4 v3,s[8:11],s81 offen sc1 lds
v_mfma_f32_16x16x32_bf16 a[212:215],v[248:251],v[212:215],a[212:215]
v_mfma_f32_16x16x32_bf16 a[216:219],v[248:251],v[216:219],a[216:219]
ds_read_b64_tr_b16 v[188:189],v23 offset:0
v_mfma_f32_16x16x32_bf16 a[220:223],v[248:251],v[220:223],a[220:223]
v_mfma_f32_16x16x32_bf16 a[224:227],v[252:255],v[192:195],a[224:227]
ds_read_b64_tr_b16 v[190:191],v23 offset:1024
v_mfma_f32_16x16x32_bf16 a[228:231],v[252:255],v[196:199],a[228:231]
v_mfma_f32_16x16x32_bf16 a[232:235],v[252:255],v[200:203],a[232:235]
v_mfma_f32_16x16x32_bf16 a[236:239],v[252:255],v[204:207],a[236:239]
v_mfma_f32_16x16x32_bf16 a[240:243],v[252:255],v[208:211],a[240:243]
v_mfma_f32_16x16x32_bf16 a[244:247],v[252:255],v[212:215],a[244:247]
v_mfma_f32_16x16x32_bf16 a[248:251],v[252:255],v[216:219],a[248:251]
v_mfma_f32_16x16x32_bf16 a[252:255],v[252:255],v[220:223],a[252:255]
s_waitcnt vmcnt(16) lgkmcnt(0)
s_barrier
v_mfma_f32_16x16x32_bf16 a[0:3],v[160:163],v[128:131],a[0:3]
v_add_u32 v8,131072,v5
v_mfma_f32_16x16x32_bf16 a[4:7],v[160:163],v[132:135],a[4:7]
v_mfma_f32_16x16x32_bf16 a[8:11],v[160:163],v[136:139],a[8:11]
ds_read_b128 v[192:195],v8 offset:0
v_add_u32 v16,147456,v24
v_mfma_f32_16x16x32_bf16 a[12:15],v[160:163],v[140:143],a[12:15]
s_add_u32 m0,s80,65536
s_mov_b32 s81,s76
buffer_load_dwordx4 v4,s[56:59],s81 offen lds
v_mfma_f32_16x16x32_bf16 a[16:19],v[160:163],v[144:147],a[16:19]
ds_read_b128 v[196:199],v8 offset:1024
v_add_u32 v17,147456,v25
v_mfma_f32_16x16x32_bf16 a[20:23],v[160:163],v[148:151],a[20:23]
v_mfma_f32_16x16x32_bf16 a[24:27],v[160:163],v[152:155],a[24:27]
ds_read_b128 v[200:203],v8 offset:2048
v_add_u32 v18,147456,v26
v_mfma_f32_16x16x32_bf16 a[28:31],v[160:163],v[156:159],a[28:31]
v_mfma_f32_16x16x32_bf16 a[32:35],v[164:167],v[128:131],a[32:35]
ds_read_b128 v[204:207],v8 offset:3072
v_add_u32 v19,147456,v27
v_mfma_f32_16x16x32_bf16 a[36:39],v[164:167],v[132:135],a[36:39]
v_mfma_f32_16x16x32_bf16 a[40:43],v[164:167],v[136:139],a[40:43]
s_add_u32 m0,s80,66560
s_add_u32 s81,s76,s68
buffer_load_dwordx4 v4,s[56:59],s81 offen lds
v_mfma_f32_16x16x32_bf16 a[44:47],v[164:167],v[140:143],a[44:47]
v_mfma_f32_16x16x32_bf16 a[48:51],v[164:167],v[144:147],a[48:51]
ds_read_b128 v[208:211],v8 offset:4096
v_add_u32 v20,147456,v28
v_mfma_f32_16x16x32_bf16 a[52:55],v[164:167],v[148:151],a[52:55]
v_mfma_f32_16x16x32_bf16 a[56:59],v[164:167],v[152:155],a[56:59]
ds_read_b128 v[212:215],v8 offset:5120
v_add_u32 v21,147456,v29
v_mfma_f32_16x16x32_bf16 a[60:63],v[164:167],v[156:159],a[60:63]
v_mfma_f32_16x16x32_bf16 a[64:67],v[168:171],v[128:131],a[64:67]
ds_read_b128 v[216:219],v8 offset:6144
v_add_u32 v22,147456,v30
v_mfma_f32_16x16x32_bf16 a[68:71],v[168:171],v[132:135],a[68:71]
s_add_u32 m0,s80,69632
s_add_u32 s81,s76,s69
buffer_load_dwordx4 v4,s[56:59],s81 offen lds
v_mfma_f32_16x16x32_bf16 a[72:75],v[168:171],v[136:139],a[72:75]
ds_read_b128 v[220:223],v8 offset:7168
v_add_u32 v23,147456,v31
v_mfma_f32_16x16x32_bf16 a[76:79],v[168:171],v[140:143],a[76:79]
v_mfma_f32_16x16x32_bf16 a[80:83],v[168:171],v[144:147],a[80:83]
ds_read_b64_tr_b16 v[224:225],v16 offset:0
v_mfma_f32_16x16x32_bf16 a[84:87],v[168:171],v[148:151],a[84:87]
v_mfma_f32_16x16x32_bf16 a[88:91],v[168:171],v[152:155],a[88:91]
ds_read_b64_tr_b16 v[226:227],v16 offset:1024
v_mfma_f32_16x16x32_bf16 a[92:95],v[168:171],v[156:159],a[92:95]
v_mfma_f32_16x16x32_bf16 a[96:99],v[172:175],v[128:131],a[96:99]
s_add_u32 m0,s80,70656
s_add_u32 s81,s81,s68
buffer_load_dwordx4 v4,s[56:59],s81 offen lds
s_add_u32 s76,s76,s70
v_mfma_f32_16x16x32_bf16 a[100:103],v[172:175],v[132:135],a[100:103]
v_mfma_f32_16x16x32_bf16 a[104:107],v[172:175],v[136:139],a[104:107]
ds_read_b64_tr_b16 v[228:229],v17 offset:0
v_mfma_f32_16x16x32_bf16 a[108:111],v[172:175],v[140:143],a[108:111]
v_mfma_f32_16x16x32_bf16 a[112:115],v[172:175],v[144:147],a[112:115]
ds_read_b64_tr_b16 v[230:231],v17 offset:1024
v_mfma_f32_16x16x32_bf16 a[116:119],v[172:175],v[148:151],a[116:119]
v_mfma_f32_16x16x32_bf16 a[120:123],v[172:175],v[152:155],a[120:123]
ds_read_b64_tr_b16 v[232:233],v18 offset:0
v_mfma_f32_16x16x32_bf16 a[124:127],v[172:175],v[156:159],a[124:127]
s_add_u32 m0,s79,65536
s_add_u32 s81,s75,12288
buffer_load_dwordx4 v3,s[8:11],s81 offen sc1 lds
v_mfma_f32_16x16x32_bf16 a[128:131],v[176:179],v[128:131],a[128:131]
ds_read_b64_tr_b16 v[234:235],v18 offset:1024
v_mfma_f32_16x16x32_bf16 a[132:135],v[176:179],v[132:135],a[132:135]
v_mfma_f32_16x16x32_bf16 a[136:139],v[176:179],v[136:139],a[136:139]
ds_read_b64_tr_b16 v[236:237],v19 offset:0
v_mfma_f32_16x16x32_bf16 a[140:143],v[176:179],v[140:143],a[140:143]
v_mfma_f32_16x16x32_bf16 a[144:147],v[176:179],v[144:147],a[144:147]
ds_read_b64_tr_b16 v[238:239],v19 offset:1024
v_mfma_f32_16x16x32_bf16 a[148:151],v[176:179],v[148:151],a[148:151]
v_mfma_f32_16x16x32_bf16 a[152:155],v[176:179],v[152:155],a[152:155]
s_add_u32 m0,s79,66560
s_add_u32 s81,s75,30720
buffer_load_dwordx4 v3,s[8:11],s81 offen sc1 lds
v_mfma_f32_16x16x32_bf16 a[156:159],v[176:179],v[156:159],a[156:159]
v_mfma_f32_16x16x32_bf16 a[160:163],v[180:183],v[128:131],a[160:163]
ds_read_b64_tr_b16 v[240:241],v20 offset:0
v_mfma_f32_16x16x32_bf16 a[164:167],v[180:183],v[132:135],a[164:167]
v_mfma_f32_16x16x32_bf16 a[168:171],v[180:183],v[136:139],a[168:171]
ds_read_b64_tr_b16 v[242:243],v20 offset:1024
v_mfma_f32_16x16x32_bf16 a[172:175],v[180:183],v[140:143],a[172:175]
v_mfma_f32_16x16x32_bf16 a[176:179],v[180:183],v[144:147],a[176:179]
ds_read_b64_tr_b16 v[244:245],v21 offset:0
v_mfma_f32_16x16x32_bf16 a[180:183],v[180:183],v[148:151],a[180:183]
s_add_u32 m0,s79,67584
s_add_u32 s81,s75,49152
buffer_load_dwordx4 v3,s[8:11],s81 offen sc1 lds
v_mfma_f32_16x16x32_bf16 a[184:187],v[180:183],v[152:155],a[184:187]
ds_read_b64_tr_b16 v[246:247],v21 offset:1024
v_mfma_f32_16x16x32_bf16 a[188:191],v[180:183],v[156:159],a[188:191]
v_mfma_f32_16x16x32_bf16 a[192:195],v[184:187],v[128:131],a[192:195]
ds_read_b64_tr_b16 v[248:249],v22 offset:0
v_mfma_f32_16x16x32_bf16 a[196:199],v[184:187],v[132:135],a[196:199]
v_mfma_f32_16x16x32_bf16 a[200:203],v[184:187],v[136:139],a[200:203]
ds_read_b64_tr_b16 v[250:251],v22 offset:1024
v_mfma_f32_16x16x32_bf16 a[204:207],v[184:187],v[140:143],a[204:207]
v_mfma_f32_16x16x32_bf16 a[208:211],v[184:187],v[144:147],a[208:211]
s_add_u32 m0,s79,68608
s_add_u32 s81,s75,67584
buffer_load_dwordx4 v3,s[8:11],s81 offen sc1 lds
v_mfma_f32_16x16x32_bf16 a[212:215],v[184:187],v[148:151],a[212:215]
v_mfma_f32_16x16x32_bf16 a[216:219],v[184:187],v[152:155],a[216:219]
ds_read_b64_tr_b16 v[252:253],v23 offset:0
v_mfma_f32_16x16x32_bf16 a[220:223],v[184:187],v[156:159],a[220:223]
v_mfma_f32_16x16x32_bf16 a[224:227],v[188:191],v[128:131],a[224:227]
ds_read_b64_tr_b16 v[254:255],v23 offset:1024
v_mfma_f32_16x16x32_bf16 a[228:231],v[188:191],v[132:135],a[228:231]
v_mfma_f32_16x16x32_bf16 a[232:235],v[188:191],v[136:139],a[232:235]
v_mfma_f32_16x16x32_bf16 a[236:239],v[188:191],v[140:143],a[236:239]
v_mfma_f32_16x16x32_bf16 a[240:243],v[188:191],v[144:147],a[240:243]
v_mfma_f32_16x16x32_bf16 a[244:247],v[188:191],v[148:151],a[244:247]
v_mfma_f32_16x16x32_bf16 a[248:251],v[188:191],v[152:155],a[248:251]
v_mfma_f32_16x16x32_bf16 a[252:255],v[188:191],v[156:159],a[252:255]
s_waitcnt vmcnt(16) lgkmcnt(0)
s_barrier
v_mfma_f32_16x16x32_bf16 a[0:3],v[224:227],v[192:195],a[0:3]
v_add_u32 v8,0,v5
v_mfma_f32_16x16x32_bf16 a[4:7],v[224:227],v[196:199],a[4:7]
v_mfma_f32_16x16x32_bf16 a[8:11],v[224:227],v[200:203],a[8:11]
ds_read_b128 v[128:131],v8 offset:0
v_add_u32 v16,16384,v24
v_mfma_f32_16x16x32_bf16 a[12:15],v[224:227],v[204:207],a[12:15]
s_add_u32 m0,s80,98304
s_mov_b32 s81,s76
buffer_load_dwordx4 v4,s[56:59],s81 offen lds
v_mfma_f32_16x16x32_bf16 a[16:19],v[224:227],v[208:211],a[16:19]
ds_read_b128 v[132:135],v8 offset:1024
v_add_u32 v17,16384,v25
v_mfma_f32_16x16x32_bf16 a[20:23],v[224:227],v[212:215],a[20:23]
v_mfma_f32_16x16x32_bf16 a[24:27],v[224:227],v[216:219],a[24:27]
ds_read_b128 v[136:139],v8 offset:2048
v_add_u32 v18,16384,v26
v_mfma_f32_16x16x32_bf16 a[28:31],v[224:227],v[220:223],a[28:31]
v_mfma_f32_16x16x32_bf16 a[32:35],v[228:231],v[192:195],a[32:35]
ds_read_b128 v[140:143],v8 offset:3072
v_add_u32 v19,16384,v27
v_mfma_f32_16x16x32_bf16 a[36:39],v[228:231],v[196:199],a[36:39]
v_mfma_f32_16x16x32_bf16 a[40:43],v[228:231],v[200:203],a[40:43]
s_add_u32 m0,s80,99328
s_add_u32 s81,s76,s68
buffer_load_dwordx4 v4,s[56:59],s81 offen lds
v_mfma_f32_16x16x32_bf16 a[44:47],v[228:231],v[204:207],a[44:47]
v_mfma_f32_16x16x32_bf16 a[48:51],v[228:231],v[208:211],a[48:51]
ds_read_b128 v[144:147],v8 offset:4096
v_add_u32 v20,16384,v28
v_mfma_f32_16x16x32_bf16 a[52:55],v[228:231],v[212:215],a[52:55]
v_mfma_f32_16x16x32_bf16 a[56:59],v[228:231],v[216:219],a[56:59]
ds_read_b128 v[148:151],v8 offset:5120
v_add_u32 v21,16384,v29
v_mfma_f32_16x16x32_bf16 a[60:63],v[228:231],v[220:223],a[60:63]
v_mfma_f32_16x16x32_bf16 a[64:67],v[232:235],v[192:195],a[64:67]
ds_read_b128 v[152:155],v8 offset:6144
v_add_u32 v22,16384,v30
v_mfma_f32_16x16x32_bf16 a[68:71],v[232:235],v[196:199],a[68:71]
s_add_u32 m0,s80,102400
s_add_u32 s81,s76,s69
buffer_load_dwordx4 v4,s[56:59],s81 offen lds
v_mfma_f32_16x16x32_bf16 a[72:75],v[232:235],v[200:203],a[72:75]
ds_read_b128 v[156:159],v8 offset:7168
v_add_u32 v23,16384,v31
v_mfma_f32_16x16x32_bf16 a[76:79],v[232:235],v[204:207],a[76:79]
v_mfma_f32_16x16x32_bf16 a[80:83],v[232:235],v[208:211],a[80:83]
ds_read_b64_tr_b16 v[160:161],v16 offset:0
v_mfma_f32_16x16x32_bf16 a[84:87],v[232:235],v[212:215],a[84:87]
v_mfma_f32_16x16x32_bf16 a[88:91],v[232:235],v[216:219],a[88:91]
ds_read_b64_tr_b16 v[162:163],v16 offset:1024
v_mfma_f32_16x16x32_bf16 a[92:95],v[232:235],v[220:223],a[92:95]
v_mfma_f32_16x16x32_bf16 a[96:99],v[236:239],v[192:195],a[96:99]
s_add_u32 m0,s80,103424
s_add_u32 s81,s81,s68
buffer_load_dwordx4 v4,s[56:59],s81 offen lds
s_add_u32 s76,s76,s70
v_mfma_f32_16x16x32_bf16 a[100:103],v[236:239],v[196:199],a[100:103]
v_mfma_f32_16x16x32_bf16 a[104:107],v[236:239],v[200:203],a[104:107]
ds_read_b64_tr_b16 v[164:165],v17 offset:0
v_mfma_f32_16x16x32_bf16 a[108:111],v[236:239],v[204:207],a[108:111]
v_mfma_f32_16x16x32_bf16 a[112:115],v[236:239],v[208:211],a[112:115]
ds_read_b64_tr_b16 v[166:167],v17 offset:1024
v_mfma_f32_16x16x32_bf16 a[116:119],v[236:239],v[212:215],a[116:119]
v_mfma_f32_16x16x32_bf16 a[120:123],v[236:239],v[216:219],a[120:123]
ds_read_b64_tr_b16 v[168:169],v18 offset:0
v_mfma_f32_16x16x32_bf16 a[124:127],v[236:239],v[220:223],a[124:127]
s_add_u32 m0,s79,98304
s_add_u32 s81,s75,13312
buffer_load_dwordx4 v3,s[8:11],s81 offen sc1 lds
v_mfma_f32_16x16x32_bf16 a[128:131],v[240:243],v[192:195],a[128:131]
ds_read_b64_tr_b16 v[170:171],v18 offset:1024
v_mfma_f32_16x16x32_bf16 a[132:135],v[240:243],v[196:199],a[132:135]
v_mfma_f32_16x16x32_bf16 a[136:139],v[240:243],v[200:203],a[136:139]
ds_read_b64_tr_b16 v[172:173],v19 offset:0
v_mfma_f32_16x16x32_bf16 a[140:143],v[240:243],v[204:207],a[140:143]
v_mfma_f32_16x16x32_bf16 a[144:147],v[240:243],v[208:211],a[144:147]
ds_read_b64_tr_b16 v[174:175],v19 offset:1024
v_mfma_f32_16x16x32_bf16 a[148:151],v[240:243],v[212:215],a[148:151]
v_mfma_f32_16x16x32_bf16 a[152:155],v[240:243],v[216:219],a[152:155]
s_add_u32 m0,s79,99328
s_add_u32 s81,s75,31744
buffer_load_dwordx4 v3,s[8:11],s81 offen sc1 lds
v_mfma_f32_16x16x32_bf16 a[156:159],v[240:243],v[220:223],a[156:159]
v_mfma_f32_16x16x32_bf16 a[160:163],v[244:247],v[192:195],a[160:163]
ds_read_b64_tr_b16 v[176:177],v20 offset:0
v_mfma_f32_16x16x32_bf16 a[164:167],v[244:247],v[196:199],a[164:167]
v_mfma_f32_16x16x32_bf16 a[168:171],v[244:247],v[200:203],a[168:171]
ds_read_b64_tr_b16 v[178:179],v20 offset:1024
v_mfma_f32_16x16x32_bf16 a[172:175],v[244:247],v[204:207],a[172:175]
v_mfma_f32_16x16x32_bf16 a[176:179],v[244:247],v[208:211],a[176:179]
ds_read_b64_tr_b16 v[180:181],v21 offset:0
v_mfma_f32_16x16x32_bf16 a[180:183],v[244:247],v[212:215],a[180:183]
s_add_u32 m0,s79,100352
s_add_u32 s81,s75,50176
buffer_load_dwordx4 v3,s[8:11],s81 offen sc1 lds
v_mfma_f32_16x16x32_bf16 a[184:187],v[244:247],v[216:219],a[184:187]
ds_read_b64_tr_b16 v[182:183],v21 offset:1024
v_mfma_f32_16x16x32_bf16 a[188:191],v[244:247],v[220:223],a[188:191]
v_mfma_f32_16x16x32_bf16 a[192:195],v[248:251],v[192:195],a[192:195]
ds_read_b64_tr_b16 v[184:185],v22 offset:0
v_mfma_f32_16x16x32_bf16 a[196:199],v[248:251],v[196:199],a[196:199]
v_mfma_f32_16x16x32_bf16 a[200:203],v[248:251],v[200:203],a[200:203]
ds_read_b64_tr_b16 v[186:187],v22 offset:1024
v_mfma_f32_16x16x32_bf16 a[204:207],v[248:251],v[204:207],a[204:207]
v_mfma_f32_16x16x32_bf16 a[208:211],v[248:251],v[208:211],a[208:211]
s_add_u32 m0,s79,101376
s_add_u32 s81,s75,68608
buffer_load_dwordx4 v3,s[8:11],s81 offen sc1 lds
v_mfma_f32_16x16x32_bf16 a[212:215],v[248:251],v[212:215],a[212:215]
v_mfma_f32_16x16x32_bf16 a[216:219],v[248:251],v[216:219],a[216:219]
ds_read_b64_tr_b16 v[188:189],v23 offset:0
v_mfma_f32_16x16x32_bf16 a[220:223],v[248:251],v[220:223],a[220:223]
v_mfma_f32_16x16x32_bf16 a[224:227],v[252:255],v[192:195],a[224:227]
ds_read_b64_tr_b16 v[190:191],v23 offset:1024
v_mfma_f32_16x16x32_bf16 a[228:231],v[252:255],v[196:199],a[228:231]
v_mfma_f32_16x16x32_bf16 a[232:235],v[252:255],v[200:203],a[232:235]
v_mfma_f32_16x16x32_bf16 a[236:239],v[252:255],v[204:207],a[236:239]
v_mfma_f32_16x16x32_bf16 a[240:243],v[252:255],v[208:211],a[240:243]
v_mfma_f32_16x16x32_bf16 a[244:247],v[252:255],v[212:215],a[244:247]
v_mfma_f32_16x16x32_bf16 a[248:251],v[252:255],v[216:219],a[248:251]
v_mfma_f32_16x16x32_bf16 a[252:255],v[252:255],v[220:223],a[252:255]
s_waitcnt vmcnt(16) lgkmcnt(0)
s_barrier
v_mfma_f32_16x16x32_bf16 a[0:3],v[160:163],v[128:131],a[0:3]
v_add_u32 v8,32768,v5
v_mfma_f32_16x16x32_bf16 a[4:7],v[160:163],v[132:135],a[4:7]
v_mfma_f32_16x16x32_bf16 a[8:11],v[160:163],v[136:139],a[8:11]
ds_read_b128 v[192:195],v8 offset:0
v_add_u32 v16,49152,v24
v_mfma_f32_16x16x32_bf16 a[12:15],v[160:163],v[140:143],a[12:15]
s_add_u32 m0,s80,131072
s_mov_b32 s81,s76
buffer_load_dwordx4 v4,s[56:59],s81 offen lds
v_mfma_f32_16x16x32_bf16 a[16:19],v[160:163],v[144:147],a[16:19]
ds_read_b128 v[196:199],v8 offset:1024
v_add_u32 v17,49152,v25
v_mfma_f32_16x16x32_bf16 a[20:23],v[160:163],v[148:151],a[20:23]
v_mfma_f32_16x16x32_bf16 a[24:27],v[160:163],v[152:155],a[24:27]
ds_read_b128 v[200:203],v8 offset:2048
v_add_u32 v18,49152,v26
v_mfma_f32_16x16x32_bf16 a[28:31],v[160:163],v[156:159],a[28:31]
v_mfma_f32_16x16x32_bf16 a[32:35],v[164:167],v[128:131],a[32:35]
ds_read_b128 v[204:207],v8 offset:3072
v_add_u32 v19,49152,v27
v_mfma_f32_16x16x32_bf16 a[36:39],v[164:167],v[132:135],a[36:39]
v_mfma_f32_16x16x32_bf16 a[40:43],v[164:167],v[136:139],a[40:43]
s_add_u32 m0,s80,132096
s_add_u32 s81,s76,s68
buffer_load_dwordx4 v4,s[56:59],s81 offen lds
v_mfma_f32_16x16x32_bf16 a[44:47],v[164:167],v[140:143],a[44:47]
v_mfma_f32_16x16x32_bf16 a[48:51],v[164:167],v[144:147],a[48:51]
ds_read_b128 v[208:211],v8 offset:4096
v_add_u32 v20,49152,v28
v_mfma_f32_16x16x32_bf16 a[52:55],v[164:167],v[148:151],a[52:55]
v_mfma_f32_16x16x32_bf16 a[56:59],v[164:167],v[152:155],a[56:59]
ds_read_b128 v[212:215],v8 offset:5120
v_add_u32 v21,49152,v29
v_mfma_f32_16x16x32_bf16 a[60:63],v[164:167],v[156:159],a[60:63]
v_mfma_f32_16x16x32_bf16 a[64:67],v[168:171],v[128:131],a[64:67]
ds_read_b128 v[216:219],v8 offset:6144
v_add_u32 v22,49152,v30
v_mfma_f32_16x16x32_bf16 a[68:71],v[168:171],v[132:135],a[68:71]
s_add_u32 m0,s80,135168
s_add_u32 s81,s76,s69
buffer_load_dwordx4 v4,s[56:59],s81 offen lds
v_mfma_f32_16x16x32_bf16 a[72:75],v[168:171],v[136:139],a[72:75]
ds_read_b128 v[220:223],v8 offset:7168
v_add_u32 v23,49152,v31
v_mfma_f32_16x16x32_bf16 a[76:79],v[168:171],v[140:143],a[76:79]
v_mfma_f32_16x16x32_bf16 a[80:83],v[168:171],v[144:147],a[80:83]
ds_read_b64_tr_b16 v[224:225],v16 offset:0
v_mfma_f32_16x16x32_bf16 a[84:87],v[168:171],v[148:151],a[84:87]
v_mfma_f32_16x16x32_bf16 a[88:91],v[168:171],v[152:155],a[88:91]
ds_read_b64_tr_b16 v[226:227],v16 offset:1024
v_mfma_f32_16x16x32_bf16 a[92:95],v[168:171],v[156:159],a[92:95]
v_mfma_f32_16x16x32_bf16 a[96:99],v[172:175],v[128:131],a[96:99]
s_add_u32 m0,s80,136192
s_add_u32 s81,s81,s68
buffer_load_dwordx4 v4,s[56:59],s81 offen lds
s_add_u32 s76,s76,s70
v_mfma_f32_16x16x32_bf16 a[100:103],v[172:175],v[132:135],a[100:103]
v_mfma_f32_16x16x32_bf16 a[104:107],v[172:175],v[136:139],a[104:107]
ds_read_b64_tr_b16 v[228:229],v17 offset:0
v_mfma_f32_16x16x32_bf16 a[108:111],v[172:175],v[140:143],a[108:111]
v_mfma_f32_16x16x32_bf16 a[112:115],v[172:175],v[144:147],a[112:115]
ds_read_b64_tr_b16 v[230:231],v17 offset:1024
v_mfma_f32_16x16x32_bf16 a[116:119],v[172:175],v[148:151],a[116:119]
v_mfma_f32_16x16x32_bf16 a[120:123],v[172:175],v[152:155],a[120:123]
ds_read_b64_tr_b16 v[232:233],v18 offset:0
v_mfma_f32_16x16x32_bf16 a[124:127],v[172:175],v[156:159],a[124:127]
s_add_u32 m0,s79,131072
s_add_u32 s81,s75,14336
buffer_load_dwordx4 v3,s[8:11],s81 offen sc1 lds
v_mfma_f32_16x16x32_bf16 a[128:131],v[176:179],v[128:131],a[128:131]
ds_read_b64_tr_b16 v[234:235],v18 offset:1024
v_mfma_f32_16x16x32_bf16 a[132:135],v[176:179],v[132:135],a[132:135]
v_mfma_f32_16x16x32_bf16 a[136:139],v[176:179],v[136:139],a[136:139]
ds_read_b64_tr_b16 v[236:237],v19 offset:0
v_mfma_f32_16x16x32_bf16 a[140:143],v[176:179],v[140:143],a[140:143]
v_mfma_f32_16x16x32_bf16 a[144:147],v[176:179],v[144:147],a[144:147]
ds_read_b64_tr_b16 v[238:239],v19 offset:1024
v_mfma_f32_16x16x32_bf16 a[148:151],v[176:179],v[148:151],a[148:151]
v_mfma_f32_16x16x32_bf16 a[152:155],v[176:179],v[152:155],a[152:155]
s_add_u32 m0,s79,132096
s_add_u32 s81,s75,32768
buffer_load_dwordx4 v3,s[8:11],s81 offen sc1 lds
v_mfma_f32_16x16x32_bf16 a[156:159],v[176:179],v[156:159],a[156:159]
v_mfma_f32_16x16x32_bf16 a[160:163],v[180:183],v[128:131],a[160:163]
ds_read_b64_tr_b16 v[240:241],v20 offset:0
v_mfma_f32_16x16x32_bf16 a[164:167],v[180:183],v[132:135],a[164:167]
v_mfma_f32_16x16x32_bf16 a[168:171],v[180:183],v[136:139],a[168:171]
ds_read_b64_tr_b16 v[242:243],v20 offset:1024
v_mfma_f32_16x16x32_bf16 a[172:175],v[180:183],v[140:143],a[172:175]
v_mfma_f32_16x16x32_bf16 a[176:179],v[180:183],v[144:147],a[176:179]
ds_read_b64_tr_b16 v[244:245],v21 offset:0
v_mfma_f32_16x16x32_bf16 a[180:183],v[180:183],v[148:151],a[180:183]
s_add_u32 m0,s79,133120
s_add_u32 s81,s75,51200
buffer_load_dwordx4 v3,s[8:11],s81 offen sc1 lds
v_mfma_f32_16x16x32_bf16 a[184:187],v[180:183],v[152:155],a[184:187]
ds_read_b64_tr_b16 v[246:247],v21 offset:1024
v_mfma_f32_16x16x32_bf16 a[188:191],v[180:183],v[156:159],a[188:191]
v_mfma_f32_16x16x32_bf16 a[192:195],v[184:187],v[128:131],a[192:195]
ds_read_b64_tr_b16 v[248:249],v22 offset:0
v_mfma_f32_16x16x32_bf16 a[196:199],v[184:187],v[132:135],a[196:199]
v_mfma_f32_16x16x32_bf16 a[200:203],v[184:187],v[136:139],a[200:203]
ds_read_b64_tr_b16 v[250:251],v22 offset:1024
v_mfma_f32_16x16x32_bf16 a[204:207],v[184:187],v[140:143],a[204:207]
v_mfma_f32_16x16x32_bf16 a[208:211],v[184:187],v[144:147],a[208:211]
s_add_u32 m0,s79,134144
s_add_u32 s81,s75,69632
buffer_load_dwordx4 v3,s[8:11],s81 offen sc1 lds
v_mfma_f32_16x16x32_bf16 a[212:215],v[184:187],v[148:151],a[212:215]
v_mfma_f32_16x16x32_bf16 a[216:219],v[184:187],v[152:155],a[216:219]
ds_read_b64_tr_b16 v[252:253],v23 offset:0
v_mfma_f32_16x16x32_bf16 a[220:223],v[184:187],v[156:159],a[220:223]
v_mfma_f32_16x16x32_bf16 a[224:227],v[188:191],v[128:131],a[224:227]
ds_read_b64_tr_b16 v[254:255],v23 offset:1024
v_mfma_f32_16x16x32_bf16 a[228:231],v[188:191],v[132:135],a[228:231]
v_mfma_f32_16x16x32_bf16 a[232:235],v[188:191],v[136:139],a[232:235]
v_mfma_f32_16x16x32_bf16 a[236:239],v[188:191],v[140:143],a[236:239]
v_mfma_f32_16x16x32_bf16 a[240:243],v[188:191],v[144:147],a[240:243]
v_mfma_f32_16x16x32_bf16 a[244:247],v[188:191],v[148:151],a[244:247]
v_mfma_f32_16x16x32_bf16 a[248:251],v[188:191],v[152:155],a[248:251]
v_mfma_f32_16x16x32_bf16 a[252:255],v[188:191],v[156:159],a[252:255]
s_waitcnt vmcnt(16) lgkmcnt(0)
s_barrier
v_mfma_f32_16x16x32_bf16 a[0:3],v[224:227],v[192:195],a[0:3]
v_add_u32 v8,65536,v5
v_mfma_f32_16x16x32_bf16 a[4:7],v[224:227],v[196:199],a[4:7]
v_mfma_f32_16x16x32_bf16 a[8:11],v[224:227],v[200:203],a[8:11]
ds_read_b128 v[128:131],v8 offset:0
v_add_u32 v16,81920,v24
v_mfma_f32_16x16x32_bf16 a[12:15],v[224:227],v[204:207],a[12:15]
s_add_u32 m0,s80,0
s_mov_b32 s81,s76
buffer_load_dwordx4 v4,s[56:59],s81 offen lds
v_mfma_f32_16x16x32_bf16 a[16:19],v[224:227],v[208:211],a[16:19]
ds_read_b128 v[132:135],v8 offset:1024
v_add_u32 v17,81920,v25
v_mfma_f32_16x16x32_bf16 a[20:23],v[224:227],v[212:215],a[20:23]
v_mfma_f32_16x16x32_bf16 a[24:27],v[224:227],v[216:219],a[24:27]
ds_read_b128 v[136:139],v8 offset:2048
v_add_u32 v18,81920,v26
v_mfma_f32_16x16x32_bf16 a[28:31],v[224:227],v[220:223],a[28:31]
v_mfma_f32_16x16x32_bf16 a[32:35],v[228:231],v[192:195],a[32:35]
ds_read_b128 v[140:143],v8 offset:3072
v_add_u32 v19,81920,v27
v_mfma_f32_16x16x32_bf16 a[36:39],v[228:231],v[196:199],a[36:39]
v_mfma_f32_16x16x32_bf16 a[40:43],v[228:231],v[200:203],a[40:43]
s_add_u32 m0,s80,1024
s_add_u32 s81,s76,s68
buffer_load_dwordx4 v4,s[56:59],s81 offen lds
v_mfma_f32_16x16x32_bf16 a[44:47],v[228:231],v[204:207],a[44:47]
v_mfma_f32_16x16x32_bf16 a[48:51],v[228:231],v[208:211],a[48:51]
ds_read_b128 v[144:147],v8 offset:4096
v_add_u32 v20,81920,v28
v_mfma_f32_16x16x32_bf16 a[52:55],v[228:231],v[212:215],a[52:55]
v_mfma_f32_16x16x32_bf16 a[56:59],v[228:231],v[216:219],a[56:59]
ds_read_b128 v[148:151],v8 offset:5120
v_add_u32 v21,81920,v29
v_mfma_f32_16x16x32_bf16 a[60:63],v[228:231],v[220:223],a[60:63]
v_mfma_f32_16x16x32_bf16 a[64:67],v[232:235],v[192:195],a[64:67]
ds_read_b128 v[152:155],v8 offset:6144
v_add_u32 v22,81920,v30
v_mfma_f32_16x16x32_bf16 a[68:71],v[232:235],v[196:199],a[68:71]
s_add_u32 m0,s80,4096
s_add_u32 s81,s76,s69
buffer_load_dwordx4 v4,s[56:59],s81 offen lds
v_mfma_f32_16x16x32_bf16 a[72:75],v[232:235],v[200:203],a[72:75]
ds_read_b128 v[156:159],v8 offset:7168
v_add_u32 v23,81920,v31
v_mfma_f32_16x16x32_bf16 a[76:79],v[232:235],v[204:207],a[76:79]
v_mfma_f32_16x16x32_bf16 a[80:83],v[232:235],v[208:211],a[80:83]
ds_read_b64_tr_b16 v[160:161],v16 offset:0
v_mfma_f32_16x16x32_bf16 a[84:87],v[232:235],v[212:215],a[84:87]
v_mfma_f32_16x16x32_bf16 a[88:91],v[232:235],v[216:219],a[88:91]
ds_read_b64_tr_b16 v[162:163],v16 offset:1024
v_mfma_f32_16x16x32_bf16 a[92:95],v[232:235],v[220:223],a[92:95]
v_mfma_f32_16x16x32_bf16 a[96:99],v[236:239],v[192:195],a[96:99]
s_add_u32 m0,s80,5120
s_add_u32 s81,s81,s68
buffer_load_dwordx4 v4,s[56:59],s81 offen lds
s_add_u32 s76,s76,s70
v_mfma_f32_16x16x32_bf16 a[100:103],v[236:239],v[196:199],a[100:103]
v_mfma_f32_16x16x32_bf16 a[104:107],v[236:239],v[200:203],a[104:107]
ds_read_b64_tr_b16 v[164:165],v17 offset:0
v_mfma_f32_16x16x32_bf16 a[108:111],v[236:239],v[204:207],a[108:111]
v_mfma_f32_16x16x32_bf16 a[112:115],v[236:239],v[208:211],a[112:115]
ds_read_b64_tr_b16 v[166:167],v17 offset:1024
v_mfma_f32_16x16x32_bf16 a[116:119],v[236:239],v[212:215],a[116:119]
v_mfma_f32_16x16x32_bf16 a[120:123],v[236:239],v[216:219],a[120:123]
ds_read_b64_tr_b16 v[168:169],v18 offset:0
v_mfma_f32_16x16x32_bf16 a[124:127],v[236:239],v[220:223],a[124:127]
s_add_u32 m0,s79,0
s_add_u32 s81,s75,15360
buffer_load_dwordx4 v3,s[8:11],s81 offen sc1 lds
v_mfma_f32_16x16x32_bf16 a[128:131],v[240:243],v[192:195],a[128:131]
ds_read_b64_tr_b16 v[170:171],v18 offset:1024
v_mfma_f32_16x16x32_bf16 a[132:135],v[240:243],v[196:199],a[132:135]
v_mfma_f32_16x16x32_bf16 a[136:139],v[240:243],v[200:203],a[136:139]
ds_read_b64_tr_b16 v[172:173],v19 offset:0
v_mfma_f32_16x16x32_bf16 a[140:143],v[240:243],v[204:207],a[140:143]
v_mfma_f32_16x16x32_bf16 a[144:147],v[240:243],v[208:211],a[144:147]
ds_read_b64_tr_b16 v[174:175],v19 offset:1024
v_mfma_f32_16x16x32_bf16 a[148:151],v[240:243],v[212:215],a[148:151]
v_mfma_f32_16x16x32_bf16 a[152:155],v[240:243],v[216:219],a[152:155]
s_add_u32 m0,s79,1024
s_add_u32 s81,s75,33792
buffer_load_dwordx4 v3,s[8:11],s81 offen sc1 lds
v_mfma_f32_16x16x32_bf16 a[156:159],v[240:243],v[220:223],a[156:159]
v_mfma_f32_16x16x32_bf16 a[160:163],v[244:247],v[192:195],a[160:163]
ds_read_b64_tr_b16 v[176:177],v20 offset:0
v_mfma_f32_16x16x32_bf16 a[164:167],v[244:247],v[196:199],a[164:167]
v_mfma_f32_16x16x32_bf16 a[168:171],v[244:247],v[200:203],a[168:171]
ds_read_b64_tr_b16 v[178:179],v20 offset:1024
v_mfma_f32_16x16x32_bf16 a[172:175],v[244:247],v[204:207],a[172:175]
v_mfma_f32_16x16x32_bf16 a[176:179],v[244:247],v[208:211],a[176:179]
ds_read_b64_tr_b16 v[180:181],v21 offset:0
v_mfma_f32_16x16x32_bf16 a[180:183],v[244:247],v[212:215],a[180:183]
s_add_u32 m0,s79,2048
s_add_u32 s81,s75,52224
buffer_load_dwordx4 v3,s[8:11],s81 offen sc1 lds
v_mfma_f32_16x16x32_bf16 a[184:187],v[244:247],v[216:219],a[184:187]
ds_read_b64_tr_b16 v[182:183],v21 offset:1024
v_mfma_f32_16x16x32_bf16 a[188:191],v[244:247],v[220:223],a[188:191]
v_mfma_f32_16x16x32_bf16 a[192:195],v[248:251],v[192:195],a[192:195]
ds_read_b64_tr_b16 v[184:185],v22 offset:0
v_mfma_f32_16x16x32_bf16 a[196:199],v[248:251],v[196:199],a[196:199]
v_mfma_f32_16x16x32_bf16 a[200:203],v[248:251],v[200:203],a[200:203]
ds_read_b64_tr_b16 v[186:187],v22 offset:1024
v_mfma_f32_16x16x32_bf16 a[204:207],v[248:251],v[204:207],a[204:207]
v_mfma_f32_16x16x32_bf16 a[208:211],v[248:251],v[208:211],a[208:211]
s_add_u32 m0,s79,3072
s_add_u32 s81,s75,70656
buffer_load_dwordx4 v3,s[8:11],s81 offen sc1 lds
v_mfma_f32_16x16x32_bf16 a[212:215],v[248:251],v[212:215],a[212:215]
v_mfma_f32_16x16x32_bf16 a[216:219],v[248:251],v[216:219],a[216:219]
ds_read_b64_tr_b16 v[188:189],v23 offset:0
v_mfma_f32_16x16x32_bf16 a[220:223],v[248:251],v[220:223],a[220:223]
v_mfma_f32_16x16x32_bf16 a[224:227],v[252:255],v[192:195],a[224:227]
ds_read_b64_tr_b16 v[190:191],v23 offset:1024
v_mfma_f32_16x16x32_bf16 a[228:231],v[252:255],v[196:199],a[228:231]
v_mfma_f32_16x16x32_bf16 a[232:235],v[252:255],v[200:203],a[232:235]
v_mfma_f32_16x16x32_bf16 a[236:239],v[252:255],v[204:207],a[236:239]
v_mfma_f32_16x16x32_bf16 a[240:243],v[252:255],v[208:211],a[240:243]
v_mfma_f32_16x16x32_bf16 a[244:247],v[252:255],v[212:215],a[244:247]
v_mfma_f32_16x16x32_bf16 a[248:251],v[252:255],v[216:219],a[248:251]
v_mfma_f32_16x16x32_bf16 a[252:255],v[252:255],v[220:223],a[252:255]
s_waitcnt vmcnt(16) lgkmcnt(0)
s_barrier
v_mfma_f32_16x16x32_bf16 a[0:3],v[160:163],v[128:131],a[0:3]
v_add_u32 v8,98304,v5
v_mfma_f32_16x16x32_bf16 a[4:7],v[160:163],v[132:135],a[4:7]
v_mfma_f32_16x16x32_bf16 a[8:11],v[160:163],v[136:139],a[8:11]
ds_read_b128 v[192:195],v8 offset:0
v_add_u32 v16,114688,v24
v_mfma_f32_16x16x32_bf16 a[12:15],v[160:163],v[140:143],a[12:15]
s_add_u32 m0,s80,32768
s_mov_b32 s81,s76
buffer_load_dwordx4 v4,s[56:59],s81 offen lds
v_mfma_f32_16x16x32_bf16 a[16:19],v[160:163],v[144:147],a[16:19]
ds_read_b128 v[196:199],v8 offset:1024
v_add_u32 v17,114688,v25
v_mfma_f32_16x16x32_bf16 a[20:23],v[160:163],v[148:151],a[20:23]
v_mfma_f32_16x16x32_bf16 a[24:27],v[160:163],v[152:155],a[24:27]
ds_read_b128 v[200:203],v8 offset:2048
v_add_u32 v18,114688,v26
v_mfma_f32_16x16x32_bf16 a[28:31],v[160:163],v[156:159],a[28:31]
v_mfma_f32_16x16x32_bf16 a[32:35],v[164:167],v[128:131],a[32:35]
ds_read_b128 v[204:207],v8 offset:3072
v_add_u32 v19,114688,v27
v_mfma_f32_16x16x32_bf16 a[36:39],v[164:167],v[132:135],a[36:39]
v_mfma_f32_16x16x32_bf16 a[40:43],v[164:167],v[136:139],a[40:43]
s_add_u32 m0,s80,33792
s_add_u32 s81,s76,s68
buffer_load_dwordx4 v4,s[56:59],s81 offen lds
v_mfma_f32_16x16x32_bf16 a[44:47],v[164:167],v[140:143],a[44:47]
v_mfma_f32_16x16x32_bf16 a[48:51],v[164:167],v[144:147],a[48:51]
ds_read_b128 v[208:211],v8 offset:4096
v_add_u32 v20,114688,v28
v_mfma_f32_16x16x32_bf16 a[52:55],v[164:167],v[148:151],a[52:55]
v_mfma_f32_16x16x32_bf16 a[56:59],v[164:167],v[152:155],a[56:59]
ds_read_b128 v[212:215],v8 offset:5120
v_add_u32 v21,114688,v29
v_mfma_f32_16x16x32_bf16 a[60:63],v[164:167],v[156:159],a[60:63]
v_mfma_f32_16x16x32_bf16 a[64:67],v[168:171],v[128:131],a[64:67]
ds_read_b128 v[216:219],v8 offset:6144
v_add_u32 v22,114688,v30
v_mfma_f32_16x16x32_bf16 a[68:71],v[168:171],v[132:135],a[68:71]
s_add_u32 m0,s80,36864
s_add_u32 s81,s76,s69
buffer_load_dwordx4 v4,s[56:59],s81 offen lds
v_mfma_f32_16x16x32_bf16 a[72:75],v[168:171],v[136:139],a[72:75]
ds_read_b128 v[220:223],v8 offset:7168
v_add_u32 v23,114688,v31
v_mfma_f32_16x16x32_bf16 a[76:79],v[168:171],v[140:143],a[76:79]
v_mfma_f32_16x16x32_bf16 a[80:83],v[168:171],v[144:147],a[80:83]
ds_read_b64_tr_b16 v[224:225],v16 offset:0
v_mfma_f32_16x16x32_bf16 a[84:87],v[168:171],v[148:151],a[84:87]
v_mfma_f32_16x16x32_bf16 a[88:91],v[168:171],v[152:155],a[88:91]
ds_read_b64_tr_b16 v[226:227],v16 offset:1024
v_mfma_f32_16x16x32_bf16 a[92:95],v[168:171],v[156:159],a[92:95]
v_mfma_f32_16x16x32_bf16 a[96:99],v[172:175],v[128:131],a[96:99]
s_add_u32 m0,s80,37888
s_add_u32 s81,s81,s68
buffer_load_dwordx4 v4,s[56:59],s81 offen lds
s_add_u32 s76,s76,s70
v_mfma_f32_16x16x32_bf16 a[100:103],v[172:175],v[132:135],a[100:103]
v_mfma_f32_16x16x32_bf16 a[104:107],v[172:175],v[136:139],a[104:107]
ds_read_b64_tr_b16 v[228:229],v17 offset:0
v_mfma_f32_16x16x32_bf16 a[108:111],v[172:175],v[140:143],a[108:111]
v_mfma_f32_16x16x32_bf16 a[112:115],v[172:175],v[144:147],a[112:115]
ds_read_b64_tr_b16 v[230:231],v17 offset:1024
v_mfma_f32_16x16x32_bf16 a[116:119],v[172:175],v[148:151],a[116:119]
v_mfma_f32_16x16x32_bf16 a[120:123],v[172:175],v[152:155],a[120:123]
ds_read_b64_tr_b16 v[232:233],v18 offset:0
v_mfma_f32_16x16x32_bf16 a[124:127],v[172:175],v[156:159],a[124:127]
s_add_u32 m0,s79,32768
s_add_u32 s81,s75,16384
buffer_load_dwordx4 v3,s[8:11],s81 offen sc1 lds
v_mfma_f32_16x16x32_bf16 a[128:131],v[176:179],v[128:131],a[128:131]
ds_read_b64_tr_b16 v[234:235],v18 offset:1024
v_mfma_f32_16x16x32_bf16 a[132:135],v[176:179],v[132:135],a[132:135]
v_mfma_f32_16x16x32_bf16 a[136:139],v[176:179],v[136:139],a[136:139]
ds_read_b64_tr_b16 v[236:237],v19 offset:0
v_mfma_f32_16x16x32_bf16 a[140:143],v[176:179],v[140:143],a[140:143]
v_mfma_f32_16x16x32_bf16 a[144:147],v[176:179],v[144:147],a[144:147]
ds_read_b64_tr_b16 v[238:239],v19 offset:1024
v_mfma_f32_16x16x32_bf16 a[148:151],v[176:179],v[148:151],a[148:151]
v_mfma_f32_16x16x32_bf16 a[152:155],v[176:179],v[152:155],a[152:155]
s_add_u32 m0,s79,33792
s_add_u32 s81,s75,34816
buffer_load_dwordx4 v3,s[8:11],s81 offen sc1 lds
v_mfma_f32_16x16x32_bf16 a[156:159],v[176:179],v[156:159],a[156:159]
v_mfma_f32_16x16x32_bf16 a[160:163],v[180:183],v[128:131],a[160:163]
ds_read_b64_tr_b16 v[240:241],v20 offset:0
v_mfma_f32_16x16x32_bf16 a[164:167],v[180:183],v[132:135],a[164:167]
v_mfma_f32_16x16x32_bf16 a[168:171],v[180:183],v[136:139],a[168:171]
ds_read_b64_tr_b16 v[242:243],v20 offset:1024
v_mfma_f32_16x16x32_bf16 a[172:175],v[180:183],v[140:143],a[172:175]
v_mfma_f32_16x16x32_bf16 a[176:179],v[180:183],v[144:147],a[176:179]
ds_read_b64_tr_b16 v[244:245],v21 offset:0
v_mfma_f32_16x16x32_bf16 a[180:183],v[180:183],v[148:151],a[180:183]
s_add_u32 m0,s79,34816
s_add_u32 s81,s75,53248
buffer_load_dwordx4 v3,s[8:11],s81 offen sc1 lds
v_mfma_f32_16x16x32_bf16 a[184:187],v[180:183],v[152:155],a[184:187]
ds_read_b64_tr_b16 v[246:247],v21 offset:1024
v_mfma_f32_16x16x32_bf16 a[188:191],v[180:183],v[156:159],a[188:191]
v_mfma_f32_16x16x32_bf16 a[192:195],v[184:187],v[128:131],a[192:195]
ds_read_b64_tr_b16 v[248:249],v22 offset:0
v_mfma_f32_16x16x32_bf16 a[196:199],v[184:187],v[132:135],a[196:199]
v_mfma_f32_16x16x32_bf16 a[200:203],v[184:187],v[136:139],a[200:203]
ds_read_b64_tr_b16 v[250:251],v22 offset:1024
v_mfma_f32_16x16x32_bf16 a[204:207],v[184:187],v[140:143],a[204:207]
v_mfma_f32_16x16x32_bf16 a[208:211],v[184:187],v[144:147],a[208:211]
s_add_u32 m0,s79,35840
s_add_u32 s81,s75,71680
buffer_load_dwordx4 v3,s[8:11],s81 offen sc1 lds
v_mfma_f32_16x16x32_bf16 a[212:215],v[184:187],v[148:151],a[212:215]
v_mfma_f32_16x16x32_bf16 a[216:219],v[184:187],v[152:155],a[216:219]
ds_read_b64_tr_b16 v[252:253],v23 offset:0
v_mfma_f32_16x16x32_bf16 a[220:223],v[184:187],v[156:159],a[220:223]
v_mfma_f32_16x16x32_bf16 a[224:227],v[188:191],v[128:131],a[224:227]
ds_read_b64_tr_b16 v[254:255],v23 offset:1024
v_mfma_f32_16x16x32_bf16 a[228:231],v[188:191],v[132:135],a[228:231]
v_mfma_f32_16x16x32_bf16 a[232:235],v[188:191],v[136:139],a[232:235]
v_mfma_f32_16x16x32_bf16 a[236:239],v[188:191],v[140:143],a[236:239]
v_mfma_f32_16x16x32_bf16 a[240:243],v[188:191],v[144:147],a[240:243]
v_mfma_f32_16x16x32_bf16 a[244:247],v[188:191],v[148:151],a[244:247]
v_mfma_f32_16x16x32_bf16 a[248:251],v[188:191],v[152:155],a[248:251]
v_mfma_f32_16x16x32_bf16 a[252:255],v[188:191],v[156:159],a[252:255]
s_waitcnt vmcnt(16) lgkmcnt(0)
s_barrier
v_mfma_f32_16x16x32_bf16 a[0:3],v[224:227],v[192:195],a[0:3]
v_add_u32 v8,131072,v5
v_mfma_f32_16x16x32_bf16 a[4:7],v[224:227],v[196:199],a[4:7]
v_mfma_f32_16x16x32_bf16 a[8:11],v[224:227],v[200:203],a[8:11]
ds_read_b128 v[128:131],v8 offset:0
v_add_u32 v16,147456,v24
v_mfma_f32_16x16x32_bf16 a[12:15],v[224:227],v[204:207],a[12:15]
s_add_u32 m0,s80,65536
s_mov_b32 s81,s76
buffer_load_dwordx4 v4,s[56:59],s81 offen lds
v_mfma_f32_16x16x32_bf16 a[16:19],v[224:227],v[208:211],a[16:19]
ds_read_b128 v[132:135],v8 offset:1024
v_add_u32 v17,147456,v25
v_mfma_f32_16x16x32_bf16 a[20:23],v[224:227],v[212:215],a[20:23]
v_mfma_f32_16x16x32_bf16 a[24:27],v[224:227],v[216:219],a[24:27]
ds_read_b128 v[136:139],v8 offset:2048
v_add_u32 v18,147456,v26
v_mfma_f32_16x16x32_bf16 a[28:31],v[224:227],v[220:223],a[28:31]
v_mfma_f32_16x16x32_bf16 a[32:35],v[228:231],v[192:195],a[32:35]
ds_read_b128 v[140:143],v8 offset:3072
v_add_u32 v19,147456,v27
v_mfma_f32_16x16x32_bf16 a[36:39],v[228:231],v[196:199],a[36:39]
v_mfma_f32_16x16x32_bf16 a[40:43],v[228:231],v[200:203],a[40:43]
s_add_u32 m0,s80,66560
s_add_u32 s81,s76,s68
buffer_load_dwordx4 v4,s[56:59],s81 offen lds
v_mfma_f32_16x16x32_bf16 a[44:47],v[228:231],v[204:207],a[44:47]
v_mfma_f32_16x16x32_bf16 a[48:51],v[228:231],v[208:211],a[48:51]
ds_read_b128 v[144:147],v8 offset:4096
v_add_u32 v20,147456,v28
v_mfma_f32_16x16x32_bf16 a[52:55],v[228:231],v[212:215],a[52:55]
v_mfma_f32_16x16x32_bf16 a[56:59],v[228:231],v[216:219],a[56:59]
ds_read_b128 v[148:151],v8 offset:5120
v_add_u32 v21,147456,v29
v_mfma_f32_16x16x32_bf16 a[60:63],v[228:231],v[220:223],a[60:63]
v_mfma_f32_16x16x32_bf16 a[64:67],v[232:235],v[192:195],a[64:67]
ds_read_b128 v[152:155],v8 offset:6144
v_add_u32 v22,147456,v30
v_mfma_f32_16x16x32_bf16 a[68:71],v[232:235],v[196:199],a[68:71]
s_add_u32 m0,s80,69632
s_add_u32 s81,s76,s69
buffer_load_dwordx4 v4,s[56:59],s81 offen lds
v_mfma_f32_16x16x32_bf16 a[72:75],v[232:235],v[200:203],a[72:75]
ds_read_b128 v[156:159],v8 offset:7168
v_add_u32 v23,147456,v31
v_mfma_f32_16x16x32_bf16 a[76:79],v[232:235],v[204:207],a[76:79]
v_mfma_f32_16x16x32_bf16 a[80:83],v[232:235],v[208:211],a[80:83]
ds_read_b64_tr_b16 v[160:161],v16 offset:0
v_mfma_f32_16x16x32_bf16 a[84:87],v[232:235],v[212:215],a[84:87]
v_mfma_f32_16x16x32_bf16 a[88:91],v[232:235],v[216:219],a[88:91]
ds_read_b64_tr_b16 v[162:163],v16 offset:1024
v_mfma_f32_16x16x32_bf16 a[92:95],v[232:235],v[220:223],a[92:95]
v_mfma_f32_16x16x32_bf16 a[96:99],v[236:239],v[192:195],a[96:99]
s_add_u32 m0,s80,70656
s_add_u32 s81,s81,s68
buffer_load_dwordx4 v4,s[56:59],s81 offen lds
s_add_u32 s76,s76,s70
v_mfma_f32_16x16x32_bf16 a[100:103],v[236:239],v[196:199],a[100:103]
v_mfma_f32_16x16x32_bf16 a[104:107],v[236:239],v[200:203],a[104:107]
ds_read_b64_tr_b16 v[164:165],v17 offset:0
v_mfma_f32_16x16x32_bf16 a[108:111],v[236:239],v[204:207],a[108:111]
v_mfma_f32_16x16x32_bf16 a[112:115],v[236:239],v[208:211],a[112:115]
ds_read_b64_tr_b16 v[166:167],v17 offset:1024
v_mfma_f32_16x16x32_bf16 a[116:119],v[236:239],v[212:215],a[116:119]
v_mfma_f32_16x16x32_bf16 a[120:123],v[236:239],v[216:219],a[120:123]
ds_read_b64_tr_b16 v[168:169],v18 offset:0
v_mfma_f32_16x16x32_bf16 a[124:127],v[236:239],v[220:223],a[124:127]
s_add_u32 m0,s79,65536
s_add_u32 s81,s75,17408
buffer_load_dwordx4 v3,s[8:11],s81 offen sc1 lds
v_mfma_f32_16x16x32_bf16 a[128:131],v[240:243],v[192:195],a[128:131]
ds_read_b64_tr_b16 v[170:171],v18 offset:1024
v_mfma_f32_16x16x32_bf16 a[132:135],v[240:243],v[196:199],a[132:135]
v_mfma_f32_16x16x32_bf16 a[136:139],v[240:243],v[200:203],a[136:139]
ds_read_b64_tr_b16 v[172:173],v19 offset:0
v_mfma_f32_16x16x32_bf16 a[140:143],v[240:243],v[204:207],a[140:143]
v_mfma_f32_16x16x32_bf16 a[144:147],v[240:243],v[208:211],a[144:147]
ds_read_b64_tr_b16 v[174:175],v19 offset:1024
v_mfma_f32_16x16x32_bf16 a[148:151],v[240:243],v[212:215],a[148:151]
v_mfma_f32_16x16x32_bf16 a[152:155],v[240:243],v[216:219],a[152:155]
s_add_u32 m0,s79,66560
s_add_u32 s81,s75,35840
buffer_load_dwordx4 v3,s[8:11],s81 offen sc1 lds
v_mfma_f32_16x16x32_bf16 a[156:159],v[240:243],v[220:223],a[156:159]
v_mfma_f32_16x16x32_bf16 a[160:163],v[244:247],v[192:195],a[160:163]
ds_read_b64_tr_b16 v[176:177],v20 offset:0
v_mfma_f32_16x16x32_bf16 a[164:167],v[244:247],v[196:199],a[164:167]
v_mfma_f32_16x16x32_bf16 a[168:171],v[244:247],v[200:203],a[168:171]
ds_read_b64_tr_b16 v[178:179],v20 offset:1024
v_mfma_f32_16x16x32_bf16 a[172:175],v[244:247],v[204:207],a[172:175]
v_mfma_f32_16x16x32_bf16 a[176:179],v[244:247],v[208:211],a[176:179]
ds_read_b64_tr_b16 v[180:181],v21 offset:0
v_mfma_f32_16x16x32_bf16 a[180:183],v[244:247],v[212:215],a[180:183]
s_add_u32 m0,s79,67584
s_add_u32 s81,s75,54272
buffer_load_dwordx4 v3,s[8:11],s81 offen sc1 lds
v_mfma_f32_16x16x32_bf16 a[184:187],v[244:247],v[216:219],a[184:187]
ds_read_b64_tr_b16 v[182:183],v21 offset:1024
v_mfma_f32_16x16x32_bf16 a[188:191],v[244:247],v[220:223],a[188:191]
v_mfma_f32_16x16x32_bf16 a[192:195],v[248:251],v[192:195],a[192:195]
ds_read_b64_tr_b16 v[184:185],v22 offset:0
v_mfma_f32_16x16x32_bf16 a[196:199],v[248:251],v[196:199],a[196:199]
v_mfma_f32_16x16x32_bf16 a[200:203],v[248:251],v[200:203],a[200:203]
ds_read_b64_tr_b16 v[186:187],v22 offset:1024
v_mfma_f32_16x16x32_bf16 a[204:207],v[248:251],v[204:207],a[204:207]
v_mfma_f32_16x16x32_bf16 a[208:211],v[248:251],v[208:211],a[208:211]
s_add_u32 m0,s79,68608
s_add_u32 s81,s75,72704
buffer_load_dwordx4 v3,s[8:11],s81 offen sc1 lds
v_mfma_f32_16x16x32_bf16 a[212:215],v[248:251],v[212:215],a[212:215]
v_mfma_f32_16x16x32_bf16 a[216:219],v[248:251],v[216:219],a[216:219]
ds_read_b64_tr_b16 v[188:189],v23 offset:0
v_mfma_f32_16x16x32_bf16 a[220:223],v[248:251],v[220:223],a[220:223]
v_mfma_f32_16x16x32_bf16 a[224:227],v[252:255],v[192:195],a[224:227]
ds_read_b64_tr_b16 v[190:191],v23 offset:1024
v_mfma_f32_16x16x32_bf16 a[228:231],v[252:255],v[196:199],a[228:231]
v_mfma_f32_16x16x32_bf16 a[232:235],v[252:255],v[200:203],a[232:235]
v_mfma_f32_16x16x32_bf16 a[236:239],v[252:255],v[204:207],a[236:239]
v_mfma_f32_16x16x32_bf16 a[240:243],v[252:255],v[208:211],a[240:243]
v_mfma_f32_16x16x32_bf16 a[244:247],v[252:255],v[212:215],a[244:247]
v_mfma_f32_16x16x32_bf16 a[248:251],v[252:255],v[216:219],a[248:251]
v_mfma_f32_16x16x32_bf16 a[252:255],v[252:255],v[220:223],a[252:255]
s_waitcnt vmcnt(16) lgkmcnt(0)
s_barrier
v_mfma_f32_16x16x32_bf16 a[0:3],v[160:163],v[128:131],a[0:3]
v_add_u32 v8,0,v5
v_mfma_f32_16x16x32_bf16 a[4:7],v[160:163],v[132:135],a[4:7]
v_mfma_f32_16x16x32_bf16 a[8:11],v[160:163],v[136:139],a[8:11]
ds_read_b128 v[192:195],v8 offset:0
v_add_u32 v16,16384,v24
v_mfma_f32_16x16x32_bf16 a[12:15],v[160:163],v[140:143],a[12:15]
v_mfma_f32_16x16x32_bf16 a[16:19],v[160:163],v[144:147],a[16:19]
ds_read_b128 v[196:199],v8 offset:1024
v_add_u32 v17,16384,v25
v_mfma_f32_16x16x32_bf16 a[20:23],v[160:163],v[148:151],a[20:23]
v_mfma_f32_16x16x32_bf16 a[24:27],v[160:163],v[152:155],a[24:27]
ds_read_b128 v[200:203],v8 offset:2048
v_add_u32 v18,16384,v26
v_mfma_f32_16x16x32_bf16 a[28:31],v[160:163],v[156:159],a[28:31]
v_mfma_f32_16x16x32_bf16 a[32:35],v[164:167],v[128:131],a[32:35]
ds_read_b128 v[204:207],v8 offset:3072
v_add_u32 v19,16384,v27
v_mfma_f32_16x16x32_bf16 a[36:39],v[164:167],v[132:135],a[36:39]
v_mfma_f32_16x16x32_bf16 a[40:43],v[164:167],v[136:139],a[40:43]
ds_read_b128 v[208:211],v8 offset:4096
v_add_u32 v20,16384,v28
v_mfma_f32_16x16x32_bf16 a[44:47],v[164:167],v[140:143],a[44:47]
v_mfma_f32_16x16x32_bf16 a[48:51],v[164:167],v[144:147],a[48:51]
ds_read_b128 v[212:215],v8 offset:5120
v_add_u32 v21,16384,v29
v_mfma_f32_16x16x32_bf16 a[52:55],v[164:167],v[148:151],a[52:55]
v_mfma_f32_16x16x32_bf16 a[56:59],v[164:167],v[152:155],a[56:59]
ds_read_b128 v[216:219],v8 offset:6144
v_add_u32 v22,16384,v30
v_mfma_f32_16x16x32_bf16 a[60:63],v[164:167],v[156:159],a[60:63]
v_mfma_f32_16x16x32_bf16 a[64:67],v[168:171],v[128:131],a[64:67]
ds_read_b128 v[220:223],v8 offset:7168
v_add_u32 v23,16384,v31
v_mfma_f32_16x16x32_bf16 a[68:71],v[168:171],v[132:135],a[68:71]
v_mfma_f32_16x16x32_bf16 a[72:75],v[168:171],v[136:139],a[72:75]
ds_read_b64_tr_b16 v[224:225],v16 offset:0
v_mfma_f32_16x16x32_bf16 a[76:79],v[168:171],v[140:143],a[76:79]
v_mfma_f32_16x16x32_bf16 a[80:83],v[168:171],v[144:147],a[80:83]
ds_read_b64_tr_b16 v[226:227],v16 offset:1024
v_mfma_f32_16x16x32_bf16 a[84:87],v[168:171],v[148:151],a[84:87]
v_mfma_f32_16x16x32_bf16 a[88:91],v[168:171],v[152:155],a[88:91]
ds_read_b64_tr_b16 v[228:229],v17 offset:0
v_mfma_f32_16x16x32_bf16 a[92:95],v[168:171],v[156:159],a[92:95]
v_mfma_f32_16x16x32_bf16 a[96:99],v[172:175],v[128:131],a[96:99]
ds_read_b64_tr_b16 v[230:231],v17 offset:1024
v_mfma_f32_16x16x32_bf16 a[100:103],v[172:175],v[132:135],a[100:103]
v_mfma_f32_16x16x32_bf16 a[104:107],v[172:175],v[136:139],a[104:107]
ds_read_b64_tr_b16 v[232:233],v18 offset:0
v_mfma_f32_16x16x32_bf16 a[108:111],v[172:175],v[140:143],a[108:111]
v_mfma_f32_16x16x32_bf16 a[112:115],v[172:175],v[144:147],a[112:115]
ds_read_b64_tr_b16 v[234:235],v18 offset:1024
v_mfma_f32_16x16x32_bf16 a[116:119],v[172:175],v[148:151],a[116:119]
v_mfma_f32_16x16x32_bf16 a[120:123],v[172:175],v[152:155],a[120:123]
ds_read_b64_tr_b16 v[236:237],v19 offset:0
v_mfma_f32_16x16x32_bf16 a[124:127],v[172:175],v[156:159],a[124:127]
v_mfma_f32_16x16x32_bf16 a[128:131],v[176:179],v[128:131],a[128:131]
ds_read_b64_tr_b16 v[238:239],v19 offset:1024
v_mfma_f32_16x16x32_bf16 a[132:135],v[176:179],v[132:135],a[132:135]
v_mfma_f32_16x16x32_bf16 a[136:139],v[176:179],v[136:139],a[136:139]
ds_read_b64_tr_b16 v[240:241],v20 offset:0
v_mfma_f32_16x16x32_bf16 a[140:143],v[176:179],v[140:143],a[140:143]
v_mfma_f32_16x16x32_bf16 a[144:147],v[176:179],v[144:147],a[144:147]
ds_read_b64_tr_b16 v[242:243],v20 offset:1024
v_mfma_f32_16x16x32_bf16 a[148:151],v[176:179],v[148:151],a[148:151]
v_mfma_f32_16x16x32_bf16 a[152:155],v[176:179],v[152:155],a[152:155]
ds_read_b64_tr_b16 v[244:245],v21 offset:0
v_mfma_f32_16x16x32_bf16 a[156:159],v[176:179],v[156:159],a[156:159]
v_mfma_f32_16x16x32_bf16 a[160:163],v[180:183],v[128:131],a[160:163]
ds_read_b64_tr_b16 v[246:247],v21 offset:1024
v_mfma_f32_16x16x32_bf16 a[164:167],v[180:183],v[132:135],a[164:167]
v_mfma_f32_16x16x32_bf16 a[168:171],v[180:183],v[136:139],a[168:171]
ds_read_b64_tr_b16 v[248:249],v22 offset:0
v_mfma_f32_16x16x32_bf16 a[172:175],v[180:183],v[140:143],a[172:175]
v_mfma_f32_16x16x32_bf16 a[176:179],v[180:183],v[144:147],a[176:179]
ds_read_b64_tr_b16 v[250:251],v22 offset:1024
v_mfma_f32_16x16x32_bf16 a[180:183],v[180:183],v[148:151],a[180:183]
v_mfma_f32_16x16x32_bf16 a[184:187],v[180:183],v[152:155],a[184:187]
ds_read_b64_tr_b16 v[252:253],v23 offset:0
v_mfma_f32_16x16x32_bf16 a[188:191],v[180:183],v[156:159],a[188:191]
v_mfma_f32_16x16x32_bf16 a[192:195],v[184:187],v[128:131],a[192:195]
ds_read_b64_tr_b16 v[254:255],v23 offset:1024
v_mfma_f32_16x16x32_bf16 a[196:199],v[184:187],v[132:135],a[196:199]
v_mfma_f32_16x16x32_bf16 a[200:203],v[184:187],v[136:139],a[200:203]
v_mfma_f32_16x16x32_bf16 a[204:207],v[184:187],v[140:143],a[204:207]
v_mfma_f32_16x16x32_bf16 a[208:211],v[184:187],v[144:147],a[208:211]
v_mfma_f32_16x16x32_bf16 a[212:215],v[184:187],v[148:151],a[212:215]
v_mfma_f32_16x16x32_bf16 a[216:219],v[184:187],v[152:155],a[216:219]
v_mfma_f32_16x16x32_bf16 a[220:223],v[184:187],v[156:159],a[220:223]
v_mfma_f32_16x16x32_bf16 a[224:227],v[188:191],v[128:131],a[224:227]
v_mfma_f32_16x16x32_bf16 a[228:231],v[188:191],v[132:135],a[228:231]
v_mfma_f32_16x16x32_bf16 a[232:235],v[188:191],v[136:139],a[232:235]
v_mfma_f32_16x16x32_bf16 a[236:239],v[188:191],v[140:143],a[236:239]
v_mfma_f32_16x16x32_bf16 a[240:243],v[188:191],v[144:147],a[240:243]
v_mfma_f32_16x16x32_bf16 a[244:247],v[188:191],v[148:151],a[244:247]
v_mfma_f32_16x16x32_bf16 a[248:251],v[188:191],v[152:155],a[248:251]
v_mfma_f32_16x16x32_bf16 a[252:255],v[188:191],v[156:159],a[252:255]
s_waitcnt vmcnt(8) lgkmcnt(0)
s_barrier
v_mfma_f32_16x16x32_bf16 a[0:3],v[224:227],v[192:195],a[0:3]
v_add_u32 v8,32768,v5
v_mfma_f32_16x16x32_bf16 a[4:7],v[224:227],v[196:199],a[4:7]
v_mfma_f32_16x16x32_bf16 a[8:11],v[224:227],v[200:203],a[8:11]
ds_read_b128 v[128:131],v8 offset:0
v_add_u32 v16,49152,v24
v_mfma_f32_16x16x32_bf16 a[12:15],v[224:227],v[204:207],a[12:15]
v_mfma_f32_16x16x32_bf16 a[16:19],v[224:227],v[208:211],a[16:19]
ds_read_b128 v[132:135],v8 offset:1024
v_add_u32 v17,49152,v25
v_mfma_f32_16x16x32_bf16 a[20:23],v[224:227],v[212:215],a[20:23]
v_mfma_f32_16x16x32_bf16 a[24:27],v[224:227],v[216:219],a[24:27]
ds_read_b128 v[136:139],v8 offset:2048
v_add_u32 v18,49152,v26
v_mfma_f32_16x16x32_bf16 a[28:31],v[224:227],v[220:223],a[28:31]
v_mfma_f32_16x16x32_bf16 a[32:35],v[228:231],v[192:195],a[32:35]
ds_read_b128 v[140:143],v8 offset:3072
v_add_u32 v19,49152,v27
v_mfma_f32_16x16x32_bf16 a[36:39],v[228:231],v[196:199],a[36:39]
v_mfma_f32_16x16x32_bf16 a[40:43],v[228:231],v[200:203],a[40:43]
ds_read_b128 v[144:147],v8 offset:4096
v_add_u32 v20,49152,v28
v_mfma_f32_16x16x32_bf16 a[44:47],v[228:231],v[204:207],a[44:47]
v_mfma_f32_16x16x32_bf16 a[48:51],v[228:231],v[208:211],a[48:51]
ds_read_b128 v[148:151],v8 offset:5120
v_add_u32 v21,49152,v29
v_mfma_f32_16x16x32_bf16 a[52:55],v[228:231],v[212:215],a[52:55]
v_mfma_f32_16x16x32_bf16 a[56:59],v[228:231],v[216:219],a[56:59]
ds_read_b128 v[152:155],v8 offset:6144
v_add_u32 v22,49152,v30
v_mfma_f32_16x16x32_bf16 a[60:63],v[228:231],v[220:223],a[60:63]
v_mfma_f32_16x16x32_bf16 a[64:67],v[232:235],v[192:195],a[64:67]
ds_read_b128 v[156:159],v8 offset:7168
v_add_u32 v23,49152,v31
v_mfma_f32_16x16x32_bf16 a[68:71],v[232:235],v[196:199],a[68:71]
v_mfma_f32_16x16x32_bf16 a[72:75],v[232:235],v[200:203],a[72:75]
ds_read_b64_tr_b16 v[160:161],v16 offset:0
v_mfma_f32_16x16x32_bf16 a[76:79],v[232:235],v[204:207],a[76:79]
v_mfma_f32_16x16x32_bf16 a[80:83],v[232:235],v[208:211],a[80:83]
ds_read_b64_tr_b16 v[162:163],v16 offset:1024
v_mfma_f32_16x16x32_bf16 a[84:87],v[232:235],v[212:215],a[84:87]
v_mfma_f32_16x16x32_bf16 a[88:91],v[232:235],v[216:219],a[88:91]
ds_read_b64_tr_b16 v[164:165],v17 offset:0
v_mfma_f32_16x16x32_bf16 a[92:95],v[232:235],v[220:223],a[92:95]
v_mfma_f32_16x16x32_bf16 a[96:99],v[236:239],v[192:195],a[96:99]
ds_read_b64_tr_b16 v[166:167],v17 offset:1024
v_mfma_f32_16x16x32_bf16 a[100:103],v[236:239],v[196:199],a[100:103]
v_mfma_f32_16x16x32_bf16 a[104:107],v[236:239],v[200:203],a[104:107]
ds_read_b64_tr_b16 v[168:169],v18 offset:0
v_mfma_f32_16x16x32_bf16 a[108:111],v[236:239],v[204:207],a[108:111]
v_mfma_f32_16x16x32_bf16 a[112:115],v[236:239],v[208:211],a[112:115]
ds_read_b64_tr_b16 v[170:171],v18 offset:1024
v_mfma_f32_16x16x32_bf16 a[116:119],v[236:239],v[212:215],a[116:119]
v_mfma_f32_16x16x32_bf16 a[120:123],v[236:239],v[216:219],a[120:123]
ds_read_b64_tr_b16 v[172:173],v19 offset:0
v_mfma_f32_16x16x32_bf16 a[124:127],v[236:239],v[220:223],a[124:127]
v_mfma_f32_16x16x32_bf16 a[128:131],v[240:243],v[192:195],a[128:131]
ds_read_b64_tr_b16 v[174:175],v19 offset:1024
v_mfma_f32_16x16x32_bf16 a[132:135],v[240:243],v[196:199],a[132:135]
v_mfma_f32_16x16x32_bf16 a[136:139],v[240:243],v[200:203],a[136:139]
ds_read_b64_tr_b16 v[176:177],v20 offset:0
v_mfma_f32_16x16x32_bf16 a[140:143],v[240:243],v[204:207],a[140:143]
v_mfma_f32_16x16x32_bf16 a[144:147],v[240:243],v[208:211],a[144:147]
ds_read_b64_tr_b16 v[178:179],v20 offset:1024
v_mfma_f32_16x16x32_bf16 a[148:151],v[240:243],v[212:215],a[148:151]
v_mfma_f32_16x16x32_bf16 a[152:155],v[240:243],v[216:219],a[152:155]
ds_read_b64_tr_b16 v[180:181],v21 offset:0
v_mfma_f32_16x16x32_bf16 a[156:159],v[240:243],v[220:223],a[156:159]
v_mfma_f32_16x16x32_bf16 a[160:163],v[244:247],v[192:195],a[160:163]
ds_read_b64_tr_b16 v[182:183],v21 offset:1024
v_mfma_f32_16x16x32_bf16 a[164:167],v[244:247],v[196:199],a[164:167]
v_mfma_f32_16x16x32_bf16 a[168:171],v[244:247],v[200:203],a[168:171]
ds_read_b64_tr_b16 v[184:185],v22 offset:0
v_mfma_f32_16x16x32_bf16 a[172:175],v[244:247],v[204:207],a[172:175]
v_mfma_f32_16x16x32_bf16 a[176:179],v[244:247],v[208:211],a[176:179]
ds_read_b64_tr_b16 v[186:187],v22 offset:1024
v_mfma_f32_16x16x32_bf16 a[180:183],v[244:247],v[212:215],a[180:183]
v_mfma_f32_16x16x32_bf16 a[184:187],v[244:247],v[216:219],a[184:187]
ds_read_b64_tr_b16 v[188:189],v23 offset:0
v_mfma_f32_16x16x32_bf16 a[188:191],v[244:247],v[220:223],a[188:191]
v_mfma_f32_16x16x32_bf16 a[192:195],v[248:251],v[192:195],a[192:195]
ds_read_b64_tr_b16 v[190:191],v23 offset:1024
v_mfma_f32_16x16x32_bf16 a[196:199],v[248:251],v[196:199],a[196:199]
v_mfma_f32_16x16x32_bf16 a[200:203],v[248:251],v[200:203],a[200:203]
s_mov_b64 exec,s[64:65]
ds_write_b32 v11,v9
s_mov_b64 exec,-1
v_mfma_f32_16x16x32_bf16 a[204:207],v[248:251],v[204:207],a[204:207]
v_mfma_f32_16x16x32_bf16 a[208:211],v[248:251],v[208:211],a[208:211]
v_mfma_f32_16x16x32_bf16 a[212:215],v[248:251],v[212:215],a[212:215]
v_mfma_f32_16x16x32_bf16 a[216:219],v[248:251],v[216:219],a[216:219]
v_mfma_f32_16x16x32_bf16 a[220:223],v[248:251],v[220:223],a[220:223]
v_mfma_f32_16x16x32_bf16 a[224:227],v[252:255],v[192:195],a[224:227]
v_mfma_f32_16x16x32_bf16 a[228:231],v[252:255],v[196:199],a[228:231]
v_mfma_f32_16x16x32_bf16 a[232:235],v[252:255],v[200:203],a[232:235]
v_mfma_f32_16x16x32_bf16 a[236:239],v[252:255],v[204:207],a[236:239]
v_mfma_f32_16x16x32_bf16 a[240:243],v[252:255],v[208:211],a[240:243]
v_mfma_f32_16x16x32_bf16 a[244:247],v[252:255],v[212:215],a[244:247]
v_mfma_f32_16x16x32_bf16 a[248:251],v[252:255],v[216:219],a[248:251]
v_mfma_f32_16x16x32_bf16 a[252:255],v[252:255],v[220:223],a[252:255]
s_waitcnt vmcnt(0) lgkmcnt(0)
s_barrier
v_mfma_f32_16x16x32_bf16 a[0:3],v[160:163],v[128:131],a[0:3]
v_add_u32 v8,65536,v5
v_mfma_f32_16x16x32_bf16 a[4:7],v[160:163],v[132:135],a[4:7]
v_mfma_f32_16x16x32_bf16 a[8:11],v[160:163],v[136:139],a[8:11]
ds_read_b128 v[192:195],v8 offset:0
v_add_u32 v16,81920,v24
v_mfma_f32_16x16x32_bf16 a[12:15],v[160:163],v[140:143],a[12:15]
v_mfma_f32_16x16x32_bf16 a[16:19],v[160:163],v[144:147],a[16:19]
ds_read_b128 v[196:199],v8 offset:1024
v_add_u32 v17,81920,v25
v_mfma_f32_16x16x32_bf16 a[20:23],v[160:163],v[148:151],a[20:23]
v_mfma_f32_16x16x32_bf16 a[24:27],v[160:163],v[152:155],a[24:27]
ds_read_b128 v[200:203],v8 offset:2048
v_add_u32 v18,81920,v26
v_mfma_f32_16x16x32_bf16 a[28:31],v[160:163],v[156:159],a[28:31]
v_mfma_f32_16x16x32_bf16 a[32:35],v[164:167],v[128:131],a[32:35]
ds_read_b128 v[204:207],v8 offset:3072
v_add_u32 v19,81920,v27
v_mfma_f32_16x16x32_bf16 a[36:39],v[164:167],v[132:135],a[36:39]
v_mfma_f32_16x16x32_bf16 a[40:43],v[164:167],v[136:139],a[40:43]
ds_read_b128 v[208:211],v8 offset:4096
v_add_u32 v20,81920,v28
v_mfma_f32_16x16x32_bf16 a[44:47],v[164:167],v[140:143],a[44:47]
v_mfma_f32_16x16x32_bf16 a[48:51],v[164:167],v[144:147],a[48:51]
ds_read_b128 v[212:215],v8 offset:5120
v_add_u32 v21,81920,v29
v_mfma_f32_16x16x32_bf16 a[52:55],v[164:167],v[148:151],a[52:55]
v_mfma_f32_16x16x32_bf16 a[56:59],v[164:167],v[152:155],a[56:59]
ds_read_b128 v[216:219],v8 offset:6144
v_add_u32 v22,81920,v30
v_mfma_f32_16x16x32_bf16 a[60:63],v[164:167],v[156:159],a[60:63]
v_mfma_f32_16x16x32_bf16 a[64:67],v[168:171],v[128:131],a[64:67]
ds_read_b128 v[220:223],v8 offset:7168
v_add_u32 v23,81920,v31
v_mfma_f32_16x16x32_bf16 a[68:71],v[168:171],v[132:135],a[68:71]
v_mfma_f32_16x16x32_bf16 a[72:75],v[168:171],v[136:139],a[72:75]
ds_read_b64_tr_b16 v[224:225],v16 offset:0
v_mfma_f32_16x16x32_bf16 a[76:79],v[168:171],v[140:143],a[76:79]
v_mfma_f32_16x16x32_bf16 a[80:83],v[168:171],v[144:147],a[80:83]
ds_read_b64_tr_b16 v[226:227],v16 offset:1024
v_mfma_f32_16x16x32_bf16 a[84:87],v[168:171],v[148:151],a[84:87]
v_mfma_f32_16x16x32_bf16 a[88:91],v[168:171],v[152:155],a[88:91]
ds_read_b64_tr_b16 v[228:229],v17 offset:0
v_mfma_f32_16x16x32_bf16 a[92:95],v[168:171],v[156:159],a[92:95]
v_mfma_f32_16x16x32_bf16 a[96:99],v[172:175],v[128:131],a[96:99]
ds_read_b64_tr_b16 v[230:231],v17 offset:1024
v_mfma_f32_16x16x32_bf16 a[100:103],v[172:175],v[132:135],a[100:103]
v_mfma_f32_16x16x32_bf16 a[104:107],v[172:175],v[136:139],a[104:107]
ds_read_b64_tr_b16 v[232:233],v18 offset:0
v_mfma_f32_16x16x32_bf16 a[108:111],v[172:175],v[140:143],a[108:111]
v_mfma_f32_16x16x32_bf16 a[112:115],v[172:175],v[144:147],a[112:115]
ds_read_b64_tr_b16 v[234:235],v18 offset:1024
v_mfma_f32_16x16x32_bf16 a[116:119],v[172:175],v[148:151],a[116:119]
v_mfma_f32_16x16x32_bf16 a[120:123],v[172:175],v[152:155],a[120:123]
ds_read_b64_tr_b16 v[236:237],v19 offset:0
v_mfma_f32_16x16x32_bf16 a[124:127],v[172:175],v[156:159],a[124:127]
v_mfma_f32_16x16x32_bf16 a[128:131],v[176:179],v[128:131],a[128:131]
ds_read_b64_tr_b16 v[238:239],v19 offset:1024
v_mfma_f32_16x16x32_bf16 a[132:135],v[176:179],v[132:135],a[132:135]
v_mfma_f32_16x16x32_bf16 a[136:139],v[176:179],v[136:139],a[136:139]
ds_read_b64_tr_b16 v[240:241],v20 offset:0
v_mfma_f32_16x16x32_bf16 a[140:143],v[176:179],v[140:143],a[140:143]
v_mfma_f32_16x16x32_bf16 a[144:147],v[176:179],v[144:147],a[144:147]
ds_read_b64_tr_b16 v[242:243],v20 offset:1024
v_mfma_f32_16x16x32_bf16 a[148:151],v[176:179],v[148:151],a[148:151]
v_mfma_f32_16x16x32_bf16 a[152:155],v[176:179],v[152:155],a[152:155]
ds_read_b64_tr_b16 v[244:245],v21 offset:0
v_mfma_f32_16x16x32_bf16 a[156:159],v[176:179],v[156:159],a[156:159]
v_mfma_f32_16x16x32_bf16 a[160:163],v[180:183],v[128:131],a[160:163]
ds_read_b64_tr_b16 v[246:247],v21 offset:1024
v_mfma_f32_16x16x32_bf16 a[164:167],v[180:183],v[132:135],a[164:167]
v_mfma_f32_16x16x32_bf16 a[168:171],v[180:183],v[136:139],a[168:171]
ds_read_b64_tr_b16 v[248:249],v22 offset:0
v_mfma_f32_16x16x32_bf16 a[172:175],v[180:183],v[140:143],a[172:175]
v_mfma_f32_16x16x32_bf16 a[176:179],v[180:183],v[144:147],a[176:179]
ds_read_b64_tr_b16 v[250:251],v22 offset:1024
v_mfma_f32_16x16x32_bf16 a[180:183],v[180:183],v[148:151],a[180:183]
v_mfma_f32_16x16x32_bf16 a[184:187],v[180:183],v[152:155],a[184:187]
ds_read_b64_tr_b16 v[252:253],v23 offset:0
v_mfma_f32_16x16x32_bf16 a[188:191],v[180:183],v[156:159],a[188:191]
v_mfma_f32_16x16x32_bf16 a[192:195],v[184:187],v[128:131],a[192:195]
ds_read_b64_tr_b16 v[254:255],v23 offset:1024
v_mfma_f32_16x16x32_bf16 a[196:199],v[184:187],v[132:135],a[196:199]
v_mfma_f32_16x16x32_bf16 a[200:203],v[184:187],v[136:139],a[200:203]
ds_read_b32 v9,v11
v_mfma_f32_16x16x32_bf16 a[204:207],v[184:187],v[140:143],a[204:207]
v_mfma_f32_16x16x32_bf16 a[208:211],v[184:187],v[144:147],a[208:211]
v_mfma_f32_16x16x32_bf16 a[212:215],v[184:187],v[148:151],a[212:215]
v_mfma_f32_16x16x32_bf16 a[216:219],v[184:187],v[152:155],a[216:219]
v_mfma_f32_16x16x32_bf16 a[220:223],v[184:187],v[156:159],a[220:223]
v_mfma_f32_16x16x32_bf16 a[224:227],v[188:191],v[128:131],a[224:227]
v_mfma_f32_16x16x32_bf16 a[228:231],v[188:191],v[132:135],a[228:231]
v_mfma_f32_16x16x32_bf16 a[232:235],v[188:191],v[136:139],a[232:235]
v_mfma_f32_16x16x32_bf16 a[236:239],v[188:191],v[140:143],a[236:239]
v_mfma_f32_16x16x32_bf16 a[240:243],v[188:191],v[144:147],a[240:243]
v_mfma_f32_16x16x32_bf16 a[244:247],v[188:191],v[148:151],a[244:247]
v_mfma_f32_16x16x32_bf16 a[248:251],v[188:191],v[152:155],a[248:251]
v_mfma_f32_16x16x32_bf16 a[252:255],v[188:191],v[156:159],a[252:255]
s_waitcnt lgkmcnt(0)
v_mfma_f32_16x16x32_bf16 a[0:3],v[224:227],v[192:195],a[0:3]
v_mfma_f32_16x16x32_bf16 a[4:7],v[224:227],v[196:199],a[4:7]
v_mfma_f32_16x16x32_bf16 a[8:11],v[224:227],v[200:203],a[8:11]
v_mfma_f32_16x16x32_bf16 a[12:15],v[224:227],v[204:207],a[12:15]
v_mfma_f32_16x16x32_bf16 a[16:19],v[224:227],v[208:211],a[16:19]
v_mfma_f32_16x16x32_bf16 a[20:23],v[224:227],v[212:215],a[20:23]
v_mfma_f32_16x16x32_bf16 a[24:27],v[224:227],v[216:219],a[24:27]
v_mfma_f32_16x16x32_bf16 a[28:31],v[224:227],v[220:223],a[28:31]
v_mfma_f32_16x16x32_bf16 a[32:35],v[228:231],v[192:195],a[32:35]
v_mfma_f32_16x16x32_bf16 a[36:39],v[228:231],v[196:199],a[36:39]
v_mfma_f32_16x16x32_bf16 a[40:43],v[228:231],v[200:203],a[40:43]
v_mfma_f32_16x16x32_bf16 a[44:47],v[228:231],v[204:207],a[44:47]
v_mfma_f32_16x16x32_bf16 a[48:51],v[228:231],v[208:211],a[48:51]
v_mfma_f32_16x16x32_bf16 a[52:55],v[228:231],v[212:215],a[52:55]
v_mfma_f32_16x16x32_bf16 a[56:59],v[228:231],v[216:219],a[56:59]
v_mfma_f32_16x16x32_bf16 a[60:63],v[228:231],v[220:223],a[60:63]
v_mfma_f32_16x16x32_bf16 a[64:67],v[232:235],v[192:195],a[64:67]
v_mfma_f32_16x16x32_bf16 a[68:71],v[232:235],v[196:199],a[68:71]
v_mfma_f32_16x16x32_bf16 a[72:75],v[232:235],v[200:203],a[72:75]
v_mfma_f32_16x16x32_bf16 a[76:79],v[232:235],v[204:207],a[76:79]
v_mfma_f32_16x16x32_bf16 a[80:83],v[232:235],v[208:211],a[80:83]
v_mfma_f32_16x16x32_bf16 a[84:87],v[232:235],v[212:215],a[84:87]
v_mfma_f32_16x16x32_bf16 a[88:91],v[232:235],v[216:219],a[88:91]
v_mfma_f32_16x16x32_bf16 a[92:95],v[232:235],v[220:223],a[92:95]
v_mfma_f32_16x16x32_bf16 a[96:99],v[236:239],v[192:195],a[96:99]
v_mfma_f32_16x16x32_bf16 a[100:103],v[236:239],v[196:199],a[100:103]
v_mfma_f32_16x16x32_bf16 a[104:107],v[236:239],v[200:203],a[104:107]
v_mfma_f32_16x16x32_bf16 a[108:111],v[236:239],v[204:207],a[108:111]
v_mfma_f32_16x16x32_bf16 a[112:115],v[236:239],v[208:211],a[112:115]
v_mfma_f32_16x16x32_bf16 a[116:119],v[236:239],v[212:215],a[116:119]
v_mfma_f32_16x16x32_bf16 a[120:123],v[236:239],v[216:219],a[120:123]
v_mfma_f32_16x16x32_bf16 a[124:127],v[236:239],v[220:223],a[124:127]
v_mfma_f32_16x16x32_bf16 a[128:131],v[240:243],v[192:195],a[128:131]
v_mfma_f32_16x16x32_bf16 a[132:135],v[240:243],v[196:199],a[132:135]
v_mfma_f32_16x16x32_bf16 a[136:139],v[240:243],v[200:203],a[136:139]
v_mfma_f32_16x16x32_bf16 a[140:143],v[240:243],v[204:207],a[140:143]
v_mfma_f32_16x16x32_bf16 a[144:147],v[240:243],v[208:211],a[144:147]
v_mfma_f32_16x16x32_bf16 a[148:151],v[240:243],v[212:215],a[148:151]
v_mfma_f32_16x16x32_bf16 a[152:155],v[240:243],v[216:219],a[152:155]
v_mfma_f32_16x16x32_bf16 a[156:159],v[240:243],v[220:223],a[156:159]
v_mfma_f32_16x16x32_bf16 a[160:163],v[244:247],v[192:195],a[160:163]
v_mfma_f32_16x16x32_bf16 a[164:167],v[244:247],v[196:199],a[164:167]
v_mfma_f32_16x16x32_bf16 a[168:171],v[244:247],v[200:203],a[168:171]
v_mfma_f32_16x16x32_bf16 a[172:175],v[244:247],v[204:207],a[172:175]
v_mfma_f32_16x16x32_bf16 a[176:179],v[244:247],v[208:211],a[176:179]
v_mfma_f32_16x16x32_bf16 a[180:183],v[244:247],v[212:215],a[180:183]
v_mfma_f32_16x16x32_bf16 a[184:187],v[244:247],v[216:219],a[184:187]
v_mfma_f32_16x16x32_bf16 a[188:191],v[244:247],v[220:223],a[188:191]
v_mfma_f32_16x16x32_bf16 a[192:195],v[248:251],v[192:195],a[192:195]
v_mfma_f32_16x16x32_bf16 a[196:199],v[248:251],v[196:199],a[196:199]
v_mfma_f32_16x16x32_bf16 a[200:203],v[248:251],v[200:203],a[200:203]
v_mfma_f32_16x16x32_bf16 a[204:207],v[248:251],v[204:207],a[204:207]
v_mfma_f32_16x16x32_bf16 a[208:211],v[248:251],v[208:211],a[208:211]
v_mfma_f32_16x16x32_bf16 a[212:215],v[248:251],v[212:215],a[212:215]
v_mfma_f32_16x16x32_bf16 a[216:219],v[248:251],v[216:219],a[216:219]
v_mfma_f32_16x16x32_bf16 a[220:223],v[248:251],v[220:223],a[220:223]
v_mfma_f32_16x16x32_bf16 a[224:227],v[252:255],v[192:195],a[224:227]
v_mfma_f32_16x16x32_bf16 a[228:231],v[252:255],v[196:199],a[228:231]
v_mfma_f32_16x16x32_bf16 a[232:235],v[252:255],v[200:203],a[232:235]
v_mfma_f32_16x16x32_bf16 a[236:239],v[252:255],v[204:207],a[236:239]
v_mfma_f32_16x16x32_bf16 a[240:243],v[252:255],v[208:211],a[240:243]
v_mfma_f32_16x16x32_bf16 a[244:247],v[252:255],v[212:215],a[244:247]
v_mfma_f32_16x16x32_bf16 a[248:251],v[252:255],v[216:219],a[248:251]
v_mfma_f32_16x16x32_bf16 a[252:255],v[252:255],v[220:223],a[252:255]
s_branch Lg1_next
Lg1_vloop:
s_waitcnt vmcnt(40)
s_barrier
v_add_u32 v8,0,v5
v_add_u32 v16,16384,v24
v_add_u32 v17,16384,v25
v_add_u32 v18,16384,v26
v_add_u32 v19,16384,v27
v_add_u32 v20,16384,v28
v_add_u32 v21,16384,v29
v_add_u32 v22,16384,v30
v_add_u32 v23,16384,v31
ds_read_b128 v[128:131],v8 offset:0
ds_read_b128 v[132:135],v8 offset:1024
ds_read_b128 v[136:139],v8 offset:2048
ds_read_b128 v[140:143],v8 offset:3072
ds_read_b128 v[144:147],v8 offset:4096
ds_read_b128 v[148:151],v8 offset:5120
ds_read_b128 v[152:155],v8 offset:6144
ds_read_b128 v[156:159],v8 offset:7168
ds_read_b64_tr_b16 v[160:161],v16 offset:0
ds_read_b64_tr_b16 v[162:163],v16 offset:1024
ds_read_b64_tr_b16 v[164:165],v17 offset:0
ds_read_b64_tr_b16 v[166:167],v17 offset:1024
ds_read_b64_tr_b16 v[168:169],v18 offset:0
ds_read_b64_tr_b16 v[170:171],v18 offset:1024
ds_read_b64_tr_b16 v[172:173],v19 offset:0
ds_read_b64_tr_b16 v[174:175],v19 offset:1024
ds_read_b64_tr_b16 v[176:177],v20 offset:0
ds_read_b64_tr_b16 v[178:179],v20 offset:1024
ds_read_b64_tr_b16 v[180:181],v21 offset:0
ds_read_b64_tr_b16 v[182:183],v21 offset:1024
ds_read_b64_tr_b16 v[184:185],v22 offset:0
ds_read_b64_tr_b16 v[186:187],v22 offset:1024
ds_read_b64_tr_b16 v[188:189],v23 offset:0
ds_read_b64_tr_b16 v[190:191],v23 offset:1024
s_waitcnt vmcnt(32) lgkmcnt(0)
s_barrier
v_mfma_f32_16x16x32_bf16 a[0:3],v[128:131],v[160:163],0
v_add_u32 v8,32768,v5
v_mfma_f32_16x16x32_bf16 a[4:7],v[132:135],v[160:163],0
v_mfma_f32_16x16x32_bf16 a[8:11],v[136:139],v[160:163],0
ds_read_b128 v[192:195],v8 offset:0
v_add_u32 v16,49152,v24
v_mfma_f32_16x16x32_bf16 a[12:15],v[140:143],v[160:163],0
s_add_u32 m0,s80,131072
s_mov_b32 s81,s76
buffer_load_dwordx4 v4,s[56:59],s81 offen lds
v_mfma_f32_16x16x32_bf16 a[16:19],v[144:147],v[160:163],0
ds_read_b128 v[196:199],v8 offset:1024
v_add_u32 v17,49152,v25
v_mfma_f32_16x16x32_bf16 a[20:23],v[148:151],v[160:163],0
v_mfma_f32_16x16x32_bf16 a[24:27],v[152:155],v[160:163],0
ds_read_b128 v[200:203],v8 offset:2048
v_add_u32 v18,49152,v26
v_mfma_f32_16x16x32_bf16 a[28:31],v[156:159],v[160:163],0
v_mfma_f32_16x16x32_bf16 a[32:35],v[128:131],v[164:167],0
ds_read_b128 v[204:207],v8 offset:3072
v_add_u32 v19,49152,v27
v_mfma_f32_16x16x32_bf16 a[36:39],v[132:135],v[164:167],0
v_mfma_f32_16x16x32_bf16 a[40:43],v[136:139],v[164:167],0
s_add_u32 m0,s80,132096
s_add_u32 s81,s76,s68
buffer_load_dwordx4 v4,s[56:59],s81 offen lds
v_mfma_f32_16x16x32_bf16 a[44:47],v[140:143],v[164:167],0
v_mfma_f32_16x16x32_bf16 a[48:51],v[144:147],v[164:167],0
ds_read_b128 v[208:211],v8 offset:4096
v_add_u32 v20,49152,v28
v_mfma_f32_16x16x32_bf16 a[52:55],v[148:151],v[164:167],0
v_mfma_f32_16x16x32_bf16 a[56:59],v[152:155],v[164:167],0
ds_read_b128 v[212:215],v8 offset:5120
v_add_u32 v21,49152,v29
v_mfma_f32_16x16x32_bf16 a[60:63],v[156:159],v[164:167],0
v_mfma_f32_16x16x32_bf16 a[64:67],v[128:131],v[168:171],0
ds_read_b128 v[216:219],v8 offset:6144
v_add_u32 v22,49152,v30
v_mfma_f32_16x16x32_bf16 a[68:71],v[132:135],v[168:171],0
s_add_u32 m0,s80,135168
s_add_u32 s81,s76,s69
buffer_load_dwordx4 v4,s[56:59],s81 offen lds
v_mfma_f32_16x16x32_bf16 a[72:75],v[136:139],v[168:171],0
ds_read_b128 v[220:223],v8 offset:7168
v_add_u32 v23,49152,v31
v_mfma_f32_16x16x32_bf16 a[76:79],v[140:143],v[168:171],0
v_mfma_f32_16x16x32_bf16 a[80:83],v[144:147],v[168:171],0
ds_read_b64_tr_b16 v[224:225],v16 offset:0
v_mfma_f32_16x16x32_bf16 a[84:87],v[148:151],v[168:171],0
v_mfma_f32_16x16x32_bf16 a[88:91],v[152:155],v[168:171],0
ds_read_b64_tr_b16 v[226:227],v16 offset:1024
v_mfma_f32_16x16x32_bf16 a[92:95],v[156:159],v[168:171],0
v_mfma_f32_16x16x32_bf16 a[96:99],v[128:131],v[172:175],0
s_add_u32 m0,s80,136192
s_add_u32 s81,s81,s68
buffer_load_dwordx4 v4,s[56:59],s81 offen lds
s_add_u32 s76,s76,s70
v_mfma_f32_16x16x32_bf16 a[100:103],v[132:135],v[172:175],0
v_mfma_f32_16x16x32_bf16 a[104:107],v[136:139],v[172:175],0
ds_read_b64_tr_b16 v[228:229],v17 offset:0
v_mfma_f32_16x16x32_bf16 a[108:111],v[140:143],v[172:175],0
v_mfma_f32_16x16x32_bf16 a[112:115],v[144:147],v[172:175],0
ds_read_b64_tr_b16 v[230:231],v17 offset:1024
v_mfma_f32_16x16x32_bf16 a[116:119],v[148:151],v[172:175],0
v_mfma_f32_16x16x32_bf16 a[120:123],v[152:155],v[172:175],0
ds_read_b64_tr_b16 v[232:233],v18 offset:0
v_mfma_f32_16x16x32_bf16 a[124:127],v[156:159],v[172:175],0
s_add_u32 m0,s79,131072
s_add_u32 s81,s75,4096
buffer_load_dwordx4 v3,s[8:11],s81 offen sc1 lds
v_mfma_f32_16x16x32_bf16 a[128:131],v[128:131],v[176:179],0
ds_read_b64_tr_b16 v[234:235],v18 offset:1024
v_mfma_f32_16x16x32_bf16 a[132:135],v[132:135],v[176:179],0
v_mfma_f32_16x16x32_bf16 a[136:139],v[136:139],v[176:179],0
ds_read_b64_tr_b16 v[236:237],v19 offset:0
v_mfma_f32_16x16x32_bf16 a[140:143],v[140:143],v[176:179],0
v_mfma_f32_16x16x32_bf16 a[144:147],v[144:147],v[176:179],0
ds_read_b64_tr_b16 v[238:239],v19 offset:1024
v_mfma_f32_16x16x32_bf16 a[148:151],v[148:151],v[176:179],0
v_mfma_f32_16x16x32_bf16 a[152:155],v[152:155],v[176:179],0
s_add_u32 m0,s79,132096
s_add_u32 s81,s75,22528
buffer_load_dwordx4 v3,s[8:11],s81 offen sc1 lds
v_mfma_f32_16x16x32_bf16 a[156:159],v[156:159],v[176:179],0
v_mfma_f32_16x16x32_bf16 a[160:163],v[128:131],v[180:183],0
ds_read_b64_tr_b16 v[240:241],v20 offset:0
v_mfma_f32_16x16x32_bf16 a[164:167],v[132:135],v[180:183],0
v_mfma_f32_16x16x32_bf16 a[168:171],v[136:139],v[180:183],0
ds_read_b64_tr_b16 v[242:243],v20 offset:1024
v_mfma_f32_16x16x32_bf16 a[172:175],v[140:143],v[180:183],0
v_mfma_f32_16x16x32_bf16 a[176:179],v[144:147],v[180:183],0
ds_read_b64_tr_b16 v[244:245],v21 offset:0
v_mfma_f32_16x16x32_bf16 a[180:183],v[148:151],v[180:183],0
s_add_u32 m0,s79,133120
s_add_u32 s81,s75,40960
buffer_load_dwordx4 v3,s[8:11],s81 offen sc1 lds
v_mfma_f32_16x16x32_bf16 a[184:187],v[152:155],v[180:183],0
ds_read_b64_tr_b16 v[246:247],v21 offset:1024
v_mfma_f32_16x16x32_bf16 a[188:191],v[156:159],v[180:183],0
v_mfma_f32_16x16x32_bf16 a[192:195],v[128:131],v[184:187],0
ds_read_b64_tr_b16 v[248:249],v22 offset:0
v_mfma_f32_16x16x32_bf16 a[196:199],v[132:135],v[184:187],0
v_mfma_f32_16x16x32_bf16 a[200:203],v[136:139],v[184:187],0
ds_read_b64_tr_b16 v[250:251],v22 offset:1024
v_mfma_f32_16x16x32_bf16 a[204:207],v[140:143],v[184:187],0
v_mfma_f32_16x16x32_bf16 a[208:211],v[144:147],v[184:187],0
s_add_u32 m0,s79,134144
s_add_u32 s81,s75,59392
buffer_load_dwordx4 v3,s[8:11],s81 offen sc1 lds
v_mfma_f32_16x16x32_bf16 a[212:215],v[148:151],v[184:187],0
v_mfma_f32_16x16x32_bf16 a[216:219],v[152:155],v[184:187],0
ds_read_b64_tr_b16 v[252:253],v23 offset:0
v_mfma_f32_16x16x32_bf16 a[220:223],v[156:159],v[184:187],0
v_mfma_f32_16x16x32_bf16 a[224:227],v[128:131],v[188:191],0
ds_read_b64_tr_b16 v[254:255],v23 offset:1024
v_mfma_f32_16x16x32_bf16 a[228:231],v[132:135],v[188:191],0
v_mfma_f32_16x16x32_bf16 a[232:235],v[136:139],v[188:191],0
v_mfma_f32_16x16x32_bf16 a[236:239],v[140:143],v[188:191],0
v_mfma_f32_16x16x32_bf16 a[240:243],v[144:147],v[188:191],0
v_mfma_f32_16x16x32_bf16 a[244:247],v[148:151],v[188:191],0
v_mfma_f32_16x16x32_bf16 a[248:251],v[152:155],v[188:191],0
v_mfma_f32_16x16x32_bf16 a[252:255],v[156:159],v[188:191],0
s_waitcnt vmcnt(32) lgkmcnt(0)
s_barrier
v_mfma_f32_16x16x32_bf16 a[0:3],v[192:195],v[224:227],a[0:3]
v_add_u32 v8,65536,v5
v_mfma_f32_16x16x32_bf16 a[4:7],v[196:199],v[224:227],a[4:7]
v_mfma_f32_16x16x32_bf16 a[8:11],v[200:203],v[224:227],a[8:11]
ds_read_b128 v[128:131],v8 offset:0
v_add_u32 v16,81920,v24
v_mfma_f32_16x16x32_bf16 a[12:15],v[204:207],v[224:227],a[12:15]
s_add_u32 m0,s80,0
s_mov_b32 s81,s76
buffer_load_dwordx4 v4,s[56:59],s81 offen lds
v_mfma_f32_16x16x32_bf16 a[16:19],v[208:211],v[224:227],a[16:19]
ds_read_b128 v[132:135],v8 offset:1024
v_add_u32 v17,81920,v25
v_mfma_f32_16x16x32_bf16 a[20:23],v[212:215],v[224:227],a[20:23]
v_mfma_f32_16x16x32_bf16 a[24:27],v[216:219],v[224:227],a[24:27]
ds_read_b128 v[136:139],v8 offset:2048
v_add_u32 v18,81920,v26
v_mfma_f32_16x16x32_bf16 a[28:31],v[220:223],v[224:227],a[28:31]
v_mfma_f32_16x16x32_bf16 a[32:35],v[192:195],v[228:231],a[32:35]
ds_read_b128 v[140:143],v8 offset:3072
v_add_u32 v19,81920,v27
v_mfma_f32_16x16x32_bf16 a[36:39],v[196:199],v[228:231],a[36:39]
v_mfma_f32_16x16x32_bf16 a[40:43],v[200:203],v[228:231],a[40:43]
s_add_u32 m0,s80,1024
s_add_u32 s81,s76,s68
buffer_load_dwordx4 v4,s[56:59],s81 offen lds
v_mfma_f32_16x16x32_bf16 a[44:47],v[204:207],v[228:231],a[44:47]
v_mfma_f32_16x16x32_bf16 a[48:51],v[208:211],v[228:231],a[48:51]
ds_read_b128 v[144:147],v8 offset:4096
v_add_u32 v20,81920,v28
v_mfma_f32_16x16x32_bf16 a[52:55],v[212:215],v[228:231],a[52:55]
v_mfma_f32_16x16x32_bf16 a[56:59],v[216:219],v[228:231],a[56:59]
ds_read_b128 v[148:151],v8 offset:5120
v_add_u32 v21,81920,v29
v_mfma_f32_16x16x32_bf16 a[60:63],v[220:223],v[228:231],a[60:63]
v_mfma_f32_16x16x32_bf16 a[64:67],v[192:195],v[232:235],a[64:67]
ds_read_b128 v[152:155],v8 offset:6144
v_add_u32 v22,81920,v30
v_mfma_f32_16x16x32_bf16 a[68:71],v[196:199],v[232:235],a[68:71]
s_add_u32 m0,s80,4096
s_add_u32 s81,s76,s69
buffer_load_dwordx4 v4,s[56:59],s81 offen lds
v_mfma_f32_16x16x32_bf16 a[72:75],v[200:203],v[232:235],a[72:75]
ds_read_b128 v[156:159],v8 offset:7168
v_add_u32 v23,81920,v31
v_mfma_f32_16x16x32_bf16 a[76:79],v[204:207],v[232:235],a[76:79]
v_mfma_f32_16x16x32_bf16 a[80:83],v[208:211],v[232:235],a[80:83]
ds_read_b64_tr_b16 v[160:161],v16 offset:0
v_mfma_f32_16x16x32_bf16 a[84:87],v[212:215],v[232:235],a[84:87]
v_mfma_f32_16x16x32_bf16 a[88:91],v[216:219],v[232:235],a[88:91]
ds_read_b64_tr_b16 v[162:163],v16 offset:1024
v_mfma_f32_16x16x32_bf16 a[92:95],v[220:223],v[232:235],a[92:95]
v_mfma_f32_16x16x32_bf16 a[96:99],v[192:195],v[236:239],a[96:99]
s_add_u32 m0,s80,5120
s_add_u32 s81,s81,s68
buffer_load_dwordx4 v4,s[56:59],s81 offen lds
s_add_u32 s76,s76,s70
v_mfma_f32_16x16x32_bf16 a[100:103],v[196:199],v[236:239],a[100:103]
v_mfma_f32_16x16x32_bf16 a[104:107],v[200:203],v[236:239],a[104:107]
ds_read_b64_tr_b16 v[164:165],v17 offset:0
v_mfma_f32_16x16x32_bf16 a[108:111],v[204:207],v[236:239],a[108:111]
v_mfma_f32_16x16x32_bf16 a[112:115],v[208:211],v[236:239],a[112:115]
ds_read_b64_tr_b16 v[166:167],v17 offset:1024
v_mfma_f32_16x16x32_bf16 a[116:119],v[212:215],v[236:239],a[116:119]
v_mfma_f32_16x16x32_bf16 a[120:123],v[216:219],v[236:239],a[120:123]
ds_read_b64_tr_b16 v[168:169],v18 offset:0
v_mfma_f32_16x16x32_bf16 a[124:127],v[220:223],v[236:239],a[124:127]
s_add_u32 m0,s79,0
s_add_u32 s81,s75,5120
buffer_load_dwordx4 v3,s[8:11],s81 offen sc1 lds
v_mfma_f32_16x16x32_bf16 a[128:131],v[192:195],v[240:243],a[128:131]
ds_read_b64_tr_b16 v[170:171],v18 offset:1024
v_mfma_f32_16x16x32_bf16 a[132:135],v[196:199],v[240:243],a[132:135]
v_mfma_f32_16x16x32_bf16 a[136:139],v[200:203],v[240:243],a[136:139]
ds_read_b64_tr_b16 v[172:173],v19 offset:0
v_mfma_f32_16x16x32_bf16 a[140:143],v[204:207],v[240:243],a[140:143]
v_mfma_f32_16x16x32_bf16 a[144:147],v[208:211],v[240:243],a[144:147]
ds_read_b64_tr_b16 v[174:175],v19 offset:1024
v_mfma_f32_16x16x32_bf16 a[148:151],v[212:215],v[240:243],a[148:151]
v_mfma_f32_16x16x32_bf16 a[152:155],v[216:219],v[240:243],a[152:155]
s_add_u32 m0,s79,1024
s_add_u32 s81,s75,23552
buffer_load_dwordx4 v3,s[8:11],s81 offen sc1 lds
v_mfma_f32_16x16x32_bf16 a[156:159],v[220:223],v[240:243],a[156:159]
v_mfma_f32_16x16x32_bf16 a[160:163],v[192:195],v[244:247],a[160:163]
ds_read_b64_tr_b16 v[176:177],v20 offset:0
v_mfma_f32_16x16x32_bf16 a[164:167],v[196:199],v[244:247],a[164:167]
v_mfma_f32_16x16x32_bf16 a[168:171],v[200:203],v[244:247],a[168:171]
ds_read_b64_tr_b16 v[178:179],v20 offset:1024
v_mfma_f32_16x16x32_bf16 a[172:175],v[204:207],v[244:247],a[172:175]
v_mfma_f32_16x16x32_bf16 a[176:179],v[208:211],v[244:247],a[176:179]
ds_read_b64_tr_b16 v[180:181],v21 offset:0
v_mfma_f32_16x16x32_bf16 a[180:183],v[212:215],v[244:247],a[180:183]
s_add_u32 m0,s79,2048
s_add_u32 s81,s75,41984
buffer_load_dwordx4 v3,s[8:11],s81 offen sc1 lds
v_mfma_f32_16x16x32_bf16 a[184:187],v[216:219],v[244:247],a[184:187]
ds_read_b64_tr_b16 v[182:183],v21 offset:1024
v_mfma_f32_16x16x32_bf16 a[188:191],v[220:223],v[244:247],a[188:191]
v_mfma_f32_16x16x32_bf16 a[192:195],v[192:195],v[248:251],a[192:195]
ds_read_b64_tr_b16 v[184:185],v22 offset:0
v_mfma_f32_16x16x32_bf16 a[196:199],v[196:199],v[248:251],a[196:199]
v_mfma_f32_16x16x32_bf16 a[200:203],v[200:203],v[248:251],a[200:203]
ds_read_b64_tr_b16 v[186:187],v22 offset:1024
v_mfma_f32_16x16x32_bf16 a[204:207],v[204:207],v[248:251],a[204:207]
v_mfma_f32_16x16x32_bf16 a[208:211],v[208:211],v[248:251],a[208:211]
s_add_u32 m0,s79,3072
s_add_u32 s81,s75,60416
buffer_load_dwordx4 v3,s[8:11],s81 offen sc1 lds
v_mfma_f32_16x16x32_bf16 a[212:215],v[212:215],v[248:251],a[212:215]
v_mfma_f32_16x16x32_bf16 a[216:219],v[216:219],v[248:251],a[216:219]
ds_read_b64_tr_b16 v[188:189],v23 offset:0
v_mfma_f32_16x16x32_bf16 a[220:223],v[220:223],v[248:251],a[220:223]
v_mfma_f32_16x16x32_bf16 a[224:227],v[192:195],v[252:255],a[224:227]
ds_read_b64_tr_b16 v[190:191],v23 offset:1024
v_mfma_f32_16x16x32_bf16 a[228:231],v[196:199],v[252:255],a[228:231]
v_mfma_f32_16x16x32_bf16 a[232:235],v[200:203],v[252:255],a[232:235]
v_mfma_f32_16x16x32_bf16 a[236:239],v[204:207],v[252:255],a[236:239]
v_mfma_f32_16x16x32_bf16 a[240:243],v[208:211],v[252:255],a[240:243]
v_mfma_f32_16x16x32_bf16 a[244:247],v[212:215],v[252:255],a[244:247]
v_mfma_f32_16x16x32_bf16 a[248:251],v[216:219],v[252:255],a[248:251]
v_mfma_f32_16x16x32_bf16 a[252:255],v[220:223],v[252:255],a[252:255]
s_waitcnt vmcnt(32) lgkmcnt(0)
s_barrier
v_mfma_f32_16x16x32_bf16 a[0:3],v[128:131],v[160:163],a[0:3]
v_add_u32 v8,98304,v5
v_mfma_f32_16x16x32_bf16 a[4:7],v[132:135],v[160:163],a[4:7]
v_mfma_f32_16x16x32_bf16 a[8:11],v[136:139],v[160:163],a[8:11]
ds_read_b128 v[192:195],v8 offset:0
v_add_u32 v16,114688,v24
v_mfma_f32_16x16x32_bf16 a[12:15],v[140:143],v[160:163],a[12:15]
s_add_u32 m0,s80,32768
s_mov_b32 s81,s76
buffer_load_dwordx4 v4,s[56:59],s81 offen lds
v_mfma_f32_16x16x32_bf16 a[16:19],v[144:147],v[160:163],a[16:19]
ds_read_b128 v[196:199],v8 offset:1024
v_add_u32 v17,114688,v25
v_mfma_f32_16x16x32_bf16 a[20:23],v[148:151],v[160:163],a[20:23]
v_mfma_f32_16x16x32_bf16 a[24:27],v[152:155],v[160:163],a[24:27]
ds_read_b128 v[200:203],v8 offset:2048
v_add_u32 v18,114688,v26
v_mfma_f32_16x16x32_bf16 a[28:31],v[156:159],v[160:163],a[28:31]
v_mfma_f32_16x16x32_bf16 a[32:35],v[128:131],v[164:167],a[32:35]
ds_read_b128 v[204:207],v8 offset:3072
v_add_u32 v19,114688,v27
v_mfma_f32_16x16x32_bf16 a[36:39],v[132:135],v[164:167],a[36:39]
v_mfma_f32_16x16x32_bf16 a[40:43],v[136:139],v[164:167],a[40:43]
s_add_u32 m0,s80,33792
s_add_u32 s81,s76,s68
buffer_load_dwordx4 v4,s[56:59],s81 offen lds
v_mfma_f32_16x16x32_bf16 a[44:47],v[140:143],v[164:167],a[44:47]
v_mfma_f32_16x16x32_bf16 a[48:51],v[144:147],v[164:167],a[48:51]
ds_read_b128 v[208:211],v8 offset:4096
v_add_u32 v20,114688,v28
v_mfma_f32_16x16x32_bf16 a[52:55],v[148:151],v[164:167],a[52:55]
v_mfma_f32_16x16x32_bf16 a[56:59],v[152:155],v[164:167],a[56:59]
ds_read_b128 v[212:215],v8 offset:5120
v_add_u32 v21,114688,v29
v_mfma_f32_16x16x32_bf16 a[60:63],v[156:159],v[164:167],a[60:63]
v_mfma_f32_16x16x32_bf16 a[64:67],v[128:131],v[168:171],a[64:67]
ds_read_b128 v[216:219],v8 offset:6144
v_add_u32 v22,114688,v30
v_mfma_f32_16x16x32_bf16 a[68:71],v[132:135],v[168:171],a[68:71]
s_add_u32 m0,s80,36864
s_add_u32 s81,s76,s69
buffer_load_dwordx4 v4,s[56:59],s81 offen lds
v_mfma_f32_16x16x32_bf16 a[72:75],v[136:139],v[168:171],a[72:75]
ds_read_b128 v[220:223],v8 offset:7168
v_add_u32 v23,114688,v31
v_mfma_f32_16x16x32_bf16 a[76:79],v[140:143],v[168:171],a[76:79]
v_mfma_f32_16x16x32_bf16 a[80:83],v[144:147],v[168:171],a[80:83]
ds_read_b64_tr_b16 v[224:225],v16 offset:0
v_mfma_f32_16x16x32_bf16 a[84:87],v[148:151],v[168:171],a[84:87]
v_mfma_f32_16x16x32_bf16 a[88:91],v[152:155],v[168:171],a[88:91]
ds_read_b64_tr_b16 v[226:227],v16 offset:1024
v_mfma_f32_16x16x32_bf16 a[92:95],v[156:159],v[168:171],a[92:95]
v_mfma_f32_16x16x32_bf16 a[96:99],v[128:131],v[172:175],a[96:99]
s_add_u32 m0,s80,37888
s_add_u32 s81,s81,s68
buffer_load_dwordx4 v4,s[56:59],s81 offen lds
s_add_u32 s76,s76,s70
v_mfma_f32_16x16x32_bf16 a[100:103],v[132:135],v[172:175],a[100:103]
v_mfma_f32_16x16x32_bf16 a[104:107],v[136:139],v[172:175],a[104:107]
ds_read_b64_tr_b16 v[228:229],v17 offset:0
v_mfma_f32_16x16x32_bf16 a[108:111],v[140:143],v[172:175],a[108:111]
v_mfma_f32_16x16x32_bf16 a[112:115],v[144:147],v[172:175],a[112:115]
ds_read_b64_tr_b16 v[230:231],v17 offset:1024
v_mfma_f32_16x16x32_bf16 a[116:119],v[148:151],v[172:175],a[116:119]
v_mfma_f32_16x16x32_bf16 a[120:123],v[152:155],v[172:175],a[120:123]
ds_read_b64_tr_b16 v[232:233],v18 offset:0
v_mfma_f32_16x16x32_bf16 a[124:127],v[156:159],v[172:175],a[124:127]
s_add_u32 m0,s79,32768
s_add_u32 s81,s75,6144
buffer_load_dwordx4 v3,s[8:11],s81 offen sc1 lds
v_mfma_f32_16x16x32_bf16 a[128:131],v[128:131],v[176:179],a[128:131]
ds_read_b64_tr_b16 v[234:235],v18 offset:1024
v_mfma_f32_16x16x32_bf16 a[132:135],v[132:135],v[176:179],a[132:135]
v_mfma_f32_16x16x32_bf16 a[136:139],v[136:139],v[176:179],a[136:139]
ds_read_b64_tr_b16 v[236:237],v19 offset:0
v_mfma_f32_16x16x32_bf16 a[140:143],v[140:143],v[176:179],a[140:143]
v_mfma_f32_16x16x32_bf16 a[144:147],v[144:147],v[176:179],a[144:147]
ds_read_b64_tr_b16 v[238:239],v19 offset:1024
v_mfma_f32_16x16x32_bf16 a[148:151],v[148:151],v[176:179],a[148:151]
v_mfma_f32_16x16x32_bf16 a[152:155],v[152:155],v[176:179],a[152:155]
s_add_u32 m0,s79,33792
s_add_u32 s81,s75,24576
buffer_load_dwordx4 v3,s[8:11],s81 offen sc1 lds
v_mfma_f32_16x16x32_bf16 a[156:159],v[156:159],v[176:179],a[156:159]
v_mfma_f32_16x16x32_bf16 a[160:163],v[128:131],v[180:183],a[160:163]
ds_read_b64_tr_b16 v[240:241],v20 offset:0
v_mfma_f32_16x16x32_bf16 a[164:167],v[132:135],v[180:183],a[164:167]
v_mfma_f32_16x16x32_bf16 a[168:171],v[136:139],v[180:183],a[168:171]
ds_read_b64_tr_b16 v[242:243],v20 offset:1024
v_mfma_f32_16x16x32_bf16 a[172:175],v[140:143],v[180:183],a[172:175]
v_mfma_f32_16x16x32_bf16 a[176:179],v[144:147],v[180:183],a[176:179]
ds_read_b64_tr_b16 v[244:245],v21 offset:0
v_mfma_f32_16x16x32_bf16 a[180:183],v[148:151],v[180:183],a[180:183]
s_add_u32 m0,s79,34816
s_add_u32 s81,s75,43008
buffer_load_dwordx4 v3,s[8:11],s81 offen sc1 lds
v_mfma_f32_16x16x32_bf16 a[184:187],v[152:155],v[180:183],a[184:187]
ds_read_b64_tr_b16 v[246:247],v21 offset:1024
v_mfma_f32_16x16x32_bf16 a[188:191],v[156:159],v[180:183],a[188:191]
v_mfma_f32_16x16x32_bf16 a[192:195],v[128:131],v[184:187],a[192:195]
ds_read_b64_tr_b16 v[248:249],v22 offset:0
v_mfma_f32_16x16x32_bf16 a[196:199],v[132:135],v[184:187],a[196:199]
v_mfma_f32_16x16x32_bf16 a[200:203],v[136:139],v[184:187],a[200:203]
ds_read_b64_tr_b16 v[250:251],v22 offset:1024
v_mfma_f32_16x16x32_bf16 a[204:207],v[140:143],v[184:187],a[204:207]
v_mfma_f32_16x16x32_bf16 a[208:211],v[144:147],v[184:187],a[208:211]
s_add_u32 m0,s79,35840
s_add_u32 s81,s75,61440
buffer_load_dwordx4 v3,s[8:11],s81 offen sc1 lds
v_mfma_f32_16x16x32_bf16 a[212:215],v[148:151],v[184:187],a[212:215]
v_mfma_f32_16x16x32_bf16 a[216:219],v[152:155],v[184:187],a[216:219]
ds_read_b64_tr_b16 v[252:253],v23 offset:0
v_mfma_f32_16x16x32_bf16 a[220:223],v[156:159],v[184:187],a[220:223]
v_mfma_f32_16x16x32_bf16 a[224:227],v[128:131],v[188:191],a[224:227]
ds_read_b64_tr_b16 v[254:255],v23 offset:1024
v_mfma_f32_16x16x32_bf16 a[228:231],v[132:135],v[188:191],a[228:231]
v_mfma_f32_16x16x32_bf16 a[232:235],v[136:139],v[188:191],a[232:235]
v_mfma_f32_16x16x32_bf16 a[236:239],v[140:143],v[188:191],a[236:239]
v_mfma_f32_16x16x32_bf16 a[240:243],v[144:147],v[188:191],a[240:243]
v_mfma_f32_16x16x32_bf16 a[244:247],v[148:151],v[188:191],a[244:247]
v_mfma_f32_16x16x32_bf16 a[248:251],v[152:155],v[188:191],a[248:251]
v_mfma_f32_16x16x32_bf16 a[252:255],v[156:159],v[188:191],a[252:255]
s_waitcnt vmcnt(16) lgkmcnt(0)
s_barrier
v_mfma_f32_16x16x32_bf16 a[0:3],v[192:195],v[224:227],a[0:3]
v_add_u32 v8,131072,v5
v_mfma_f32_16x16x32_bf16 a[4:7],v[196:199],v[224:227],a[4:7]
v_mfma_f32_16x16x32_bf16 a[8:11],v[200:203],v[224:227],a[8:11]
ds_read_b128 v[128:131],v8 offset:0
v_add_u32 v16,147456,v24
v_mfma_f32_16x16x32_bf16 a[12:15],v[204:207],v[224:227],a[12:15]
s_add_u32 m0,s80,65536
s_mov_b32 s81,s76
buffer_load_dwordx4 v4,s[56:59],s81 offen lds
v_mfma_f32_16x16x32_bf16 a[16:19],v[208:211],v[224:227],a[16:19]
ds_read_b128 v[132:135],v8 offset:1024
v_add_u32 v17,147456,v25
v_mfma_f32_16x16x32_bf16 a[20:23],v[212:215],v[224:227],a[20:23]
v_mfma_f32_16x16x32_bf16 a[24:27],v[216:219],v[224:227],a[24:27]
ds_read_b128 v[136:139],v8 offset:2048
v_add_u32 v18,147456,v26
v_mfma_f32_16x16x32_bf16 a[28:31],v[220:223],v[224:227],a[28:31]
v_mfma_f32_16x16x32_bf16 a[32:35],v[192:195],v[228:231],a[32:35]
ds_read_b128 v[140:143],v8 offset:3072
v_add_u32 v19,147456,v27
v_mfma_f32_16x16x32_bf16 a[36:39],v[196:199],v[228:231],a[36:39]
v_mfma_f32_16x16x32_bf16 a[40:43],v[200:203],v[228:231],a[40:43]
s_add_u32 m0,s80,66560
s_add_u32 s81,s76,s68
buffer_load_dwordx4 v4,s[56:59],s81 offen lds
v_mfma_f32_16x16x32_bf16 a[44:47],v[204:207],v[228:231],a[44:47]
v_mfma_f32_16x16x32_bf16 a[48:51],v[208:211],v[228:231],a[48:51]
ds_read_b128 v[144:147],v8 offset:4096
v_add_u32 v20,147456,v28
v_mfma_f32_16x16x32_bf16 a[52:55],v[212:215],v[228:231],a[52:55]
v_mfma_f32_16x16x32_bf16 a[56:59],v[216:219],v[228:231],a[56:59]
ds_read_b128 v[148:151],v8 offset:5120
v_add_u32 v21,147456,v29
v_mfma_f32_16x16x32_bf16 a[60:63],v[220:223],v[228:231],a[60:63]
v_mfma_f32_16x16x32_bf16 a[64:67],v[192:195],v[232:235],a[64:67]
ds_read_b128 v[152:155],v8 offset:6144
v_add_u32 v22,147456,v30
v_mfma_f32_16x16x32_bf16 a[68:71],v[196:199],v[232:235],a[68:71]
s_add_u32 m0,s80,69632
s_add_u32 s81,s76,s69
buffer_load_dwordx4 v4,s[56:59],s81 offen lds
v_mfma_f32_16x16x32_bf16 a[72:75],v[200:203],v[232:235],a[72:75]
ds_read_b128 v[156:159],v8 offset:7168
v_add_u32 v23,147456,v31
v_mfma_f32_16x16x32_bf16 a[76:79],v[204:207],v[232:235],a[76:79]
v_mfma_f32_16x16x32_bf16 a[80:83],v[208:211],v[232:235],a[80:83]
ds_read_b64_tr_b16 v[160:161],v16 offset:0
v_mfma_f32_16x16x32_bf16 a[84:87],v[212:215],v[232:235],a[84:87]
v_mfma_f32_16x16x32_bf16 a[88:91],v[216:219],v[232:235],a[88:91]
ds_read_b64_tr_b16 v[162:163],v16 offset:1024
v_mfma_f32_16x16x32_bf16 a[92:95],v[220:223],v[232:235],a[92:95]
v_mfma_f32_16x16x32_bf16 a[96:99],v[192:195],v[236:239],a[96:99]
s_add_u32 m0,s80,70656
s_add_u32 s81,s81,s68
buffer_load_dwordx4 v4,s[56:59],s81 offen lds
s_add_u32 s76,s76,s70
v_mfma_f32_16x16x32_bf16 a[100:103],v[196:199],v[236:239],a[100:103]
v_mfma_f32_16x16x32_bf16 a[104:107],v[200:203],v[236:239],a[104:107]
ds_read_b64_tr_b16 v[164:165],v17 offset:0
v_mfma_f32_16x16x32_bf16 a[108:111],v[204:207],v[236:239],a[108:111]
v_mfma_f32_16x16x32_bf16 a[112:115],v[208:211],v[236:239],a[112:115]
ds_read_b64_tr_b16 v[166:167],v17 offset:1024
v_mfma_f32_16x16x32_bf16 a[116:119],v[212:215],v[236:239],a[116:119]
v_mfma_f32_16x16x32_bf16 a[120:123],v[216:219],v[236:239],a[120:123]
ds_read_b64_tr_b16 v[168:169],v18 offset:0
v_mfma_f32_16x16x32_bf16 a[124:127],v[220:223],v[236:239],a[124:127]
s_add_u32 m0,s79,65536
s_add_u32 s81,s75,7168
buffer_load_dwordx4 v3,s[8:11],s81 offen sc1 lds
v_mfma_f32_16x16x32_bf16 a[128:131],v[192:195],v[240:243],a[128:131]
ds_read_b64_tr_b16 v[170:171],v18 offset:1024
v_mfma_f32_16x16x32_bf16 a[132:135],v[196:199],v[240:243],a[132:135]
v_mfma_f32_16x16x32_bf16 a[136:139],v[200:203],v[240:243],a[136:139]
ds_read_b64_tr_b16 v[172:173],v19 offset:0
v_mfma_f32_16x16x32_bf16 a[140:143],v[204:207],v[240:243],a[140:143]
v_mfma_f32_16x16x32_bf16 a[144:147],v[208:211],v[240:243],a[144:147]
ds_read_b64_tr_b16 v[174:175],v19 offset:1024
v_mfma_f32_16x16x32_bf16 a[148:151],v[212:215],v[240:243],a[148:151]
v_mfma_f32_16x16x32_bf16 a[152:155],v[216:219],v[240:243],a[152:155]
s_add_u32 m0,s79,66560
s_add_u32 s81,s75,25600
buffer_load_dwordx4 v3,s[8:11],s81 offen sc1 lds
v_mfma_f32_16x16x32_bf16 a[156:159],v[220:223],v[240:243],a[156:159]
v_mfma_f32_16x16x32_bf16 a[160:163],v[192:195],v[244:247],a[160:163]
ds_read_b64_tr_b16 v[176:177],v20 offset:0
v_mfma_f32_16x16x32_bf16 a[164:167],v[196:199],v[244:247],a[164:167]
v_mfma_f32_16x16x32_bf16 a[168:171],v[200:203],v[244:247],a[168:171]
ds_read_b64_tr_b16 v[178:179],v20 offset:1024
v_mfma_f32_16x16x32_bf16 a[172:175],v[204:207],v[244:247],a[172:175]
v_mfma_f32_16x16x32_bf16 a[176:179],v[208:211],v[244:247],a[176:179]
ds_read_b64_tr_b16 v[180:181],v21 offset:0
v_mfma_f32_16x16x32_bf16 a[180:183],v[212:215],v[244:247],a[180:183]
s_add_u32 m0,s79,67584
s_add_u32 s81,s75,44032
buffer_load_dwordx4 v3,s[8:11],s81 offen sc1 lds
v_mfma_f32_16x16x32_bf16 a[184:187],v[216:219],v[244:247],a[184:187]
ds_read_b64_tr_b16 v[182:183],v21 offset:1024
v_mfma_f32_16x16x32_bf16 a[188:191],v[220:223],v[244:247],a[188:191]
v_mfma_f32_16x16x32_bf16 a[192:195],v[192:195],v[248:251],a[192:195]
ds_read_b64_tr_b16 v[184:185],v22 offset:0
v_mfma_f32_16x16x32_bf16 a[196:199],v[196:199],v[248:251],a[196:199]
v_mfma_f32_16x16x32_bf16 a[200:203],v[200:203],v[248:251],a[200:203]
ds_read_b64_tr_b16 v[186:187],v22 offset:1024
v_mfma_f32_16x16x32_bf16 a[204:207],v[204:207],v[248:251],a[204:207]
v_mfma_f32_16x16x32_bf16 a[208:211],v[208:211],v[248:251],a[208:211]
s_add_u32 m0,s79,68608
s_add_u32 s81,s75,62464
buffer_load_dwordx4 v3,s[8:11],s81 offen sc1 lds
v_mfma_f32_16x16x32_bf16 a[212:215],v[212:215],v[248:251],a[212:215]
v_mfma_f32_16x16x32_bf16 a[216:219],v[216:219],v[248:251],a[216:219]
ds_read_b64_tr_b16 v[188:189],v23 offset:0
v_mfma_f32_16x16x32_bf16 a[220:223],v[220:223],v[248:251],a[220:223]
v_mfma_f32_16x16x32_bf16 a[224:227],v[192:195],v[252:255],a[224:227]
ds_read_b64_tr_b16 v[190:191],v23 offset:1024
v_mfma_f32_16x16x32_bf16 a[228:231],v[196:199],v[252:255],a[228:231]
v_mfma_f32_16x16x32_bf16 a[232:235],v[200:203],v[252:255],a[232:235]
v_mfma_f32_16x16x32_bf16 a[236:239],v[204:207],v[252:255],a[236:239]
v_mfma_f32_16x16x32_bf16 a[240:243],v[208:211],v[252:255],a[240:243]
v_mfma_f32_16x16x32_bf16 a[244:247],v[212:215],v[252:255],a[244:247]
v_mfma_f32_16x16x32_bf16 a[248:251],v[216:219],v[252:255],a[248:251]
v_mfma_f32_16x16x32_bf16 a[252:255],v[220:223],v[252:255],a[252:255]
s_waitcnt vmcnt(16) lgkmcnt(0)
s_barrier
v_mfma_f32_16x16x32_bf16 a[0:3],v[128:131],v[160:163],a[0:3]
v_add_u32 v8,0,v5
v_mfma_f32_16x16x32_bf16 a[4:7],v[132:135],v[160:163],a[4:7]
v_mfma_f32_16x16x32_bf16 a[8:11],v[136:139],v[160:163],a[8:11]
ds_read_b128 v[192:195],v8 offset:0
v_add_u32 v16,16384,v24
v_mfma_f32_16x16x32_bf16 a[12:15],v[140:143],v[160:163],a[12:15]
s_add_u32 m0,s80,98304
s_mov_b32 s81,s76
buffer_load_dwordx4 v4,s[56:59],s81 offen lds
v_mfma_f32_16x16x32_bf16 a[16:19],v[144:147],v[160:163],a[16:19]
ds_read_b128 v[196:199],v8 offset:1024
v_add_u32 v17,16384,v25
v_mfma_f32_16x16x32_bf16 a[20:23],v[148:151],v[160:163],a[20:23]
v_mfma_f32_16x16x32_bf16 a[24:27],v[152:155],v[160:163],a[24:27]
ds_read_b128 v[200:203],v8 offset:2048
v_add_u32 v18,16384,v26
v_mfma_f32_16x16x32_bf16 a[28:31],v[156:159],v[160:163],a[28:31]
v_mfma_f32_16x16x32_bf16 a[32:35],v[128:131],v[164:167],a[32:35]
ds_read_b128 v[204:207],v8 offset:3072
v_add_u32 v19,16384,v27
v_mfma_f32_16x16x32_bf16 a[36:39],v[132:135],v[164:167],a[36:39]
v_mfma_f32_16x16x32_bf16 a[40:43],v[136:139],v[164:167],a[40:43]
s_add_u32 m0,s80,99328
s_add_u32 s81,s76,s68
buffer_load_dwordx4 v4,s[56:59],s81 offen lds
v_mfma_f32_16x16x32_bf16 a[44:47],v[140:143],v[164:167],a[44:47]
v_mfma_f32_16x16x32_bf16 a[48:51],v[144:147],v[164:167],a[48:51]
ds_read_b128 v[208:211],v8 offset:4096
v_add_u32 v20,16384,v28
v_mfma_f32_16x16x32_bf16 a[52:55],v[148:151],v[164:167],a[52:55]
v_mfma_f32_16x16x32_bf16 a[56:59],v[152:155],v[164:167],a[56:59]
ds_read_b128 v[212:215],v8 offset:5120
v_add_u32 v21,16384,v29
v_mfma_f32_16x16x32_bf16 a[60:63],v[156:159],v[164:167],a[60:63]
v_mfma_f32_16x16x32_bf16 a[64:67],v[128:131],v[168:171],a[64:67]
ds_read_b128 v[216:219],v8 offset:6144
v_add_u32 v22,16384,v30
v_mfma_f32_16x16x32_bf16 a[68:71],v[132:135],v[168:171],a[68:71]
s_add_u32 m0,s80,102400
s_add_u32 s81,s76,s69
buffer_load_dwordx4 v4,s[56:59],s81 offen lds
v_mfma_f32_16x16x32_bf16 a[72:75],v[136:139],v[168:171],a[72:75]
ds_read_b128 v[220:223],v8 offset:7168
v_add_u32 v23,16384,v31
v_mfma_f32_16x16x32_bf16 a[76:79],v[140:143],v[168:171],a[76:79]
v_mfma_f32_16x16x32_bf16 a[80:83],v[144:147],v[168:171],a[80:83]
ds_read_b64_tr_b16 v[224:225],v16 offset:0
v_mfma_f32_16x16x32_bf16 a[84:87],v[148:151],v[168:171],a[84:87]
v_mfma_f32_16x16x32_bf16 a[88:91],v[152:155],v[168:171],a[88:91]
ds_read_b64_tr_b16 v[226:227],v16 offset:1024
v_mfma_f32_16x16x32_bf16 a[92:95],v[156:159],v[168:171],a[92:95]
v_mfma_f32_16x16x32_bf16 a[96:99],v[128:131],v[172:175],a[96:99]
s_add_u32 m0,s80,103424
s_add_u32 s81,s81,s68
buffer_load_dwordx4 v4,s[56:59],s81 offen lds
s_add_u32 s76,s76,s70
v_mfma_f32_16x16x32_bf16 a[100:103],v[132:135],v[172:175],a[100:103]
v_mfma_f32_16x16x32_bf16 a[104:107],v[136:139],v[172:175],a[104:107]
ds_read_b64_tr_b16 v[228:229],v17 offset:0
v_mfma_f32_16x16x32_bf16 a[108:111],v[140:143],v[172:175],a[108:111]
v_mfma_f32_16x16x32_bf16 a[112:115],v[144:147],v[172:175],a[112:115]
ds_read_b64_tr_b16 v[230:231],v17 offset:1024
v_mfma_f32_16x16x32_bf16 a[116:119],v[148:151],v[172:175],a[116:119]
v_mfma_f32_16x16x32_bf16 a[120:123],v[152:155],v[172:175],a[120:123]
ds_read_b64_tr_b16 v[232:233],v18 offset:0
v_mfma_f32_16x16x32_bf16 a[124:127],v[156:159],v[172:175],a[124:127]
s_add_u32 m0,s79,98304
s_add_u32 s81,s75,8192
buffer_load_dwordx4 v3,s[8:11],s81 offen sc1 lds
v_mfma_f32_16x16x32_bf16 a[128:131],v[128:131],v[176:179],a[128:131]
ds_read_b64_tr_b16 v[234:235],v18 offset:1024
v_mfma_f32_16x16x32_bf16 a[132:135],v[132:135],v[176:179],a[132:135]
v_mfma_f32_16x16x32_bf16 a[136:139],v[136:139],v[176:179],a[136:139]
ds_read_b64_tr_b16 v[236:237],v19 offset:0
v_mfma_f32_16x16x32_bf16 a[140:143],v[140:143],v[176:179],a[140:143]
v_mfma_f32_16x16x32_bf16 a[144:147],v[144:147],v[176:179],a[144:147]
ds_read_b64_tr_b16 v[238:239],v19 offset:1024
v_mfma_f32_16x16x32_bf16 a[148:151],v[148:151],v[176:179],a[148:151]
v_mfma_f32_16x16x32_bf16 a[152:155],v[152:155],v[176:179],a[152:155]
s_add_u32 m0,s79,99328
s_add_u32 s81,s75,26624
buffer_load_dwordx4 v3,s[8:11],s81 offen sc1 lds
v_mfma_f32_16x16x32_bf16 a[156:159],v[156:159],v[176:179],a[156:159]
v_mfma_f32_16x16x32_bf16 a[160:163],v[128:131],v[180:183],a[160:163]
ds_read_b64_tr_b16 v[240:241],v20 offset:0
v_mfma_f32_16x16x32_bf16 a[164:167],v[132:135],v[180:183],a[164:167]
v_mfma_f32_16x16x32_bf16 a[168:171],v[136:139],v[180:183],a[168:171]
ds_read_b64_tr_b16 v[242:243],v20 offset:1024
v_mfma_f32_16x16x32_bf16 a[172:175],v[140:143],v[180:183],a[172:175]
v_mfma_f32_16x16x32_bf16 a[176:179],v[144:147],v[180:183],a[176:179]
ds_read_b64_tr_b16 v[244:245],v21 offset:0
v_mfma_f32_16x16x32_bf16 a[180:183],v[148:151],v[180:183],a[180:183]
s_add_u32 m0,s79,100352
s_add_u32 s81,s75,45056
buffer_load_dwordx4 v3,s[8:11],s81 offen sc1 lds
v_mfma_f32_16x16x32_bf16 a[184:187],v[152:155],v[180:183],a[184:187]
ds_read_b64_tr_b16 v[246:247],v21 offset:1024
v_mfma_f32_16x16x32_bf16 a[188:191],v[156:159],v[180:183],a[188:191]
v_mfma_f32_16x16x32_bf16 a[192:195],v[128:131],v[184:187],a[192:195]
ds_read_b64_tr_b16 v[248:249],v22 offset:0
v_mfma_f32_16x16x32_bf16 a[196:199],v[132:135],v[184:187],a[196:199]
v_mfma_f32_16x16x32_bf16 a[200:203],v[136:139],v[184:187],a[200:203]
ds_read_b64_tr_b16 v[250:251],v22 offset:1024
v_mfma_f32_16x16x32_bf16 a[204:207],v[140:143],v[184:187],a[204:207]
v_mfma_f32_16x16x32_bf16 a[208:211],v[144:147],v[184:187],a[208:211]
s_add_u32 m0,s79,101376
s_add_u32 s81,s75,63488
buffer_load_dwordx4 v3,s[8:11],s81 offen sc1 lds
v_mfma_f32_16x16x32_bf16 a[212:215],v[148:151],v[184:187],a[212:215]
v_mfma_f32_16x16x32_bf16 a[216:219],v[152:155],v[184:187],a[216:219]
ds_read_b64_tr_b16 v[252:253],v23 offset:0
v_mfma_f32_16x16x32_bf16 a[220:223],v[156:159],v[184:187],a[220:223]
v_mfma_f32_16x16x32_bf16 a[224:227],v[128:131],v[188:191],a[224:227]
ds_read_b64_tr_b16 v[254:255],v23 offset:1024
v_mfma_f32_16x16x32_bf16 a[228:231],v[132:135],v[188:191],a[228:231]
v_mfma_f32_16x16x32_bf16 a[232:235],v[136:139],v[188:191],a[232:235]
v_mfma_f32_16x16x32_bf16 a[236:239],v[140:143],v[188:191],a[236:239]
s_mov_b64 exec,s[64:65]
buffer_atomic_add v1,v2,s[8:11],s87 offen
s_mov_b64 exec,-1
v_mfma_f32_16x16x32_bf16 a[240:243],v[144:147],v[188:191],a[240:243]
v_mfma_f32_16x16x32_bf16 a[244:247],v[148:151],v[188:191],a[244:247]
v_mfma_f32_16x16x32_bf16 a[248:251],v[152:155],v[188:191],a[248:251]
v_mfma_f32_16x16x32_bf16 a[252:255],v[156:159],v[188:191],a[252:255]
s_waitcnt vmcnt(16) lgkmcnt(0)
s_barrier
v_mfma_f32_16x16x32_bf16 a[0:3],v[192:195],v[224:227],a[0:3]
v_add_u32 v8,32768,v5
v_mfma_f32_16x16x32_bf16 a[4:7],v[196:199],v[224:227],a[4:7]
v_mfma_f32_16x16x32_bf16 a[8:11],v[200:203],v[224:227],a[8:11]
ds_read_b128 v[128:131],v8 offset:0
v_add_u32 v16,49152,v24
v_mfma_f32_16x16x32_bf16 a[12:15],v[204:207],v[224:227],a[12:15]
s_add_u32 m0,s80,131072
s_mov_b32 s81,s76
buffer_load_dwordx4 v4,s[56:59],s81 offen lds
v_mfma_f32_16x16x32_bf16 a[16:19],v[208:211],v[224:227],a[16:19]
ds_read_b128 v[132:135],v8 offset:1024
v_add_u32 v17,49152,v25
v_mfma_f32_16x16x32_bf16 a[20:23],v[212:215],v[224:227],a[20:23]
v_mfma_f32_16x16x32_bf16 a[24:27],v[216:219],v[224:227],a[24:27]
ds_read_b128 v[136:139],v8 offset:2048
v_add_u32 v18,49152,v26
v_mfma_f32_16x16x32_bf16 a[28:31],v[220:223],v[224:227],a[28:31]
v_mfma_f32_16x16x32_bf16 a[32:35],v[192:195],v[228:231],a[32:35]
ds_read_b128 v[140:143],v8 offset:3072
v_add_u32 v19,49152,v27
v_mfma_f32_16x16x32_bf16 a[36:39],v[196:199],v[228:231],a[36:39]
v_mfma_f32_16x16x32_bf16 a[40:43],v[200:203],v[228:231],a[40:43]
s_add_u32 m0,s80,132096
s_add_u32 s81,s76,s68
buffer_load_dwordx4 v4,s[56:59],s81 offen lds
v_mfma_f32_16x16x32_bf16 a[44:47],v[204:207],v[228:231],a[44:47]
v_mfma_f32_16x16x32_bf16 a[48:51],v[208:211],v[228:231],a[48:51]
ds_read_b128 v[144:147],v8 offset:4096
v_add_u32 v20,49152,v28
v_mfma_f32_16x16x32_bf16 a[52:55],v[212:215],v[228:231],a[52:55]
v_mfma_f32_16x16x32_bf16 a[56:59],v[216:219],v[228:231],a[56:59]
ds_read_b128 v[148:151],v8 offset:5120
v_add_u32 v21,49152,v29
v_mfma_f32_16x16x32_bf16 a[60:63],v[220:223],v[228:231],a[60:63]
v_mfma_f32_16x16x32_bf16 a[64:67],v[192:195],v[232:235],a[64:67]
ds_read_b128 v[152:155],v8 offset:6144
v_add_u32 v22,49152,v30
v_mfma_f32_16x16x32_bf16 a[68:71],v[196:199],v[232:235],a[68:71]
s_add_u32 m0,s80,135168
s_add_u32 s81,s76,s69
buffer_load_dwordx4 v4,s[56:59],s81 offen lds
v_mfma_f32_16x16x32_bf16 a[72:75],v[200:203],v[232:235],a[72:75]
ds_read_b128 v[156:159],v8 offset:7168
v_add_u32 v23,49152,v31
v_mfma_f32_16x16x32_bf16 a[76:79],v[204:207],v[232:235],a[76:79]
v_mfma_f32_16x16x32_bf16 a[80:83],v[208:211],v[232:235],a[80:83]
ds_read_b64_tr_b16 v[160:161],v16 offset:0
v_mfma_f32_16x16x32_bf16 a[84:87],v[212:215],v[232:235],a[84:87]
v_mfma_f32_16x16x32_bf16 a[88:91],v[216:219],v[232:235],a[88:91]
ds_read_b64_tr_b16 v[162:163],v16 offset:1024
v_mfma_f32_16x16x32_bf16 a[92:95],v[220:223],v[232:235],a[92:95]
v_mfma_f32_16x16x32_bf16 a[96:99],v[192:195],v[236:239],a[96:99]
s_add_u32 m0,s80,136192
s_add_u32 s81,s81,s68
buffer_load_dwordx4 v4,s[56:59],s81 offen lds
s_add_u32 s76,s76,s70
v_mfma_f32_16x16x32_bf16 a[100:103],v[196:199],v[236:239],a[100:103]
v_mfma_f32_16x16x32_bf16 a[104:107],v[200:203],v[236:239],a[104:107]
ds_read_b64_tr_b16 v[164:165],v17 offset:0
v_mfma_f32_16x16x32_bf16 a[108:111],v[204:207],v[236:239],a[108:111]
v_mfma_f32_16x16x32_bf16 a[112:115],v[208:211],v[236:239],a[112:115]
ds_read_b64_tr_b16 v[166:167],v17 offset:1024
v_mfma_f32_16x16x32_bf16 a[116:119],v[212:215],v[236:239],a[116:119]
v_mfma_f32_16x16x32_bf16 a[120:123],v[216:219],v[236:239],a[120:123]
ds_read_b64_tr_b16 v[168:169],v18 offset:0
v_mfma_f32_16x16x32_bf16 a[124:127],v[220:223],v[236:239],a[124:127]
s_add_u32 m0,s79,131072
s_add_u32 s81,s75,9216
buffer_load_dwordx4 v3,s[8:11],s81 offen sc1 lds
v_mfma_f32_16x16x32_bf16 a[128:131],v[192:195],v[240:243],a[128:131]
ds_read_b64_tr_b16 v[170:171],v18 offset:1024
v_mfma_f32_16x16x32_bf16 a[132:135],v[196:199],v[240:243],a[132:135]
v_mfma_f32_16x16x32_bf16 a[136:139],v[200:203],v[240:243],a[136:139]
ds_read_b64_tr_b16 v[172:173],v19 offset:0
v_mfma_f32_16x16x32_bf16 a[140:143],v[204:207],v[240:243],a[140:143]
v_mfma_f32_16x16x32_bf16 a[144:147],v[208:211],v[240:243],a[144:147]
ds_read_b64_tr_b16 v[174:175],v19 offset:1024
v_mfma_f32_16x16x32_bf16 a[148:151],v[212:215],v[240:243],a[148:151]
v_mfma_f32_16x16x32_bf16 a[152:155],v[216:219],v[240:243],a[152:155]
s_add_u32 m0,s79,132096
s_add_u32 s81,s75,27648
buffer_load_dwordx4 v3,s[8:11],s81 offen sc1 lds
v_mfma_f32_16x16x32_bf16 a[156:159],v[220:223],v[240:243],a[156:159]
v_mfma_f32_16x16x32_bf16 a[160:163],v[192:195],v[244:247],a[160:163]
ds_read_b64_tr_b16 v[176:177],v20 offset:0
v_mfma_f32_16x16x32_bf16 a[164:167],v[196:199],v[244:247],a[164:167]
v_mfma_f32_16x16x32_bf16 a[168:171],v[200:203],v[244:247],a[168:171]
ds_read_b64_tr_b16 v[178:179],v20 offset:1024
v_mfma_f32_16x16x32_bf16 a[172:175],v[204:207],v[244:247],a[172:175]
v_mfma_f32_16x16x32_bf16 a[176:179],v[208:211],v[244:247],a[176:179]
ds_read_b64_tr_b16 v[180:181],v21 offset:0
v_mfma_f32_16x16x32_bf16 a[180:183],v[212:215],v[244:247],a[180:183]
s_add_u32 m0,s79,133120
s_add_u32 s81,s75,46080
buffer_load_dwordx4 v3,s[8:11],s81 offen sc1 lds
v_mfma_f32_16x16x32_bf16 a[184:187],v[216:219],v[244:247],a[184:187]
ds_read_b64_tr_b16 v[182:183],v21 offset:1024
v_mfma_f32_16x16x32_bf16 a[188:191],v[220:223],v[244:247],a[188:191]
v_mfma_f32_16x16x32_bf16 a[192:195],v[192:195],v[248:251],a[192:195]
ds_read_b64_tr_b16 v[184:185],v22 offset:0
v_mfma_f32_16x16x32_bf16 a[196:199],v[196:199],v[248:251],a[196:199]
v_mfma_f32_16x16x32_bf16 a[200:203],v[200:203],v[248:251],a[200:203]
ds_read_b64_tr_b16 v[186:187],v22 offset:1024
v_mfma_f32_16x16x32_bf16 a[204:207],v[204:207],v[248:251],a[204:207]
v_mfma_f32_16x16x32_bf16 a[208:211],v[208:211],v[248:251],a[208:211]
s_add_u32 m0,s79,134144
s_add_u32 s81,s75,64512
buffer_load_dwordx4 v3,s[8:11],s81 offen sc1 lds
v_mfma_f32_16x16x32_bf16 a[212:215],v[212:215],v[248:251],a[212:215]
v_mfma_f32_16x16x32_bf16 a[216:219],v[216:219],v[248:251],a[216:219]
ds_read_b64_tr_b16 v[188:189],v23 offset:0
v_mfma_f32_16x16x32_bf16 a[220:223],v[220:223],v[248:251],a[220:223]
v_mfma_f32_16x16x32_bf16 a[224:227],v[192:195],v[252:255],a[224:227]
ds_read_b64_tr_b16 v[190:191],v23 offset:1024
v_mfma_f32_16x16x32_bf16 a[228:231],v[196:199],v[252:255],a[228:231]
v_mfma_f32_16x16x32_bf16 a[232:235],v[200:203],v[252:255],a[232:235]
v_mfma_f32_16x16x32_bf16 a[236:239],v[204:207],v[252:255],a[236:239]
v_mfma_f32_16x16x32_bf16 a[240:243],v[208:211],v[252:255],a[240:243]
v_mfma_f32_16x16x32_bf16 a[244:247],v[212:215],v[252:255],a[244:247]
v_mfma_f32_16x16x32_bf16 a[248:251],v[216:219],v[252:255],a[248:251]
v_mfma_f32_16x16x32_bf16 a[252:255],v[220:223],v[252:255],a[252:255]
s_waitcnt vmcnt(16) lgkmcnt(0)
s_barrier
v_mfma_f32_16x16x32_bf16 a[0:3],v[128:131],v[160:163],a[0:3]
v_add_u32 v8,65536,v5
v_mfma_f32_16x16x32_bf16 a[4:7],v[132:135],v[160:163],a[4:7]
v_mfma_f32_16x16x32_bf16 a[8:11],v[136:139],v[160:163],a[8:11]
ds_read_b128 v[192:195],v8 offset:0
v_add_u32 v16,81920,v24
v_mfma_f32_16x16x32_bf16 a[12:15],v[140:143],v[160:163],a[12:15]
s_add_u32 m0,s80,0
s_mov_b32 s81,s76
buffer_load_dwordx4 v4,s[56:59],s81 offen lds
v_mfma_f32_16x16x32_bf16 a[16:19],v[144:147],v[160:163],a[16:19]
ds_read_b128 v[196:199],v8 offset:1024
v_add_u32 v17,81920,v25
v_mfma_f32_16x16x32_bf16 a[20:23],v[148:151],v[160:163],a[20:23]
v_mfma_f32_16x16x32_bf16 a[24:27],v[152:155],v[160:163],a[24:27]
ds_read_b128 v[200:203],v8 offset:2048
v_add_u32 v18,81920,v26
v_mfma_f32_16x16x32_bf16 a[28:31],v[156:159],v[160:163],a[28:31]
v_mfma_f32_16x16x32_bf16 a[32:35],v[128:131],v[164:167],a[32:35]
ds_read_b128 v[204:207],v8 offset:3072
v_add_u32 v19,81920,v27
v_mfma_f32_16x16x32_bf16 a[36:39],v[132:135],v[164:167],a[36:39]
v_mfma_f32_16x16x32_bf16 a[40:43],v[136:139],v[164:167],a[40:43]
s_add_u32 m0,s80,1024
s_add_u32 s81,s76,s68
buffer_load_dwordx4 v4,s[56:59],s81 offen lds
v_mfma_f32_16x16x32_bf16 a[44:47],v[140:143],v[164:167],a[44:47]
v_mfma_f32_16x16x32_bf16 a[48:51],v[144:147],v[164:167],a[48:51]
ds_read_b128 v[208:211],v8 offset:4096
v_add_u32 v20,81920,v28
v_mfma_f32_16x16x32_bf16 a[52:55],v[148:151],v[164:167],a[52:55]
v_mfma_f32_16x16x32_bf16 a[56:59],v[152:155],v[164:167],a[56:59]
ds_read_b128 v[212:215],v8 offset:5120
v_add_u32 v21,81920,v29
v_mfma_f32_16x16x32_bf16 a[60:63],v[156:159],v[164:167],a[60:63]
v_mfma_f32_16x16x32_bf16 a[64:67],v[128:131],v[168:171],a[64:67]
ds_read_b128 v[216:219],v8 offset:6144
v_add_u32 v22,81920,v30
v_mfma_f32_16x16x32_bf16 a[68:71],v[132:135],v[168:171],a[68:71]
s_add_u32 m0,s80,4096
s_add_u32 s81,s76,s69
buffer_load_dwordx4 v4,s[56:59],s81 offen lds
v_mfma_f32_16x16x32_bf16 a[72:75],v[136:139],v[168:171],a[72:75]
ds_read_b128 v[220:223],v8 offset:7168
v_add_u32 v23,81920,v31
v_mfma_f32_16x16x32_bf16 a[76:79],v[140:143],v[168:171],a[76:79]
v_mfma_f32_16x16x32_bf16 a[80:83],v[144:147],v[168:171],a[80:83]
ds_read_b64_tr_b16 v[224:225],v16 offset:0
v_mfma_f32_16x16x32_bf16 a[84:87],v[148:151],v[168:171],a[84:87]
v_mfma_f32_16x16x32_bf16 a[88:91],v[152:155],v[168:171],a[88:91]
ds_read_b64_tr_b16 v[226:227],v16 offset:1024
v_mfma_f32_16x16x32_bf16 a[92:95],v[156:159],v[168:171],a[92:95]
v_mfma_f32_16x16x32_bf16 a[96:99],v[128:131],v[172:175],a[96:99]
s_add_u32 m0,s80,5120
s_add_u32 s81,s81,s68
buffer_load_dwordx4 v4,s[56:59],s81 offen lds
s_add_u32 s76,s76,s70
v_mfma_f32_16x16x32_bf16 a[100:103],v[132:135],v[172:175],a[100:103]
v_mfma_f32_16x16x32_bf16 a[104:107],v[136:139],v[172:175],a[104:107]
ds_read_b64_tr_b16 v[228:229],v17 offset:0
v_mfma_f32_16x16x32_bf16 a[108:111],v[140:143],v[172:175],a[108:111]
v_mfma_f32_16x16x32_bf16 a[112:115],v[144:147],v[172:175],a[112:115]
ds_read_b64_tr_b16 v[230:231],v17 offset:1024
v_mfma_f32_16x16x32_bf16 a[116:119],v[148:151],v[172:175],a[116:119]
v_mfma_f32_16x16x32_bf16 a[120:123],v[152:155],v[172:175],a[120:123]
ds_read_b64_tr_b16 v[232:233],v18 offset:0
v_mfma_f32_16x16x32_bf16 a[124:127],v[156:159],v[172:175],a[124:127]
s_add_u32 m0,s79,0
s_add_u32 s81,s75,10240
buffer_load_dwordx4 v3,s[8:11],s81 offen sc1 lds
v_mfma_f32_16x16x32_bf16 a[128:131],v[128:131],v[176:179],a[128:131]
ds_read_b64_tr_b16 v[234:235],v18 offset:1024
v_mfma_f32_16x16x32_bf16 a[132:135],v[132:135],v[176:179],a[132:135]
v_mfma_f32_16x16x32_bf16 a[136:139],v[136:139],v[176:179],a[136:139]
ds_read_b64_tr_b16 v[236:237],v19 offset:0
v_mfma_f32_16x16x32_bf16 a[140:143],v[140:143],v[176:179],a[140:143]
v_mfma_f32_16x16x32_bf16 a[144:147],v[144:147],v[176:179],a[144:147]
ds_read_b64_tr_b16 v[238:239],v19 offset:1024
v_mfma_f32_16x16x32_bf16 a[148:151],v[148:151],v[176:179],a[148:151]
v_mfma_f32_16x16x32_bf16 a[152:155],v[152:155],v[176:179],a[152:155]
s_add_u32 m0,s79,1024
s_add_u32 s81,s75,28672
buffer_load_dwordx4 v3,s[8:11],s81 offen sc1 lds
v_mfma_f32_16x16x32_bf16 a[156:159],v[156:159],v[176:179],a[156:159]
v_mfma_f32_16x16x32_bf16 a[160:163],v[128:131],v[180:183],a[160:163]
ds_read_b64_tr_b16 v[240:241],v20 offset:0
v_mfma_f32_16x16x32_bf16 a[164:167],v[132:135],v[180:183],a[164:167]
v_mfma_f32_16x16x32_bf16 a[168:171],v[136:139],v[180:183],a[168:171]
ds_read_b64_tr_b16 v[242:243],v20 offset:1024
v_mfma_f32_16x16x32_bf16 a[172:175],v[140:143],v[180:183],a[172:175]
v_mfma_f32_16x16x32_bf16 a[176:179],v[144:147],v[180:183],a[176:179]
ds_read_b64_tr_b16 v[244:245],v21 offset:0
v_mfma_f32_16x16x32_bf16 a[180:183],v[148:151],v[180:183],a[180:183]
s_add_u32 m0,s79,2048
s_add_u32 s81,s75,47104
buffer_load_dwordx4 v3,s[8:11],s81 offen sc1 lds
v_mfma_f32_16x16x32_bf16 a[184:187],v[152:155],v[180:183],a[184:187]
ds_read_b64_tr_b16 v[246:247],v21 offset:1024
v_mfma_f32_16x16x32_bf16 a[188:191],v[156:159],v[180:183],a[188:191]
v_mfma_f32_16x16x32_bf16 a[192:195],v[128:131],v[184:187],a[192:195]
ds_read_b64_tr_b16 v[248:249],v22 offset:0
v_mfma_f32_16x16x32_bf16 a[196:199],v[132:135],v[184:187],a[196:199]
v_mfma_f32_16x16x32_bf16 a[200:203],v[136:139],v[184:187],a[200:203]
ds_read_b64_tr_b16 v[250:251],v22 offset:1024
v_mfma_f32_16x16x32_bf16 a[204:207],v[140:143],v[184:187],a[204:207]
v_mfma_f32_16x16x32_bf16 a[208:211],v[144:147],v[184:187],a[208:211]
s_add_u32 m0,s79,3072
s_add_u32 s81,s75,65536
buffer_load_dwordx4 v3,s[8:11],s81 offen sc1 lds
v_mfma_f32_16x16x32_bf16 a[212:215],v[148:151],v[184:187],a[212:215]
v_mfma_f32_16x16x32_bf16 a[216:219],v[152:155],v[184:187],a[216:219]
ds_read_b64_tr_b16 v[252:253],v23 offset:0
v_mfma_f32_16x16x32_bf16 a[220:223],v[156:159],v[184:187],a[220:223]
v_mfma_f32_16x16x32_bf16 a[224:227],v[128:131],v[188:191],a[224:227]
ds_read_b64_tr_b16 v[254:255],v23 offset:1024
v_mfma_f32_16x16x32_bf16 a[228:231],v[132:135],v[188:191],a[228:231]
v_mfma_f32_16x16x32_bf16 a[232:235],v[136:139],v[188:191],a[232:235]
v_mfma_f32_16x16x32_bf16 a[236:239],v[140:143],v[188:191],a[236:239]
v_mfma_f32_16x16x32_bf16 a[240:243],v[144:147],v[188:191],a[240:243]
v_mfma_f32_16x16x32_bf16 a[244:247],v[148:151],v[188:191],a[244:247]
v_mfma_f32_16x16x32_bf16 a[248:251],v[152:155],v[188:191],a[248:251]
v_mfma_f32_16x16x32_bf16 a[252:255],v[156:159],v[188:191],a[252:255]
s_waitcnt vmcnt(16) lgkmcnt(0)
s_barrier
v_mfma_f32_16x16x32_bf16 a[0:3],v[192:195],v[224:227],a[0:3]
v_add_u32 v8,98304,v5
v_mfma_f32_16x16x32_bf16 a[4:7],v[196:199],v[224:227],a[4:7]
v_mfma_f32_16x16x32_bf16 a[8:11],v[200:203],v[224:227],a[8:11]
ds_read_b128 v[128:131],v8 offset:0
v_add_u32 v16,114688,v24
v_mfma_f32_16x16x32_bf16 a[12:15],v[204:207],v[224:227],a[12:15]
s_add_u32 m0,s80,32768
s_mov_b32 s81,s76
buffer_load_dwordx4 v4,s[56:59],s81 offen lds
v_mfma_f32_16x16x32_bf16 a[16:19],v[208:211],v[224:227],a[16:19]
ds_read_b128 v[132:135],v8 offset:1024
v_add_u32 v17,114688,v25
v_mfma_f32_16x16x32_bf16 a[20:23],v[212:215],v[224:227],a[20:23]
v_mfma_f32_16x16x32_bf16 a[24:27],v[216:219],v[224:227],a[24:27]
ds_read_b128 v[136:139],v8 offset:2048
v_add_u32 v18,114688,v26
v_mfma_f32_16x16x32_bf16 a[28:31],v[220:223],v[224:227],a[28:31]
v_mfma_f32_16x16x32_bf16 a[32:35],v[192:195],v[228:231],a[32:35]
ds_read_b128 v[140:143],v8 offset:3072
v_add_u32 v19,114688,v27
v_mfma_f32_16x16x32_bf16 a[36:39],v[196:199],v[228:231],a[36:39]
v_mfma_f32_16x16x32_bf16 a[40:43],v[200:203],v[228:231],a[40:43]
s_add_u32 m0,s80,33792
s_add_u32 s81,s76,s68
buffer_load_dwordx4 v4,s[56:59],s81 offen lds
v_mfma_f32_16x16x32_bf16 a[44:47],v[204:207],v[228:231],a[44:47]
v_mfma_f32_16x16x32_bf16 a[48:51],v[208:211],v[228:231],a[48:51]
ds_read_b128 v[144:147],v8 offset:4096
v_add_u32 v20,114688,v28
v_mfma_f32_16x16x32_bf16 a[52:55],v[212:215],v[228:231],a[52:55]
v_mfma_f32_16x16x32_bf16 a[56:59],v[216:219],v[228:231],a[56:59]
ds_read_b128 v[148:151],v8 offset:5120
v_add_u32 v21,114688,v29
v_mfma_f32_16x16x32_bf16 a[60:63],v[220:223],v[228:231],a[60:63]
v_mfma_f32_16x16x32_bf16 a[64:67],v[192:195],v[232:235],a[64:67]
ds_read_b128 v[152:155],v8 offset:6144
v_add_u32 v22,114688,v30
v_mfma_f32_16x16x32_bf16 a[68:71],v[196:199],v[232:235],a[68:71]
s_add_u32 m0,s80,36864
s_add_u32 s81,s76,s69
buffer_load_dwordx4 v4,s[56:59],s81 offen lds
v_mfma_f32_16x16x32_bf16 a[72:75],v[200:203],v[232:235],a[72:75]
ds_read_b128 v[156:159],v8 offset:7168
v_add_u32 v23,114688,v31
v_mfma_f32_16x16x32_bf16 a[76:79],v[204:207],v[232:235],a[76:79]
v_mfma_f32_16x16x32_bf16 a[80:83],v[208:211],v[232:235],a[80:83]
ds_read_b64_tr_b16 v[160:161],v16 offset:0
v_mfma_f32_16x16x32_bf16 a[84:87],v[212:215],v[232:235],a[84:87]
v_mfma_f32_16x16x32_bf16 a[88:91],v[216:219],v[232:235],a[88:91]
ds_read_b64_tr_b16 v[162:163],v16 offset:1024
v_mfma_f32_16x16x32_bf16 a[92:95],v[220:223],v[232:235],a[92:95]
v_mfma_f32_16x16x32_bf16 a[96:99],v[192:195],v[236:239],a[96:99]
s_add_u32 m0,s80,37888
s_add_u32 s81,s81,s68
buffer_load_dwordx4 v4,s[56:59],s81 offen lds
s_add_u32 s76,s76,s70
v_mfma_f32_16x16x32_bf16 a[100:103],v[196:199],v[236:239],a[100:103]
v_mfma_f32_16x16x32_bf16 a[104:107],v[200:203],v[236:239],a[104:107]
ds_read_b64_tr_b16 v[164:165],v17 offset:0
v_mfma_f32_16x16x32_bf16 a[108:111],v[204:207],v[236:239],a[108:111]
v_mfma_f32_16x16x32_bf16 a[112:115],v[208:211],v[236:239],a[112:115]
ds_read_b64_tr_b16 v[166:167],v17 offset:1024
v_mfma_f32_16x16x32_bf16 a[116:119],v[212:215],v[236:239],a[116:119]
v_mfma_f32_16x16x32_bf16 a[120:123],v[216:219],v[236:239],a[120:123]
ds_read_b64_tr_b16 v[168:169],v18 offset:0
v_mfma_f32_16x16x32_bf16 a[124:127],v[220:223],v[236:239],a[124:127]
s_add_u32 m0,s79,32768
s_add_u32 s81,s75,11264
buffer_load_dwordx4 v3,s[8:11],s81 offen sc1 lds
v_mfma_f32_16x16x32_bf16 a[128:131],v[192:195],v[240:243],a[128:131]
ds_read_b64_tr_b16 v[170:171],v18 offset:1024
v_mfma_f32_16x16x32_bf16 a[132:135],v[196:199],v[240:243],a[132:135]
v_mfma_f32_16x16x32_bf16 a[136:139],v[200:203],v[240:243],a[136:139]
ds_read_b64_tr_b16 v[172:173],v19 offset:0
v_mfma_f32_16x16x32_bf16 a[140:143],v[204:207],v[240:243],a[140:143]
v_mfma_f32_16x16x32_bf16 a[144:147],v[208:211],v[240:243],a[144:147]
ds_read_b64_tr_b16 v[174:175],v19 offset:1024
v_mfma_f32_16x16x32_bf16 a[148:151],v[212:215],v[240:243],a[148:151]
v_mfma_f32_16x16x32_bf16 a[152:155],v[216:219],v[240:243],a[152:155]
s_add_u32 m0,s79,33792
s_add_u32 s81,s75,29696
buffer_load_dwordx4 v3,s[8:11],s81 offen sc1 lds
v_mfma_f32_16x16x32_bf16 a[156:159],v[220:223],v[240:243],a[156:159]
v_mfma_f32_16x16x32_bf16 a[160:163],v[192:195],v[244:247],a[160:163]
ds_read_b64_tr_b16 v[176:177],v20 offset:0
v_mfma_f32_16x16x32_bf16 a[164:167],v[196:199],v[244:247],a[164:167]
v_mfma_f32_16x16x32_bf16 a[168:171],v[200:203],v[244:247],a[168:171]
ds_read_b64_tr_b16 v[178:179],v20 offset:1024
v_mfma_f32_16x16x32_bf16 a[172:175],v[204:207],v[244:247],a[172:175]
v_mfma_f32_16x16x32_bf16 a[176:179],v[208:211],v[244:247],a[176:179]
ds_read_b64_tr_b16 v[180:181],v21 offset:0
v_mfma_f32_16x16x32_bf16 a[180:183],v[212:215],v[244:247],a[180:183]
s_add_u32 m0,s79,34816
s_add_u32 s81,s75,48128
buffer_load_dwordx4 v3,s[8:11],s81 offen sc1 lds
v_mfma_f32_16x16x32_bf16 a[184:187],v[216:219],v[244:247],a[184:187]
ds_read_b64_tr_b16 v[182:183],v21 offset:1024
v_mfma_f32_16x16x32_bf16 a[188:191],v[220:223],v[244:247],a[188:191]
v_mfma_f32_16x16x32_bf16 a[192:195],v[192:195],v[248:251],a[192:195]
ds_read_b64_tr_b16 v[184:185],v22 offset:0
v_mfma_f32_16x16x32_bf16 a[196:199],v[196:199],v[248:251],a[196:199]
v_mfma_f32_16x16x32_bf16 a[200:203],v[200:203],v[248:251],a[200:203]
ds_read_b64_tr_b16 v[186:187],v22 offset:1024
v_mfma_f32_16x16x32_bf16 a[204:207],v[204:207],v[248:251],a[204:207]
v_mfma_f32_16x16x32_bf16 a[208:211],v[208:211],v[248:251],a[208:211]
s_add_u32 m0,s79,35840
s_add_u32 s81,s75,66560
buffer_load_dwordx4 v3,s[8:11],s81 offen sc1 lds
v_mfma_f32_16x16x32_bf16 a[212:215],v[212:215],v[248:251],a[212:215]
v_mfma_f32_16x16x32_bf16 a[216:219],v[216:219],v[248:251],a[216:219]
ds_read_b64_tr_b16 v[188:189],v23 offset:0
v_mfma_f32_16x16x32_bf16 a[220:223],v[220:223],v[248:251],a[220:223]
v_mfma_f32_16x16x32_bf16 a[224:227],v[192:195],v[252:255],a[224:227]
ds_read_b64_tr_b16 v[190:191],v23 offset:1024
v_mfma_f32_16x16x32_bf16 a[228:231],v[196:199],v[252:255],a[228:231]
v_mfma_f32_16x16x32_bf16 a[232:235],v[200:203],v[252:255],a[232:235]
v_mfma_f32_16x16x32_bf16 a[236:239],v[204:207],v[252:255],a[236:239]
v_mfma_f32_16x16x32_bf16 a[240:243],v[208:211],v[252:255],a[240:243]
v_mfma_f32_16x16x32_bf16 a[244:247],v[212:215],v[252:255],a[244:247]
v_mfma_f32_16x16x32_bf16 a[248:251],v[216:219],v[252:255],a[248:251]
v_mfma_f32_16x16x32_bf16 a[252:255],v[220:223],v[252:255],a[252:255]
s_waitcnt vmcnt(16) lgkmcnt(0)
s_barrier
v_mfma_f32_16x16x32_bf16 a[0:3],v[128:131],v[160:163],a[0:3]
v_add_u32 v8,131072,v5
v_mfma_f32_16x16x32_bf16 a[4:7],v[132:135],v[160:163],a[4:7]
v_mfma_f32_16x16x32_bf16 a[8:11],v[136:139],v[160:163],a[8:11]
ds_read_b128 v[192:195],v8 offset:0
v_add_u32 v16,147456,v24
v_mfma_f32_16x16x32_bf16 a[12:15],v[140:143],v[160:163],a[12:15]
s_add_u32 m0,s80,65536
s_mov_b32 s81,s76
buffer_load_dwordx4 v4,s[56:59],s81 offen lds
v_mfma_f32_16x16x32_bf16 a[16:19],v[144:147],v[160:163],a[16:19]
ds_read_b128 v[196:199],v8 offset:1024
v_add_u32 v17,147456,v25
v_mfma_f32_16x16x32_bf16 a[20:23],v[148:151],v[160:163],a[20:23]
v_mfma_f32_16x16x32_bf16 a[24:27],v[152:155],v[160:163],a[24:27]
ds_read_b128 v[200:203],v8 offset:2048
v_add_u32 v18,147456,v26
v_mfma_f32_16x16x32_bf16 a[28:31],v[156:159],v[160:163],a[28:31]
v_mfma_f32_16x16x32_bf16 a[32:35],v[128:131],v[164:167],a[32:35]
ds_read_b128 v[204:207],v8 offset:3072
v_add_u32 v19,147456,v27
v_mfma_f32_16x16x32_bf16 a[36:39],v[132:135],v[164:167],a[36:39]
v_mfma_f32_16x16x32_bf16 a[40:43],v[136:139],v[164:167],a[40:43]
s_add_u32 m0,s80,66560
s_add_u32 s81,s76,s68
buffer_load_dwordx4 v4,s[56:59],s81 offen lds
v_mfma_f32_16x16x32_bf16 a[44:47],v[140:143],v[164:167],a[44:47]
v_mfma_f32_16x16x32_bf16 a[48:51],v[144:147],v[164:167],a[48:51]
ds_read_b128 v[208:211],v8 offset:4096
v_add_u32 v20,147456,v28
v_mfma_f32_16x16x32_bf16 a[52:55],v[148:151],v[164:167],a[52:55]
v_mfma_f32_16x16x32_bf16 a[56:59],v[152:155],v[164:167],a[56:59]
ds_read_b128 v[212:215],v8 offset:5120
v_add_u32 v21,147456,v29
v_mfma_f32_16x16x32_bf16 a[60:63],v[156:159],v[164:167],a[60:63]
v_mfma_f32_16x16x32_bf16 a[64:67],v[128:131],v[168:171],a[64:67]
ds_read_b128 v[216:219],v8 offset:6144
v_add_u32 v22,147456,v30
v_mfma_f32_16x16x32_bf16 a[68:71],v[132:135],v[168:171],a[68:71]
s_add_u32 m0,s80,69632
s_add_u32 s81,s76,s69
buffer_load_dwordx4 v4,s[56:59],s81 offen lds
v_mfma_f32_16x16x32_bf16 a[72:75],v[136:139],v[168:171],a[72:75]
ds_read_b128 v[220:223],v8 offset:7168
v_add_u32 v23,147456,v31
v_mfma_f32_16x16x32_bf16 a[76:79],v[140:143],v[168:171],a[76:79]
v_mfma_f32_16x16x32_bf16 a[80:83],v[144:147],v[168:171],a[80:83]
ds_read_b64_tr_b16 v[224:225],v16 offset:0
v_mfma_f32_16x16x32_bf16 a[84:87],v[148:151],v[168:171],a[84:87]
v_mfma_f32_16x16x32_bf16 a[88:91],v[152:155],v[168:171],a[88:91]
ds_read_b64_tr_b16 v[226:227],v16 offset:1024
v_mfma_f32_16x16x32_bf16 a[92:95],v[156:159],v[168:171],a[92:95]
v_mfma_f32_16x16x32_bf16 a[96:99],v[128:131],v[172:175],a[96:99]
s_add_u32 m0,s80,70656
s_add_u32 s81,s81,s68
buffer_load_dwordx4 v4,s[56:59],s81 offen lds
s_add_u32 s76,s76,s70
v_mfma_f32_16x16x32_bf16 a[100:103],v[132:135],v[172:175],a[100:103]
v_mfma_f32_16x16x32_bf16 a[104:107],v[136:139],v[172:175],a[104:107]
ds_read_b64_tr_b16 v[228:229],v17 offset:0
v_mfma_f32_16x16x32_bf16 a[108:111],v[140:143],v[172:175],a[108:111]
v_mfma_f32_16x16x32_bf16 a[112:115],v[144:147],v[172:175],a[112:115]
ds_read_b64_tr_b16 v[230:231],v17 offset:1024
v_mfma_f32_16x16x32_bf16 a[116:119],v[148:151],v[172:175],a[116:119]
v_mfma_f32_16x16x32_bf16 a[120:123],v[152:155],v[172:175],a[120:123]
ds_read_b64_tr_b16 v[232:233],v18 offset:0
v_mfma_f32_16x16x32_bf16 a[124:127],v[156:159],v[172:175],a[124:127]
s_add_u32 m0,s79,65536
s_add_u32 s81,s75,12288
buffer_load_dwordx4 v3,s[8:11],s81 offen sc1 lds
v_mfma_f32_16x16x32_bf16 a[128:131],v[128:131],v[176:179],a[128:131]
ds_read_b64_tr_b16 v[234:235],v18 offset:1024
v_mfma_f32_16x16x32_bf16 a[132:135],v[132:135],v[176:179],a[132:135]
v_mfma_f32_16x16x32_bf16 a[136:139],v[136:139],v[176:179],a[136:139]
ds_read_b64_tr_b16 v[236:237],v19 offset:0
v_mfma_f32_16x16x32_bf16 a[140:143],v[140:143],v[176:179],a[140:143]
v_mfma_f32_16x16x32_bf16 a[144:147],v[144:147],v[176:179],a[144:147]
ds_read_b64_tr_b16 v[238:239],v19 offset:1024
v_mfma_f32_16x16x32_bf16 a[148:151],v[148:151],v[176:179],a[148:151]
v_mfma_f32_16x16x32_bf16 a[152:155],v[152:155],v[176:179],a[152:155]
s_add_u32 m0,s79,66560
s_add_u32 s81,s75,30720
buffer_load_dwordx4 v3,s[8:11],s81 offen sc1 lds
v_mfma_f32_16x16x32_bf16 a[156:159],v[156:159],v[176:179],a[156:159]
v_mfma_f32_16x16x32_bf16 a[160:163],v[128:131],v[180:183],a[160:163]
ds_read_b64_tr_b16 v[240:241],v20 offset:0
v_mfma_f32_16x16x32_bf16 a[164:167],v[132:135],v[180:183],a[164:167]
v_mfma_f32_16x16x32_bf16 a[168:171],v[136:139],v[180:183],a[168:171]
ds_read_b64_tr_b16 v[242:243],v20 offset:1024
v_mfma_f32_16x16x32_bf16 a[172:175],v[140:143],v[180:183],a[172:175]
v_mfma_f32_16x16x32_bf16 a[176:179],v[144:147],v[180:183],a[176:179]
ds_read_b64_tr_b16 v[244:245],v21 offset:0
v_mfma_f32_16x16x32_bf16 a[180:183],v[148:151],v[180:183],a[180:183]
s_add_u32 m0,s79,67584
s_add_u32 s81,s75,49152
buffer_load_dwordx4 v3,s[8:11],s81 offen sc1 lds
v_mfma_f32_16x16x32_bf16 a[184:187],v[152:155],v[180:183],a[184:187]
ds_read_b64_tr_b16 v[246:247],v21 offset:1024
v_mfma_f32_16x16x32_bf16 a[188:191],v[156:159],v[180:183],a[188:191]
v_mfma_f32_16x16x32_bf16 a[192:195],v[128:131],v[184:187],a[192:195]
ds_read_b64_tr_b16 v[248:249],v22 offset:0
v_mfma_f32_16x16x32_bf16 a[196:199],v[132:135],v[184:187],a[196:199]
v_mfma_f32_16x16x32_bf16 a[200:203],v[136:139],v[184:187],a[200:203]
ds_read_b64_tr_b16 v[250:251],v22 offset:1024
v_mfma_f32_16x16x32_bf16 a[204:207],v[140:143],v[184:187],a[204:207]
v_mfma_f32_16x16x32_bf16 a[208:211],v[144:147],v[184:187],a[208:211]
s_add_u32 m0,s79,68608
s_add_u32 s81,s75,67584
buffer_load_dwordx4 v3,s[8:11],s81 offen sc1 lds
v_mfma_f32_16x16x32_bf16 a[212:215],v[148:151],v[184:187],a[212:215]
v_mfma_f32_16x16x32_bf16 a[216:219],v[152:155],v[184:187],a[216:219]
ds_read_b64_tr_b16 v[252:253],v23 offset:0
v_mfma_f32_16x16x32_bf16 a[220:223],v[156:159],v[184:187],a[220:223]
v_mfma_f32_16x16x32_bf16 a[224:227],v[128:131],v[188:191],a[224:227]
ds_read_b64_tr_b16 v[254:255],v23 offset:1024
v_mfma_f32_16x16x32_bf16 a[228:231],v[132:135],v[188:191],a[228:231]
v_mfma_f32_16x16x32_bf16 a[232:235],v[136:139],v[188:191],a[232:235]
v_mfma_f32_16x16x32_bf16 a[236:239],v[140:143],v[188:191],a[236:239]
v_mfma_f32_16x16x32_bf16 a[240:243],v[144:147],v[188:191],a[240:243]
v_mfma_f32_16x16x32_bf16 a[244:247],v[148:151],v[188:191],a[244:247]
v_mfma_f32_16x16x32_bf16 a[248:251],v[152:155],v[188:191],a[248:251]
v_mfma_f32_16x16x32_bf16 a[252:255],v[156:159],v[188:191],a[252:255]
s_waitcnt vmcnt(16) lgkmcnt(0)
s_barrier
v_mfma_f32_16x16x32_bf16 a[0:3],v[192:195],v[224:227],a[0:3]
v_add_u32 v8,0,v5
v_mfma_f32_16x16x32_bf16 a[4:7],v[196:199],v[224:227],a[4:7]
v_mfma_f32_16x16x32_bf16 a[8:11],v[200:203],v[224:227],a[8:11]
ds_read_b128 v[128:131],v8 offset:0
v_add_u32 v16,16384,v24
v_mfma_f32_16x16x32_bf16 a[12:15],v[204:207],v[224:227],a[12:15]
s_add_u32 m0,s80,98304
s_mov_b32 s81,s76
buffer_load_dwordx4 v4,s[56:59],s81 offen lds
v_mfma_f32_16x16x32_bf16 a[16:19],v[208:211],v[224:227],a[16:19]
ds_read_b128 v[132:135],v8 offset:1024
v_add_u32 v17,16384,v25
v_mfma_f32_16x16x32_bf16 a[20:23],v[212:215],v[224:227],a[20:23]
v_mfma_f32_16x16x32_bf16 a[24:27],v[216:219],v[224:227],a[24:27]
ds_read_b128 v[136:139],v8 offset:2048
v_add_u32 v18,16384,v26
v_mfma_f32_16x16x32_bf16 a[28:31],v[220:223],v[224:227],a[28:31]
v_mfma_f32_16x16x32_bf16 a[32:35],v[192:195],v[228:231],a[32:35]
ds_read_b128 v[140:143],v8 offset:3072
v_add_u32 v19,16384,v27
v_mfma_f32_16x16x32_bf16 a[36:39],v[196:199],v[228:231],a[36:39]
v_mfma_f32_16x16x32_bf16 a[40:43],v[200:203],v[228:231],a[40:43]
s_add_u32 m0,s80,99328
s_add_u32 s81,s76,s68
buffer_load_dwordx4 v4,s[56:59],s81 offen lds
v_mfma_f32_16x16x32_bf16 a[44:47],v[204:207],v[228:231],a[44:47]
v_mfma_f32_16x16x32_bf16 a[48:51],v[208:211],v[228:231],a[48:51]
ds_read_b128 v[144:147],v8 offset:4096
v_add_u32 v20,16384,v28
v_mfma_f32_16x16x32_bf16 a[52:55],v[212:215],v[228:231],a[52:55]
v_mfma_f32_16x16x32_bf16 a[56:59],v[216:219],v[228:231],a[56:59]
ds_read_b128 v[148:151],v8 offset:5120
v_add_u32 v21,16384,v29
v_mfma_f32_16x16x32_bf16 a[60:63],v[220:223],v[228:231],a[60:63]
v_mfma_f32_16x16x32_bf16 a[64:67],v[192:195],v[232:235],a[64:67]
ds_read_b128 v[152:155],v8 offset:6144
v_add_u32 v22,16384,v30
v_mfma_f32_16x16x32_bf16 a[68:71],v[196:199],v[232:235],a[68:71]
s_add_u32 m0,s80,102400
s_add_u32 s81,s76,s69
buffer_load_dwordx4 v4,s[56:59],s81 offen lds
v_mfma_f32_16x16x32_bf16 a[72:75],v[200:203],v[232:235],a[72:75]
ds_read_b128 v[156:159],v8 offset:7168
v_add_u32 v23,16384,v31
v_mfma_f32_16x16x32_bf16 a[76:79],v[204:207],v[232:235],a[76:79]
v_mfma_f32_16x16x32_bf16 a[80:83],v[208:211],v[232:235],a[80:83]
ds_read_b64_tr_b16 v[160:161],v16 offset:0
v_mfma_f32_16x16x32_bf16 a[84:87],v[212:215],v[232:235],a[84:87]
v_mfma_f32_16x16x32_bf16 a[88:91],v[216:219],v[232:235],a[88:91]
ds_read_b64_tr_b16 v[162:163],v16 offset:1024
v_mfma_f32_16x16x32_bf16 a[92:95],v[220:223],v[232:235],a[92:95]
v_mfma_f32_16x16x32_bf16 a[96:99],v[192:195],v[236:239],a[96:99]
s_add_u32 m0,s80,103424
s_add_u32 s81,s81,s68
buffer_load_dwordx4 v4,s[56:59],s81 offen lds
s_add_u32 s76,s76,s70
v_mfma_f32_16x16x32_bf16 a[100:103],v[196:199],v[236:239],a[100:103]
v_mfma_f32_16x16x32_bf16 a[104:107],v[200:203],v[236:239],a[104:107]
ds_read_b64_tr_b16 v[164:165],v17 offset:0
v_mfma_f32_16x16x32_bf16 a[108:111],v[204:207],v[236:239],a[108:111]
v_mfma_f32_16x16x32_bf16 a[112:115],v[208:211],v[236:239],a[112:115]
ds_read_b64_tr_b16 v[166:167],v17 offset:1024
v_mfma_f32_16x16x32_bf16 a[116:119],v[212:215],v[236:239],a[116:119]
v_mfma_f32_16x16x32_bf16 a[120:123],v[216:219],v[236:239],a[120:123]
ds_read_b64_tr_b16 v[168:169],v18 offset:0
v_mfma_f32_16x16x32_bf16 a[124:127],v[220:223],v[236:239],a[124:127]
s_add_u32 m0,s79,98304
s_add_u32 s81,s75,13312
buffer_load_dwordx4 v3,s[8:11],s81 offen sc1 lds
v_mfma_f32_16x16x32_bf16 a[128:131],v[192:195],v[240:243],a[128:131]
ds_read_b64_tr_b16 v[170:171],v18 offset:1024
v_mfma_f32_16x16x32_bf16 a[132:135],v[196:199],v[240:243],a[132:135]
v_mfma_f32_16x16x32_bf16 a[136:139],v[200:203],v[240:243],a[136:139]
ds_read_b64_tr_b16 v[172:173],v19 offset:0
v_mfma_f32_16x16x32_bf16 a[140:143],v[204:207],v[240:243],a[140:143]
v_mfma_f32_16x16x32_bf16 a[144:147],v[208:211],v[240:243],a[144:147]
ds_read_b64_tr_b16 v[174:175],v19 offset:1024
v_mfma_f32_16x16x32_bf16 a[148:151],v[212:215],v[240:243],a[148:151]
v_mfma_f32_16x16x32_bf16 a[152:155],v[216:219],v[240:243],a[152:155]
s_add_u32 m0,s79,99328
s_add_u32 s81,s75,31744
buffer_load_dwordx4 v3,s[8:11],s81 offen sc1 lds
v_mfma_f32_16x16x32_bf16 a[156:159],v[220:223],v[240:243],a[156:159]
v_mfma_f32_16x16x32_bf16 a[160:163],v[192:195],v[244:247],a[160:163]
ds_read_b64_tr_b16 v[176:177],v20 offset:0
v_mfma_f32_16x16x32_bf16 a[164:167],v[196:199],v[244:247],a[164:167]
v_mfma_f32_16x16x32_bf16 a[168:171],v[200:203],v[244:247],a[168:171]
ds_read_b64_tr_b16 v[178:179],v20 offset:1024
v_mfma_f32_16x16x32_bf16 a[172:175],v[204:207],v[244:247],a[172:175]
v_mfma_f32_16x16x32_bf16 a[176:179],v[208:211],v[244:247],a[176:179]
ds_read_b64_tr_b16 v[180:181],v21 offset:0
v_mfma_f32_16x16x32_bf16 a[180:183],v[212:215],v[244:247],a[180:183]
s_add_u32 m0,s79,100352
s_add_u32 s81,s75,50176
buffer_load_dwordx4 v3,s[8:11],s81 offen sc1 lds
v_mfma_f32_16x16x32_bf16 a[184:187],v[216:219],v[244:247],a[184:187]
ds_read_b64_tr_b16 v[182:183],v21 offset:1024
v_mfma_f32_16x16x32_bf16 a[188:191],v[220:223],v[244:247],a[188:191]
v_mfma_f32_16x16x32_bf16 a[192:195],v[192:195],v[248:251],a[192:195]
ds_read_b64_tr_b16 v[184:185],v22 offset:0
v_mfma_f32_16x16x32_bf16 a[196:199],v[196:199],v[248:251],a[196:199]
v_mfma_f32_16x16x32_bf16 a[200:203],v[200:203],v[248:251],a[200:203]
ds_read_b64_tr_b16 v[186:187],v22 offset:1024
v_mfma_f32_16x16x32_bf16 a[204:207],v[204:207],v[248:251],a[204:207]
v_mfma_f32_16x16x32_bf16 a[208:211],v[208:211],v[248:251],a[208:211]
s_add_u32 m0,s79,101376
s_add_u32 s81,s75,68608
buffer_load_dwordx4 v3,s[8:11],s81 offen sc1 lds
v_mfma_f32_16x16x32_bf16 a[212:215],v[212:215],v[248:251],a[212:215]
v_mfma_f32_16x16x32_bf16 a[216:219],v[216:219],v[248:251],a[216:219]
ds_read_b64_tr_b16 v[188:189],v23 offset:0
v_mfma_f32_16x16x32_bf16 a[220:223],v[220:223],v[248:251],a[220:223]
v_mfma_f32_16x16x32_bf16 a[224:227],v[192:195],v[252:255],a[224:227]
ds_read_b64_tr_b16 v[190:191],v23 offset:1024
v_mfma_f32_16x16x32_bf16 a[228:231],v[196:199],v[252:255],a[228:231]
v_mfma_f32_16x16x32_bf16 a[232:235],v[200:203],v[252:255],a[232:235]
v_mfma_f32_16x16x32_bf16 a[236:239],v[204:207],v[252:255],a[236:239]
v_mfma_f32_16x16x32_bf16 a[240:243],v[208:211],v[252:255],a[240:243]
v_mfma_f32_16x16x32_bf16 a[244:247],v[212:215],v[252:255],a[244:247]
v_mfma_f32_16x16x32_bf16 a[248:251],v[216:219],v[252:255],a[248:251]
v_mfma_f32_16x16x32_bf16 a[252:255],v[220:223],v[252:255],a[252:255]
s_waitcnt vmcnt(16) lgkmcnt(0)
s_barrier
v_mfma_f32_16x16x32_bf16 a[0:3],v[128:131],v[160:163],a[0:3]
v_add_u32 v8,32768,v5
v_mfma_f32_16x16x32_bf16 a[4:7],v[132:135],v[160:163],a[4:7]
v_mfma_f32_16x16x32_bf16 a[8:11],v[136:139],v[160:163],a[8:11]
ds_read_b128 v[192:195],v8 offset:0
v_add_u32 v16,49152,v24
v_mfma_f32_16x16x32_bf16 a[12:15],v[140:143],v[160:163],a[12:15]
s_add_u32 m0,s80,131072
s_mov_b32 s81,s76
buffer_load_dwordx4 v4,s[56:59],s81 offen lds
v_mfma_f32_16x16x32_bf16 a[16:19],v[144:147],v[160:163],a[16:19]
ds_read_b128 v[196:199],v8 offset:1024
v_add_u32 v17,49152,v25
v_mfma_f32_16x16x32_bf16 a[20:23],v[148:151],v[160:163],a[20:23]
v_mfma_f32_16x16x32_bf16 a[24:27],v[152:155],v[160:163],a[24:27]
ds_read_b128 v[200:203],v8 offset:2048
v_add_u32 v18,49152,v26
v_mfma_f32_16x16x32_bf16 a[28:31],v[156:159],v[160:163],a[28:31]
v_mfma_f32_16x16x32_bf16 a[32:35],v[128:131],v[164:167],a[32:35]
ds_read_b128 v[204:207],v8 offset:3072
v_add_u32 v19,49152,v27
v_mfma_f32_16x16x32_bf16 a[36:39],v[132:135],v[164:167],a[36:39]
v_mfma_f32_16x16x32_bf16 a[40:43],v[136:139],v[164:167],a[40:43]
s_add_u32 m0,s80,132096
s_add_u32 s81,s76,s68
buffer_load_dwordx4 v4,s[56:59],s81 offen lds
v_mfma_f32_16x16x32_bf16 a[44:47],v[140:143],v[164:167],a[44:47]
v_mfma_f32_16x16x32_bf16 a[48:51],v[144:147],v[164:167],a[48:51]
ds_read_b128 v[208:211],v8 offset:4096
v_add_u32 v20,49152,v28
v_mfma_f32_16x16x32_bf16 a[52:55],v[148:151],v[164:167],a[52:55]
v_mfma_f32_16x16x32_bf16 a[56:59],v[152:155],v[164:167],a[56:59]
ds_read_b128 v[212:215],v8 offset:5120
v_add_u32 v21,49152,v29
v_mfma_f32_16x16x32_bf16 a[60:63],v[156:159],v[164:167],a[60:63]
v_mfma_f32_16x16x32_bf16 a[64:67],v[128:131],v[168:171],a[64:67]
ds_read_b128 v[216:219],v8 offset:6144
v_add_u32 v22,49152,v30
v_mfma_f32_16x16x32_bf16 a[68:71],v[132:135],v[168:171],a[68:71]
s_add_u32 m0,s80,135168
s_add_u32 s81,s76,s69
buffer_load_dwordx4 v4,s[56:59],s81 offen lds
v_mfma_f32_16x16x32_bf16 a[72:75],v[136:139],v[168:171],a[72:75]
ds_read_b128 v[220:223],v8 offset:7168
v_add_u32 v23,49152,v31
v_mfma_f32_16x16x32_bf16 a[76:79],v[140:143],v[168:171],a[76:79]
v_mfma_f32_16x16x32_bf16 a[80:83],v[144:147],v[168:171],a[80:83]
ds_read_b64_tr_b16 v[224:225],v16 offset:0
v_mfma_f32_16x16x32_bf16 a[84:87],v[148:151],v[168:171],a[84:87]
v_mfma_f32_16x16x32_bf16 a[88:91],v[152:155],v[168:171],a[88:91]
ds_read_b64_tr_b16 v[226:227],v16 offset:1024
v_mfma_f32_16x16x32_bf16 a[92:95],v[156:159],v[168:171],a[92:95]
v_mfma_f32_16x16x32_bf16 a[96:99],v[128:131],v[172:175],a[96:99]
s_add_u32 m0,s80,136192
s_add_u32 s81,s81,s68
buffer_load_dwordx4 v4,s[56:59],s81 offen lds
s_add_u32 s76,s76,s70
v_mfma_f32_16x16x32_bf16 a[100:103],v[132:135],v[172:175],a[100:103]
v_mfma_f32_16x16x32_bf16 a[104:107],v[136:139],v[172:175],a[104:107]
ds_read_b64_tr_b16 v[228:229],v17 offset:0
v_mfma_f32_16x16x32_bf16 a[108:111],v[140:143],v[172:175],a[108:111]
v_mfma_f32_16x16x32_bf16 a[112:115],v[144:147],v[172:175],a[112:115]
ds_read_b64_tr_b16 v[230:231],v17 offset:1024
v_mfma_f32_16x16x32_bf16 a[116:119],v[148:151],v[172:175],a[116:119]
v_mfma_f32_16x16x32_bf16 a[120:123],v[152:155],v[172:175],a[120:123]
ds_read_b64_tr_b16 v[232:233],v18 offset:0
v_mfma_f32_16x16x32_bf16 a[124:127],v[156:159],v[172:175],a[124:127]
s_add_u32 m0,s79,131072
s_add_u32 s81,s75,14336
buffer_load_dwordx4 v3,s[8:11],s81 offen sc1 lds
v_mfma_f32_16x16x32_bf16 a[128:131],v[128:131],v[176:179],a[128:131]
ds_read_b64_tr_b16 v[234:235],v18 offset:1024
v_mfma_f32_16x16x32_bf16 a[132:135],v[132:135],v[176:179],a[132:135]
v_mfma_f32_16x16x32_bf16 a[136:139],v[136:139],v[176:179],a[136:139]
ds_read_b64_tr_b16 v[236:237],v19 offset:0
v_mfma_f32_16x16x32_bf16 a[140:143],v[140:143],v[176:179],a[140:143]
v_mfma_f32_16x16x32_bf16 a[144:147],v[144:147],v[176:179],a[144:147]
ds_read_b64_tr_b16 v[238:239],v19 offset:1024
v_mfma_f32_16x16x32_bf16 a[148:151],v[148:151],v[176:179],a[148:151]
v_mfma_f32_16x16x32_bf16 a[152:155],v[152:155],v[176:179],a[152:155]
s_add_u32 m0,s79,132096
s_add_u32 s81,s75,32768
buffer_load_dwordx4 v3,s[8:11],s81 offen sc1 lds
v_mfma_f32_16x16x32_bf16 a[156:159],v[156:159],v[176:179],a[156:159]
v_mfma_f32_16x16x32_bf16 a[160:163],v[128:131],v[180:183],a[160:163]
ds_read_b64_tr_b16 v[240:241],v20 offset:0
v_mfma_f32_16x16x32_bf16 a[164:167],v[132:135],v[180:183],a[164:167]
v_mfma_f32_16x16x32_bf16 a[168:171],v[136:139],v[180:183],a[168:171]
ds_read_b64_tr_b16 v[242:243],v20 offset:1024
v_mfma_f32_16x16x32_bf16 a[172:175],v[140:143],v[180:183],a[172:175]
v_mfma_f32_16x16x32_bf16 a[176:179],v[144:147],v[180:183],a[176:179]
ds_read_b64_tr_b16 v[244:245],v21 offset:0
v_mfma_f32_16x16x32_bf16 a[180:183],v[148:151],v[180:183],a[180:183]
s_add_u32 m0,s79,133120
s_add_u32 s81,s75,51200
buffer_load_dwordx4 v3,s[8:11],s81 offen sc1 lds
v_mfma_f32_16x16x32_bf16 a[184:187],v[152:155],v[180:183],a[184:187]
ds_read_b64_tr_b16 v[246:247],v21 offset:1024
v_mfma_f32_16x16x32_bf16 a[188:191],v[156:159],v[180:183],a[188:191]
v_mfma_f32_16x16x32_bf16 a[192:195],v[128:131],v[184:187],a[192:195]
ds_read_b64_tr_b16 v[248:249],v22 offset:0
v_mfma_f32_16x16x32_bf16 a[196:199],v[132:135],v[184:187],a[196:199]
v_mfma_f32_16x16x32_bf16 a[200:203],v[136:139],v[184:187],a[200:203]
ds_read_b64_tr_b16 v[250:251],v22 offset:1024
v_mfma_f32_16x16x32_bf16 a[204:207],v[140:143],v[184:187],a[204:207]
v_mfma_f32_16x16x32_bf16 a[208:211],v[144:147],v[184:187],a[208:211]
s_add_u32 m0,s79,134144
s_add_u32 s81,s75,69632
buffer_load_dwordx4 v3,s[8:11],s81 offen sc1 lds
v_mfma_f32_16x16x32_bf16 a[212:215],v[148:151],v[184:187],a[212:215]
v_mfma_f32_16x16x32_bf16 a[216:219],v[152:155],v[184:187],a[216:219]
ds_read_b64_tr_b16 v[252:253],v23 offset:0
v_mfma_f32_16x16x32_bf16 a[220:223],v[156:159],v[184:187],a[220:223]
v_mfma_f32_16x16x32_bf16 a[224:227],v[128:131],v[188:191],a[224:227]
ds_read_b64_tr_b16 v[254:255],v23 offset:1024
v_mfma_f32_16x16x32_bf16 a[228:231],v[132:135],v[188:191],a[228:231]
v_mfma_f32_16x16x32_bf16 a[232:235],v[136:139],v[188:191],a[232:235]
v_mfma_f32_16x16x32_bf16 a[236:239],v[140:143],v[188:191],a[236:239]
v_mfma_f32_16x16x32_bf16 a[240:243],v[144:147],v[188:191],a[240:243]
v_mfma_f32_16x16x32_bf16 a[244:247],v[148:151],v[188:191],a[244:247]
v_mfma_f32_16x16x32_bf16 a[248:251],v[152:155],v[188:191],a[248:251]
v_mfma_f32_16x16x32_bf16 a[252:255],v[156:159],v[188:191],a[252:255]
s_waitcnt vmcnt(16) lgkmcnt(0)
s_barrier
v_mfma_f32_16x16x32_bf16 a[0:3],v[192:195],v[224:227],a[0:3]
v_add_u32 v8,65536,v5
v_mfma_f32_16x16x32_bf16 a[4:7],v[196:199],v[224:227],a[4:7]
v_mfma_f32_16x16x32_bf16 a[8:11],v[200:203],v[224:227],a[8:11]
ds_read_b128 v[128:131],v8 offset:0
v_add_u32 v16,81920,v24
v_mfma_f32_16x16x32_bf16 a[12:15],v[204:207],v[224:227],a[12:15]
s_add_u32 m0,s80,0
s_mov_b32 s81,s76
buffer_load_dwordx4 v4,s[56:59],s81 offen lds
v_mfma_f32_16x16x32_bf16 a[16:19],v[208:211],v[224:227],a[16:19]
ds_read_b128 v[132:135],v8 offset:1024
v_add_u32 v17,81920,v25
v_mfma_f32_16x16x32_bf16 a[20:23],v[212:215],v[224:227],a[20:23]
v_mfma_f32_16x16x32_bf16 a[24:27],v[216:219],v[224:227],a[24:27]
ds_read_b128 v[136:139],v8 offset:2048
v_add_u32 v18,81920,v26
v_mfma_f32_16x16x32_bf16 a[28:31],v[220:223],v[224:227],a[28:31]
v_mfma_f32_16x16x32_bf16 a[32:35],v[192:195],v[228:231],a[32:35]
ds_read_b128 v[140:143],v8 offset:3072
v_add_u32 v19,81920,v27
v_mfma_f32_16x16x32_bf16 a[36:39],v[196:199],v[228:231],a[36:39]
v_mfma_f32_16x16x32_bf16 a[40:43],v[200:203],v[228:231],a[40:43]
s_add_u32 m0,s80,1024
s_add_u32 s81,s76,s68
buffer_load_dwordx4 v4,s[56:59],s81 offen lds
v_mfma_f32_16x16x32_bf16 a[44:47],v[204:207],v[228:231],a[44:47]
v_mfma_f32_16x16x32_bf16 a[48:51],v[208:211],v[228:231],a[48:51]
ds_read_b128 v[144:147],v8 offset:4096
v_add_u32 v20,81920,v28
v_mfma_f32_16x16x32_bf16 a[52:55],v[212:215],v[228:231],a[52:55]
v_mfma_f32_16x16x32_bf16 a[56:59],v[216:219],v[228:231],a[56:59]
ds_read_b128 v[148:151],v8 offset:5120
v_add_u32 v21,81920,v29
v_mfma_f32_16x16x32_bf16 a[60:63],v[220:223],v[228:231],a[60:63]
v_mfma_f32_16x16x32_bf16 a[64:67],v[192:195],v[232:235],a[64:67]
ds_read_b128 v[152:155],v8 offset:6144
v_add_u32 v22,81920,v30
v_mfma_f32_16x16x32_bf16 a[68:71],v[196:199],v[232:235],a[68:71]
s_add_u32 m0,s80,4096
s_add_u32 s81,s76,s69
buffer_load_dwordx4 v4,s[56:59],s81 offen lds
v_mfma_f32_16x16x32_bf16 a[72:75],v[200:203],v[232:235],a[72:75]
ds_read_b128 v[156:159],v8 offset:7168
v_add_u32 v23,81920,v31
v_mfma_f32_16x16x32_bf16 a[76:79],v[204:207],v[232:235],a[76:79]
v_mfma_f32_16x16x32_bf16 a[80:83],v[208:211],v[232:235],a[80:83]
ds_read_b64_tr_b16 v[160:161],v16 offset:0
v_mfma_f32_16x16x32_bf16 a[84:87],v[212:215],v[232:235],a[84:87]
v_mfma_f32_16x16x32_bf16 a[88:91],v[216:219],v[232:235],a[88:91]
ds_read_b64_tr_b16 v[162:163],v16 offset:1024
v_mfma_f32_16x16x32_bf16 a[92:95],v[220:223],v[232:235],a[92:95]
v_mfma_f32_16x16x32_bf16 a[96:99],v[192:195],v[236:239],a[96:99]
s_add_u32 m0,s80,5120
s_add_u32 s81,s81,s68
buffer_load_dwordx4 v4,s[56:59],s81 offen lds
s_add_u32 s76,s76,s70
v_mfma_f32_16x16x32_bf16 a[100:103],v[196:199],v[236:239],a[100:103]
v_mfma_f32_16x16x32_bf16 a[104:107],v[200:203],v[236:239],a[104:107]
ds_read_b64_tr_b16 v[164:165],v17 offset:0
v_mfma_f32_16x16x32_bf16 a[108:111],v[204:207],v[236:239],a[108:111]
v_mfma_f32_16x16x32_bf16 a[112:115],v[208:211],v[236:239],a[112:115]
ds_read_b64_tr_b16 v[166:167],v17 offset:1024
v_mfma_f32_16x16x32_bf16 a[116:119],v[212:215],v[236:239],a[116:119]
v_mfma_f32_16x16x32_bf16 a[120:123],v[216:219],v[236:239],a[120:123]
ds_read_b64_tr_b16 v[168:169],v18 offset:0
v_mfma_f32_16x16x32_bf16 a[124:127],v[220:223],v[236:239],a[124:127]
s_add_u32 m0,s79,0
s_add_u32 s81,s75,15360
buffer_load_dwordx4 v3,s[8:11],s81 offen sc1 lds
v_mfma_f32_16x16x32_bf16 a[128:131],v[192:195],v[240:243],a[128:131]
ds_read_b64_tr_b16 v[170:171],v18 offset:1024
v_mfma_f32_16x16x32_bf16 a[132:135],v[196:199],v[240:243],a[132:135]
v_mfma_f32_16x16x32_bf16 a[136:139],v[200:203],v[240:243],a[136:139]
ds_read_b64_tr_b16 v[172:173],v19 offset:0
v_mfma_f32_16x16x32_bf16 a[140:143],v[204:207],v[240:243],a[140:143]
v_mfma_f32_16x16x32_bf16 a[144:147],v[208:211],v[240:243],a[144:147]
ds_read_b64_tr_b16 v[174:175],v19 offset:1024
v_mfma_f32_16x16x32_bf16 a[148:151],v[212:215],v[240:243],a[148:151]
v_mfma_f32_16x16x32_bf16 a[152:155],v[216:219],v[240:243],a[152:155]
s_add_u32 m0,s79,1024
s_add_u32 s81,s75,33792
buffer_load_dwordx4 v3,s[8:11],s81 offen sc1 lds
v_mfma_f32_16x16x32_bf16 a[156:159],v[220:223],v[240:243],a[156:159]
v_mfma_f32_16x16x32_bf16 a[160:163],v[192:195],v[244:247],a[160:163]
ds_read_b64_tr_b16 v[176:177],v20 offset:0
v_mfma_f32_16x16x32_bf16 a[164:167],v[196:199],v[244:247],a[164:167]
v_mfma_f32_16x16x32_bf16 a[168:171],v[200:203],v[244:247],a[168:171]
ds_read_b64_tr_b16 v[178:179],v20 offset:1024
v_mfma_f32_16x16x32_bf16 a[172:175],v[204:207],v[244:247],a[172:175]
v_mfma_f32_16x16x32_bf16 a[176:179],v[208:211],v[244:247],a[176:179]
ds_read_b64_tr_b16 v[180:181],v21 offset:0
v_mfma_f32_16x16x32_bf16 a[180:183],v[212:215],v[244:247],a[180:183]
s_add_u32 m0,s79,2048
s_add_u32 s81,s75,52224
buffer_load_dwordx4 v3,s[8:11],s81 offen sc1 lds
v_mfma_f32_16x16x32_bf16 a[184:187],v[216:219],v[244:247],a[184:187]
ds_read_b64_tr_b16 v[182:183],v21 offset:1024
v_mfma_f32_16x16x32_bf16 a[188:191],v[220:223],v[244:247],a[188:191]
v_mfma_f32_16x16x32_bf16 a[192:195],v[192:195],v[248:251],a[192:195]
ds_read_b64_tr_b16 v[184:185],v22 offset:0
v_mfma_f32_16x16x32_bf16 a[196:199],v[196:199],v[248:251],a[196:199]
v_mfma_f32_16x16x32_bf16 a[200:203],v[200:203],v[248:251],a[200:203]
ds_read_b64_tr_b16 v[186:187],v22 offset:1024
v_mfma_f32_16x16x32_bf16 a[204:207],v[204:207],v[248:251],a[204:207]
v_mfma_f32_16x16x32_bf16 a[208:211],v[208:211],v[248:251],a[208:211]
s_add_u32 m0,s79,3072
s_add_u32 s81,s75,70656
buffer_load_dwordx4 v3,s[8:11],s81 offen sc1 lds
v_mfma_f32_16x16x32_bf16 a[212:215],v[212:215],v[248:251],a[212:215]
v_mfma_f32_16x16x32_bf16 a[216:219],v[216:219],v[248:251],a[216:219]
ds_read_b64_tr_b16 v[188:189],v23 offset:0
v_mfma_f32_16x16x32_bf16 a[220:223],v[220:223],v[248:251],a[220:223]
v_mfma_f32_16x16x32_bf16 a[224:227],v[192:195],v[252:255],a[224:227]
ds_read_b64_tr_b16 v[190:191],v23 offset:1024
v_mfma_f32_16x16x32_bf16 a[228:231],v[196:199],v[252:255],a[228:231]
v_mfma_f32_16x16x32_bf16 a[232:235],v[200:203],v[252:255],a[232:235]
v_mfma_f32_16x16x32_bf16 a[236:239],v[204:207],v[252:255],a[236:239]
v_mfma_f32_16x16x32_bf16 a[240:243],v[208:211],v[252:255],a[240:243]
v_mfma_f32_16x16x32_bf16 a[244:247],v[212:215],v[252:255],a[244:247]
v_mfma_f32_16x16x32_bf16 a[248:251],v[216:219],v[252:255],a[248:251]
v_mfma_f32_16x16x32_bf16 a[252:255],v[220:223],v[252:255],a[252:255]
s_waitcnt vmcnt(16) lgkmcnt(0)
s_barrier
v_mfma_f32_16x16x32_bf16 a[0:3],v[128:131],v[160:163],a[0:3]
v_add_u32 v8,98304,v5
v_mfma_f32_16x16x32_bf16 a[4:7],v[132:135],v[160:163],a[4:7]
v_mfma_f32_16x16x32_bf16 a[8:11],v[136:139],v[160:163],a[8:11]
ds_read_b128 v[192:195],v8 offset:0
v_add_u32 v16,114688,v24
v_mfma_f32_16x16x32_bf16 a[12:15],v[140:143],v[160:163],a[12:15]
s_add_u32 m0,s80,32768
s_mov_b32 s81,s76
buffer_load_dwordx4 v4,s[56:59],s81 offen lds
v_mfma_f32_16x16x32_bf16 a[16:19],v[144:147],v[160:163],a[16:19]
ds_read_b128 v[196:199],v8 offset:1024
v_add_u32 v17,114688,v25
v_mfma_f32_16x16x32_bf16 a[20:23],v[148:151],v[160:163],a[20:23]
v_mfma_f32_16x16x32_bf16 a[24:27],v[152:155],v[160:163],a[24:27]
ds_read_b128 v[200:203],v8 offset:2048
v_add_u32 v18,114688,v26
v_mfma_f32_16x16x32_bf16 a[28:31],v[156:159],v[160:163],a[28:31]
v_mfma_f32_16x16x32_bf16 a[32:35],v[128:131],v[164:167],a[32:35]
ds_read_b128 v[204:207],v8 offset:3072
v_add_u32 v19,114688,v27
v_mfma_f32_16x16x32_bf16 a[36:39],v[132:135],v[164:167],a[36:39]
v_mfma_f32_16x16x32_bf16 a[40:43],v[136:139],v[164:167],a[40:43]
s_add_u32 m0,s80,33792
s_add_u32 s81,s76,s68
buffer_load_dwordx4 v4,s[56:59],s81 offen lds
v_mfma_f32_16x16x32_bf16 a[44:47],v[140:143],v[164:167],a[44:47]
v_mfma_f32_16x16x32_bf16 a[48:51],v[144:147],v[164:167],a[48:51]
ds_read_b128 v[208:211],v8 offset:4096
v_add_u32 v20,114688,v28
v_mfma_f32_16x16x32_bf16 a[52:55],v[148:151],v[164:167],a[52:55]
v_mfma_f32_16x16x32_bf16 a[56:59],v[152:155],v[164:167],a[56:59]
ds_read_b128 v[212:215],v8 offset:5120
v_add_u32 v21,114688,v29
v_mfma_f32_16x16x32_bf16 a[60:63],v[156:159],v[164:167],a[60:63]
v_mfma_f32_16x16x32_bf16 a[64:67],v[128:131],v[168:171],a[64:67]
ds_read_b128 v[216:219],v8 offset:6144
v_add_u32 v22,114688,v30
v_mfma_f32_16x16x32_bf16 a[68:71],v[132:135],v[168:171],a[68:71]
s_add_u32 m0,s80,36864
s_add_u32 s81,s76,s69
buffer_load_dwordx4 v4,s[56:59],s81 offen lds
v_mfma_f32_16x16x32_bf16 a[72:75],v[136:139],v[168:171],a[72:75]
ds_read_b128 v[220:223],v8 offset:7168
v_add_u32 v23,114688,v31
v_mfma_f32_16x16x32_bf16 a[76:79],v[140:143],v[168:171],a[76:79]
v_mfma_f32_16x16x32_bf16 a[80:83],v[144:147],v[168:171],a[80:83]
ds_read_b64_tr_b16 v[224:225],v16 offset:0
v_mfma_f32_16x16x32_bf16 a[84:87],v[148:151],v[168:171],a[84:87]
v_mfma_f32_16x16x32_bf16 a[88:91],v[152:155],v[168:171],a[88:91]
ds_read_b64_tr_b16 v[226:227],v16 offset:1024
v_mfma_f32_16x16x32_bf16 a[92:95],v[156:159],v[168:171],a[92:95]
v_mfma_f32_16x16x32_bf16 a[96:99],v[128:131],v[172:175],a[96:99]
s_add_u32 m0,s80,37888
s_add_u32 s81,s81,s68
buffer_load_dwordx4 v4,s[56:59],s81 offen lds
s_add_u32 s76,s76,s70
v_mfma_f32_16x16x32_bf16 a[100:103],v[132:135],v[172:175],a[100:103]
v_mfma_f32_16x16x32_bf16 a[104:107],v[136:139],v[172:175],a[104:107]
ds_read_b64_tr_b16 v[228:229],v17 offset:0
v_mfma_f32_16x16x32_bf16 a[108:111],v[140:143],v[172:175],a[108:111]
v_mfma_f32_16x16x32_bf16 a[112:115],v[144:147],v[172:175],a[112:115]
ds_read_b64_tr_b16 v[230:231],v17 offset:1024
v_mfma_f32_16x16x32_bf16 a[116:119],v[148:151],v[172:175],a[116:119]
v_mfma_f32_16x16x32_bf16 a[120:123],v[152:155],v[172:175],a[120:123]
ds_read_b64_tr_b16 v[232:233],v18 offset:0
v_mfma_f32_16x16x32_bf16 a[124:127],v[156:159],v[172:175],a[124:127]
s_add_u32 m0,s79,32768
s_add_u32 s81,s75,16384
buffer_load_dwordx4 v3,s[8:11],s81 offen sc1 lds
v_mfma_f32_16x16x32_bf16 a[128:131],v[128:131],v[176:179],a[128:131]
ds_read_b64_tr_b16 v[234:235],v18 offset:1024
v_mfma_f32_16x16x32_bf16 a[132:135],v[132:135],v[176:179],a[132:135]
v_mfma_f32_16x16x32_bf16 a[136:139],v[136:139],v[176:179],a[136:139]
ds_read_b64_tr_b16 v[236:237],v19 offset:0
v_mfma_f32_16x16x32_bf16 a[140:143],v[140:143],v[176:179],a[140:143]
v_mfma_f32_16x16x32_bf16 a[144:147],v[144:147],v[176:179],a[144:147]
ds_read_b64_tr_b16 v[238:239],v19 offset:1024
v_mfma_f32_16x16x32_bf16 a[148:151],v[148:151],v[176:179],a[148:151]
v_mfma_f32_16x16x32_bf16 a[152:155],v[152:155],v[176:179],a[152:155]
s_add_u32 m0,s79,33792
s_add_u32 s81,s75,34816
buffer_load_dwordx4 v3,s[8:11],s81 offen sc1 lds
v_mfma_f32_16x16x32_bf16 a[156:159],v[156:159],v[176:179],a[156:159]
v_mfma_f32_16x16x32_bf16 a[160:163],v[128:131],v[180:183],a[160:163]
ds_read_b64_tr_b16 v[240:241],v20 offset:0
v_mfma_f32_16x16x32_bf16 a[164:167],v[132:135],v[180:183],a[164:167]
v_mfma_f32_16x16x32_bf16 a[168:171],v[136:139],v[180:183],a[168:171]
ds_read_b64_tr_b16 v[242:243],v20 offset:1024
v_mfma_f32_16x16x32_bf16 a[172:175],v[140:143],v[180:183],a[172:175]
v_mfma_f32_16x16x32_bf16 a[176:179],v[144:147],v[180:183],a[176:179]
ds_read_b64_tr_b16 v[244:245],v21 offset:0
v_mfma_f32_16x16x32_bf16 a[180:183],v[148:151],v[180:183],a[180:183]
s_add_u32 m0,s79,34816
s_add_u32 s81,s75,53248
buffer_load_dwordx4 v3,s[8:11],s81 offen sc1 lds
v_mfma_f32_16x16x32_bf16 a[184:187],v[152:155],v[180:183],a[184:187]
ds_read_b64_tr_b16 v[246:247],v21 offset:1024
v_mfma_f32_16x16x32_bf16 a[188:191],v[156:159],v[180:183],a[188:191]
v_mfma_f32_16x16x32_bf16 a[192:195],v[128:131],v[184:187],a[192:195]
ds_read_b64_tr_b16 v[248:249],v22 offset:0
v_mfma_f32_16x16x32_bf16 a[196:199],v[132:135],v[184:187],a[196:199]
v_mfma_f32_16x16x32_bf16 a[200:203],v[136:139],v[184:187],a[200:203]
ds_read_b64_tr_b16 v[250:251],v22 offset:1024
v_mfma_f32_16x16x32_bf16 a[204:207],v[140:143],v[184:187],a[204:207]
v_mfma_f32_16x16x32_bf16 a[208:211],v[144:147],v[184:187],a[208:211]
s_add_u32 m0,s79,35840
s_add_u32 s81,s75,71680
buffer_load_dwordx4 v3,s[8:11],s81 offen sc1 lds
v_mfma_f32_16x16x32_bf16 a[212:215],v[148:151],v[184:187],a[212:215]
v_mfma_f32_16x16x32_bf16 a[216:219],v[152:155],v[184:187],a[216:219]
ds_read_b64_tr_b16 v[252:253],v23 offset:0
v_mfma_f32_16x16x32_bf16 a[220:223],v[156:159],v[184:187],a[220:223]
v_mfma_f32_16x16x32_bf16 a[224:227],v[128:131],v[188:191],a[224:227]
ds_read_b64_tr_b16 v[254:255],v23 offset:1024
v_mfma_f32_16x16x32_bf16 a[228:231],v[132:135],v[188:191],a[228:231]
v_mfma_f32_16x16x32_bf16 a[232:235],v[136:139],v[188:191],a[232:235]
v_mfma_f32_16x16x32_bf16 a[236:239],v[140:143],v[188:191],a[236:239]
v_mfma_f32_16x16x32_bf16 a[240:243],v[144:147],v[188:191],a[240:243]
v_mfma_f32_16x16x32_bf16 a[244:247],v[148:151],v[188:191],a[244:247]
v_mfma_f32_16x16x32_bf16 a[248:251],v[152:155],v[188:191],a[248:251]
v_mfma_f32_16x16x32_bf16 a[252:255],v[156:159],v[188:191],a[252:255]
s_waitcnt vmcnt(16) lgkmcnt(0)
s_barrier
v_mfma_f32_16x16x32_bf16 a[0:3],v[192:195],v[224:227],a[0:3]
v_add_u32 v8,131072,v5
v_mfma_f32_16x16x32_bf16 a[4:7],v[196:199],v[224:227],a[4:7]
v_mfma_f32_16x16x32_bf16 a[8:11],v[200:203],v[224:227],a[8:11]
ds_read_b128 v[128:131],v8 offset:0
v_add_u32 v16,147456,v24
v_mfma_f32_16x16x32_bf16 a[12:15],v[204:207],v[224:227],a[12:15]
s_add_u32 m0,s80,65536
s_mov_b32 s81,s76
buffer_load_dwordx4 v4,s[56:59],s81 offen lds
v_mfma_f32_16x16x32_bf16 a[16:19],v[208:211],v[224:227],a[16:19]
ds_read_b128 v[132:135],v8 offset:1024
v_add_u32 v17,147456,v25
v_mfma_f32_16x16x32_bf16 a[20:23],v[212:215],v[224:227],a[20:23]
v_mfma_f32_16x16x32_bf16 a[24:27],v[216:219],v[224:227],a[24:27]
ds_read_b128 v[136:139],v8 offset:2048
v_add_u32 v18,147456,v26
v_mfma_f32_16x16x32_bf16 a[28:31],v[220:223],v[224:227],a[28:31]
v_mfma_f32_16x16x32_bf16 a[32:35],v[192:195],v[228:231],a[32:35]
ds_read_b128 v[140:143],v8 offset:3072
v_add_u32 v19,147456,v27
v_mfma_f32_16x16x32_bf16 a[36:39],v[196:199],v[228:231],a[36:39]
v_mfma_f32_16x16x32_bf16 a[40:43],v[200:203],v[228:231],a[40:43]
s_add_u32 m0,s80,66560
s_add_u32 s81,s76,s68
buffer_load_dwordx4 v4,s[56:59],s81 offen lds
v_mfma_f32_16x16x32_bf16 a[44:47],v[204:207],v[228:231],a[44:47]
v_mfma_f32_16x16x32_bf16 a[48:51],v[208:211],v[228:231],a[48:51]
ds_read_b128 v[144:147],v8 offset:4096
v_add_u32 v20,147456,v28
v_mfma_f32_16x16x32_bf16 a[52:55],v[212:215],v[228:231],a[52:55]
v_mfma_f32_16x16x32_bf16 a[56:59],v[216:219],v[228:231],a[56:59]
ds_read_b128 v[148:151],v8 offset:5120
v_add_u32 v21,147456,v29
v_mfma_f32_16x16x32_bf16 a[60:63],v[220:223],v[228:231],a[60:63]
v_mfma_f32_16x16x32_bf16 a[64:67],v[192:195],v[232:235],a[64:67]
ds_read_b128 v[152:155],v8 offset:6144
v_add_u32 v22,147456,v30
v_mfma_f32_16x16x32_bf16 a[68:71],v[196:199],v[232:235],a[68:71]
s_add_u32 m0,s80,69632
s_add_u32 s81,s76,s69
buffer_load_dwordx4 v4,s[56:59],s81 offen lds
v_mfma_f32_16x16x32_bf16 a[72:75],v[200:203],v[232:235],a[72:75]
ds_read_b128 v[156:159],v8 offset:7168
v_add_u32 v23,147456,v31
v_mfma_f32_16x16x32_bf16 a[76:79],v[204:207],v[232:235],a[76:79]
v_mfma_f32_16x16x32_bf16 a[80:83],v[208:211],v[232:235],a[80:83]
ds_read_b64_tr_b16 v[160:161],v16 offset:0
v_mfma_f32_16x16x32_bf16 a[84:87],v[212:215],v[232:235],a[84:87]
v_mfma_f32_16x16x32_bf16 a[88:91],v[216:219],v[232:235],a[88:91]
ds_read_b64_tr_b16 v[162:163],v16 offset:1024
v_mfma_f32_16x16x32_bf16 a[92:95],v[220:223],v[232:235],a[92:95]
v_mfma_f32_16x16x32_bf16 a[96:99],v[192:195],v[236:239],a[96:99]
s_add_u32 m0,s80,70656
s_add_u32 s81,s81,s68
buffer_load_dwordx4 v4,s[56:59],s81 offen lds
s_add_u32 s76,s76,s70
v_mfma_f32_16x16x32_bf16 a[100:103],v[196:199],v[236:239],a[100:103]
v_mfma_f32_16x16x32_bf16 a[104:107],v[200:203],v[236:239],a[104:107]
ds_read_b64_tr_b16 v[164:165],v17 offset:0
v_mfma_f32_16x16x32_bf16 a[108:111],v[204:207],v[236:239],a[108:111]
v_mfma_f32_16x16x32_bf16 a[112:115],v[208:211],v[236:239],a[112:115]
ds_read_b64_tr_b16 v[166:167],v17 offset:1024
v_mfma_f32_16x16x32_bf16 a[116:119],v[212:215],v[236:239],a[116:119]
v_mfma_f32_16x16x32_bf16 a[120:123],v[216:219],v[236:239],a[120:123]
ds_read_b64_tr_b16 v[168:169],v18 offset:0
v_mfma_f32_16x16x32_bf16 a[124:127],v[220:223],v[236:239],a[124:127]
s_add_u32 m0,s79,65536
s_add_u32 s81,s75,17408
buffer_load_dwordx4 v3,s[8:11],s81 offen sc1 lds
v_mfma_f32_16x16x32_bf16 a[128:131],v[192:195],v[240:243],a[128:131]
ds_read_b64_tr_b16 v[170:171],v18 offset:1024
v_mfma_f32_16x16x32_bf16 a[132:135],v[196:199],v[240:243],a[132:135]
v_mfma_f32_16x16x32_bf16 a[136:139],v[200:203],v[240:243],a[136:139]
ds_read_b64_tr_b16 v[172:173],v19 offset:0
v_mfma_f32_16x16x32_bf16 a[140:143],v[204:207],v[240:243],a[140:143]
v_mfma_f32_16x16x32_bf16 a[144:147],v[208:211],v[240:243],a[144:147]
ds_read_b64_tr_b16 v[174:175],v19 offset:1024
v_mfma_f32_16x16x32_bf16 a[148:151],v[212:215],v[240:243],a[148:151]
v_mfma_f32_16x16x32_bf16 a[152:155],v[216:219],v[240:243],a[152:155]
s_add_u32 m0,s79,66560
s_add_u32 s81,s75,35840
buffer_load_dwordx4 v3,s[8:11],s81 offen sc1 lds
v_mfma_f32_16x16x32_bf16 a[156:159],v[220:223],v[240:243],a[156:159]
v_mfma_f32_16x16x32_bf16 a[160:163],v[192:195],v[244:247],a[160:163]
ds_read_b64_tr_b16 v[176:177],v20 offset:0
v_mfma_f32_16x16x32_bf16 a[164:167],v[196:199],v[244:247],a[164:167]
v_mfma_f32_16x16x32_bf16 a[168:171],v[200:203],v[244:247],a[168:171]
ds_read_b64_tr_b16 v[178:179],v20 offset:1024
v_mfma_f32_16x16x32_bf16 a[172:175],v[204:207],v[244:247],a[172:175]
v_mfma_f32_16x16x32_bf16 a[176:179],v[208:211],v[244:247],a[176:179]
ds_read_b64_tr_b16 v[180:181],v21 offset:0
v_mfma_f32_16x16x32_bf16 a[180:183],v[212:215],v[244:247],a[180:183]
s_add_u32 m0,s79,67584
s_add_u32 s81,s75,54272
buffer_load_dwordx4 v3,s[8:11],s81 offen sc1 lds
v_mfma_f32_16x16x32_bf16 a[184:187],v[216:219],v[244:247],a[184:187]
ds_read_b64_tr_b16 v[182:183],v21 offset:1024
v_mfma_f32_16x16x32_bf16 a[188:191],v[220:223],v[244:247],a[188:191]
v_mfma_f32_16x16x32_bf16 a[192:195],v[192:195],v[248:251],a[192:195]
ds_read_b64_tr_b16 v[184:185],v22 offset:0
v_mfma_f32_16x16x32_bf16 a[196:199],v[196:199],v[248:251],a[196:199]
v_mfma_f32_16x16x32_bf16 a[200:203],v[200:203],v[248:251],a[200:203]
ds_read_b64_tr_b16 v[186:187],v22 offset:1024
v_mfma_f32_16x16x32_bf16 a[204:207],v[204:207],v[248:251],a[204:207]
v_mfma_f32_16x16x32_bf16 a[208:211],v[208:211],v[248:251],a[208:211]
s_add_u32 m0,s79,68608
s_add_u32 s81,s75,72704
buffer_load_dwordx4 v3,s[8:11],s81 offen sc1 lds
v_mfma_f32_16x16x32_bf16 a[212:215],v[212:215],v[248:251],a[212:215]
v_mfma_f32_16x16x32_bf16 a[216:219],v[216:219],v[248:251],a[216:219]
ds_read_b64_tr_b16 v[188:189],v23 offset:0
v_mfma_f32_16x16x32_bf16 a[220:223],v[220:223],v[248:251],a[220:223]
v_mfma_f32_16x16x32_bf16 a[224:227],v[192:195],v[252:255],a[224:227]
ds_read_b64_tr_b16 v[190:191],v23 offset:1024
v_mfma_f32_16x16x32_bf16 a[228:231],v[196:199],v[252:255],a[228:231]
v_mfma_f32_16x16x32_bf16 a[232:235],v[200:203],v[252:255],a[232:235]
v_mfma_f32_16x16x32_bf16 a[236:239],v[204:207],v[252:255],a[236:239]
v_mfma_f32_16x16x32_bf16 a[240:243],v[208:211],v[252:255],a[240:243]
v_mfma_f32_16x16x32_bf16 a[244:247],v[212:215],v[252:255],a[244:247]
v_mfma_f32_16x16x32_bf16 a[248:251],v[216:219],v[252:255],a[248:251]
v_mfma_f32_16x16x32_bf16 a[252:255],v[220:223],v[252:255],a[252:255]
s_waitcnt vmcnt(16) lgkmcnt(0)
s_barrier
v_mfma_f32_16x16x32_bf16 a[0:3],v[128:131],v[160:163],a[0:3]
v_add_u32 v8,0,v5
v_mfma_f32_16x16x32_bf16 a[4:7],v[132:135],v[160:163],a[4:7]
v_mfma_f32_16x16x32_bf16 a[8:11],v[136:139],v[160:163],a[8:11]
ds_read_b128 v[192:195],v8 offset:0
v_add_u32 v16,16384,v24
v_mfma_f32_16x16x32_bf16 a[12:15],v[140:143],v[160:163],a[12:15]
v_mfma_f32_16x16x32_bf16 a[16:19],v[144:147],v[160:163],a[16:19]
ds_read_b128 v[196:199],v8 offset:1024
v_add_u32 v17,16384,v25
v_mfma_f32_16x16x32_bf16 a[20:23],v[148:151],v[160:163],a[20:23]
v_mfma_f32_16x16x32_bf16 a[24:27],v[152:155],v[160:163],a[24:27]
ds_read_b128 v[200:203],v8 offset:2048
v_add_u32 v18,16384,v26
v_mfma_f32_16x16x32_bf16 a[28:31],v[156:159],v[160:163],a[28:31]
v_mfma_f32_16x16x32_bf16 a[32:35],v[128:131],v[164:167],a[32:35]
ds_read_b128 v[204:207],v8 offset:3072
v_add_u32 v19,16384,v27
v_mfma_f32_16x16x32_bf16 a[36:39],v[132:135],v[164:167],a[36:39]
v_mfma_f32_16x16x32_bf16 a[40:43],v[136:139],v[164:167],a[40:43]
ds_read_b128 v[208:211],v8 offset:4096
v_add_u32 v20,16384,v28
v_mfma_f32_16x16x32_bf16 a[44:47],v[140:143],v[164:167],a[44:47]
v_mfma_f32_16x16x32_bf16 a[48:51],v[144:147],v[164:167],a[48:51]
ds_read_b128 v[212:215],v8 offset:5120
v_add_u32 v21,16384,v29
v_mfma_f32_16x16x32_bf16 a[52:55],v[148:151],v[164:167],a[52:55]
v_mfma_f32_16x16x32_bf16 a[56:59],v[152:155],v[164:167],a[56:59]
ds_read_b128 v[216:219],v8 offset:6144
v_add_u32 v22,16384,v30
v_mfma_f32_16x16x32_bf16 a[60:63],v[156:159],v[164:167],a[60:63]
v_mfma_f32_16x16x32_bf16 a[64:67],v[128:131],v[168:171],a[64:67]
ds_read_b128 v[220:223],v8 offset:7168
v_add_u32 v23,16384,v31
v_mfma_f32_16x16x32_bf16 a[68:71],v[132:135],v[168:171],a[68:71]
v_mfma_f32_16x16x32_bf16 a[72:75],v[136:139],v[168:171],a[72:75]
ds_read_b64_tr_b16 v[224:225],v16 offset:0
v_mfma_f32_16x16x32_bf16 a[76:79],v[140:143],v[168:171],a[76:79]
v_mfma_f32_16x16x32_bf16 a[80:83],v[144:147],v[168:171],a[80:83]
ds_read_b64_tr_b16 v[226:227],v16 offset:1024
v_mfma_f32_16x16x32_bf16 a[84:87],v[148:151],v[168:171],a[84:87]
v_mfma_f32_16x16x32_bf16 a[88:91],v[152:155],v[168:171],a[88:91]
ds_read_b64_tr_b16 v[228:229],v17 offset:0
v_mfma_f32_16x16x32_bf16 a[92:95],v[156:159],v[168:171],a[92:95]
v_mfma_f32_16x16x32_bf16 a[96:99],v[128:131],v[172:175],a[96:99]
ds_read_b64_tr_b16 v[230:231],v17 offset:1024
v_mfma_f32_16x16x32_bf16 a[100:103],v[132:135],v[172:175],a[100:103]
v_mfma_f32_16x16x32_bf16 a[104:107],v[136:139],v[172:175],a[104:107]
ds_read_b64_tr_b16 v[232:233],v18 offset:0
v_mfma_f32_16x16x32_bf16 a[108:111],v[140:143],v[172:175],a[108:111]
v_mfma_f32_16x16x32_bf16 a[112:115],v[144:147],v[172:175],a[112:115]
ds_read_b64_tr_b16 v[234:235],v18 offset:1024
v_mfma_f32_16x16x32_bf16 a[116:119],v[148:151],v[172:175],a[116:119]
v_mfma_f32_16x16x32_bf16 a[120:123],v[152:155],v[172:175],a[120:123]
ds_read_b64_tr_b16 v[236:237],v19 offset:0
v_mfma_f32_16x16x32_bf16 a[124:127],v[156:159],v[172:175],a[124:127]
v_mfma_f32_16x16x32_bf16 a[128:131],v[128:131],v[176:179],a[128:131]
ds_read_b64_tr_b16 v[238:239],v19 offset:1024
v_mfma_f32_16x16x32_bf16 a[132:135],v[132:135],v[176:179],a[132:135]
v_mfma_f32_16x16x32_bf16 a[136:139],v[136:139],v[176:179],a[136:139]
ds_read_b64_tr_b16 v[240:241],v20 offset:0
v_mfma_f32_16x16x32_bf16 a[140:143],v[140:143],v[176:179],a[140:143]
v_mfma_f32_16x16x32_bf16 a[144:147],v[144:147],v[176:179],a[144:147]
ds_read_b64_tr_b16 v[242:243],v20 offset:1024
v_mfma_f32_16x16x32_bf16 a[148:151],v[148:151],v[176:179],a[148:151]
v_mfma_f32_16x16x32_bf16 a[152:155],v[152:155],v[176:179],a[152:155]
ds_read_b64_tr_b16 v[244:245],v21 offset:0
v_mfma_f32_16x16x32_bf16 a[156:159],v[156:159],v[176:179],a[156:159]
v_mfma_f32_16x16x32_bf16 a[160:163],v[128:131],v[180:183],a[160:163]
ds_read_b64_tr_b16 v[246:247],v21 offset:1024
v_mfma_f32_16x16x32_bf16 a[164:167],v[132:135],v[180:183],a[164:167]
v_mfma_f32_16x16x32_bf16 a[168:171],v[136:139],v[180:183],a[168:171]
ds_read_b64_tr_b16 v[248:249],v22 offset:0
v_mfma_f32_16x16x32_bf16 a[172:175],v[140:143],v[180:183],a[172:175]
v_mfma_f32_16x16x32_bf16 a[176:179],v[144:147],v[180:183],a[176:179]
ds_read_b64_tr_b16 v[250:251],v22 offset:1024
v_mfma_f32_16x16x32_bf16 a[180:183],v[148:151],v[180:183],a[180:183]
v_mfma_f32_16x16x32_bf16 a[184:187],v[152:155],v[180:183],a[184:187]
ds_read_b64_tr_b16 v[252:253],v23 offset:0
v_mfma_f32_16x16x32_bf16 a[188:191],v[156:159],v[180:183],a[188:191]
v_mfma_f32_16x16x32_bf16 a[192:195],v[128:131],v[184:187],a[192:195]
ds_read_b64_tr_b16 v[254:255],v23 offset:1024
v_mfma_f32_16x16x32_bf16 a[196:199],v[132:135],v[184:187],a[196:199]
v_mfma_f32_16x16x32_bf16 a[200:203],v[136:139],v[184:187],a[200:203]
v_mfma_f32_16x16x32_bf16 a[204:207],v[140:143],v[184:187],a[204:207]
v_mfma_f32_16x16x32_bf16 a[208:211],v[144:147],v[184:187],a[208:211]
v_mfma_f32_16x16x32_bf16 a[212:215],v[148:151],v[184:187],a[212:215]
v_mfma_f32_16x16x32_bf16 a[216:219],v[152:155],v[184:187],a[216:219]
v_mfma_f32_16x16x32_bf16 a[220:223],v[156:159],v[184:187],a[220:223]
v_mfma_f32_16x16x32_bf16 a[224:227],v[128:131],v[188:191],a[224:227]
v_mfma_f32_16x16x32_bf16 a[228:231],v[132:135],v[188:191],a[228:231]
v_mfma_f32_16x16x32_bf16 a[232:235],v[136:139],v[188:191],a[232:235]
v_mfma_f32_16x16x32_bf16 a[236:239],v[140:143],v[188:191],a[236:239]
v_mfma_f32_16x16x32_bf16 a[240:243],v[144:147],v[188:191],a[240:243]
v_mfma_f32_16x16x32_bf16 a[244:247],v[148:151],v[188:191],a[244:247]
v_mfma_f32_16x16x32_bf16 a[248:251],v[152:155],v[188:191],a[248:251]
v_mfma_f32_16x16x32_bf16 a[252:255],v[156:159],v[188:191],a[252:255]
s_waitcnt vmcnt(8) lgkmcnt(0)
s_barrier
v_mfma_f32_16x16x32_bf16 a[0:3],v[192:195],v[224:227],a[0:3]
v_add_u32 v8,32768,v5
v_mfma_f32_16x16x32_bf16 a[4:7],v[196:199],v[224:227],a[4:7]
v_mfma_f32_16x16x32_bf16 a[8:11],v[200:203],v[224:227],a[8:11]
ds_read_b128 v[128:131],v8 offset:0
v_add_u32 v16,49152,v24
v_mfma_f32_16x16x32_bf16 a[12:15],v[204:207],v[224:227],a[12:15]
v_mfma_f32_16x16x32_bf16 a[16:19],v[208:211],v[224:227],a[16:19]
ds_read_b128 v[132:135],v8 offset:1024
v_add_u32 v17,49152,v25
v_mfma_f32_16x16x32_bf16 a[20:23],v[212:215],v[224:227],a[20:23]
v_mfma_f32_16x16x32_bf16 a[24:27],v[216:219],v[224:227],a[24:27]
ds_read_b128 v[136:139],v8 offset:2048
v_add_u32 v18,49152,v26
v_mfma_f32_16x16x32_bf16 a[28:31],v[220:223],v[224:227],a[28:31]
v_mfma_f32_16x16x32_bf16 a[32:35],v[192:195],v[228:231],a[32:35]
ds_read_b128 v[140:143],v8 offset:3072
v_add_u32 v19,49152,v27
v_mfma_f32_16x16x32_bf16 a[36:39],v[196:199],v[228:231],a[36:39]
v_mfma_f32_16x16x32_bf16 a[40:43],v[200:203],v[228:231],a[40:43]
ds_read_b128 v[144:147],v8 offset:4096
v_add_u32 v20,49152,v28
v_mfma_f32_16x16x32_bf16 a[44:47],v[204:207],v[228:231],a[44:47]
v_mfma_f32_16x16x32_bf16 a[48:51],v[208:211],v[228:231],a[48:51]
ds_read_b128 v[148:151],v8 offset:5120
v_add_u32 v21,49152,v29
v_mfma_f32_16x16x32_bf16 a[52:55],v[212:215],v[228:231],a[52:55]
v_mfma_f32_16x16x32_bf16 a[56:59],v[216:219],v[228:231],a[56:59]
ds_read_b128 v[152:155],v8 offset:6144
v_add_u32 v22,49152,v30
v_mfma_f32_16x16x32_bf16 a[60:63],v[220:223],v[228:231],a[60:63]
v_mfma_f32_16x16x32_bf16 a[64:67],v[192:195],v[232:235],a[64:67]
ds_read_b128 v[156:159],v8 offset:7168
v_add_u32 v23,49152,v31
v_mfma_f32_16x16x32_bf16 a[68:71],v[196:199],v[232:235],a[68:71]
v_mfma_f32_16x16x32_bf16 a[72:75],v[200:203],v[232:235],a[72:75]
ds_read_b64_tr_b16 v[160:161],v16 offset:0
v_mfma_f32_16x16x32_bf16 a[76:79],v[204:207],v[232:235],a[76:79]
v_mfma_f32_16x16x32_bf16 a[80:83],v[208:211],v[232:235],a[80:83]
ds_read_b64_tr_b16 v[162:163],v16 offset:1024
v_mfma_f32_16x16x32_bf16 a[84:87],v[212:215],v[232:235],a[84:87]
v_mfma_f32_16x16x32_bf16 a[88:91],v[216:219],v[232:235],a[88:91]
ds_read_b64_tr_b16 v[164:165],v17 offset:0
v_mfma_f32_16x16x32_bf16 a[92:95],v[220:223],v[232:235],a[92:95]
v_mfma_f32_16x16x32_bf16 a[96:99],v[192:195],v[236:239],a[96:99]
ds_read_b64_tr_b16 v[166:167],v17 offset:1024
v_mfma_f32_16x16x32_bf16 a[100:103],v[196:199],v[236:239],a[100:103]
v_mfma_f32_16x16x32_bf16 a[104:107],v[200:203],v[236:239],a[104:107]
ds_read_b64_tr_b16 v[168:169],v18 offset:0
v_mfma_f32_16x16x32_bf16 a[108:111],v[204:207],v[236:239],a[108:111]
v_mfma_f32_16x16x32_bf16 a[112:115],v[208:211],v[236:239],a[112:115]
ds_read_b64_tr_b16 v[170:171],v18 offset:1024
v_mfma_f32_16x16x32_bf16 a[116:119],v[212:215],v[236:239],a[116:119]
v_mfma_f32_16x16x32_bf16 a[120:123],v[216:219],v[236:239],a[120:123]
ds_read_b64_tr_b16 v[172:173],v19 offset:0
v_mfma_f32_16x16x32_bf16 a[124:127],v[220:223],v[236:239],a[124:127]
v_mfma_f32_16x16x32_bf16 a[128:131],v[192:195],v[240:243],a[128:131]
ds_read_b64_tr_b16 v[174:175],v19 offset:1024
v_mfma_f32_16x16x32_bf16 a[132:135],v[196:199],v[240:243],a[132:135]
v_mfma_f32_16x16x32_bf16 a[136:139],v[200:203],v[240:243],a[136:139]
ds_read_b64_tr_b16 v[176:177],v20 offset:0
v_mfma_f32_16x16x32_bf16 a[140:143],v[204:207],v[240:243],a[140:143]
v_mfma_f32_16x16x32_bf16 a[144:147],v[208:211],v[240:243],a[144:147]
ds_read_b64_tr_b16 v[178:179],v20 offset:1024
v_mfma_f32_16x16x32_bf16 a[148:151],v[212:215],v[240:243],a[148:151]
v_mfma_f32_16x16x32_bf16 a[152:155],v[216:219],v[240:243],a[152:155]
ds_read_b64_tr_b16 v[180:181],v21 offset:0
v_mfma_f32_16x16x32_bf16 a[156:159],v[220:223],v[240:243],a[156:159]
v_mfma_f32_16x16x32_bf16 a[160:163],v[192:195],v[244:247],a[160:163]
ds_read_b64_tr_b16 v[182:183],v21 offset:1024
v_mfma_f32_16x16x32_bf16 a[164:167],v[196:199],v[244:247],a[164:167]
v_mfma_f32_16x16x32_bf16 a[168:171],v[200:203],v[244:247],a[168:171]
ds_read_b64_tr_b16 v[184:185],v22 offset:0
v_mfma_f32_16x16x32_bf16 a[172:175],v[204:207],v[244:247],a[172:175]
v_mfma_f32_16x16x32_bf16 a[176:179],v[208:211],v[244:247],a[176:179]
ds_read_b64_tr_b16 v[186:187],v22 offset:1024
v_mfma_f32_16x16x32_bf16 a[180:183],v[212:215],v[244:247],a[180:183]
v_mfma_f32_16x16x32_bf16 a[184:187],v[216:219],v[244:247],a[184:187]
ds_read_b64_tr_b16 v[188:189],v23 offset:0
v_mfma_f32_16x16x32_bf16 a[188:191],v[220:223],v[244:247],a[188:191]
v_mfma_f32_16x16x32_bf16 a[192:195],v[192:195],v[248:251],a[192:195]
ds_read_b64_tr_b16 v[190:191],v23 offset:1024
v_mfma_f32_16x16x32_bf16 a[196:199],v[196:199],v[248:251],a[196:199]
v_mfma_f32_16x16x32_bf16 a[200:203],v[200:203],v[248:251],a[200:203]
s_mov_b64 exec,s[64:65]
ds_write_b32 v11,v9
s_mov_b64 exec,-1
v_mfma_f32_16x16x32_bf16 a[204:207],v[204:207],v[248:251],a[204:207]
v_mfma_f32_16x16x32_bf16 a[208:211],v[208:211],v[248:251],a[208:211]
v_mfma_f32_16x16x32_bf16 a[212:215],v[212:215],v[248:251],a[212:215]
v_mfma_f32_16x16x32_bf16 a[216:219],v[216:219],v[248:251],a[216:219]
v_mfma_f32_16x16x32_bf16 a[220:223],v[220:223],v[248:251],a[220:223]
v_mfma_f32_16x16x32_bf16 a[224:227],v[192:195],v[252:255],a[224:227]
v_mfma_f32_16x16x32_bf16 a[228:231],v[196:199],v[252:255],a[228:231]
v_mfma_f32_16x16x32_bf16 a[232:235],v[200:203],v[252:255],a[232:235]
v_mfma_f32_16x16x32_bf16 a[236:239],v[204:207],v[252:255],a[236:239]
v_mfma_f32_16x16x32_bf16 a[240:243],v[208:211],v[252:255],a[240:243]
v_mfma_f32_16x16x32_bf16 a[244:247],v[212:215],v[252:255],a[244:247]
v_mfma_f32_16x16x32_bf16 a[248:251],v[216:219],v[252:255],a[248:251]
v_mfma_f32_16x16x32_bf16 a[252:255],v[220:223],v[252:255],a[252:255]
s_waitcnt vmcnt(0) lgkmcnt(0)
s_barrier
v_mfma_f32_16x16x32_bf16 a[0:3],v[128:131],v[160:163],a[0:3]
v_add_u32 v8,65536,v5
v_mfma_f32_16x16x32_bf16 a[4:7],v[132:135],v[160:163],a[4:7]
v_mfma_f32_16x16x32_bf16 a[8:11],v[136:139],v[160:163],a[8:11]
ds_read_b128 v[192:195],v8 offset:0
v_add_u32 v16,81920,v24
v_mfma_f32_16x16x32_bf16 a[12:15],v[140:143],v[160:163],a[12:15]
v_mfma_f32_16x16x32_bf16 a[16:19],v[144:147],v[160:163],a[16:19]
ds_read_b128 v[196:199],v8 offset:1024
v_add_u32 v17,81920,v25
v_mfma_f32_16x16x32_bf16 a[20:23],v[148:151],v[160:163],a[20:23]
v_mfma_f32_16x16x32_bf16 a[24:27],v[152:155],v[160:163],a[24:27]
ds_read_b128 v[200:203],v8 offset:2048
v_add_u32 v18,81920,v26
v_mfma_f32_16x16x32_bf16 a[28:31],v[156:159],v[160:163],a[28:31]
v_mfma_f32_16x16x32_bf16 a[32:35],v[128:131],v[164:167],a[32:35]
ds_read_b128 v[204:207],v8 offset:3072
v_add_u32 v19,81920,v27
v_mfma_f32_16x16x32_bf16 a[36:39],v[132:135],v[164:167],a[36:39]
v_mfma_f32_16x16x32_bf16 a[40:43],v[136:139],v[164:167],a[40:43]
ds_read_b128 v[208:211],v8 offset:4096
v_add_u32 v20,81920,v28
v_mfma_f32_16x16x32_bf16 a[44:47],v[140:143],v[164:167],a[44:47]
v_mfma_f32_16x16x32_bf16 a[48:51],v[144:147],v[164:167],a[48:51]
ds_read_b128 v[212:215],v8 offset:5120
v_add_u32 v21,81920,v29
v_mfma_f32_16x16x32_bf16 a[52:55],v[148:151],v[164:167],a[52:55]
v_mfma_f32_16x16x32_bf16 a[56:59],v[152:155],v[164:167],a[56:59]
ds_read_b128 v[216:219],v8 offset:6144
v_add_u32 v22,81920,v30
v_mfma_f32_16x16x32_bf16 a[60:63],v[156:159],v[164:167],a[60:63]
v_mfma_f32_16x16x32_bf16 a[64:67],v[128:131],v[168:171],a[64:67]
ds_read_b128 v[220:223],v8 offset:7168
v_add_u32 v23,81920,v31
v_mfma_f32_16x16x32_bf16 a[68:71],v[132:135],v[168:171],a[68:71]
v_mfma_f32_16x16x32_bf16 a[72:75],v[136:139],v[168:171],a[72:75]
ds_read_b64_tr_b16 v[224:225],v16 offset:0
v_mfma_f32_16x16x32_bf16 a[76:79],v[140:143],v[168:171],a[76:79]
v_mfma_f32_16x16x32_bf16 a[80:83],v[144:147],v[168:171],a[80:83]
ds_read_b64_tr_b16 v[226:227],v16 offset:1024
v_mfma_f32_16x16x32_bf16 a[84:87],v[148:151],v[168:171],a[84:87]
v_mfma_f32_16x16x32_bf16 a[88:91],v[152:155],v[168:171],a[88:91]
ds_read_b64_tr_b16 v[228:229],v17 offset:0
v_mfma_f32_16x16x32_bf16 a[92:95],v[156:159],v[168:171],a[92:95]
v_mfma_f32_16x16x32_bf16 a[96:99],v[128:131],v[172:175],a[96:99]
ds_read_b64_tr_b16 v[230:231],v17 offset:1024
v_mfma_f32_16x16x32_bf16 a[100:103],v[132:135],v[172:175],a[100:103]
v_mfma_f32_16x16x32_bf16 a[104:107],v[136:139],v[172:175],a[104:107]
ds_read_b64_tr_b16 v[232:233],v18 offset:0
v_mfma_f32_16x16x32_bf16 a[108:111],v[140:143],v[172:175],a[108:111]
v_mfma_f32_16x16x32_bf16 a[112:115],v[144:147],v[172:175],a[112:115]
ds_read_b64_tr_b16 v[234:235],v18 offset:1024
v_mfma_f32_16x16x32_bf16 a[116:119],v[148:151],v[172:175],a[116:119]
v_mfma_f32_16x16x32_bf16 a[120:123],v[152:155],v[172:175],a[120:123]
ds_read_b64_tr_b16 v[236:237],v19 offset:0
v_mfma_f32_16x16x32_bf16 a[124:127],v[156:159],v[172:175],a[124:127]
v_mfma_f32_16x16x32_bf16 a[128:131],v[128:131],v[176:179],a[128:131]
ds_read_b64_tr_b16 v[238:239],v19 offset:1024
v_mfma_f32_16x16x32_bf16 a[132:135],v[132:135],v[176:179],a[132:135]
v_mfma_f32_16x16x32_bf16 a[136:139],v[136:139],v[176:179],a[136:139]
ds_read_b64_tr_b16 v[240:241],v20 offset:0
v_mfma_f32_16x16x32_bf16 a[140:143],v[140:143],v[176:179],a[140:143]
v_mfma_f32_16x16x32_bf16 a[144:147],v[144:147],v[176:179],a[144:147]
ds_read_b64_tr_b16 v[242:243],v20 offset:1024
v_mfma_f32_16x16x32_bf16 a[148:151],v[148:151],v[176:179],a[148:151]
v_mfma_f32_16x16x32_bf16 a[152:155],v[152:155],v[176:179],a[152:155]
ds_read_b64_tr_b16 v[244:245],v21 offset:0
v_mfma_f32_16x16x32_bf16 a[156:159],v[156:159],v[176:179],a[156:159]
v_mfma_f32_16x16x32_bf16 a[160:163],v[128:131],v[180:183],a[160:163]
ds_read_b64_tr_b16 v[246:247],v21 offset:1024
v_mfma_f32_16x16x32_bf16 a[164:167],v[132:135],v[180:183],a[164:167]
v_mfma_f32_16x16x32_bf16 a[168:171],v[136:139],v[180:183],a[168:171]
ds_read_b64_tr_b16 v[248:249],v22 offset:0
v_mfma_f32_16x16x32_bf16 a[172:175],v[140:143],v[180:183],a[172:175]
v_mfma_f32_16x16x32_bf16 a[176:179],v[144:147],v[180:183],a[176:179]
ds_read_b64_tr_b16 v[250:251],v22 offset:1024
v_mfma_f32_16x16x32_bf16 a[180:183],v[148:151],v[180:183],a[180:183]
v_mfma_f32_16x16x32_bf16 a[184:187],v[152:155],v[180:183],a[184:187]
ds_read_b64_tr_b16 v[252:253],v23 offset:0
v_mfma_f32_16x16x32_bf16 a[188:191],v[156:159],v[180:183],a[188:191]
v_mfma_f32_16x16x32_bf16 a[192:195],v[128:131],v[184:187],a[192:195]
ds_read_b64_tr_b16 v[254:255],v23 offset:1024
v_mfma_f32_16x16x32_bf16 a[196:199],v[132:135],v[184:187],a[196:199]
v_mfma_f32_16x16x32_bf16 a[200:203],v[136:139],v[184:187],a[200:203]
ds_read_b32 v9,v11
v_mfma_f32_16x16x32_bf16 a[204:207],v[140:143],v[184:187],a[204:207]
v_mfma_f32_16x16x32_bf16 a[208:211],v[144:147],v[184:187],a[208:211]
v_mfma_f32_16x16x32_bf16 a[212:215],v[148:151],v[184:187],a[212:215]
v_mfma_f32_16x16x32_bf16 a[216:219],v[152:155],v[184:187],a[216:219]
v_mfma_f32_16x16x32_bf16 a[220:223],v[156:159],v[184:187],a[220:223]
v_mfma_f32_16x16x32_bf16 a[224:227],v[128:131],v[188:191],a[224:227]
v_mfma_f32_16x16x32_bf16 a[228:231],v[132:135],v[188:191],a[228:231]
v_mfma_f32_16x16x32_bf16 a[232:235],v[136:139],v[188:191],a[232:235]
v_mfma_f32_16x16x32_bf16 a[236:239],v[140:143],v[188:191],a[236:239]
v_mfma_f32_16x16x32_bf16 a[240:243],v[144:147],v[188:191],a[240:243]
v_mfma_f32_16x16x32_bf16 a[244:247],v[148:151],v[188:191],a[244:247]
v_mfma_f32_16x16x32_bf16 a[248:251],v[152:155],v[188:191],a[248:251]
v_mfma_f32_16x16x32_bf16 a[252:255],v[156:159],v[188:191],a[252:255]
s_waitcnt lgkmcnt(0)
v_mfma_f32_16x16x32_bf16 a[0:3],v[192:195],v[224:227],a[0:3]
v_mfma_f32_16x16x32_bf16 a[4:7],v[196:199],v[224:227],a[4:7]
v_mfma_f32_16x16x32_bf16 a[8:11],v[200:203],v[224:227],a[8:11]
v_mfma_f32_16x16x32_bf16 a[12:15],v[204:207],v[224:227],a[12:15]
v_mfma_f32_16x16x32_bf16 a[16:19],v[208:211],v[224:227],a[16:19]
v_mfma_f32_16x16x32_bf16 a[20:23],v[212:215],v[224:227],a[20:23]
v_mfma_f32_16x16x32_bf16 a[24:27],v[216:219],v[224:227],a[24:27]
v_mfma_f32_16x16x32_bf16 a[28:31],v[220:223],v[224:227],a[28:31]
v_mfma_f32_16x16x32_bf16 a[32:35],v[192:195],v[228:231],a[32:35]
v_mfma_f32_16x16x32_bf16 a[36:39],v[196:199],v[228:231],a[36:39]
v_mfma_f32_16x16x32_bf16 a[40:43],v[200:203],v[228:231],a[40:43]
v_mfma_f32_16x16x32_bf16 a[44:47],v[204:207],v[228:231],a[44:47]
v_mfma_f32_16x16x32_bf16 a[48:51],v[208:211],v[228:231],a[48:51]
v_mfma_f32_16x16x32_bf16 a[52:55],v[212:215],v[228:231],a[52:55]
v_mfma_f32_16x16x32_bf16 a[56:59],v[216:219],v[228:231],a[56:59]
v_mfma_f32_16x16x32_bf16 a[60:63],v[220:223],v[228:231],a[60:63]
v_mfma_f32_16x16x32_bf16 a[64:67],v[192:195],v[232:235],a[64:67]
v_mfma_f32_16x16x32_bf16 a[68:71],v[196:199],v[232:235],a[68:71]
v_mfma_f32_16x16x32_bf16 a[72:75],v[200:203],v[232:235],a[72:75]
v_mfma_f32_16x16x32_bf16 a[76:79],v[204:207],v[232:235],a[76:79]
v_mfma_f32_16x16x32_bf16 a[80:83],v[208:211],v[232:235],a[80:83]
v_mfma_f32_16x16x32_bf16 a[84:87],v[212:215],v[232:235],a[84:87]
v_mfma_f32_16x16x32_bf16 a[88:91],v[216:219],v[232:235],a[88:91]
v_mfma_f32_16x16x32_bf16 a[92:95],v[220:223],v[232:235],a[92:95]
v_mfma_f32_16x16x32_bf16 a[96:99],v[192:195],v[236:239],a[96:99]
v_mfma_f32_16x16x32_bf16 a[100:103],v[196:199],v[236:239],a[100:103]
v_mfma_f32_16x16x32_bf16 a[104:107],v[200:203],v[236:239],a[104:107]
v_mfma_f32_16x16x32_bf16 a[108:111],v[204:207],v[236:239],a[108:111]
v_mfma_f32_16x16x32_bf16 a[112:115],v[208:211],v[236:239],a[112:115]
v_mfma_f32_16x16x32_bf16 a[116:119],v[212:215],v[236:239],a[116:119]
v_mfma_f32_16x16x32_bf16 a[120:123],v[216:219],v[236:239],a[120:123]
v_mfma_f32_16x16x32_bf16 a[124:127],v[220:223],v[236:239],a[124:127]
v_mfma_f32_16x16x32_bf16 a[128:131],v[192:195],v[240:243],a[128:131]
v_mfma_f32_16x16x32_bf16 a[132:135],v[196:199],v[240:243],a[132:135]
v_mfma_f32_16x16x32_bf16 a[136:139],v[200:203],v[240:243],a[136:139]
v_mfma_f32_16x16x32_bf16 a[140:143],v[204:207],v[240:243],a[140:143]
v_mfma_f32_16x16x32_bf16 a[144:147],v[208:211],v[240:243],a[144:147]
v_mfma_f32_16x16x32_bf16 a[148:151],v[212:215],v[240:243],a[148:151]
v_mfma_f32_16x16x32_bf16 a[152:155],v[216:219],v[240:243],a[152:155]
v_mfma_f32_16x16x32_bf16 a[156:159],v[220:223],v[240:243],a[156:159]
v_mfma_f32_16x16x32_bf16 a[160:163],v[192:195],v[244:247],a[160:163]
v_mfma_f32_16x16x32_bf16 a[164:167],v[196:199],v[244:247],a[164:167]
v_mfma_f32_16x16x32_bf16 a[168:171],v[200:203],v[244:247],a[168:171]
v_mfma_f32_16x16x32_bf16 a[172:175],v[204:207],v[244:247],a[172:175]
v_mfma_f32_16x16x32_bf16 a[176:179],v[208:211],v[244:247],a[176:179]
v_mfma_f32_16x16x32_bf16 a[180:183],v[212:215],v[244:247],a[180:183]
v_mfma_f32_16x16x32_bf16 a[184:187],v[216:219],v[244:247],a[184:187]
v_mfma_f32_16x16x32_bf16 a[188:191],v[220:223],v[244:247],a[188:191]
v_mfma_f32_16x16x32_bf16 a[192:195],v[192:195],v[248:251],a[192:195]
v_mfma_f32_16x16x32_bf16 a[196:199],v[196:199],v[248:251],a[196:199]
v_mfma_f32_16x16x32_bf16 a[200:203],v[200:203],v[248:251],a[200:203]
v_mfma_f32_16x16x32_bf16 a[204:207],v[204:207],v[248:251],a[204:207]
v_mfma_f32_16x16x32_bf16 a[208:211],v[208:211],v[248:251],a[208:211]
v_mfma_f32_16x16x32_bf16 a[212:215],v[212:215],v[248:251],a[212:215]
v_mfma_f32_16x16x32_bf16 a[216:219],v[216:219],v[248:251],a[216:219]
v_mfma_f32_16x16x32_bf16 a[220:223],v[220:223],v[248:251],a[220:223]
v_mfma_f32_16x16x32_bf16 a[224:227],v[192:195],v[252:255],a[224:227]
v_mfma_f32_16x16x32_bf16 a[228:231],v[196:199],v[252:255],a[228:231]
v_mfma_f32_16x16x32_bf16 a[232:235],v[200:203],v[252:255],a[232:235]
v_mfma_f32_16x16x32_bf16 a[236:239],v[204:207],v[252:255],a[236:239]
v_mfma_f32_16x16x32_bf16 a[240:243],v[208:211],v[252:255],a[240:243]
v_mfma_f32_16x16x32_bf16 a[244:247],v[212:215],v[252:255],a[244:247]
v_mfma_f32_16x16x32_bf16 a[248:251],v[216:219],v[252:255],a[248:251]
v_mfma_f32_16x16x32_bf16 a[252:255],v[220:223],v[252:255],a[252:255]
Lg1_next:
v_readfirstlane_b32 s96,v9
s_barrier
s_cmp_lt_u32 s84,4
s_cselect_b32 s65,5,4
s_cmp_lt_u32 s96,s65
s_cselect_b32 s61,0,2
s_cselect_b32 s67,0,s65
s_sub_u32 s96,s96,s67
s_cmp_lt_u32 s96,s67
s_cselect_b32 s61,1,s61
s_cmp_lt_u32 s96,96
s_cbranch_scc0 Lg1_epi
s_mov_b32 s66,s96
s_mul_hi_u32 s72,s66,357913942
s_mul_i32 s65,s72,12
s_sub_u32 s65,s66,s65
s_mul_i32 s65,s65,7
s_add_u32 s65,s65,s84
s_lshr_b32 s66,s60,1
s_and_b32 s67,s60,1
s_cmp_ge_u32 s65,48
s_cbranch_scc1 Lg1_gu_b
s_mov_b32 s77,8192
s_cmp_ge_u32 s65,32
s_cbranch_scc1 Lg1_q_b
s_and_b32 s74,s65,1
s_lshr_b32 s68,s65,1
s_cmp_eq_u32 s74,0
s_cselect_b32 s56,s16,s20
s_cselect_b32 s57,s17,s21
s_add_u32 s78,s74,1
s_lshl_b32 s78,s78,24
s_mov_b32 s82,5248
s_branch Lg1_kvq_b
Lg1_q_b:
s_mov_b32 s74,2
s_sub_u32 s68,s65,32
s_mov_b32 s56,s12
s_mov_b32 s57,s13
s_mov_b32 s78,50331648
s_mov_b32 s82,6272
Lg1_kvq_b:
s_mov_b32 s58,4718592
s_lshl_b32 s76,s68,9
s_lshl_b32 s69,s66,8
s_add_u32 s76,s76,s69
s_lshl_b32 s69,s68,1
s_add_u32 s69,s69,s67
s_lshl_b32 s69,s69,13
s_add_u32 s78,s78,s69
s_lshl_b32 s69,s72,1
s_add_u32 s69,s69,s66
s_lshl_b32 s69,s69,20
s_add_u32 s78,s78,s69
s_lshl_b32 s69,s67,13
s_add_u32 s70,s69,128
s_branch Lg1_dec_b
Lg1_gu_b:
s_mov_b32 s74,3
s_mov_b32 s77,9216
s_sub_u32 s68,s65,48
s_cmp_eq_u32 s66,0
s_cselect_b32 s56,s40,s44
s_cselect_b32 s57,s41,s45
s_mov_b32 s58,5308416
s_lshl_b32 s76,s68,8
s_mov_b32 s82,7296
s_lshl_b32 s69,s72,1
s_add_u32 s69,s69,s66
s_mul_i32 s78,s69,1179648
s_lshl_b32 s69,s68,1
s_add_u32 s69,s69,s67
s_lshl_b32 s69,s69,11
s_add_u32 s78,s78,s69
s_add_u32 s78,s78,83886080
s_lshl_b32 s69,s67,7
s_add_u32 s70,s69,8192
Lg1_dec_b:
s_mov_b32 s59,0x20000
s_lshl_b32 s81,s72,7
s_add_u32 s82,s82,s81
v_and_b32 v11,63,v0
v_lshrrev_b32 v12,4,v11
s_lshl_b32 s81,s67,2
v_or_b32 v13,s81,v12
v_lshlrev_b32 v13,1,v13
v_and_b32 v14,15,v11
v_xor_b32 v13,v13,v14
s_lshl_b32 s81,s67,3
v_add_u32 v12,s81,v12
v_mul_lo_u32 v12,v12,s77
v_lshl_add_u32 v4,v13,4,v12
v_xor_b32 v6,s69,v10
v_xor_b32 v7,s70,v10
s_lshl_b32 s75,s72,4
s_lshl_b32 s81,s60,2
s_add_u32 s75,s75,s81
s_mul_i32 s75,s75,18432
s_add_u32 s75,s75,1048576
s_lshl_b32 s68,s77,2
s_lshl_b32 s69,s77,4
s_lshl_b32 s70,s77,5
s_bitcmp1_b32 s85,s72
s_cbranch_scc1 Lg1_lnok_b
s_add_u32 m0,s80,0
s_mov_b32 s81,s76
buffer_load_dwordx4 v4,s[56:59],s81 offen lds
s_add_u32 m0,s80,1024
s_add_u32 s81,s76,s68
buffer_load_dwordx4 v4,s[56:59],s81 offen lds
s_add_u32 m0,s80,4096
s_add_u32 s81,s76,s69
buffer_load_dwordx4 v4,s[56:59],s81 offen lds
s_add_u32 m0,s80,5120
s_add_u32 s81,s81,s68
buffer_load_dwordx4 v4,s[56:59],s81 offen lds
s_add_u32 s76,s76,s70
s_add_u32 m0,s80,32768
s_mov_b32 s81,s76
buffer_load_dwordx4 v4,s[56:59],s81 offen lds
s_add_u32 m0,s80,33792
s_add_u32 s81,s76,s68
buffer_load_dwordx4 v4,s[56:59],s81 offen lds
s_add_u32 m0,s80,36864
s_add_u32 s81,s76,s69
buffer_load_dwordx4 v4,s[56:59],s81 offen lds
s_add_u32 m0,s80,37888
s_add_u32 s81,s81,s68
buffer_load_dwordx4 v4,s[56:59],s81 offen lds
s_add_u32 s76,s76,s70
s_add_u32 m0,s80,65536
s_mov_b32 s81,s76
buffer_load_dwordx4 v4,s[56:59],s81 offen lds
s_add_u32 m0,s80,66560
s_add_u32 s81,s76,s68
buffer_load_dwordx4 v4,s[56:59],s81 offen lds
s_add_u32 m0,s80,69632
s_add_u32 s81,s76,s69
buffer_load_dwordx4 v4,s[56:59],s81 offen lds
s_add_u32 m0,s80,70656
s_add_u32 s81,s81,s68
buffer_load_dwordx4 v4,s[56:59],s81 offen lds
s_add_u32 s76,s76,s70
s_add_u32 m0,s80,98304
s_mov_b32 s81,s76
buffer_load_dwordx4 v4,s[56:59],s81 offen lds
s_add_u32 m0,s80,99328
s_add_u32 s81,s76,s68
buffer_load_dwordx4 v4,s[56:59],s81 offen lds
s_add_u32 m0,s80,102400
s_add_u32 s81,s76,s69
buffer_load_dwordx4 v4,s[56:59],s81 offen lds
s_add_u32 m0,s80,103424
s_add_u32 s81,s81,s68
buffer_load_dwordx4 v4,s[56:59],s81 offen lds
s_add_u32 s76,s76,s70
s_lshl_b32 s81,s72,7
s_add_u32 s67,s81,4096
s_cmp_lg_u32 s60,0
s_cbranch_scc1 Lwd_lnb
s_mov_b32 s71,0x800000
v_mov_b32 v2,0
s_mov_b64 exec,1
Lw_lnb:
buffer_load_dword v1,v2,s[8:11],s67 offen sc1
s_sub_u32 s71,s71,1
s_cbranch_scc1 Lwe_lnb
s_waitcnt vmcnt(0)
v_cmp_gt_u32 vcc,16,v1
s_cbranch_vccz Lwe_lnb
s_sleep 1
s_branch Lw_lnb
Lwe_lnb:
s_waitcnt vmcnt(0)
s_mov_b64 exec,-1
Lwd_lnb:
s_barrier
s_bitset1_b32 s85,s72
s_add_u32 m0,s79,0
s_add_u32 s81,s75,0
buffer_load_dwordx4 v3,s[8:11],s81 offen sc1 lds
s_add_u32 m0,s79,1024
s_add_u32 s81,s75,18432
buffer_load_dwordx4 v3,s[8:11],s81 offen sc1 lds
s_add_u32 m0,s79,2048
s_add_u32 s81,s75,36864
buffer_load_dwordx4 v3,s[8:11],s81 offen sc1 lds
s_add_u32 m0,s79,3072
s_add_u32 s81,s75,55296
buffer_load_dwordx4 v3,s[8:11],s81 offen sc1 lds
s_add_u32 m0,s79,32768
s_add_u32 s81,s75,1024
buffer_load_dwordx4 v3,s[8:11],s81 offen sc1 lds
s_add_u32 m0,s79,33792
s_add_u32 s81,s75,19456
buffer_load_dwordx4 v3,s[8:11],s81 offen sc1 lds
s_add_u32 m0,s79,34816
s_add_u32 s81,s75,37888
buffer_load_dwordx4 v3,s[8:11],s81 offen sc1 lds
s_add_u32 m0,s79,35840
s_add_u32 s81,s75,56320
buffer_load_dwordx4 v3,s[8:11],s81 offen sc1 lds
s_add_u32 m0,s79,65536
s_add_u32 s81,s75,2048
buffer_load_dwordx4 v3,s[8:11],s81 offen sc1 lds
s_add_u32 m0,s79,66560
s_add_u32 s81,s75,20480
buffer_load_dwordx4 v3,s[8:11],s81 offen sc1 lds
s_add_u32 m0,s79,67584
s_add_u32 s81,s75,38912
buffer_load_dwordx4 v3,s[8:11],s81 offen sc1 lds
s_add_u32 m0,s79,68608
s_add_u32 s81,s75,57344
buffer_load_dwordx4 v3,s[8:11],s81 offen sc1 lds
s_add_u32 m0,s79,98304
s_add_u32 s81,s75,3072
buffer_load_dwordx4 v3,s[8:11],s81 offen sc1 lds
s_add_u32 m0,s79,99328
s_add_u32 s81,s75,21504
buffer_load_dwordx4 v3,s[8:11],s81 offen sc1 lds
s_add_u32 m0,s79,100352
s_add_u32 s81,s75,39936
buffer_load_dwordx4 v3,s[8:11],s81 offen sc1 lds
s_add_u32 m0,s79,101376
s_add_u32 s81,s75,58368
buffer_load_dwordx4 v3,s[8:11],s81 offen sc1 lds
s_waitcnt vmcnt(0)
s_branch Lg1_started_b
Lg1_lnok_b:
s_add_u32 m0,s80,0
s_mov_b32 s81,s76
buffer_load_dwordx4 v4,s[56:59],s81 offen lds
s_add_u32 m0,s80,1024
s_add_u32 s81,s76,s68
buffer_load_dwordx4 v4,s[56:59],s81 offen lds
s_add_u32 m0,s80,4096
s_add_u32 s81,s76,s69
buffer_load_dwordx4 v4,s[56:59],s81 offen lds
s_add_u32 m0,s80,5120
s_add_u32 s81,s81,s68
buffer_load_dwordx4 v4,s[56:59],s81 offen lds
s_add_u32 s76,s76,s70
s_add_u32 m0,s79,0
s_add_u32 s81,s75,0
buffer_load_dwordx4 v3,s[8:11],s81 offen sc1 lds
s_add_u32 m0,s79,1024
s_add_u32 s81,s75,18432
buffer_load_dwordx4 v3,s[8:11],s81 offen sc1 lds
s_add_u32 m0,s79,2048
s_add_u32 s81,s75,36864
buffer_load_dwordx4 v3,s[8:11],s81 offen sc1 lds
s_add_u32 m0,s79,3072
s_add_u32 s81,s75,55296
buffer_load_dwordx4 v3,s[8:11],s81 offen sc1 lds
s_add_u32 m0,s80,32768
s_mov_b32 s81,s76
buffer_load_dwordx4 v4,s[56:59],s81 offen lds
s_add_u32 m0,s80,33792
s_add_u32 s81,s76,s68
buffer_load_dwordx4 v4,s[56:59],s81 offen lds
s_add_u32 m0,s80,36864
s_add_u32 s81,s76,s69
buffer_load_dwordx4 v4,s[56:59],s81 offen lds
s_add_u32 m0,s80,37888
s_add_u32 s81,s81,s68
buffer_load_dwordx4 v4,s[56:59],s81 offen lds
s_add_u32 s76,s76,s70
s_add_u32 m0,s79,32768
s_add_u32 s81,s75,1024
buffer_load_dwordx4 v3,s[8:11],s81 offen sc1 lds
s_add_u32 m0,s79,33792
s_add_u32 s81,s75,19456
buffer_load_dwordx4 v3,s[8:11],s81 offen sc1 lds
s_add_u32 m0,s79,34816
s_add_u32 s81,s75,37888
buffer_load_dwordx4 v3,s[8:11],s81 offen sc1 lds
s_add_u32 m0,s79,35840
s_add_u32 s81,s75,56320
buffer_load_dwordx4 v3,s[8:11],s81 offen sc1 lds
s_add_u32 m0,s80,65536
s_mov_b32 s81,s76
buffer_load_dwordx4 v4,s[56:59],s81 offen lds
s_add_u32 m0,s80,66560
s_add_u32 s81,s76,s68
buffer_load_dwordx4 v4,s[56:59],s81 offen lds
s_add_u32 m0,s80,69632
s_add_u32 s81,s76,s69
buffer_load_dwordx4 v4,s[56:59],s81 offen lds
s_add_u32 m0,s80,70656
s_add_u32 s81,s81,s68
buffer_load_dwordx4 v4,s[56:59],s81 offen lds
s_add_u32 s76,s76,s70
s_add_u32 m0,s79,65536
s_add_u32 s81,s75,2048
buffer_load_dwordx4 v3,s[8:11],s81 offen sc1 lds
s_add_u32 m0,s79,66560
s_add_u32 s81,s75,20480
buffer_load_dwordx4 v3,s[8:11],s81 offen sc1 lds
s_add_u32 m0,s79,67584
s_add_u32 s81,s75,38912
buffer_load_dwordx4 v3,s[8:11],s81 offen sc1 lds
s_add_u32 m0,s79,68608
s_add_u32 s81,s75,57344
buffer_load_dwordx4 v3,s[8:11],s81 offen sc1 lds
s_add_u32 m0,s80,98304
s_mov_b32 s81,s76
buffer_load_dwordx4 v4,s[56:59],s81 offen lds
s_add_u32 m0,s80,99328
s_add_u32 s81,s76,s68
buffer_load_dwordx4 v4,s[56:59],s81 offen lds
s_add_u32 m0,s80,102400
s_add_u32 s81,s76,s69
buffer_load_dwordx4 v4,s[56:59],s81 offen lds
s_add_u32 m0,s80,103424
s_add_u32 s81,s81,s68
buffer_load_dwordx4 v4,s[56:59],s81 offen lds
s_add_u32 s76,s76,s70
s_add_u32 m0,s79,98304
s_add_u32 s81,s75,3072
buffer_load_dwordx4 v3,s[8:11],s81 offen sc1 lds
s_add_u32 m0,s79,99328
s_add_u32 s81,s75,21504
buffer_load_dwordx4 v3,s[8:11],s81 offen sc1 lds
s_add_u32 m0,s79,100352
s_add_u32 s81,s75,39936
buffer_load_dwordx4 v3,s[8:11],s81 offen sc1 lds
s_add_u32 m0,s79,101376
s_add_u32 s81,s75,58368
buffer_load_dwordx4 v3,s[8:11],s81 offen sc1 lds
Lg1_started_b:
v_xor_b32 v24,0,v6
v_xor_b32 v25,32,v6
v_xor_b32 v26,64,v6
v_xor_b32 v27,96,v6
v_xor_b32 v28,0,v7
v_xor_b32 v29,32,v7
v_xor_b32 v30,64,v7
v_xor_b32 v31,96,v7
Lg1_epi:
s_cmp_eq_u32 s73,1
s_cbranch_scc1 Lg1_ev
s_cmp_eq_u32 s73,3
s_cbranch_scc1 Lg1_egu
v_accvgpr_read_b32 v32,a0
v_accvgpr_read_b32 v33,a1
v_accvgpr_read_b32 v34,a2
v_accvgpr_read_b32 v35,a3
v_accvgpr_read_b32 v36,a32
v_accvgpr_read_b32 v37,a33
v_accvgpr_read_b32 v38,a34
v_accvgpr_read_b32 v39,a35
s_add_u32 s81,s83,0
v_cvt_pk_bf16_f32 v40,v32,v33
v_cvt_pk_bf16_f32 v41,v34,v35
v_cvt_pk_bf16_f32 v42,v36,v37
v_cvt_pk_bf16_f32 v43,v38,v39
buffer_store_dwordx4 v[40:43],v3,s[8:11],s81 offen offset:0 sc1
v_accvgpr_read_b32 v44,a64
v_accvgpr_read_b32 v45,a65
v_accvgpr_read_b32 v46,a66
v_accvgpr_read_b32 v47,a67
v_accvgpr_read_b32 v48,a96
v_accvgpr_read_b32 v49,a97
v_accvgpr_read_b32 v50,a98
v_accvgpr_read_b32 v51,a99
v_cvt_pk_bf16_f32 v52,v44,v45
v_cvt_pk_bf16_f32 v53,v46,v47
v_cvt_pk_bf16_f32 v54,v48,v49
v_cvt_pk_bf16_f32 v55,v50,v51
buffer_store_dwordx4 v[52:55],v3,s[8:11],s81 offen offset:2048 sc1
v_accvgpr_read_b32 v56,a128
v_accvgpr_read_b32 v57,a129
v_accvgpr_read_b32 v58,a130
v_accvgpr_read_b32 v59,a131
v_accvgpr_read_b32 v60,a160
v_accvgpr_read_b32 v61,a161
v_accvgpr_read_b32 v62,a162
v_accvgpr_read_b32 v63,a163
s_add_u32 s81,s83,4096
v_cvt_pk_bf16_f32 v64,v56,v57
v_cvt_pk_bf16_f32 v65,v58,v59
v_cvt_pk_bf16_f32 v66,v60,v61
v_cvt_pk_bf16_f32 v67,v62,v63
buffer_store_dwordx4 v[64:67],v3,s[8:11],s81 offen offset:0 sc1
v_accvgpr_read_b32 v68,a192
v_accvgpr_read_b32 v69,a193
v_accvgpr_read_b32 v70,a194
v_accvgpr_read_b32 v71,a195
v_accvgpr_read_b32 v72,a224
v_accvgpr_read_b32 v73,a225
v_accvgpr_read_b32 v74,a226
v_accvgpr_read_b32 v75,a227
v_cvt_pk_bf16_f32 v76,v68,v69
v_cvt_pk_bf16_f32 v77,v70,v71
v_cvt_pk_bf16_f32 v78,v72,v73
v_cvt_pk_bf16_f32 v79,v74,v75
buffer_store_dwordx4 v[76:79],v3,s[8:11],s81 offen offset:2048 sc1
v_accvgpr_read_b32 v32,a4
v_accvgpr_read_b32 v33,a5
v_accvgpr_read_b32 v34,a6
v_accvgpr_read_b32 v35,a7
v_accvgpr_read_b32 v36,a36
v_accvgpr_read_b32 v37,a37
v_accvgpr_read_b32 v38,a38
v_accvgpr_read_b32 v39,a39
s_add_u32 s81,s83,0
v_cvt_pk_bf16_f32 v40,v32,v33
v_cvt_pk_bf16_f32 v41,v34,v35
v_cvt_pk_bf16_f32 v42,v36,v37
v_cvt_pk_bf16_f32 v43,v38,v39
buffer_store_dwordx4 v[40:43],v3,s[8:11],s81 offen offset:1024 sc1
v_accvgpr_read_b32 v44,a68
v_accvgpr_read_b32 v45,a69
v_accvgpr_read_b32 v46,a70
v_accvgpr_read_b32 v47,a71
v_accvgpr_read_b32 v48,a100
v_accvgpr_read_b32 v49,a101
v_accvgpr_read_b32 v50,a102
v_accvgpr_read_b32 v51,a103
v_cvt_pk_bf16_f32 v52,v44,v45
v_cvt_pk_bf16_f32 v53,v46,v47
v_cvt_pk_bf16_f32 v54,v48,v49
v_cvt_pk_bf16_f32 v55,v50,v51
buffer_store_dwordx4 v[52:55],v3,s[8:11],s81 offen offset:3072 sc1
v_accvgpr_read_b32 v56,a132
v_accvgpr_read_b32 v57,a133
v_accvgpr_read_b32 v58,a134
v_accvgpr_read_b32 v59,a135
v_accvgpr_read_b32 v60,a164
v_accvgpr_read_b32 v61,a165
v_accvgpr_read_b32 v62,a166
v_accvgpr_read_b32 v63,a167
s_add_u32 s81,s83,4096
v_cvt_pk_bf16_f32 v64,v56,v57
v_cvt_pk_bf16_f32 v65,v58,v59
v_cvt_pk_bf16_f32 v66,v60,v61
v_cvt_pk_bf16_f32 v67,v62,v63
buffer_store_dwordx4 v[64:67],v3,s[8:11],s81 offen offset:1024 sc1
v_accvgpr_read_b32 v68,a196
v_accvgpr_read_b32 v69,a197
v_accvgpr_read_b32 v70,a198
v_accvgpr_read_b32 v71,a199
v_accvgpr_read_b32 v72,a228
v_accvgpr_read_b32 v73,a229
v_accvgpr_read_b32 v74,a230
v_accvgpr_read_b32 v75,a231
v_cvt_pk_bf16_f32 v76,v68,v69
v_cvt_pk_bf16_f32 v77,v70,v71
v_cvt_pk_bf16_f32 v78,v72,v73
v_cvt_pk_bf16_f32 v79,v74,v75
buffer_store_dwordx4 v[76:79],v3,s[8:11],s81 offen offset:3072 sc1
v_accvgpr_read_b32 v32,a8
v_accvgpr_read_b32 v33,a9
v_accvgpr_read_b32 v34,a10
v_accvgpr_read_b32 v35,a11
v_accvgpr_read_b32 v36,a40
v_accvgpr_read_b32 v37,a41
v_accvgpr_read_b32 v38,a42
v_accvgpr_read_b32 v39,a43
s_add_u32 s81,s83,262144
v_cvt_pk_bf16_f32 v40,v32,v33
v_cvt_pk_bf16_f32 v41,v34,v35
v_cvt_pk_bf16_f32 v42,v36,v37
v_cvt_pk_bf16_f32 v43,v38,v39
buffer_store_dwordx4 v[40:43],v3,s[8:11],s81 offen offset:0 sc1
v_accvgpr_read_b32 v44,a72
v_accvgpr_read_b32 v45,a73
v_accvgpr_read_b32 v46,a74
v_accvgpr_read_b32 v47,a75
v_accvgpr_read_b32 v48,a104
v_accvgpr_read_b32 v49,a105
v_accvgpr_read_b32 v50,a106
v_accvgpr_read_b32 v51,a107
v_cvt_pk_bf16_f32 v52,v44,v45
v_cvt_pk_bf16_f32 v53,v46,v47
v_cvt_pk_bf16_f32 v54,v48,v49
v_cvt_pk_bf16_f32 v55,v50,v51
buffer_store_dwordx4 v[52:55],v3,s[8:11],s81 offen offset:2048 sc1
v_accvgpr_read_b32 v56,a136
v_accvgpr_read_b32 v57,a137
v_accvgpr_read_b32 v58,a138
v_accvgpr_read_b32 v59,a139
v_accvgpr_read_b32 v60,a168
v_accvgpr_read_b32 v61,a169
v_accvgpr_read_b32 v62,a170
v_accvgpr_read_b32 v63,a171
s_add_u32 s81,s83,266240
v_cvt_pk_bf16_f32 v64,v56,v57
v_cvt_pk_bf16_f32 v65,v58,v59
v_cvt_pk_bf16_f32 v66,v60,v61
v_cvt_pk_bf16_f32 v67,v62,v63
buffer_store_dwordx4 v[64:67],v3,s[8:11],s81 offen offset:0 sc1
v_accvgpr_read_b32 v68,a200
v_accvgpr_read_b32 v69,a201
v_accvgpr_read_b32 v70,a202
v_accvgpr_read_b32 v71,a203
v_accvgpr_read_b32 v72,a232
v_accvgpr_read_b32 v73,a233
v_accvgpr_read_b32 v74,a234
v_accvgpr_read_b32 v75,a235
v_cvt_pk_bf16_f32 v76,v68,v69
v_cvt_pk_bf16_f32 v77,v70,v71
v_cvt_pk_bf16_f32 v78,v72,v73
v_cvt_pk_bf16_f32 v79,v74,v75
buffer_store_dwordx4 v[76:79],v3,s[8:11],s81 offen offset:2048 sc1
v_accvgpr_read_b32 v32,a12
v_accvgpr_read_b32 v33,a13
v_accvgpr_read_b32 v34,a14
v_accvgpr_read_b32 v35,a15
v_accvgpr_read_b32 v36,a44
v_accvgpr_read_b32 v37,a45
v_accvgpr_read_b32 v38,a46
v_accvgpr_read_b32 v39,a47
s_add_u32 s81,s83,262144
v_cvt_pk_bf16_f32 v40,v32,v33
v_cvt_pk_bf16_f32 v41,v34,v35
v_cvt_pk_bf16_f32 v42,v36,v37
v_cvt_pk_bf16_f32 v43,v38,v39
buffer_store_dwordx4 v[40:43],v3,s[8:11],s81 offen offset:1024 sc1
v_accvgpr_read_b32 v44,a76
v_accvgpr_read_b32 v45,a77
v_accvgpr_read_b32 v46,a78
v_accvgpr_read_b32 v47,a79
v_accvgpr_read_b32 v48,a108
v_accvgpr_read_b32 v49,a109
v_accvgpr_read_b32 v50,a110
v_accvgpr_read_b32 v51,a111
v_cvt_pk_bf16_f32 v52,v44,v45
v_cvt_pk_bf16_f32 v53,v46,v47
v_cvt_pk_bf16_f32 v54,v48,v49
v_cvt_pk_bf16_f32 v55,v50,v51
buffer_store_dwordx4 v[52:55],v3,s[8:11],s81 offen offset:3072 sc1
v_accvgpr_read_b32 v56,a140
v_accvgpr_read_b32 v57,a141
v_accvgpr_read_b32 v58,a142
v_accvgpr_read_b32 v59,a143
v_accvgpr_read_b32 v60,a172
v_accvgpr_read_b32 v61,a173
v_accvgpr_read_b32 v62,a174
v_accvgpr_read_b32 v63,a175
s_add_u32 s81,s83,266240
v_cvt_pk_bf16_f32 v64,v56,v57
v_cvt_pk_bf16_f32 v65,v58,v59
v_cvt_pk_bf16_f32 v66,v60,v61
v_cvt_pk_bf16_f32 v67,v62,v63
buffer_store_dwordx4 v[64:67],v3,s[8:11],s81 offen offset:1024 sc1
v_accvgpr_read_b32 v68,a204
v_accvgpr_read_b32 v69,a205
v_accvgpr_read_b32 v70,a206
v_accvgpr_read_b32 v71,a207
v_accvgpr_read_b32 v72,a236
v_accvgpr_read_b32 v73,a237
v_accvgpr_read_b32 v74,a238
v_accvgpr_read_b32 v75,a239
v_cvt_pk_bf16_f32 v76,v68,v69
v_cvt_pk_bf16_f32 v77,v70,v71
v_cvt_pk_bf16_f32 v78,v72,v73
v_cvt_pk_bf16_f32 v79,v74,v75
buffer_store_dwordx4 v[76:79],v3,s[8:11],s81 offen offset:3072 sc1
v_accvgpr_read_b32 v32,a16
v_accvgpr_read_b32 v33,a17
v_accvgpr_read_b32 v34,a18
v_accvgpr_read_b32 v35,a19
v_accvgpr_read_b32 v36,a48
v_accvgpr_read_b32 v37,a49
v_accvgpr_read_b32 v38,a50
v_accvgpr_read_b32 v39,a51
s_add_u32 s81,s83,524288
v_cvt_pk_bf16_f32 v40,v32,v33
v_cvt_pk_bf16_f32 v41,v34,v35
v_cvt_pk_bf16_f32 v42,v36,v37
v_cvt_pk_bf16_f32 v43,v38,v39
buffer_store_dwordx4 v[40:43],v3,s[8:11],s81 offen offset:0 sc1
v_accvgpr_read_b32 v44,a80
v_accvgpr_read_b32 v45,a81
v_accvgpr_read_b32 v46,a82
v_accvgpr_read_b32 v47,a83
v_accvgpr_read_b32 v48,a112
v_accvgpr_read_b32 v49,a113
v_accvgpr_read_b32 v50,a114
v_accvgpr_read_b32 v51,a115
v_cvt_pk_bf16_f32 v52,v44,v45
v_cvt_pk_bf16_f32 v53,v46,v47
v_cvt_pk_bf16_f32 v54,v48,v49
v_cvt_pk_bf16_f32 v55,v50,v51
buffer_store_dwordx4 v[52:55],v3,s[8:11],s81 offen offset:2048 sc1
v_accvgpr_read_b32 v56,a144
v_accvgpr_read_b32 v57,a145
v_accvgpr_read_b32 v58,a146
v_accvgpr_read_b32 v59,a147
v_accvgpr_read_b32 v60,a176
v_accvgpr_read_b32 v61,a177
v_accvgpr_read_b32 v62,a178
v_accvgpr_read_b32 v63,a179
s_add_u32 s81,s83,528384
v_cvt_pk_bf16_f32 v64,v56,v57
v_cvt_pk_bf16_f32 v65,v58,v59
v_cvt_pk_bf16_f32 v66,v60,v61
v_cvt_pk_bf16_f32 v67,v62,v63
buffer_store_dwordx4 v[64:67],v3,s[8:11],s81 offen offset:0 sc1
v_accvgpr_read_b32 v68,a208
v_accvgpr_read_b32 v69,a209
v_accvgpr_read_b32 v70,a210
v_accvgpr_read_b32 v71,a211
v_accvgpr_read_b32 v72,a240
v_accvgpr_read_b32 v73,a241
v_accvgpr_read_b32 v74,a242
v_accvgpr_read_b32 v75,a243
v_cvt_pk_bf16_f32 v76,v68,v69
v_cvt_pk_bf16_f32 v77,v70,v71
v_cvt_pk_bf16_f32 v78,v72,v73
v_cvt_pk_bf16_f32 v79,v74,v75
buffer_store_dwordx4 v[76:79],v3,s[8:11],s81 offen offset:2048 sc1
v_accvgpr_read_b32 v32,a20
v_accvgpr_read_b32 v33,a21
v_accvgpr_read_b32 v34,a22
v_accvgpr_read_b32 v35,a23
v_accvgpr_read_b32 v36,a52
v_accvgpr_read_b32 v37,a53
v_accvgpr_read_b32 v38,a54
v_accvgpr_read_b32 v39,a55
s_add_u32 s81,s83,524288
v_cvt_pk_bf16_f32 v40,v32,v33
v_cvt_pk_bf16_f32 v41,v34,v35
v_cvt_pk_bf16_f32 v42,v36,v37
v_cvt_pk_bf16_f32 v43,v38,v39
buffer_store_dwordx4 v[40:43],v3,s[8:11],s81 offen offset:1024 sc1
v_accvgpr_read_b32 v44,a84
v_accvgpr_read_b32 v45,a85
v_accvgpr_read_b32 v46,a86
v_accvgpr_read_b32 v47,a87
v_accvgpr_read_b32 v48,a116
v_accvgpr_read_b32 v49,a117
v_accvgpr_read_b32 v50,a118
v_accvgpr_read_b32 v51,a119
v_cvt_pk_bf16_f32 v52,v44,v45
v_cvt_pk_bf16_f32 v53,v46,v47
v_cvt_pk_bf16_f32 v54,v48,v49
v_cvt_pk_bf16_f32 v55,v50,v51
buffer_store_dwordx4 v[52:55],v3,s[8:11],s81 offen offset:3072 sc1
v_accvgpr_read_b32 v56,a148
v_accvgpr_read_b32 v57,a149
v_accvgpr_read_b32 v58,a150
v_accvgpr_read_b32 v59,a151
v_accvgpr_read_b32 v60,a180
v_accvgpr_read_b32 v61,a181
v_accvgpr_read_b32 v62,a182
v_accvgpr_read_b32 v63,a183
s_add_u32 s81,s83,528384
v_cvt_pk_bf16_f32 v64,v56,v57
v_cvt_pk_bf16_f32 v65,v58,v59
v_cvt_pk_bf16_f32 v66,v60,v61
v_cvt_pk_bf16_f32 v67,v62,v63
buffer_store_dwordx4 v[64:67],v3,s[8:11],s81 offen offset:1024 sc1
v_accvgpr_read_b32 v68,a212
v_accvgpr_read_b32 v69,a213
v_accvgpr_read_b32 v70,a214
v_accvgpr_read_b32 v71,a215
v_accvgpr_read_b32 v72,a244
v_accvgpr_read_b32 v73,a245
v_accvgpr_read_b32 v74,a246
v_accvgpr_read_b32 v75,a247
v_cvt_pk_bf16_f32 v76,v68,v69
v_cvt_pk_bf16_f32 v77,v70,v71
v_cvt_pk_bf16_f32 v78,v72,v73
v_cvt_pk_bf16_f32 v79,v74,v75
buffer_store_dwordx4 v[76:79],v3,s[8:11],s81 offen offset:3072 sc1
v_accvgpr_read_b32 v32,a24
v_accvgpr_read_b32 v33,a25
v_accvgpr_read_b32 v34,a26
v_accvgpr_read_b32 v35,a27
v_accvgpr_read_b32 v36,a56
v_accvgpr_read_b32 v37,a57
v_accvgpr_read_b32 v38,a58
v_accvgpr_read_b32 v39,a59
s_add_u32 s81,s83,786432
v_cvt_pk_bf16_f32 v40,v32,v33
v_cvt_pk_bf16_f32 v41,v34,v35
v_cvt_pk_bf16_f32 v42,v36,v37
v_cvt_pk_bf16_f32 v43,v38,v39
buffer_store_dwordx4 v[40:43],v3,s[8:11],s81 offen offset:0 sc1
v_accvgpr_read_b32 v44,a88
v_accvgpr_read_b32 v45,a89
v_accvgpr_read_b32 v46,a90
v_accvgpr_read_b32 v47,a91
v_accvgpr_read_b32 v48,a120
v_accvgpr_read_b32 v49,a121
v_accvgpr_read_b32 v50,a122
v_accvgpr_read_b32 v51,a123
v_cvt_pk_bf16_f32 v52,v44,v45
v_cvt_pk_bf16_f32 v53,v46,v47
v_cvt_pk_bf16_f32 v54,v48,v49
v_cvt_pk_bf16_f32 v55,v50,v51
buffer_store_dwordx4 v[52:55],v3,s[8:11],s81 offen offset:2048 sc1
v_accvgpr_read_b32 v56,a152
v_accvgpr_read_b32 v57,a153
v_accvgpr_read_b32 v58,a154
v_accvgpr_read_b32 v59,a155
v_accvgpr_read_b32 v60,a184
v_accvgpr_read_b32 v61,a185
v_accvgpr_read_b32 v62,a186
v_accvgpr_read_b32 v63,a187
s_add_u32 s81,s83,790528
v_cvt_pk_bf16_f32 v64,v56,v57
v_cvt_pk_bf16_f32 v65,v58,v59
v_cvt_pk_bf16_f32 v66,v60,v61
v_cvt_pk_bf16_f32 v67,v62,v63
buffer_store_dwordx4 v[64:67],v3,s[8:11],s81 offen offset:0 sc1
v_accvgpr_read_b32 v68,a216
v_accvgpr_read_b32 v69,a217
v_accvgpr_read_b32 v70,a218
v_accvgpr_read_b32 v71,a219
v_accvgpr_read_b32 v72,a248
v_accvgpr_read_b32 v73,a249
v_accvgpr_read_b32 v74,a250
v_accvgpr_read_b32 v75,a251
v_cvt_pk_bf16_f32 v76,v68,v69
v_cvt_pk_bf16_f32 v77,v70,v71
v_cvt_pk_bf16_f32 v78,v72,v73
v_cvt_pk_bf16_f32 v79,v74,v75
buffer_store_dwordx4 v[76:79],v3,s[8:11],s81 offen offset:2048 sc1
v_accvgpr_read_b32 v32,a28
v_accvgpr_read_b32 v33,a29
v_accvgpr_read_b32 v34,a30
v_accvgpr_read_b32 v35,a31
v_accvgpr_read_b32 v36,a60
v_accvgpr_read_b32 v37,a61
v_accvgpr_read_b32 v38,a62
v_accvgpr_read_b32 v39,a63
s_add_u32 s81,s83,786432
v_cvt_pk_bf16_f32 v40,v32,v33
v_cvt_pk_bf16_f32 v41,v34,v35
v_cvt_pk_bf16_f32 v42,v36,v37
v_cvt_pk_bf16_f32 v43,v38,v39
buffer_store_dwordx4 v[40:43],v3,s[8:11],s81 offen offset:1024 sc1
v_accvgpr_read_b32 v44,a92
v_accvgpr_read_b32 v45,a93
v_accvgpr_read_b32 v46,a94
v_accvgpr_read_b32 v47,a95
v_accvgpr_read_b32 v48,a124
v_accvgpr_read_b32 v49,a125
v_accvgpr_read_b32 v50,a126
v_accvgpr_read_b32 v51,a127
v_cvt_pk_bf16_f32 v52,v44,v45
v_cvt_pk_bf16_f32 v53,v46,v47
v_cvt_pk_bf16_f32 v54,v48,v49
v_cvt_pk_bf16_f32 v55,v50,v51
buffer_store_dwordx4 v[52:55],v3,s[8:11],s81 offen offset:3072 sc1
v_accvgpr_read_b32 v56,a156
v_accvgpr_read_b32 v57,a157
v_accvgpr_read_b32 v58,a158
v_accvgpr_read_b32 v59,a159
v_accvgpr_read_b32 v60,a188
v_accvgpr_read_b32 v61,a189
v_accvgpr_read_b32 v62,a190
v_accvgpr_read_b32 v63,a191
s_add_u32 s81,s83,790528
v_cvt_pk_bf16_f32 v64,v56,v57
v_cvt_pk_bf16_f32 v65,v58,v59
v_cvt_pk_bf16_f32 v66,v60,v61
v_cvt_pk_bf16_f32 v67,v62,v63
buffer_store_dwordx4 v[64:67],v3,s[8:11],s81 offen offset:1024 sc1
v_accvgpr_read_b32 v68,a220
v_accvgpr_read_b32 v69,a221
v_accvgpr_read_b32 v70,a222
v_accvgpr_read_b32 v71,a223
v_accvgpr_read_b32 v72,a252
v_accvgpr_read_b32 v73,a253
v_accvgpr_read_b32 v74,a254
v_accvgpr_read_b32 v75,a255
v_cvt_pk_bf16_f32 v76,v68,v69
v_cvt_pk_bf16_f32 v77,v70,v71
v_cvt_pk_bf16_f32 v78,v72,v73
v_cvt_pk_bf16_f32 v79,v74,v75
buffer_store_dwordx4 v[76:79],v3,s[8:11],s81 offen offset:3072 sc1
s_branch Lg1_eend
Lg1_ev:
v_accvgpr_read_b32 v32,a0
v_accvgpr_read_b32 v33,a1
v_accvgpr_read_b32 v34,a2
v_accvgpr_read_b32 v35,a3
v_accvgpr_read_b32 v36,a4
v_accvgpr_read_b32 v37,a5
v_accvgpr_read_b32 v38,a6
v_accvgpr_read_b32 v39,a7
s_add_u32 s81,s83,0
v_cvt_pk_bf16_f32 v40,v32,v33
v_cvt_pk_bf16_f32 v41,v34,v35
v_cvt_pk_bf16_f32 v42,v36,v37
v_cvt_pk_bf16_f32 v43,v38,v39
buffer_store_dwordx4 v[40:43],v3,s[8:11],s81 offen offset:0 sc1
v_accvgpr_read_b32 v44,a32
v_accvgpr_read_b32 v45,a33
v_accvgpr_read_b32 v46,a34
v_accvgpr_read_b32 v47,a35
v_accvgpr_read_b32 v48,a36
v_accvgpr_read_b32 v49,a37
v_accvgpr_read_b32 v50,a38
v_accvgpr_read_b32 v51,a39
v_cvt_pk_bf16_f32 v52,v44,v45
v_cvt_pk_bf16_f32 v53,v46,v47
v_cvt_pk_bf16_f32 v54,v48,v49
v_cvt_pk_bf16_f32 v55,v50,v51
buffer_store_dwordx4 v[52:55],v3,s[8:11],s81 offen offset:1024 sc1
v_accvgpr_read_b32 v56,a64
v_accvgpr_read_b32 v57,a65
v_accvgpr_read_b32 v58,a66
v_accvgpr_read_b32 v59,a67
v_accvgpr_read_b32 v60,a68
v_accvgpr_read_b32 v61,a69
v_accvgpr_read_b32 v62,a70
v_accvgpr_read_b32 v63,a71
v_cvt_pk_bf16_f32 v64,v56,v57
v_cvt_pk_bf16_f32 v65,v58,v59
v_cvt_pk_bf16_f32 v66,v60,v61
v_cvt_pk_bf16_f32 v67,v62,v63
buffer_store_dwordx4 v[64:67],v3,s[8:11],s81 offen offset:2048 sc1
v_accvgpr_read_b32 v68,a96
v_accvgpr_read_b32 v69,a97
v_accvgpr_read_b32 v70,a98
v_accvgpr_read_b32 v71,a99
v_accvgpr_read_b32 v72,a100
v_accvgpr_read_b32 v73,a101
v_accvgpr_read_b32 v74,a102
v_accvgpr_read_b32 v75,a103
v_cvt_pk_bf16_f32 v76,v68,v69
v_cvt_pk_bf16_f32 v77,v70,v71
v_cvt_pk_bf16_f32 v78,v72,v73
v_cvt_pk_bf16_f32 v79,v74,v75
buffer_store_dwordx4 v[76:79],v3,s[8:11],s81 offen offset:3072 sc1
v_accvgpr_read_b32 v32,a128
v_accvgpr_read_b32 v33,a129
v_accvgpr_read_b32 v34,a130
v_accvgpr_read_b32 v35,a131
v_accvgpr_read_b32 v36,a132
v_accvgpr_read_b32 v37,a133
v_accvgpr_read_b32 v38,a134
v_accvgpr_read_b32 v39,a135
s_add_u32 s81,s83,4096
v_cvt_pk_bf16_f32 v40,v32,v33
v_cvt_pk_bf16_f32 v41,v34,v35
v_cvt_pk_bf16_f32 v42,v36,v37
v_cvt_pk_bf16_f32 v43,v38,v39
buffer_store_dwordx4 v[40:43],v3,s[8:11],s81 offen offset:0 sc1
v_accvgpr_read_b32 v44,a160
v_accvgpr_read_b32 v45,a161
v_accvgpr_read_b32 v46,a162
v_accvgpr_read_b32 v47,a163
v_accvgpr_read_b32 v48,a164
v_accvgpr_read_b32 v49,a165
v_accvgpr_read_b32 v50,a166
v_accvgpr_read_b32 v51,a167
v_cvt_pk_bf16_f32 v52,v44,v45
v_cvt_pk_bf16_f32 v53,v46,v47
v_cvt_pk_bf16_f32 v54,v48,v49
v_cvt_pk_bf16_f32 v55,v50,v51
buffer_store_dwordx4 v[52:55],v3,s[8:11],s81 offen offset:1024 sc1
v_accvgpr_read_b32 v56,a192
v_accvgpr_read_b32 v57,a193
v_accvgpr_read_b32 v58,a194
v_accvgpr_read_b32 v59,a195
v_accvgpr_read_b32 v60,a196
v_accvgpr_read_b32 v61,a197
v_accvgpr_read_b32 v62,a198
v_accvgpr_read_b32 v63,a199
v_cvt_pk_bf16_f32 v64,v56,v57
v_cvt_pk_bf16_f32 v65,v58,v59
v_cvt_pk_bf16_f32 v66,v60,v61
v_cvt_pk_bf16_f32 v67,v62,v63
buffer_store_dwordx4 v[64:67],v3,s[8:11],s81 offen offset:2048 sc1
v_accvgpr_read_b32 v68,a224
v_accvgpr_read_b32 v69,a225
v_accvgpr_read_b32 v70,a226
v_accvgpr_read_b32 v71,a227
v_accvgpr_read_b32 v72,a228
v_accvgpr_read_b32 v73,a229
v_accvgpr_read_b32 v74,a230
v_accvgpr_read_b32 v75,a231
v_cvt_pk_bf16_f32 v76,v68,v69
v_cvt_pk_bf16_f32 v77,v70,v71
v_cvt_pk_bf16_f32 v78,v72,v73
v_cvt_pk_bf16_f32 v79,v74,v75
buffer_store_dwordx4 v[76:79],v3,s[8:11],s81 offen offset:3072 sc1
v_accvgpr_read_b32 v32,a8
v_accvgpr_read_b32 v33,a9
v_accvgpr_read_b32 v34,a10
v_accvgpr_read_b32 v35,a11
v_accvgpr_read_b32 v36,a12
v_accvgpr_read_b32 v37,a13
v_accvgpr_read_b32 v38,a14
v_accvgpr_read_b32 v39,a15
s_add_u32 s81,s83,262144
v_cvt_pk_bf16_f32 v40,v32,v33
v_cvt_pk_bf16_f32 v41,v34,v35
v_cvt_pk_bf16_f32 v42,v36,v37
v_cvt_pk_bf16_f32 v43,v38,v39
buffer_store_dwordx4 v[40:43],v3,s[8:11],s81 offen offset:0 sc1
v_accvgpr_read_b32 v44,a40
v_accvgpr_read_b32 v45,a41
v_accvgpr_read_b32 v46,a42
v_accvgpr_read_b32 v47,a43
v_accvgpr_read_b32 v48,a44
v_accvgpr_read_b32 v49,a45
v_accvgpr_read_b32 v50,a46
v_accvgpr_read_b32 v51,a47
v_cvt_pk_bf16_f32 v52,v44,v45
v_cvt_pk_bf16_f32 v53,v46,v47
v_cvt_pk_bf16_f32 v54,v48,v49
v_cvt_pk_bf16_f32 v55,v50,v51
buffer_store_dwordx4 v[52:55],v3,s[8:11],s81 offen offset:1024 sc1
v_accvgpr_read_b32 v56,a72
v_accvgpr_read_b32 v57,a73
v_accvgpr_read_b32 v58,a74
v_accvgpr_read_b32 v59,a75
v_accvgpr_read_b32 v60,a76
v_accvgpr_read_b32 v61,a77
v_accvgpr_read_b32 v62,a78
v_accvgpr_read_b32 v63,a79
v_cvt_pk_bf16_f32 v64,v56,v57
v_cvt_pk_bf16_f32 v65,v58,v59
v_cvt_pk_bf16_f32 v66,v60,v61
v_cvt_pk_bf16_f32 v67,v62,v63
buffer_store_dwordx4 v[64:67],v3,s[8:11],s81 offen offset:2048 sc1
v_accvgpr_read_b32 v68,a104
v_accvgpr_read_b32 v69,a105
v_accvgpr_read_b32 v70,a106
v_accvgpr_read_b32 v71,a107
v_accvgpr_read_b32 v72,a108
v_accvgpr_read_b32 v73,a109
v_accvgpr_read_b32 v74,a110
v_accvgpr_read_b32 v75,a111
v_cvt_pk_bf16_f32 v76,v68,v69
v_cvt_pk_bf16_f32 v77,v70,v71
v_cvt_pk_bf16_f32 v78,v72,v73
v_cvt_pk_bf16_f32 v79,v74,v75
buffer_store_dwordx4 v[76:79],v3,s[8:11],s81 offen offset:3072 sc1
v_accvgpr_read_b32 v32,a136
v_accvgpr_read_b32 v33,a137
v_accvgpr_read_b32 v34,a138
v_accvgpr_read_b32 v35,a139
v_accvgpr_read_b32 v36,a140
v_accvgpr_read_b32 v37,a141
v_accvgpr_read_b32 v38,a142
v_accvgpr_read_b32 v39,a143
s_add_u32 s81,s83,266240
v_cvt_pk_bf16_f32 v40,v32,v33
v_cvt_pk_bf16_f32 v41,v34,v35
v_cvt_pk_bf16_f32 v42,v36,v37
v_cvt_pk_bf16_f32 v43,v38,v39
buffer_store_dwordx4 v[40:43],v3,s[8:11],s81 offen offset:0 sc1
v_accvgpr_read_b32 v44,a168
v_accvgpr_read_b32 v45,a169
v_accvgpr_read_b32 v46,a170
v_accvgpr_read_b32 v47,a171
v_accvgpr_read_b32 v48,a172
v_accvgpr_read_b32 v49,a173
v_accvgpr_read_b32 v50,a174
v_accvgpr_read_b32 v51,a175
v_cvt_pk_bf16_f32 v52,v44,v45
v_cvt_pk_bf16_f32 v53,v46,v47
v_cvt_pk_bf16_f32 v54,v48,v49
v_cvt_pk_bf16_f32 v55,v50,v51
buffer_store_dwordx4 v[52:55],v3,s[8:11],s81 offen offset:1024 sc1
v_accvgpr_read_b32 v56,a200
v_accvgpr_read_b32 v57,a201
v_accvgpr_read_b32 v58,a202
v_accvgpr_read_b32 v59,a203
v_accvgpr_read_b32 v60,a204
v_accvgpr_read_b32 v61,a205
v_accvgpr_read_b32 v62,a206
v_accvgpr_read_b32 v63,a207
v_cvt_pk_bf16_f32 v64,v56,v57
v_cvt_pk_bf16_f32 v65,v58,v59
v_cvt_pk_bf16_f32 v66,v60,v61
v_cvt_pk_bf16_f32 v67,v62,v63
buffer_store_dwordx4 v[64:67],v3,s[8:11],s81 offen offset:2048 sc1
v_accvgpr_read_b32 v68,a232
v_accvgpr_read_b32 v69,a233
v_accvgpr_read_b32 v70,a234
v_accvgpr_read_b32 v71,a235
v_accvgpr_read_b32 v72,a236
v_accvgpr_read_b32 v73,a237
v_accvgpr_read_b32 v74,a238
v_accvgpr_read_b32 v75,a239
v_cvt_pk_bf16_f32 v76,v68,v69
v_cvt_pk_bf16_f32 v77,v70,v71
v_cvt_pk_bf16_f32 v78,v72,v73
v_cvt_pk_bf16_f32 v79,v74,v75
buffer_store_dwordx4 v[76:79],v3,s[8:11],s81 offen offset:3072 sc1
v_accvgpr_read_b32 v32,a16
v_accvgpr_read_b32 v33,a17
v_accvgpr_read_b32 v34,a18
v_accvgpr_read_b32 v35,a19
v_accvgpr_read_b32 v36,a20
v_accvgpr_read_b32 v37,a21
v_accvgpr_read_b32 v38,a22
v_accvgpr_read_b32 v39,a23
s_add_u32 s81,s83,524288
v_cvt_pk_bf16_f32 v40,v32,v33
v_cvt_pk_bf16_f32 v41,v34,v35
v_cvt_pk_bf16_f32 v42,v36,v37
v_cvt_pk_bf16_f32 v43,v38,v39
buffer_store_dwordx4 v[40:43],v3,s[8:11],s81 offen offset:0 sc1
v_accvgpr_read_b32 v44,a48
v_accvgpr_read_b32 v45,a49
v_accvgpr_read_b32 v46,a50
v_accvgpr_read_b32 v47,a51
v_accvgpr_read_b32 v48,a52
v_accvgpr_read_b32 v49,a53
v_accvgpr_read_b32 v50,a54
v_accvgpr_read_b32 v51,a55
v_cvt_pk_bf16_f32 v52,v44,v45
v_cvt_pk_bf16_f32 v53,v46,v47
v_cvt_pk_bf16_f32 v54,v48,v49
v_cvt_pk_bf16_f32 v55,v50,v51
buffer_store_dwordx4 v[52:55],v3,s[8:11],s81 offen offset:1024 sc1
v_accvgpr_read_b32 v56,a80
v_accvgpr_read_b32 v57,a81
v_accvgpr_read_b32 v58,a82
v_accvgpr_read_b32 v59,a83
v_accvgpr_read_b32 v60,a84
v_accvgpr_read_b32 v61,a85
v_accvgpr_read_b32 v62,a86
v_accvgpr_read_b32 v63,a87
v_cvt_pk_bf16_f32 v64,v56,v57
v_cvt_pk_bf16_f32 v65,v58,v59
v_cvt_pk_bf16_f32 v66,v60,v61
v_cvt_pk_bf16_f32 v67,v62,v63
buffer_store_dwordx4 v[64:67],v3,s[8:11],s81 offen offset:2048 sc1
v_accvgpr_read_b32 v68,a112
v_accvgpr_read_b32 v69,a113
v_accvgpr_read_b32 v70,a114
v_accvgpr_read_b32 v71,a115
v_accvgpr_read_b32 v72,a116
v_accvgpr_read_b32 v73,a117
v_accvgpr_read_b32 v74,a118
v_accvgpr_read_b32 v75,a119
v_cvt_pk_bf16_f32 v76,v68,v69
v_cvt_pk_bf16_f32 v77,v70,v71
v_cvt_pk_bf16_f32 v78,v72,v73
v_cvt_pk_bf16_f32 v79,v74,v75
buffer_store_dwordx4 v[76:79],v3,s[8:11],s81 offen offset:3072 sc1
v_accvgpr_read_b32 v32,a144
v_accvgpr_read_b32 v33,a145
v_accvgpr_read_b32 v34,a146
v_accvgpr_read_b32 v35,a147
v_accvgpr_read_b32 v36,a148
v_accvgpr_read_b32 v37,a149
v_accvgpr_read_b32 v38,a150
v_accvgpr_read_b32 v39,a151
s_add_u32 s81,s83,528384
v_cvt_pk_bf16_f32 v40,v32,v33
v_cvt_pk_bf16_f32 v41,v34,v35
v_cvt_pk_bf16_f32 v42,v36,v37
v_cvt_pk_bf16_f32 v43,v38,v39
buffer_store_dwordx4 v[40:43],v3,s[8:11],s81 offen offset:0 sc1
v_accvgpr_read_b32 v44,a176
v_accvgpr_read_b32 v45,a177
v_accvgpr_read_b32 v46,a178
v_accvgpr_read_b32 v47,a179
v_accvgpr_read_b32 v48,a180
v_accvgpr_read_b32 v49,a181
v_accvgpr_read_b32 v50,a182
v_accvgpr_read_b32 v51,a183
v_cvt_pk_bf16_f32 v52,v44,v45
v_cvt_pk_bf16_f32 v53,v46,v47
v_cvt_pk_bf16_f32 v54,v48,v49
v_cvt_pk_bf16_f32 v55,v50,v51
buffer_store_dwordx4 v[52:55],v3,s[8:11],s81 offen offset:1024 sc1
v_accvgpr_read_b32 v56,a208
v_accvgpr_read_b32 v57,a209
v_accvgpr_read_b32 v58,a210
v_accvgpr_read_b32 v59,a211
v_accvgpr_read_b32 v60,a212
v_accvgpr_read_b32 v61,a213
v_accvgpr_read_b32 v62,a214
v_accvgpr_read_b32 v63,a215
v_cvt_pk_bf16_f32 v64,v56,v57
v_cvt_pk_bf16_f32 v65,v58,v59
v_cvt_pk_bf16_f32 v66,v60,v61
v_cvt_pk_bf16_f32 v67,v62,v63
buffer_store_dwordx4 v[64:67],v3,s[8:11],s81 offen offset:2048 sc1
v_accvgpr_read_b32 v68,a240
v_accvgpr_read_b32 v69,a241
v_accvgpr_read_b32 v70,a242
v_accvgpr_read_b32 v71,a243
v_accvgpr_read_b32 v72,a244
v_accvgpr_read_b32 v73,a245
v_accvgpr_read_b32 v74,a246
v_accvgpr_read_b32 v75,a247
v_cvt_pk_bf16_f32 v76,v68,v69
v_cvt_pk_bf16_f32 v77,v70,v71
v_cvt_pk_bf16_f32 v78,v72,v73
v_cvt_pk_bf16_f32 v79,v74,v75
buffer_store_dwordx4 v[76:79],v3,s[8:11],s81 offen offset:3072 sc1
v_accvgpr_read_b32 v32,a24
v_accvgpr_read_b32 v33,a25
v_accvgpr_read_b32 v34,a26
v_accvgpr_read_b32 v35,a27
v_accvgpr_read_b32 v36,a28
v_accvgpr_read_b32 v37,a29
v_accvgpr_read_b32 v38,a30
v_accvgpr_read_b32 v39,a31
s_add_u32 s81,s83,786432
v_cvt_pk_bf16_f32 v40,v32,v33
v_cvt_pk_bf16_f32 v41,v34,v35
v_cvt_pk_bf16_f32 v42,v36,v37
v_cvt_pk_bf16_f32 v43,v38,v39
buffer_store_dwordx4 v[40:43],v3,s[8:11],s81 offen offset:0 sc1
v_accvgpr_read_b32 v44,a56
v_accvgpr_read_b32 v45,a57
v_accvgpr_read_b32 v46,a58
v_accvgpr_read_b32 v47,a59
v_accvgpr_read_b32 v48,a60
v_accvgpr_read_b32 v49,a61
v_accvgpr_read_b32 v50,a62
v_accvgpr_read_b32 v51,a63
v_cvt_pk_bf16_f32 v52,v44,v45
v_cvt_pk_bf16_f32 v53,v46,v47
v_cvt_pk_bf16_f32 v54,v48,v49
v_cvt_pk_bf16_f32 v55,v50,v51
buffer_store_dwordx4 v[52:55],v3,s[8:11],s81 offen offset:1024 sc1
v_accvgpr_read_b32 v56,a88
v_accvgpr_read_b32 v57,a89
v_accvgpr_read_b32 v58,a90
v_accvgpr_read_b32 v59,a91
v_accvgpr_read_b32 v60,a92
v_accvgpr_read_b32 v61,a93
v_accvgpr_read_b32 v62,a94
v_accvgpr_read_b32 v63,a95
v_cvt_pk_bf16_f32 v64,v56,v57
v_cvt_pk_bf16_f32 v65,v58,v59
v_cvt_pk_bf16_f32 v66,v60,v61
v_cvt_pk_bf16_f32 v67,v62,v63
buffer_store_dwordx4 v[64:67],v3,s[8:11],s81 offen offset:2048 sc1
v_accvgpr_read_b32 v68,a120
v_accvgpr_read_b32 v69,a121
v_accvgpr_read_b32 v70,a122
v_accvgpr_read_b32 v71,a123
v_accvgpr_read_b32 v72,a124
v_accvgpr_read_b32 v73,a125
v_accvgpr_read_b32 v74,a126
v_accvgpr_read_b32 v75,a127
v_cvt_pk_bf16_f32 v76,v68,v69
v_cvt_pk_bf16_f32 v77,v70,v71
v_cvt_pk_bf16_f32 v78,v72,v73
v_cvt_pk_bf16_f32 v79,v74,v75
buffer_store_dwordx4 v[76:79],v3,s[8:11],s81 offen offset:3072 sc1
v_accvgpr_read_b32 v32,a152
v_accvgpr_read_b32 v33,a153
v_accvgpr_read_b32 v34,a154
v_accvgpr_read_b32 v35,a155
v_accvgpr_read_b32 v36,a156
v_accvgpr_read_b32 v37,a157
v_accvgpr_read_b32 v38,a158
v_accvgpr_read_b32 v39,a159
s_add_u32 s81,s83,790528
v_cvt_pk_bf16_f32 v40,v32,v33
v_cvt_pk_bf16_f32 v41,v34,v35
v_cvt_pk_bf16_f32 v42,v36,v37
v_cvt_pk_bf16_f32 v43,v38,v39
buffer_store_dwordx4 v[40:43],v3,s[8:11],s81 offen offset:0 sc1
v_accvgpr_read_b32 v44,a184
v_accvgpr_read_b32 v45,a185
v_accvgpr_read_b32 v46,a186
v_accvgpr_read_b32 v47,a187
v_accvgpr_read_b32 v48,a188
v_accvgpr_read_b32 v49,a189
v_accvgpr_read_b32 v50,a190
v_accvgpr_read_b32 v51,a191
v_cvt_pk_bf16_f32 v52,v44,v45
v_cvt_pk_bf16_f32 v53,v46,v47
v_cvt_pk_bf16_f32 v54,v48,v49
v_cvt_pk_bf16_f32 v55,v50,v51
buffer_store_dwordx4 v[52:55],v3,s[8:11],s81 offen offset:1024 sc1
v_accvgpr_read_b32 v56,a216
v_accvgpr_read_b32 v57,a217
v_accvgpr_read_b32 v58,a218
v_accvgpr_read_b32 v59,a219
v_accvgpr_read_b32 v60,a220
v_accvgpr_read_b32 v61,a221
v_accvgpr_read_b32 v62,a222
v_accvgpr_read_b32 v63,a223
v_cvt_pk_bf16_f32 v64,v56,v57
v_cvt_pk_bf16_f32 v65,v58,v59
v_cvt_pk_bf16_f32 v66,v60,v61
v_cvt_pk_bf16_f32 v67,v62,v63
buffer_store_dwordx4 v[64:67],v3,s[8:11],s81 offen offset:2048 sc1
v_accvgpr_read_b32 v68,a248
v_accvgpr_read_b32 v69,a249
v_accvgpr_read_b32 v70,a250
v_accvgpr_read_b32 v71,a251
v_accvgpr_read_b32 v72,a252
v_accvgpr_read_b32 v73,a253
v_accvgpr_read_b32 v74,a254
v_accvgpr_read_b32 v75,a255
v_cvt_pk_bf16_f32 v76,v68,v69
v_cvt_pk_bf16_f32 v77,v70,v71
v_cvt_pk_bf16_f32 v78,v72,v73
v_cvt_pk_bf16_f32 v79,v74,v75
buffer_store_dwordx4 v[76:79],v3,s[8:11],s81 offen offset:3072 sc1
s_branch Lg1_eend
Lg1_egu:
v_mov_b32 v100,0xc0135761
v_mov_b32 v101,v100
v_mov_b32 v98,0xbdd2d3e8
v_mov_b32 v99,v98
v_mov_b32 v96,1.0
v_mov_b32 v97,1.0
s_add_u32 s81,s83,0
v_accvgpr_read_b32 v32,a0
v_accvgpr_read_b32 v33,a1
v_accvgpr_read_b32 v34,a2
v_accvgpr_read_b32 v35,a3
v_accvgpr_read_b32 v36,a32
v_accvgpr_read_b32 v37,a33
v_accvgpr_read_b32 v38,a34
v_accvgpr_read_b32 v39,a35
v_accvgpr_read_b32 v40,a128
v_accvgpr_read_b32 v41,a129
v_accvgpr_read_b32 v42,a130
v_accvgpr_read_b32 v43,a131
v_accvgpr_read_b32 v44,a160
v_accvgpr_read_b32 v45,a161
v_accvgpr_read_b32 v46,a162
v_accvgpr_read_b32 v47,a163
v_pk_mul_f32 v[48:49],v[32:33],v[32:33]
v_pk_mul_f32 v[50:51],v[34:35],v[34:35]
v_pk_mul_f32 v[52:53],v[36:37],v[36:37]
v_pk_mul_f32 v[54:55],v[38:39],v[38:39]
v_pk_fma_f32 v[48:49],v[48:49],v[98:99],v[100:101]
v_pk_fma_f32 v[50:51],v[50:51],v[98:99],v[100:101]
v_pk_fma_f32 v[52:53],v[52:53],v[98:99],v[100:101]
v_pk_fma_f32 v[54:55],v[54:55],v[98:99],v[100:101]
v_pk_mul_f32 v[48:49],v[48:49],v[32:33]
v_pk_mul_f32 v[50:51],v[50:51],v[34:35]
v_pk_mul_f32 v[52:53],v[52:53],v[36:37]
v_pk_mul_f32 v[54:55],v[54:55],v[38:39]
v_exp_f32 v48,v48
v_exp_f32 v49,v49
v_exp_f32 v50,v50
v_exp_f32 v51,v51
v_exp_f32 v52,v52
v_exp_f32 v53,v53
v_exp_f32 v54,v54
v_exp_f32 v55,v55
v_pk_mul_f32 v[32:33],v[32:33],v[40:41]
v_pk_mul_f32 v[34:35],v[34:35],v[42:43]
v_pk_mul_f32 v[36:37],v[36:37],v[44:45]
v_pk_mul_f32 v[38:39],v[38:39],v[46:47]
v_pk_add_f32 v[48:49],v[48:49],v[96:97]
v_pk_add_f32 v[50:51],v[50:51],v[96:97]
v_pk_add_f32 v[52:53],v[52:53],v[96:97]
v_pk_add_f32 v[54:55],v[54:55],v[96:97]
v_rcp_f32 v48,v48
v_rcp_f32 v49,v49
v_rcp_f32 v50,v50
v_rcp_f32 v51,v51
v_rcp_f32 v52,v52
v_rcp_f32 v53,v53
v_rcp_f32 v54,v54
v_rcp_f32 v55,v55
s_nop 0
v_pk_mul_f32 v[32:33],v[32:33],v[48:49]
v_pk_mul_f32 v[34:35],v[34:35],v[50:51]
v_pk_mul_f32 v[36:37],v[36:37],v[52:53]
v_pk_mul_f32 v[38:39],v[38:39],v[54:55]
v_cvt_pk_bf16_f32 v56,v32,v33
v_cvt_pk_bf16_f32 v57,v34,v35
v_cvt_pk_bf16_f32 v58,v36,v37
v_cvt_pk_bf16_f32 v59,v38,v39
buffer_store_dwordx4 v[56:59],v3,s[8:11],s81 offen offset:0 sc1
v_accvgpr_read_b32 v64,a64
v_accvgpr_read_b32 v65,a65
v_accvgpr_read_b32 v66,a66
v_accvgpr_read_b32 v67,a67
v_accvgpr_read_b32 v68,a96
v_accvgpr_read_b32 v69,a97
v_accvgpr_read_b32 v70,a98
v_accvgpr_read_b32 v71,a99
v_accvgpr_read_b32 v72,a192
v_accvgpr_read_b32 v73,a193
v_accvgpr_read_b32 v74,a194
v_accvgpr_read_b32 v75,a195
v_accvgpr_read_b32 v76,a224
v_accvgpr_read_b32 v77,a225
v_accvgpr_read_b32 v78,a226
v_accvgpr_read_b32 v79,a227
v_pk_mul_f32 v[80:81],v[64:65],v[64:65]
v_pk_mul_f32 v[82:83],v[66:67],v[66:67]
v_pk_mul_f32 v[84:85],v[68:69],v[68:69]
v_pk_mul_f32 v[86:87],v[70:71],v[70:71]
v_pk_fma_f32 v[80:81],v[80:81],v[98:99],v[100:101]
v_pk_fma_f32 v[82:83],v[82:83],v[98:99],v[100:101]
v_pk_fma_f32 v[84:85],v[84:85],v[98:99],v[100:101]
v_pk_fma_f32 v[86:87],v[86:87],v[98:99],v[100:101]
v_pk_mul_f32 v[80:81],v[80:81],v[64:65]
v_pk_mul_f32 v[82:83],v[82:83],v[66:67]
v_pk_mul_f32 v[84:85],v[84:85],v[68:69]
v_pk_mul_f32 v[86:87],v[86:87],v[70:71]
v_exp_f32 v80,v80
v_exp_f32 v81,v81
v_exp_f32 v82,v82
v_exp_f32 v83,v83
v_exp_f32 v84,v84
v_exp_f32 v85,v85
v_exp_f32 v86,v86
v_exp_f32 v87,v87
v_pk_mul_f32 v[64:65],v[64:65],v[72:73]
v_pk_mul_f32 v[66:67],v[66:67],v[74:75]
v_pk_mul_f32 v[68:69],v[68:69],v[76:77]
v_pk_mul_f32 v[70:71],v[70:71],v[78:79]
v_pk_add_f32 v[80:81],v[80:81],v[96:97]
v_pk_add_f32 v[82:83],v[82:83],v[96:97]
v_pk_add_f32 v[84:85],v[84:85],v[96:97]
v_pk_add_f32 v[86:87],v[86:87],v[96:97]
v_rcp_f32 v80,v80
v_rcp_f32 v81,v81
v_rcp_f32 v82,v82
v_rcp_f32 v83,v83
v_rcp_f32 v84,v84
v_rcp_f32 v85,v85
v_rcp_f32 v86,v86
v_rcp_f32 v87,v87
s_nop 0
v_pk_mul_f32 v[64:65],v[64:65],v[80:81]
v_pk_mul_f32 v[66:67],v[66:67],v[82:83]
v_pk_mul_f32 v[68:69],v[68:69],v[84:85]
v_pk_mul_f32 v[70:71],v[70:71],v[86:87]
v_cvt_pk_bf16_f32 v88,v64,v65
v_cvt_pk_bf16_f32 v89,v66,v67
v_cvt_pk_bf16_f32 v90,v68,v69
v_cvt_pk_bf16_f32 v91,v70,v71
buffer_store_dwordx4 v[88:91],v3,s[8:11],s81 offen offset:1024 sc1
s_add_u32 s81,s83,147456
v_accvgpr_read_b32 v32,a4
v_accvgpr_read_b32 v33,a5
v_accvgpr_read_b32 v34,a6
v_accvgpr_read_b32 v35,a7
v_accvgpr_read_b32 v36,a36
v_accvgpr_read_b32 v37,a37
v_accvgpr_read_b32 v38,a38
v_accvgpr_read_b32 v39,a39
v_accvgpr_read_b32 v40,a132
v_accvgpr_read_b32 v41,a133
v_accvgpr_read_b32 v42,a134
v_accvgpr_read_b32 v43,a135
v_accvgpr_read_b32 v44,a164
v_accvgpr_read_b32 v45,a165
v_accvgpr_read_b32 v46,a166
v_accvgpr_read_b32 v47,a167
v_pk_mul_f32 v[48:49],v[32:33],v[32:33]
v_pk_mul_f32 v[50:51],v[34:35],v[34:35]
v_pk_mul_f32 v[52:53],v[36:37],v[36:37]
v_pk_mul_f32 v[54:55],v[38:39],v[38:39]
v_pk_fma_f32 v[48:49],v[48:49],v[98:99],v[100:101]
v_pk_fma_f32 v[50:51],v[50:51],v[98:99],v[100:101]
v_pk_fma_f32 v[52:53],v[52:53],v[98:99],v[100:101]
v_pk_fma_f32 v[54:55],v[54:55],v[98:99],v[100:101]
v_pk_mul_f32 v[48:49],v[48:49],v[32:33]
v_pk_mul_f32 v[50:51],v[50:51],v[34:35]
v_pk_mul_f32 v[52:53],v[52:53],v[36:37]
v_pk_mul_f32 v[54:55],v[54:55],v[38:39]
v_exp_f32 v48,v48
v_exp_f32 v49,v49
v_exp_f32 v50,v50
v_exp_f32 v51,v51
v_exp_f32 v52,v52
v_exp_f32 v53,v53
v_exp_f32 v54,v54
v_exp_f32 v55,v55
v_pk_mul_f32 v[32:33],v[32:33],v[40:41]
v_pk_mul_f32 v[34:35],v[34:35],v[42:43]
v_pk_mul_f32 v[36:37],v[36:37],v[44:45]
v_pk_mul_f32 v[38:39],v[38:39],v[46:47]
v_pk_add_f32 v[48:49],v[48:49],v[96:97]
v_pk_add_f32 v[50:51],v[50:51],v[96:97]
v_pk_add_f32 v[52:53],v[52:53],v[96:97]
v_pk_add_f32 v[54:55],v[54:55],v[96:97]
v_rcp_f32 v48,v48
v_rcp_f32 v49,v49
v_rcp_f32 v50,v50
v_rcp_f32 v51,v51
v_rcp_f32 v52,v52
v_rcp_f32 v53,v53
v_rcp_f32 v54,v54
v_rcp_f32 v55,v55
s_nop 0
v_pk_mul_f32 v[32:33],v[32:33],v[48:49]
v_pk_mul_f32 v[34:35],v[34:35],v[50:51]
v_pk_mul_f32 v[36:37],v[36:37],v[52:53]
v_pk_mul_f32 v[38:39],v[38:39],v[54:55]
v_cvt_pk_bf16_f32 v56,v32,v33
v_cvt_pk_bf16_f32 v57,v34,v35
v_cvt_pk_bf16_f32 v58,v36,v37
v_cvt_pk_bf16_f32 v59,v38,v39
buffer_store_dwordx4 v[56:59],v3,s[8:11],s81 offen offset:0 sc1
v_accvgpr_read_b32 v64,a68
v_accvgpr_read_b32 v65,a69
v_accvgpr_read_b32 v66,a70
v_accvgpr_read_b32 v67,a71
v_accvgpr_read_b32 v68,a100
v_accvgpr_read_b32 v69,a101
v_accvgpr_read_b32 v70,a102
v_accvgpr_read_b32 v71,a103
v_accvgpr_read_b32 v72,a196
v_accvgpr_read_b32 v73,a197
v_accvgpr_read_b32 v74,a198
v_accvgpr_read_b32 v75,a199
v_accvgpr_read_b32 v76,a228
v_accvgpr_read_b32 v77,a229
v_accvgpr_read_b32 v78,a230
v_accvgpr_read_b32 v79,a231
v_pk_mul_f32 v[80:81],v[64:65],v[64:65]
v_pk_mul_f32 v[82:83],v[66:67],v[66:67]
v_pk_mul_f32 v[84:85],v[68:69],v[68:69]
v_pk_mul_f32 v[86:87],v[70:71],v[70:71]
v_pk_fma_f32 v[80:81],v[80:81],v[98:99],v[100:101]
v_pk_fma_f32 v[82:83],v[82:83],v[98:99],v[100:101]
v_pk_fma_f32 v[84:85],v[84:85],v[98:99],v[100:101]
v_pk_fma_f32 v[86:87],v[86:87],v[98:99],v[100:101]
v_pk_mul_f32 v[80:81],v[80:81],v[64:65]
v_pk_mul_f32 v[82:83],v[82:83],v[66:67]
v_pk_mul_f32 v[84:85],v[84:85],v[68:69]
v_pk_mul_f32 v[86:87],v[86:87],v[70:71]
v_exp_f32 v80,v80
v_exp_f32 v81,v81
v_exp_f32 v82,v82
v_exp_f32 v83,v83
v_exp_f32 v84,v84
v_exp_f32 v85,v85
v_exp_f32 v86,v86
v_exp_f32 v87,v87
v_pk_mul_f32 v[64:65],v[64:65],v[72:73]
v_pk_mul_f32 v[66:67],v[66:67],v[74:75]
v_pk_mul_f32 v[68:69],v[68:69],v[76:77]
v_pk_mul_f32 v[70:71],v[70:71],v[78:79]
v_pk_add_f32 v[80:81],v[80:81],v[96:97]
v_pk_add_f32 v[82:83],v[82:83],v[96:97]
v_pk_add_f32 v[84:85],v[84:85],v[96:97]
v_pk_add_f32 v[86:87],v[86:87],v[96:97]
v_rcp_f32 v80,v80
v_rcp_f32 v81,v81
v_rcp_f32 v82,v82
v_rcp_f32 v83,v83
v_rcp_f32 v84,v84
v_rcp_f32 v85,v85
v_rcp_f32 v86,v86
v_rcp_f32 v87,v87
s_nop 0
v_pk_mul_f32 v[64:65],v[64:65],v[80:81]
v_pk_mul_f32 v[66:67],v[66:67],v[82:83]
v_pk_mul_f32 v[68:69],v[68:69],v[84:85]
v_pk_mul_f32 v[70:71],v[70:71],v[86:87]
v_cvt_pk_bf16_f32 v88,v64,v65
v_cvt_pk_bf16_f32 v89,v66,v67
v_cvt_pk_bf16_f32 v90,v68,v69
v_cvt_pk_bf16_f32 v91,v70,v71
buffer_store_dwordx4 v[88:91],v3,s[8:11],s81 offen offset:1024 sc1
s_add_u32 s81,s83,294912
v_accvgpr_read_b32 v32,a8
v_accvgpr_read_b32 v33,a9
v_accvgpr_read_b32 v34,a10
v_accvgpr_read_b32 v35,a11
v_accvgpr_read_b32 v36,a40
v_accvgpr_read_b32 v37,a41
v_accvgpr_read_b32 v38,a42
v_accvgpr_read_b32 v39,a43
v_accvgpr_read_b32 v40,a136
v_accvgpr_read_b32 v41,a137
v_accvgpr_read_b32 v42,a138
v_accvgpr_read_b32 v43,a139
v_accvgpr_read_b32 v44,a168
v_accvgpr_read_b32 v45,a169
v_accvgpr_read_b32 v46,a170
v_accvgpr_read_b32 v47,a171
v_pk_mul_f32 v[48:49],v[32:33],v[32:33]
v_pk_mul_f32 v[50:51],v[34:35],v[34:35]
v_pk_mul_f32 v[52:53],v[36:37],v[36:37]
v_pk_mul_f32 v[54:55],v[38:39],v[38:39]
v_pk_fma_f32 v[48:49],v[48:49],v[98:99],v[100:101]
v_pk_fma_f32 v[50:51],v[50:51],v[98:99],v[100:101]
v_pk_fma_f32 v[52:53],v[52:53],v[98:99],v[100:101]
v_pk_fma_f32 v[54:55],v[54:55],v[98:99],v[100:101]
v_pk_mul_f32 v[48:49],v[48:49],v[32:33]
v_pk_mul_f32 v[50:51],v[50:51],v[34:35]
v_pk_mul_f32 v[52:53],v[52:53],v[36:37]
v_pk_mul_f32 v[54:55],v[54:55],v[38:39]
v_exp_f32 v48,v48
v_exp_f32 v49,v49
v_exp_f32 v50,v50
v_exp_f32 v51,v51
v_exp_f32 v52,v52
v_exp_f32 v53,v53
v_exp_f32 v54,v54
v_exp_f32 v55,v55
v_pk_mul_f32 v[32:33],v[32:33],v[40:41]
v_pk_mul_f32 v[34:35],v[34:35],v[42:43]
v_pk_mul_f32 v[36:37],v[36:37],v[44:45]
v_pk_mul_f32 v[38:39],v[38:39],v[46:47]
v_pk_add_f32 v[48:49],v[48:49],v[96:97]
v_pk_add_f32 v[50:51],v[50:51],v[96:97]
v_pk_add_f32 v[52:53],v[52:53],v[96:97]
v_pk_add_f32 v[54:55],v[54:55],v[96:97]
v_rcp_f32 v48,v48
v_rcp_f32 v49,v49
v_rcp_f32 v50,v50
v_rcp_f32 v51,v51
v_rcp_f32 v52,v52
v_rcp_f32 v53,v53
v_rcp_f32 v54,v54
v_rcp_f32 v55,v55
s_nop 0
v_pk_mul_f32 v[32:33],v[32:33],v[48:49]
v_pk_mul_f32 v[34:35],v[34:35],v[50:51]
v_pk_mul_f32 v[36:37],v[36:37],v[52:53]
v_pk_mul_f32 v[38:39],v[38:39],v[54:55]
v_cvt_pk_bf16_f32 v56,v32,v33
v_cvt_pk_bf16_f32 v57,v34,v35
v_cvt_pk_bf16_f32 v58,v36,v37
v_cvt_pk_bf16_f32 v59,v38,v39
buffer_store_dwordx4 v[56:59],v3,s[8:11],s81 offen offset:0 sc1
v_accvgpr_read_b32 v64,a72
v_accvgpr_read_b32 v65,a73
v_accvgpr_read_b32 v66,a74
v_accvgpr_read_b32 v67,a75
v_accvgpr_read_b32 v68,a104
v_accvgpr_read_b32 v69,a105
v_accvgpr_read_b32 v70,a106
v_accvgpr_read_b32 v71,a107
v_accvgpr_read_b32 v72,a200
v_accvgpr_read_b32 v73,a201
v_accvgpr_read_b32 v74,a202
v_accvgpr_read_b32 v75,a203
v_accvgpr_read_b32 v76,a232
v_accvgpr_read_b32 v77,a233
v_accvgpr_read_b32 v78,a234
v_accvgpr_read_b32 v79,a235
v_pk_mul_f32 v[80:81],v[64:65],v[64:65]
v_pk_mul_f32 v[82:83],v[66:67],v[66:67]
v_pk_mul_f32 v[84:85],v[68:69],v[68:69]
v_pk_mul_f32 v[86:87],v[70:71],v[70:71]
v_pk_fma_f32 v[80:81],v[80:81],v[98:99],v[100:101]
v_pk_fma_f32 v[82:83],v[82:83],v[98:99],v[100:101]
v_pk_fma_f32 v[84:85],v[84:85],v[98:99],v[100:101]
v_pk_fma_f32 v[86:87],v[86:87],v[98:99],v[100:101]
v_pk_mul_f32 v[80:81],v[80:81],v[64:65]
v_pk_mul_f32 v[82:83],v[82:83],v[66:67]
v_pk_mul_f32 v[84:85],v[84:85],v[68:69]
v_pk_mul_f32 v[86:87],v[86:87],v[70:71]
v_exp_f32 v80,v80
v_exp_f32 v81,v81
v_exp_f32 v82,v82
v_exp_f32 v83,v83
v_exp_f32 v84,v84
v_exp_f32 v85,v85
v_exp_f32 v86,v86
v_exp_f32 v87,v87
v_pk_mul_f32 v[64:65],v[64:65],v[72:73]
v_pk_mul_f32 v[66:67],v[66:67],v[74:75]
v_pk_mul_f32 v[68:69],v[68:69],v[76:77]
v_pk_mul_f32 v[70:71],v[70:71],v[78:79]
v_pk_add_f32 v[80:81],v[80:81],v[96:97]
v_pk_add_f32 v[82:83],v[82:83],v[96:97]
v_pk_add_f32 v[84:85],v[84:85],v[96:97]
v_pk_add_f32 v[86:87],v[86:87],v[96:97]
v_rcp_f32 v80,v80
v_rcp_f32 v81,v81
v_rcp_f32 v82,v82
v_rcp_f32 v83,v83
v_rcp_f32 v84,v84
v_rcp_f32 v85,v85
v_rcp_f32 v86,v86
v_rcp_f32 v87,v87
s_nop 0
v_pk_mul_f32 v[64:65],v[64:65],v[80:81]
v_pk_mul_f32 v[66:67],v[66:67],v[82:83]
v_pk_mul_f32 v[68:69],v[68:69],v[84:85]
v_pk_mul_f32 v[70:71],v[70:71],v[86:87]
v_cvt_pk_bf16_f32 v88,v64,v65
v_cvt_pk_bf16_f32 v89,v66,v67
v_cvt_pk_bf16_f32 v90,v68,v69
v_cvt_pk_bf16_f32 v91,v70,v71
buffer_store_dwordx4 v[88:91],v3,s[8:11],s81 offen offset:1024 sc1
s_add_u32 s81,s83,442368
v_accvgpr_read_b32 v32,a12
v_accvgpr_read_b32 v33,a13
v_accvgpr_read_b32 v34,a14
v_accvgpr_read_b32 v35,a15
v_accvgpr_read_b32 v36,a44
v_accvgpr_read_b32 v37,a45
v_accvgpr_read_b32 v38,a46
v_accvgpr_read_b32 v39,a47
v_accvgpr_read_b32 v40,a140
v_accvgpr_read_b32 v41,a141
v_accvgpr_read_b32 v42,a142
v_accvgpr_read_b32 v43,a143
v_accvgpr_read_b32 v44,a172
v_accvgpr_read_b32 v45,a173
v_accvgpr_read_b32 v46,a174
v_accvgpr_read_b32 v47,a175
v_pk_mul_f32 v[48:49],v[32:33],v[32:33]
v_pk_mul_f32 v[50:51],v[34:35],v[34:35]
v_pk_mul_f32 v[52:53],v[36:37],v[36:37]
v_pk_mul_f32 v[54:55],v[38:39],v[38:39]
v_pk_fma_f32 v[48:49],v[48:49],v[98:99],v[100:101]
v_pk_fma_f32 v[50:51],v[50:51],v[98:99],v[100:101]
v_pk_fma_f32 v[52:53],v[52:53],v[98:99],v[100:101]
v_pk_fma_f32 v[54:55],v[54:55],v[98:99],v[100:101]
v_pk_mul_f32 v[48:49],v[48:49],v[32:33]
v_pk_mul_f32 v[50:51],v[50:51],v[34:35]
v_pk_mul_f32 v[52:53],v[52:53],v[36:37]
v_pk_mul_f32 v[54:55],v[54:55],v[38:39]
v_exp_f32 v48,v48
v_exp_f32 v49,v49
v_exp_f32 v50,v50
v_exp_f32 v51,v51
v_exp_f32 v52,v52
v_exp_f32 v53,v53
v_exp_f32 v54,v54
v_exp_f32 v55,v55
v_pk_mul_f32 v[32:33],v[32:33],v[40:41]
v_pk_mul_f32 v[34:35],v[34:35],v[42:43]
v_pk_mul_f32 v[36:37],v[36:37],v[44:45]
v_pk_mul_f32 v[38:39],v[38:39],v[46:47]
v_pk_add_f32 v[48:49],v[48:49],v[96:97]
v_pk_add_f32 v[50:51],v[50:51],v[96:97]
v_pk_add_f32 v[52:53],v[52:53],v[96:97]
v_pk_add_f32 v[54:55],v[54:55],v[96:97]
v_rcp_f32 v48,v48
v_rcp_f32 v49,v49
v_rcp_f32 v50,v50
v_rcp_f32 v51,v51
v_rcp_f32 v52,v52
v_rcp_f32 v53,v53
v_rcp_f32 v54,v54
v_rcp_f32 v55,v55
s_nop 0
v_pk_mul_f32 v[32:33],v[32:33],v[48:49]
v_pk_mul_f32 v[34:35],v[34:35],v[50:51]
v_pk_mul_f32 v[36:37],v[36:37],v[52:53]
v_pk_mul_f32 v[38:39],v[38:39],v[54:55]
v_cvt_pk_bf16_f32 v56,v32,v33
v_cvt_pk_bf16_f32 v57,v34,v35
v_cvt_pk_bf16_f32 v58,v36,v37
v_cvt_pk_bf16_f32 v59,v38,v39
buffer_store_dwordx4 v[56:59],v3,s[8:11],s81 offen offset:0 sc1
v_accvgpr_read_b32 v64,a76
v_accvgpr_read_b32 v65,a77
v_accvgpr_read_b32 v66,a78
v_accvgpr_read_b32 v67,a79
v_accvgpr_read_b32 v68,a108
v_accvgpr_read_b32 v69,a109
v_accvgpr_read_b32 v70,a110
v_accvgpr_read_b32 v71,a111
v_accvgpr_read_b32 v72,a204
v_accvgpr_read_b32 v73,a205
v_accvgpr_read_b32 v74,a206
v_accvgpr_read_b32 v75,a207
v_accvgpr_read_b32 v76,a236
v_accvgpr_read_b32 v77,a237
v_accvgpr_read_b32 v78,a238
v_accvgpr_read_b32 v79,a239
v_pk_mul_f32 v[80:81],v[64:65],v[64:65]
v_pk_mul_f32 v[82:83],v[66:67],v[66:67]
v_pk_mul_f32 v[84:85],v[68:69],v[68:69]
v_pk_mul_f32 v[86:87],v[70:71],v[70:71]
v_pk_fma_f32 v[80:81],v[80:81],v[98:99],v[100:101]
v_pk_fma_f32 v[82:83],v[82:83],v[98:99],v[100:101]
v_pk_fma_f32 v[84:85],v[84:85],v[98:99],v[100:101]
v_pk_fma_f32 v[86:87],v[86:87],v[98:99],v[100:101]
v_pk_mul_f32 v[80:81],v[80:81],v[64:65]
v_pk_mul_f32 v[82:83],v[82:83],v[66:67]
v_pk_mul_f32 v[84:85],v[84:85],v[68:69]
v_pk_mul_f32 v[86:87],v[86:87],v[70:71]
v_exp_f32 v80,v80
v_exp_f32 v81,v81
v_exp_f32 v82,v82
v_exp_f32 v83,v83
v_exp_f32 v84,v84
v_exp_f32 v85,v85
v_exp_f32 v86,v86
v_exp_f32 v87,v87
v_pk_mul_f32 v[64:65],v[64:65],v[72:73]
v_pk_mul_f32 v[66:67],v[66:67],v[74:75]
v_pk_mul_f32 v[68:69],v[68:69],v[76:77]
v_pk_mul_f32 v[70:71],v[70:71],v[78:79]
v_pk_add_f32 v[80:81],v[80:81],v[96:97]
v_pk_add_f32 v[82:83],v[82:83],v[96:97]
v_pk_add_f32 v[84:85],v[84:85],v[96:97]
v_pk_add_f32 v[86:87],v[86:87],v[96:97]
v_rcp_f32 v80,v80
v_rcp_f32 v81,v81
v_rcp_f32 v82,v82
v_rcp_f32 v83,v83
v_rcp_f32 v84,v84
v_rcp_f32 v85,v85
v_rcp_f32 v86,v86
v_rcp_f32 v87,v87
s_nop 0
v_pk_mul_f32 v[64:65],v[64:65],v[80:81]
v_pk_mul_f32 v[66:67],v[66:67],v[82:83]
v_pk_mul_f32 v[68:69],v[68:69],v[84:85]
v_pk_mul_f32 v[70:71],v[70:71],v[86:87]
v_cvt_pk_bf16_f32 v88,v64,v65
v_cvt_pk_bf16_f32 v89,v66,v67
v_cvt_pk_bf16_f32 v90,v68,v69
v_cvt_pk_bf16_f32 v91,v70,v71
buffer_store_dwordx4 v[88:91],v3,s[8:11],s81 offen offset:1024 sc1
s_add_u32 s81,s83,589824
v_accvgpr_read_b32 v32,a16
v_accvgpr_read_b32 v33,a17
v_accvgpr_read_b32 v34,a18
v_accvgpr_read_b32 v35,a19
v_accvgpr_read_b32 v36,a48
v_accvgpr_read_b32 v37,a49
v_accvgpr_read_b32 v38,a50
v_accvgpr_read_b32 v39,a51
v_accvgpr_read_b32 v40,a144
v_accvgpr_read_b32 v41,a145
v_accvgpr_read_b32 v42,a146
v_accvgpr_read_b32 v43,a147
v_accvgpr_read_b32 v44,a176
v_accvgpr_read_b32 v45,a177
v_accvgpr_read_b32 v46,a178
v_accvgpr_read_b32 v47,a179
v_pk_mul_f32 v[48:49],v[32:33],v[32:33]
v_pk_mul_f32 v[50:51],v[34:35],v[34:35]
v_pk_mul_f32 v[52:53],v[36:37],v[36:37]
v_pk_mul_f32 v[54:55],v[38:39],v[38:39]
v_pk_fma_f32 v[48:49],v[48:49],v[98:99],v[100:101]
v_pk_fma_f32 v[50:51],v[50:51],v[98:99],v[100:101]
v_pk_fma_f32 v[52:53],v[52:53],v[98:99],v[100:101]
v_pk_fma_f32 v[54:55],v[54:55],v[98:99],v[100:101]
v_pk_mul_f32 v[48:49],v[48:49],v[32:33]
v_pk_mul_f32 v[50:51],v[50:51],v[34:35]
v_pk_mul_f32 v[52:53],v[52:53],v[36:37]
v_pk_mul_f32 v[54:55],v[54:55],v[38:39]
v_exp_f32 v48,v48
v_exp_f32 v49,v49
v_exp_f32 v50,v50
v_exp_f32 v51,v51
v_exp_f32 v52,v52
v_exp_f32 v53,v53
v_exp_f32 v54,v54
v_exp_f32 v55,v55
v_pk_mul_f32 v[32:33],v[32:33],v[40:41]
v_pk_mul_f32 v[34:35],v[34:35],v[42:43]
v_pk_mul_f32 v[36:37],v[36:37],v[44:45]
v_pk_mul_f32 v[38:39],v[38:39],v[46:47]
v_pk_add_f32 v[48:49],v[48:49],v[96:97]
v_pk_add_f32 v[50:51],v[50:51],v[96:97]
v_pk_add_f32 v[52:53],v[52:53],v[96:97]
v_pk_add_f32 v[54:55],v[54:55],v[96:97]
v_rcp_f32 v48,v48
v_rcp_f32 v49,v49
v_rcp_f32 v50,v50
v_rcp_f32 v51,v51
v_rcp_f32 v52,v52
v_rcp_f32 v53,v53
v_rcp_f32 v54,v54
v_rcp_f32 v55,v55
s_nop 0
v_pk_mul_f32 v[32:33],v[32:33],v[48:49]
v_pk_mul_f32 v[34:35],v[34:35],v[50:51]
v_pk_mul_f32 v[36:37],v[36:37],v[52:53]
v_pk_mul_f32 v[38:39],v[38:39],v[54:55]
v_cvt_pk_bf16_f32 v56,v32,v33
v_cvt_pk_bf16_f32 v57,v34,v35
v_cvt_pk_bf16_f32 v58,v36,v37
v_cvt_pk_bf16_f32 v59,v38,v39
buffer_store_dwordx4 v[56:59],v3,s[8:11],s81 offen offset:0 sc1
v_accvgpr_read_b32 v64,a80
v_accvgpr_read_b32 v65,a81
v_accvgpr_read_b32 v66,a82
v_accvgpr_read_b32 v67,a83
v_accvgpr_read_b32 v68,a112
v_accvgpr_read_b32 v69,a113
v_accvgpr_read_b32 v70,a114
v_accvgpr_read_b32 v71,a115
v_accvgpr_read_b32 v72,a208
v_accvgpr_read_b32 v73,a209
v_accvgpr_read_b32 v74,a210
v_accvgpr_read_b32 v75,a211
v_accvgpr_read_b32 v76,a240
v_accvgpr_read_b32 v77,a241
v_accvgpr_read_b32 v78,a242
v_accvgpr_read_b32 v79,a243
v_pk_mul_f32 v[80:81],v[64:65],v[64:65]
v_pk_mul_f32 v[82:83],v[66:67],v[66:67]
v_pk_mul_f32 v[84:85],v[68:69],v[68:69]
v_pk_mul_f32 v[86:87],v[70:71],v[70:71]
v_pk_fma_f32 v[80:81],v[80:81],v[98:99],v[100:101]
v_pk_fma_f32 v[82:83],v[82:83],v[98:99],v[100:101]
v_pk_fma_f32 v[84:85],v[84:85],v[98:99],v[100:101]
v_pk_fma_f32 v[86:87],v[86:87],v[98:99],v[100:101]
v_pk_mul_f32 v[80:81],v[80:81],v[64:65]
v_pk_mul_f32 v[82:83],v[82:83],v[66:67]
v_pk_mul_f32 v[84:85],v[84:85],v[68:69]
v_pk_mul_f32 v[86:87],v[86:87],v[70:71]
v_exp_f32 v80,v80
v_exp_f32 v81,v81
v_exp_f32 v82,v82
v_exp_f32 v83,v83
v_exp_f32 v84,v84
v_exp_f32 v85,v85
v_exp_f32 v86,v86
v_exp_f32 v87,v87
v_pk_mul_f32 v[64:65],v[64:65],v[72:73]
v_pk_mul_f32 v[66:67],v[66:67],v[74:75]
v_pk_mul_f32 v[68:69],v[68:69],v[76:77]
v_pk_mul_f32 v[70:71],v[70:71],v[78:79]
v_pk_add_f32 v[80:81],v[80:81],v[96:97]
v_pk_add_f32 v[82:83],v[82:83],v[96:97]
v_pk_add_f32 v[84:85],v[84:85],v[96:97]
v_pk_add_f32 v[86:87],v[86:87],v[96:97]
v_rcp_f32 v80,v80
v_rcp_f32 v81,v81
v_rcp_f32 v82,v82
v_rcp_f32 v83,v83
v_rcp_f32 v84,v84
v_rcp_f32 v85,v85
v_rcp_f32 v86,v86
v_rcp_f32 v87,v87
s_nop 0
v_pk_mul_f32 v[64:65],v[64:65],v[80:81]
v_pk_mul_f32 v[66:67],v[66:67],v[82:83]
v_pk_mul_f32 v[68:69],v[68:69],v[84:85]
v_pk_mul_f32 v[70:71],v[70:71],v[86:87]
v_cvt_pk_bf16_f32 v88,v64,v65
v_cvt_pk_bf16_f32 v89,v66,v67
v_cvt_pk_bf16_f32 v90,v68,v69
v_cvt_pk_bf16_f32 v91,v70,v71
buffer_store_dwordx4 v[88:91],v3,s[8:11],s81 offen offset:1024 sc1
s_add_u32 s81,s83,737280
v_accvgpr_read_b32 v32,a20
v_accvgpr_read_b32 v33,a21
v_accvgpr_read_b32 v34,a22
v_accvgpr_read_b32 v35,a23
v_accvgpr_read_b32 v36,a52
v_accvgpr_read_b32 v37,a53
v_accvgpr_read_b32 v38,a54
v_accvgpr_read_b32 v39,a55
v_accvgpr_read_b32 v40,a148
v_accvgpr_read_b32 v41,a149
v_accvgpr_read_b32 v42,a150
v_accvgpr_read_b32 v43,a151
v_accvgpr_read_b32 v44,a180
v_accvgpr_read_b32 v45,a181
v_accvgpr_read_b32 v46,a182
v_accvgpr_read_b32 v47,a183
v_pk_mul_f32 v[48:49],v[32:33],v[32:33]
v_pk_mul_f32 v[50:51],v[34:35],v[34:35]
v_pk_mul_f32 v[52:53],v[36:37],v[36:37]
v_pk_mul_f32 v[54:55],v[38:39],v[38:39]
v_pk_fma_f32 v[48:49],v[48:49],v[98:99],v[100:101]
v_pk_fma_f32 v[50:51],v[50:51],v[98:99],v[100:101]
v_pk_fma_f32 v[52:53],v[52:53],v[98:99],v[100:101]
v_pk_fma_f32 v[54:55],v[54:55],v[98:99],v[100:101]
v_pk_mul_f32 v[48:49],v[48:49],v[32:33]
v_pk_mul_f32 v[50:51],v[50:51],v[34:35]
v_pk_mul_f32 v[52:53],v[52:53],v[36:37]
v_pk_mul_f32 v[54:55],v[54:55],v[38:39]
v_exp_f32 v48,v48
v_exp_f32 v49,v49
v_exp_f32 v50,v50
v_exp_f32 v51,v51
v_exp_f32 v52,v52
v_exp_f32 v53,v53
v_exp_f32 v54,v54
v_exp_f32 v55,v55
v_pk_mul_f32 v[32:33],v[32:33],v[40:41]
v_pk_mul_f32 v[34:35],v[34:35],v[42:43]
v_pk_mul_f32 v[36:37],v[36:37],v[44:45]
v_pk_mul_f32 v[38:39],v[38:39],v[46:47]
v_pk_add_f32 v[48:49],v[48:49],v[96:97]
v_pk_add_f32 v[50:51],v[50:51],v[96:97]
v_pk_add_f32 v[52:53],v[52:53],v[96:97]
v_pk_add_f32 v[54:55],v[54:55],v[96:97]
v_rcp_f32 v48,v48
v_rcp_f32 v49,v49
v_rcp_f32 v50,v50
v_rcp_f32 v51,v51
v_rcp_f32 v52,v52
v_rcp_f32 v53,v53
v_rcp_f32 v54,v54
v_rcp_f32 v55,v55
s_nop 0
v_pk_mul_f32 v[32:33],v[32:33],v[48:49]
v_pk_mul_f32 v[34:35],v[34:35],v[50:51]
v_pk_mul_f32 v[36:37],v[36:37],v[52:53]
v_pk_mul_f32 v[38:39],v[38:39],v[54:55]
v_cvt_pk_bf16_f32 v56,v32,v33
v_cvt_pk_bf16_f32 v57,v34,v35
v_cvt_pk_bf16_f32 v58,v36,v37
v_cvt_pk_bf16_f32 v59,v38,v39
buffer_store_dwordx4 v[56:59],v3,s[8:11],s81 offen offset:0 sc1
v_accvgpr_read_b32 v64,a84
v_accvgpr_read_b32 v65,a85
v_accvgpr_read_b32 v66,a86
v_accvgpr_read_b32 v67,a87
v_accvgpr_read_b32 v68,a116
v_accvgpr_read_b32 v69,a117
v_accvgpr_read_b32 v70,a118
v_accvgpr_read_b32 v71,a119
v_accvgpr_read_b32 v72,a212
v_accvgpr_read_b32 v73,a213
v_accvgpr_read_b32 v74,a214
v_accvgpr_read_b32 v75,a215
v_accvgpr_read_b32 v76,a244
v_accvgpr_read_b32 v77,a245
v_accvgpr_read_b32 v78,a246
v_accvgpr_read_b32 v79,a247
v_pk_mul_f32 v[80:81],v[64:65],v[64:65]
v_pk_mul_f32 v[82:83],v[66:67],v[66:67]
v_pk_mul_f32 v[84:85],v[68:69],v[68:69]
v_pk_mul_f32 v[86:87],v[70:71],v[70:71]
v_pk_fma_f32 v[80:81],v[80:81],v[98:99],v[100:101]
v_pk_fma_f32 v[82:83],v[82:83],v[98:99],v[100:101]
v_pk_fma_f32 v[84:85],v[84:85],v[98:99],v[100:101]
v_pk_fma_f32 v[86:87],v[86:87],v[98:99],v[100:101]
v_pk_mul_f32 v[80:81],v[80:81],v[64:65]
v_pk_mul_f32 v[82:83],v[82:83],v[66:67]
v_pk_mul_f32 v[84:85],v[84:85],v[68:69]
v_pk_mul_f32 v[86:87],v[86:87],v[70:71]
v_exp_f32 v80,v80
v_exp_f32 v81,v81
v_exp_f32 v82,v82
v_exp_f32 v83,v83
v_exp_f32 v84,v84
v_exp_f32 v85,v85
v_exp_f32 v86,v86
v_exp_f32 v87,v87
v_pk_mul_f32 v[64:65],v[64:65],v[72:73]
v_pk_mul_f32 v[66:67],v[66:67],v[74:75]
v_pk_mul_f32 v[68:69],v[68:69],v[76:77]
v_pk_mul_f32 v[70:71],v[70:71],v[78:79]
v_pk_add_f32 v[80:81],v[80:81],v[96:97]
v_pk_add_f32 v[82:83],v[82:83],v[96:97]
v_pk_add_f32 v[84:85],v[84:85],v[96:97]
v_pk_add_f32 v[86:87],v[86:87],v[96:97]
v_rcp_f32 v80,v80
v_rcp_f32 v81,v81
v_rcp_f32 v82,v82
v_rcp_f32 v83,v83
v_rcp_f32 v84,v84
v_rcp_f32 v85,v85
v_rcp_f32 v86,v86
v_rcp_f32 v87,v87
s_nop 0
v_pk_mul_f32 v[64:65],v[64:65],v[80:81]
v_pk_mul_f32 v[66:67],v[66:67],v[82:83]
v_pk_mul_f32 v[68:69],v[68:69],v[84:85]
v_pk_mul_f32 v[70:71],v[70:71],v[86:87]
v_cvt_pk_bf16_f32 v88,v64,v65
v_cvt_pk_bf16_f32 v89,v66,v67
v_cvt_pk_bf16_f32 v90,v68,v69
v_cvt_pk_bf16_f32 v91,v70,v71
buffer_store_dwordx4 v[88:91],v3,s[8:11],s81 offen offset:1024 sc1
s_add_u32 s81,s83,884736
v_accvgpr_read_b32 v32,a24
v_accvgpr_read_b32 v33,a25
v_accvgpr_read_b32 v34,a26
v_accvgpr_read_b32 v35,a27
v_accvgpr_read_b32 v36,a56
v_accvgpr_read_b32 v37,a57
v_accvgpr_read_b32 v38,a58
v_accvgpr_read_b32 v39,a59
v_accvgpr_read_b32 v40,a152
v_accvgpr_read_b32 v41,a153
v_accvgpr_read_b32 v42,a154
v_accvgpr_read_b32 v43,a155
v_accvgpr_read_b32 v44,a184
v_accvgpr_read_b32 v45,a185
v_accvgpr_read_b32 v46,a186
v_accvgpr_read_b32 v47,a187
v_pk_mul_f32 v[48:49],v[32:33],v[32:33]
v_pk_mul_f32 v[50:51],v[34:35],v[34:35]
v_pk_mul_f32 v[52:53],v[36:37],v[36:37]
v_pk_mul_f32 v[54:55],v[38:39],v[38:39]
v_pk_fma_f32 v[48:49],v[48:49],v[98:99],v[100:101]
v_pk_fma_f32 v[50:51],v[50:51],v[98:99],v[100:101]
v_pk_fma_f32 v[52:53],v[52:53],v[98:99],v[100:101]
v_pk_fma_f32 v[54:55],v[54:55],v[98:99],v[100:101]
v_pk_mul_f32 v[48:49],v[48:49],v[32:33]
v_pk_mul_f32 v[50:51],v[50:51],v[34:35]
v_pk_mul_f32 v[52:53],v[52:53],v[36:37]
v_pk_mul_f32 v[54:55],v[54:55],v[38:39]
v_exp_f32 v48,v48
v_exp_f32 v49,v49
v_exp_f32 v50,v50
v_exp_f32 v51,v51
v_exp_f32 v52,v52
v_exp_f32 v53,v53
v_exp_f32 v54,v54
v_exp_f32 v55,v55
v_pk_mul_f32 v[32:33],v[32:33],v[40:41]
v_pk_mul_f32 v[34:35],v[34:35],v[42:43]
v_pk_mul_f32 v[36:37],v[36:37],v[44:45]
v_pk_mul_f32 v[38:39],v[38:39],v[46:47]
v_pk_add_f32 v[48:49],v[48:49],v[96:97]
v_pk_add_f32 v[50:51],v[50:51],v[96:97]
v_pk_add_f32 v[52:53],v[52:53],v[96:97]
v_pk_add_f32 v[54:55],v[54:55],v[96:97]
v_rcp_f32 v48,v48
v_rcp_f32 v49,v49
v_rcp_f32 v50,v50
v_rcp_f32 v51,v51
v_rcp_f32 v52,v52
v_rcp_f32 v53,v53
v_rcp_f32 v54,v54
v_rcp_f32 v55,v55
s_nop 0
v_pk_mul_f32 v[32:33],v[32:33],v[48:49]
v_pk_mul_f32 v[34:35],v[34:35],v[50:51]
v_pk_mul_f32 v[36:37],v[36:37],v[52:53]
v_pk_mul_f32 v[38:39],v[38:39],v[54:55]
v_cvt_pk_bf16_f32 v56,v32,v33
v_cvt_pk_bf16_f32 v57,v34,v35
v_cvt_pk_bf16_f32 v58,v36,v37
v_cvt_pk_bf16_f32 v59,v38,v39
buffer_store_dwordx4 v[56:59],v3,s[8:11],s81 offen offset:0 sc1
v_accvgpr_read_b32 v64,a88
v_accvgpr_read_b32 v65,a89
v_accvgpr_read_b32 v66,a90
v_accvgpr_read_b32 v67,a91
v_accvgpr_read_b32 v68,a120
v_accvgpr_read_b32 v69,a121
v_accvgpr_read_b32 v70,a122
v_accvgpr_read_b32 v71,a123
v_accvgpr_read_b32 v72,a216
v_accvgpr_read_b32 v73,a217
v_accvgpr_read_b32 v74,a218
v_accvgpr_read_b32 v75,a219
v_accvgpr_read_b32 v76,a248
v_accvgpr_read_b32 v77,a249
v_accvgpr_read_b32 v78,a250
v_accvgpr_read_b32 v79,a251
v_pk_mul_f32 v[80:81],v[64:65],v[64:65]
v_pk_mul_f32 v[82:83],v[66:67],v[66:67]
v_pk_mul_f32 v[84:85],v[68:69],v[68:69]
v_pk_mul_f32 v[86:87],v[70:71],v[70:71]
v_pk_fma_f32 v[80:81],v[80:81],v[98:99],v[100:101]
v_pk_fma_f32 v[82:83],v[82:83],v[98:99],v[100:101]
v_pk_fma_f32 v[84:85],v[84:85],v[98:99],v[100:101]
v_pk_fma_f32 v[86:87],v[86:87],v[98:99],v[100:101]
v_pk_mul_f32 v[80:81],v[80:81],v[64:65]
v_pk_mul_f32 v[82:83],v[82:83],v[66:67]
v_pk_mul_f32 v[84:85],v[84:85],v[68:69]
v_pk_mul_f32 v[86:87],v[86:87],v[70:71]
v_exp_f32 v80,v80
v_exp_f32 v81,v81
v_exp_f32 v82,v82
v_exp_f32 v83,v83
v_exp_f32 v84,v84
v_exp_f32 v85,v85
v_exp_f32 v86,v86
v_exp_f32 v87,v87
v_pk_mul_f32 v[64:65],v[64:65],v[72:73]
v_pk_mul_f32 v[66:67],v[66:67],v[74:75]
v_pk_mul_f32 v[68:69],v[68:69],v[76:77]
v_pk_mul_f32 v[70:71],v[70:71],v[78:79]
v_pk_add_f32 v[80:81],v[80:81],v[96:97]
v_pk_add_f32 v[82:83],v[82:83],v[96:97]
v_pk_add_f32 v[84:85],v[84:85],v[96:97]
v_pk_add_f32 v[86:87],v[86:87],v[96:97]
v_rcp_f32 v80,v80
v_rcp_f32 v81,v81
v_rcp_f32 v82,v82
v_rcp_f32 v83,v83
v_rcp_f32 v84,v84
v_rcp_f32 v85,v85
v_rcp_f32 v86,v86
v_rcp_f32 v87,v87
s_nop 0
v_pk_mul_f32 v[64:65],v[64:65],v[80:81]
v_pk_mul_f32 v[66:67],v[66:67],v[82:83]
v_pk_mul_f32 v[68:69],v[68:69],v[84:85]
v_pk_mul_f32 v[70:71],v[70:71],v[86:87]
v_cvt_pk_bf16_f32 v88,v64,v65
v_cvt_pk_bf16_f32 v89,v66,v67
v_cvt_pk_bf16_f32 v90,v68,v69
v_cvt_pk_bf16_f32 v91,v70,v71
buffer_store_dwordx4 v[88:91],v3,s[8:11],s81 offen offset:1024 sc1
s_add_u32 s81,s83,1032192
v_accvgpr_read_b32 v32,a28
v_accvgpr_read_b32 v33,a29
v_accvgpr_read_b32 v34,a30
v_accvgpr_read_b32 v35,a31
v_accvgpr_read_b32 v36,a60
v_accvgpr_read_b32 v37,a61
v_accvgpr_read_b32 v38,a62
v_accvgpr_read_b32 v39,a63
v_accvgpr_read_b32 v40,a156
v_accvgpr_read_b32 v41,a157
v_accvgpr_read_b32 v42,a158
v_accvgpr_read_b32 v43,a159
v_accvgpr_read_b32 v44,a188
v_accvgpr_read_b32 v45,a189
v_accvgpr_read_b32 v46,a190
v_accvgpr_read_b32 v47,a191
v_pk_mul_f32 v[48:49],v[32:33],v[32:33]
v_pk_mul_f32 v[50:51],v[34:35],v[34:35]
v_pk_mul_f32 v[52:53],v[36:37],v[36:37]
v_pk_mul_f32 v[54:55],v[38:39],v[38:39]
v_pk_fma_f32 v[48:49],v[48:49],v[98:99],v[100:101]
v_pk_fma_f32 v[50:51],v[50:51],v[98:99],v[100:101]
v_pk_fma_f32 v[52:53],v[52:53],v[98:99],v[100:101]
v_pk_fma_f32 v[54:55],v[54:55],v[98:99],v[100:101]
v_pk_mul_f32 v[48:49],v[48:49],v[32:33]
v_pk_mul_f32 v[50:51],v[50:51],v[34:35]
v_pk_mul_f32 v[52:53],v[52:53],v[36:37]
v_pk_mul_f32 v[54:55],v[54:55],v[38:39]
v_exp_f32 v48,v48
v_exp_f32 v49,v49
v_exp_f32 v50,v50
v_exp_f32 v51,v51
v_exp_f32 v52,v52
v_exp_f32 v53,v53
v_exp_f32 v54,v54
v_exp_f32 v55,v55
v_pk_mul_f32 v[32:33],v[32:33],v[40:41]
v_pk_mul_f32 v[34:35],v[34:35],v[42:43]
v_pk_mul_f32 v[36:37],v[36:37],v[44:45]
v_pk_mul_f32 v[38:39],v[38:39],v[46:47]
v_pk_add_f32 v[48:49],v[48:49],v[96:97]
v_pk_add_f32 v[50:51],v[50:51],v[96:97]
v_pk_add_f32 v[52:53],v[52:53],v[96:97]
v_pk_add_f32 v[54:55],v[54:55],v[96:97]
v_rcp_f32 v48,v48
v_rcp_f32 v49,v49
v_rcp_f32 v50,v50
v_rcp_f32 v51,v51
v_rcp_f32 v52,v52
v_rcp_f32 v53,v53
v_rcp_f32 v54,v54
v_rcp_f32 v55,v55
s_nop 0
v_pk_mul_f32 v[32:33],v[32:33],v[48:49]
v_pk_mul_f32 v[34:35],v[34:35],v[50:51]
v_pk_mul_f32 v[36:37],v[36:37],v[52:53]
v_pk_mul_f32 v[38:39],v[38:39],v[54:55]
v_cvt_pk_bf16_f32 v56,v32,v33
v_cvt_pk_bf16_f32 v57,v34,v35
v_cvt_pk_bf16_f32 v58,v36,v37
v_cvt_pk_bf16_f32 v59,v38,v39
buffer_store_dwordx4 v[56:59],v3,s[8:11],s81 offen offset:0 sc1
v_accvgpr_read_b32 v64,a92
v_accvgpr_read_b32 v65,a93
v_accvgpr_read_b32 v66,a94
v_accvgpr_read_b32 v67,a95
v_accvgpr_read_b32 v68,a124
v_accvgpr_read_b32 v69,a125
v_accvgpr_read_b32 v70,a126
v_accvgpr_read_b32 v71,a127
v_accvgpr_read_b32 v72,a220
v_accvgpr_read_b32 v73,a221
v_accvgpr_read_b32 v74,a222
v_accvgpr_read_b32 v75,a223
v_accvgpr_read_b32 v76,a252
v_accvgpr_read_b32 v77,a253
v_accvgpr_read_b32 v78,a254
v_accvgpr_read_b32 v79,a255
v_pk_mul_f32 v[80:81],v[64:65],v[64:65]
v_pk_mul_f32 v[82:83],v[66:67],v[66:67]
v_pk_mul_f32 v[84:85],v[68:69],v[68:69]
v_pk_mul_f32 v[86:87],v[70:71],v[70:71]
v_pk_fma_f32 v[80:81],v[80:81],v[98:99],v[100:101]
v_pk_fma_f32 v[82:83],v[82:83],v[98:99],v[100:101]
v_pk_fma_f32 v[84:85],v[84:85],v[98:99],v[100:101]
v_pk_fma_f32 v[86:87],v[86:87],v[98:99],v[100:101]
v_pk_mul_f32 v[80:81],v[80:81],v[64:65]
v_pk_mul_f32 v[82:83],v[82:83],v[66:67]
v_pk_mul_f32 v[84:85],v[84:85],v[68:69]
v_pk_mul_f32 v[86:87],v[86:87],v[70:71]
v_exp_f32 v80,v80
v_exp_f32 v81,v81
v_exp_f32 v82,v82
v_exp_f32 v83,v83
v_exp_f32 v84,v84
v_exp_f32 v85,v85
v_exp_f32 v86,v86
v_exp_f32 v87,v87
v_pk_mul_f32 v[64:65],v[64:65],v[72:73]
v_pk_mul_f32 v[66:67],v[66:67],v[74:75]
v_pk_mul_f32 v[68:69],v[68:69],v[76:77]
v_pk_mul_f32 v[70:71],v[70:71],v[78:79]
v_pk_add_f32 v[80:81],v[80:81],v[96:97]
v_pk_add_f32 v[82:83],v[82:83],v[96:97]
v_pk_add_f32 v[84:85],v[84:85],v[96:97]
v_pk_add_f32 v[86:87],v[86:87],v[96:97]
v_rcp_f32 v80,v80
v_rcp_f32 v81,v81
v_rcp_f32 v82,v82
v_rcp_f32 v83,v83
v_rcp_f32 v84,v84
v_rcp_f32 v85,v85
v_rcp_f32 v86,v86
v_rcp_f32 v87,v87
s_nop 0
v_pk_mul_f32 v[64:65],v[64:65],v[80:81]
v_pk_mul_f32 v[66:67],v[66:67],v[82:83]
v_pk_mul_f32 v[68:69],v[68:69],v[84:85]
v_pk_mul_f32 v[70:71],v[70:71],v[86:87]
v_cvt_pk_bf16_f32 v88,v64,v65
v_cvt_pk_bf16_f32 v89,v66,v67
v_cvt_pk_bf16_f32 v90,v68,v69
v_cvt_pk_bf16_f32 v91,v70,v71
buffer_store_dwordx4 v[88:91],v3,s[8:11],s81 offen offset:1024 sc1
Lg1_eend:
s_mov_b32 s87,s86
s_cmp_lt_u32 s96,96
s_cbranch_scc1 Lg1_task
Lg1_now:
s_waitcnt vmcnt(0)
s_barrier
s_cmp_lg_u32 s60,0
s_cbranch_scc1 Lsg_g1
v_mov_b32 v1,1
v_mov_b32 v2,0
s_mov_b64 exec,1
buffer_atomic_add v1,v2,s[8:11],s87 offen
s_mov_b64 exec,-1
Lsg_g1:
s_mov_b32 s66,s96
s_branch Lg1_fresh2
Lg1_x:
s_waitcnt vmcnt(0)
s_barrier
s_cmp_lg_u32 s60,0
s_cbranch_scc1 Lsg_g1xp
v_mov_b32 v1,1
v_mov_b32 v2,0
s_mov_b64 exec,1
buffer_atomic_add v1,v2,s[8:11],s87 offen
s_mov_b64 exec,-1
Lsg_g1xp:
s_mov_b32 s63,s61
s_lshr_b32 s81,s60,1
s_lshl_b32 s81,s81,12
s_lshl_b32 s66,s63,13
s_add_u32 s81,s81,s66
v_add_u32 v5,s81,v3
s_lshl_b32 s81,s81,7
s_and_b32 s83,s83,0xff0fffff
s_add_u32 s83,s83,s81
s_cmp_eq_u32 s63,0
s_cselect_b32 s87,5120,s86
s_cmp_eq_u32 s73,1
s_cbranch_scc1 Lg1_xv
s_waitcnt vmcnt(40)
s_barrier
v_add_u32 v8,0,v5
v_add_u32 v16,16384,v24
v_add_u32 v17,16384,v25
v_add_u32 v18,16384,v26
v_add_u32 v19,16384,v27
v_add_u32 v20,16384,v28
v_add_u32 v21,16384,v29
v_add_u32 v22,16384,v30
v_add_u32 v23,16384,v31
ds_read_b128 v[128:131],v8 offset:0
ds_read_b128 v[132:135],v8 offset:1024
ds_read_b128 v[136:139],v8 offset:2048
ds_read_b128 v[140:143],v8 offset:3072
ds_read_b64_tr_b16 v[160:161],v16 offset:0
ds_read_b64_tr_b16 v[162:163],v16 offset:1024
ds_read_b64_tr_b16 v[164:165],v17 offset:0
ds_read_b64_tr_b16 v[166:167],v17 offset:1024
ds_read_b64_tr_b16 v[168:169],v18 offset:0
ds_read_b64_tr_b16 v[170:171],v18 offset:1024
ds_read_b64_tr_b16 v[172:173],v19 offset:0
ds_read_b64_tr_b16 v[174:175],v19 offset:1024
ds_read_b64_tr_b16 v[176:177],v20 offset:0
ds_read_b64_tr_b16 v[178:179],v20 offset:1024
ds_read_b64_tr_b16 v[180:181],v21 offset:0
ds_read_b64_tr_b16 v[182:183],v21 offset:1024
ds_read_b64_tr_b16 v[184:185],v22 offset:0
ds_read_b64_tr_b16 v[186:187],v22 offset:1024
ds_read_b64_tr_b16 v[188:189],v23 offset:0
ds_read_b64_tr_b16 v[190:191],v23 offset:1024
s_waitcnt vmcnt(32) lgkmcnt(0)
s_barrier
v_mfma_f32_16x16x32_bf16 a[0:3],v[160:163],v[128:131],0
v_add_u32 v8,32768,v5
v_mfma_f32_16x16x32_bf16 a[4:7],v[160:163],v[132:135],0
ds_read_b128 v[192:195],v8 offset:0
v_add_u32 v16,49152,v24
v_add_u32 v17,49152,v25
v_mfma_f32_16x16x32_bf16 a[8:11],v[160:163],v[136:139],0
ds_read_b128 v[196:199],v8 offset:1024
v_add_u32 v18,49152,v26
v_add_u32 v19,49152,v27
v_mfma_f32_16x16x32_bf16 a[12:15],v[160:163],v[140:143],0
s_add_u32 m0,s80,131072
s_mov_b32 s81,s76
buffer_load_dwordx4 v4,s[56:59],s81 offen lds
v_mfma_f32_16x16x32_bf16 a[32:35],v[164:167],v[128:131],0
ds_read_b128 v[200:203],v8 offset:2048
v_add_u32 v20,49152,v28
v_add_u32 v21,49152,v29
v_mfma_f32_16x16x32_bf16 a[36:39],v[164:167],v[132:135],0
ds_read_b128 v[204:207],v8 offset:3072
v_add_u32 v22,49152,v30
v_add_u32 v23,49152,v31
v_mfma_f32_16x16x32_bf16 a[40:43],v[164:167],v[136:139],0
ds_read_b64_tr_b16 v[224:225],v16 offset:0
v_mfma_f32_16x16x32_bf16 a[44:47],v[164:167],v[140:143],0
s_add_u32 m0,s80,132096
s_add_u32 s81,s76,s68
buffer_load_dwordx4 v4,s[56:59],s81 offen lds
v_mfma_f32_16x16x32_bf16 a[64:67],v[168:171],v[128:131],0
ds_read_b64_tr_b16 v[226:227],v16 offset:1024
v_mfma_f32_16x16x32_bf16 a[68:71],v[168:171],v[132:135],0
ds_read_b64_tr_b16 v[228:229],v17 offset:0
v_mfma_f32_16x16x32_bf16 a[72:75],v[168:171],v[136:139],0
ds_read_b64_tr_b16 v[230:231],v17 offset:1024
v_mfma_f32_16x16x32_bf16 a[76:79],v[168:171],v[140:143],0
s_add_u32 m0,s80,135168
s_add_u32 s81,s76,s69
buffer_load_dwordx4 v4,s[56:59],s81 offen lds
v_mfma_f32_16x16x32_bf16 a[96:99],v[172:175],v[128:131],0
ds_read_b64_tr_b16 v[232:233],v18 offset:0
v_mfma_f32_16x16x32_bf16 a[100:103],v[172:175],v[132:135],0
ds_read_b64_tr_b16 v[234:235],v18 offset:1024
v_mfma_f32_16x16x32_bf16 a[104:107],v[172:175],v[136:139],0
ds_read_b64_tr_b16 v[236:237],v19 offset:0
v_mfma_f32_16x16x32_bf16 a[108:111],v[172:175],v[140:143],0
s_add_u32 m0,s80,136192
s_add_u32 s81,s81,s68
buffer_load_dwordx4 v4,s[56:59],s81 offen lds
s_add_u32 s76,s76,s70
v_mfma_f32_16x16x32_bf16 a[128:131],v[176:179],v[128:131],0
ds_read_b64_tr_b16 v[238:239],v19 offset:1024
v_mfma_f32_16x16x32_bf16 a[132:135],v[176:179],v[132:135],0
ds_read_b64_tr_b16 v[240:241],v20 offset:0
v_mfma_f32_16x16x32_bf16 a[136:139],v[176:179],v[136:139],0
ds_read_b64_tr_b16 v[242:243],v20 offset:1024
v_mfma_f32_16x16x32_bf16 a[140:143],v[176:179],v[140:143],0
s_add_u32 m0,s79,131072
s_add_u32 s81,s75,4096
buffer_load_dwordx4 v3,s[8:11],s81 offen sc1 lds
v_mfma_f32_16x16x32_bf16 a[160:163],v[180:183],v[128:131],0
ds_read_b64_tr_b16 v[244:245],v21 offset:0
v_mfma_f32_16x16x32_bf16 a[164:167],v[180:183],v[132:135],0
ds_read_b64_tr_b16 v[246:247],v21 offset:1024
v_mfma_f32_16x16x32_bf16 a[168:171],v[180:183],v[136:139],0
ds_read_b64_tr_b16 v[248:249],v22 offset:0
v_mfma_f32_16x16x32_bf16 a[172:175],v[180:183],v[140:143],0
s_add_u32 m0,s79,132096
s_add_u32 s81,s75,22528
buffer_load_dwordx4 v3,s[8:11],s81 offen sc1 lds
v_mfma_f32_16x16x32_bf16 a[192:195],v[184:187],v[128:131],0
ds_read_b64_tr_b16 v[250:251],v22 offset:1024
v_mfma_f32_16x16x32_bf16 a[196:199],v[184:187],v[132:135],0
ds_read_b64_tr_b16 v[252:253],v23 offset:0
v_mfma_f32_16x16x32_bf16 a[200:203],v[184:187],v[136:139],0
ds_read_b64_tr_b16 v[254:255],v23 offset:1024
v_mfma_f32_16x16x32_bf16 a[204:207],v[184:187],v[140:143],0
s_add_u32 m0,s79,133120
s_add_u32 s81,s75,40960
buffer_load_dwordx4 v3,s[8:11],s81 offen sc1 lds
v_mfma_f32_16x16x32_bf16 a[224:227],v[188:191],v[128:131],0
v_mfma_f32_16x16x32_bf16 a[228:231],v[188:191],v[132:135],0
v_mfma_f32_16x16x32_bf16 a[232:235],v[188:191],v[136:139],0
v_mfma_f32_16x16x32_bf16 a[236:239],v[188:191],v[140:143],0
s_add_u32 m0,s79,134144
s_add_u32 s81,s75,59392
buffer_load_dwordx4 v3,s[8:11],s81 offen sc1 lds
s_waitcnt vmcnt(32) lgkmcnt(0)
s_barrier
v_mfma_f32_16x16x32_bf16 a[0:3],v[224:227],v[192:195],a[0:3]
v_add_u32 v8,65536,v5
v_mfma_f32_16x16x32_bf16 a[4:7],v[224:227],v[196:199],a[4:7]
ds_read_b128 v[128:131],v8 offset:0
v_add_u32 v16,81920,v24
v_add_u32 v17,81920,v25
v_mfma_f32_16x16x32_bf16 a[8:11],v[224:227],v[200:203],a[8:11]
ds_read_b128 v[132:135],v8 offset:1024
v_add_u32 v18,81920,v26
v_add_u32 v19,81920,v27
v_mfma_f32_16x16x32_bf16 a[12:15],v[224:227],v[204:207],a[12:15]
s_add_u32 m0,s80,0
s_mov_b32 s81,s76
buffer_load_dwordx4 v4,s[56:59],s81 offen lds
v_mfma_f32_16x16x32_bf16 a[32:35],v[228:231],v[192:195],a[32:35]
ds_read_b128 v[136:139],v8 offset:2048
v_add_u32 v20,81920,v28
v_add_u32 v21,81920,v29
v_mfma_f32_16x16x32_bf16 a[36:39],v[228:231],v[196:199],a[36:39]
ds_read_b128 v[140:143],v8 offset:3072
v_add_u32 v22,81920,v30
v_add_u32 v23,81920,v31
v_mfma_f32_16x16x32_bf16 a[40:43],v[228:231],v[200:203],a[40:43]
ds_read_b64_tr_b16 v[160:161],v16 offset:0
v_mfma_f32_16x16x32_bf16 a[44:47],v[228:231],v[204:207],a[44:47]
s_add_u32 m0,s80,1024
s_add_u32 s81,s76,s68
buffer_load_dwordx4 v4,s[56:59],s81 offen lds
v_mfma_f32_16x16x32_bf16 a[64:67],v[232:235],v[192:195],a[64:67]
ds_read_b64_tr_b16 v[162:163],v16 offset:1024
v_mfma_f32_16x16x32_bf16 a[68:71],v[232:235],v[196:199],a[68:71]
ds_read_b64_tr_b16 v[164:165],v17 offset:0
v_mfma_f32_16x16x32_bf16 a[72:75],v[232:235],v[200:203],a[72:75]
ds_read_b64_tr_b16 v[166:167],v17 offset:1024
v_mfma_f32_16x16x32_bf16 a[76:79],v[232:235],v[204:207],a[76:79]
s_add_u32 m0,s80,4096
s_add_u32 s81,s76,s69
buffer_load_dwordx4 v4,s[56:59],s81 offen lds
v_mfma_f32_16x16x32_bf16 a[96:99],v[236:239],v[192:195],a[96:99]
ds_read_b64_tr_b16 v[168:169],v18 offset:0
v_mfma_f32_16x16x32_bf16 a[100:103],v[236:239],v[196:199],a[100:103]
ds_read_b64_tr_b16 v[170:171],v18 offset:1024
v_mfma_f32_16x16x32_bf16 a[104:107],v[236:239],v[200:203],a[104:107]
ds_read_b64_tr_b16 v[172:173],v19 offset:0
v_mfma_f32_16x16x32_bf16 a[108:111],v[236:239],v[204:207],a[108:111]
s_add_u32 m0,s80,5120
s_add_u32 s81,s81,s68
buffer_load_dwordx4 v4,s[56:59],s81 offen lds
s_add_u32 s76,s76,s70
v_mfma_f32_16x16x32_bf16 a[128:131],v[240:243],v[192:195],a[128:131]
ds_read_b64_tr_b16 v[174:175],v19 offset:1024
v_mfma_f32_16x16x32_bf16 a[132:135],v[240:243],v[196:199],a[132:135]
ds_read_b64_tr_b16 v[176:177],v20 offset:0
v_mfma_f32_16x16x32_bf16 a[136:139],v[240:243],v[200:203],a[136:139]
ds_read_b64_tr_b16 v[178:179],v20 offset:1024
v_mfma_f32_16x16x32_bf16 a[140:143],v[240:243],v[204:207],a[140:143]
s_add_u32 m0,s79,0
s_add_u32 s81,s75,5120
buffer_load_dwordx4 v3,s[8:11],s81 offen sc1 lds
v_mfma_f32_16x16x32_bf16 a[160:163],v[244:247],v[192:195],a[160:163]
ds_read_b64_tr_b16 v[180:181],v21 offset:0
v_mfma_f32_16x16x32_bf16 a[164:167],v[244:247],v[196:199],a[164:167]
ds_read_b64_tr_b16 v[182:183],v21 offset:1024
v_mfma_f32_16x16x32_bf16 a[168:171],v[244:247],v[200:203],a[168:171]
ds_read_b64_tr_b16 v[184:185],v22 offset:0
v_mfma_f32_16x16x32_bf16 a[172:175],v[244:247],v[204:207],a[172:175]
s_add_u32 m0,s79,1024
s_add_u32 s81,s75,23552
buffer_load_dwordx4 v3,s[8:11],s81 offen sc1 lds
v_mfma_f32_16x16x32_bf16 a[192:195],v[248:251],v[192:195],a[192:195]
ds_read_b64_tr_b16 v[186:187],v22 offset:1024
v_mfma_f32_16x16x32_bf16 a[196:199],v[248:251],v[196:199],a[196:199]
ds_read_b64_tr_b16 v[188:189],v23 offset:0
v_mfma_f32_16x16x32_bf16 a[200:203],v[248:251],v[200:203],a[200:203]
ds_read_b64_tr_b16 v[190:191],v23 offset:1024
v_mfma_f32_16x16x32_bf16 a[204:207],v[248:251],v[204:207],a[204:207]
s_add_u32 m0,s79,2048
s_add_u32 s81,s75,41984
buffer_load_dwordx4 v3,s[8:11],s81 offen sc1 lds
v_mfma_f32_16x16x32_bf16 a[224:227],v[252:255],v[192:195],a[224:227]
v_mfma_f32_16x16x32_bf16 a[228:231],v[252:255],v[196:199],a[228:231]
v_mfma_f32_16x16x32_bf16 a[232:235],v[252:255],v[200:203],a[232:235]
v_mfma_f32_16x16x32_bf16 a[236:239],v[252:255],v[204:207],a[236:239]
s_add_u32 m0,s79,3072
s_add_u32 s81,s75,60416
buffer_load_dwordx4 v3,s[8:11],s81 offen sc1 lds
s_waitcnt vmcnt(32) lgkmcnt(0)
s_barrier
v_mfma_f32_16x16x32_bf16 a[0:3],v[160:163],v[128:131],a[0:3]
v_add_u32 v8,98304,v5
v_mfma_f32_16x16x32_bf16 a[4:7],v[160:163],v[132:135],a[4:7]
ds_read_b128 v[192:195],v8 offset:0
v_add_u32 v16,114688,v24
v_add_u32 v17,114688,v25
v_mfma_f32_16x16x32_bf16 a[8:11],v[160:163],v[136:139],a[8:11]
ds_read_b128 v[196:199],v8 offset:1024
v_add_u32 v18,114688,v26
v_add_u32 v19,114688,v27
v_mfma_f32_16x16x32_bf16 a[12:15],v[160:163],v[140:143],a[12:15]
s_add_u32 m0,s80,32768
s_mov_b32 s81,s76
buffer_load_dwordx4 v4,s[56:59],s81 offen lds
v_mfma_f32_16x16x32_bf16 a[32:35],v[164:167],v[128:131],a[32:35]
ds_read_b128 v[200:203],v8 offset:2048
v_add_u32 v20,114688,v28
v_add_u32 v21,114688,v29
v_mfma_f32_16x16x32_bf16 a[36:39],v[164:167],v[132:135],a[36:39]
ds_read_b128 v[204:207],v8 offset:3072
v_add_u32 v22,114688,v30
v_add_u32 v23,114688,v31
v_mfma_f32_16x16x32_bf16 a[40:43],v[164:167],v[136:139],a[40:43]
ds_read_b64_tr_b16 v[224:225],v16 offset:0
v_mfma_f32_16x16x32_bf16 a[44:47],v[164:167],v[140:143],a[44:47]
s_add_u32 m0,s80,33792
s_add_u32 s81,s76,s68
buffer_load_dwordx4 v4,s[56:59],s81 offen lds
v_mfma_f32_16x16x32_bf16 a[64:67],v[168:171],v[128:131],a[64:67]
ds_read_b64_tr_b16 v[226:227],v16 offset:1024
v_mfma_f32_16x16x32_bf16 a[68:71],v[168:171],v[132:135],a[68:71]
ds_read_b64_tr_b16 v[228:229],v17 offset:0
v_mfma_f32_16x16x32_bf16 a[72:75],v[168:171],v[136:139],a[72:75]
ds_read_b64_tr_b16 v[230:231],v17 offset:1024
v_mfma_f32_16x16x32_bf16 a[76:79],v[168:171],v[140:143],a[76:79]
s_add_u32 m0,s80,36864
s_add_u32 s81,s76,s69
buffer_load_dwordx4 v4,s[56:59],s81 offen lds
v_mfma_f32_16x16x32_bf16 a[96:99],v[172:175],v[128:131],a[96:99]
ds_read_b64_tr_b16 v[232:233],v18 offset:0
v_mfma_f32_16x16x32_bf16 a[100:103],v[172:175],v[132:135],a[100:103]
ds_read_b64_tr_b16 v[234:235],v18 offset:1024
v_mfma_f32_16x16x32_bf16 a[104:107],v[172:175],v[136:139],a[104:107]
ds_read_b64_tr_b16 v[236:237],v19 offset:0
v_mfma_f32_16x16x32_bf16 a[108:111],v[172:175],v[140:143],a[108:111]
s_add_u32 m0,s80,37888
s_add_u32 s81,s81,s68
buffer_load_dwordx4 v4,s[56:59],s81 offen lds
s_add_u32 s76,s76,s70
v_mfma_f32_16x16x32_bf16 a[128:131],v[176:179],v[128:131],a[128:131]
ds_read_b64_tr_b16 v[238:239],v19 offset:1024
v_mfma_f32_16x16x32_bf16 a[132:135],v[176:179],v[132:135],a[132:135]
ds_read_b64_tr_b16 v[240:241],v20 offset:0
v_mfma_f32_16x16x32_bf16 a[136:139],v[176:179],v[136:139],a[136:139]
ds_read_b64_tr_b16 v[242:243],v20 offset:1024
v_mfma_f32_16x16x32_bf16 a[140:143],v[176:179],v[140:143],a[140:143]
s_add_u32 m0,s79,32768
s_add_u32 s81,s75,6144
buffer_load_dwordx4 v3,s[8:11],s81 offen sc1 lds
v_mfma_f32_16x16x32_bf16 a[160:163],v[180:183],v[128:131],a[160:163]
ds_read_b64_tr_b16 v[244:245],v21 offset:0
v_mfma_f32_16x16x32_bf16 a[164:167],v[180:183],v[132:135],a[164:167]
ds_read_b64_tr_b16 v[246:247],v21 offset:1024
v_mfma_f32_16x16x32_bf16 a[168:171],v[180:183],v[136:139],a[168:171]
ds_read_b64_tr_b16 v[248:249],v22 offset:0
v_mfma_f32_16x16x32_bf16 a[172:175],v[180:183],v[140:143],a[172:175]
s_add_u32 m0,s79,33792
s_add_u32 s81,s75,24576
buffer_load_dwordx4 v3,s[8:11],s81 offen sc1 lds
v_mfma_f32_16x16x32_bf16 a[192:195],v[184:187],v[128:131],a[192:195]
ds_read_b64_tr_b16 v[250:251],v22 offset:1024
v_mfma_f32_16x16x32_bf16 a[196:199],v[184:187],v[132:135],a[196:199]
ds_read_b64_tr_b16 v[252:253],v23 offset:0
v_mfma_f32_16x16x32_bf16 a[200:203],v[184:187],v[136:139],a[200:203]
ds_read_b64_tr_b16 v[254:255],v23 offset:1024
v_mfma_f32_16x16x32_bf16 a[204:207],v[184:187],v[140:143],a[204:207]
s_add_u32 m0,s79,34816
s_add_u32 s81,s75,43008
buffer_load_dwordx4 v3,s[8:11],s81 offen sc1 lds
v_mfma_f32_16x16x32_bf16 a[224:227],v[188:191],v[128:131],a[224:227]
v_mfma_f32_16x16x32_bf16 a[228:231],v[188:191],v[132:135],a[228:231]
v_mfma_f32_16x16x32_bf16 a[232:235],v[188:191],v[136:139],a[232:235]
v_mfma_f32_16x16x32_bf16 a[236:239],v[188:191],v[140:143],a[236:239]
s_add_u32 m0,s79,35840
s_add_u32 s81,s75,61440
buffer_load_dwordx4 v3,s[8:11],s81 offen sc1 lds
s_waitcnt vmcnt(16) lgkmcnt(0)
s_barrier
v_mfma_f32_16x16x32_bf16 a[0:3],v[224:227],v[192:195],a[0:3]
v_add_u32 v8,131072,v5
v_mfma_f32_16x16x32_bf16 a[4:7],v[224:227],v[196:199],a[4:7]
ds_read_b128 v[128:131],v8 offset:0
v_add_u32 v16,147456,v24
v_add_u32 v17,147456,v25
v_mfma_f32_16x16x32_bf16 a[8:11],v[224:227],v[200:203],a[8:11]
ds_read_b128 v[132:135],v8 offset:1024
v_add_u32 v18,147456,v26
v_add_u32 v19,147456,v27
v_mfma_f32_16x16x32_bf16 a[12:15],v[224:227],v[204:207],a[12:15]
s_add_u32 m0,s80,65536
s_mov_b32 s81,s76
buffer_load_dwordx4 v4,s[56:59],s81 offen lds
v_mfma_f32_16x16x32_bf16 a[32:35],v[228:231],v[192:195],a[32:35]
ds_read_b128 v[136:139],v8 offset:2048
v_add_u32 v20,147456,v28
v_add_u32 v21,147456,v29
v_mfma_f32_16x16x32_bf16 a[36:39],v[228:231],v[196:199],a[36:39]
ds_read_b128 v[140:143],v8 offset:3072
v_add_u32 v22,147456,v30
v_add_u32 v23,147456,v31
v_mfma_f32_16x16x32_bf16 a[40:43],v[228:231],v[200:203],a[40:43]
ds_read_b64_tr_b16 v[160:161],v16 offset:0
v_mfma_f32_16x16x32_bf16 a[44:47],v[228:231],v[204:207],a[44:47]
s_add_u32 m0,s80,66560
s_add_u32 s81,s76,s68
buffer_load_dwordx4 v4,s[56:59],s81 offen lds
v_mfma_f32_16x16x32_bf16 a[64:67],v[232:235],v[192:195],a[64:67]
ds_read_b64_tr_b16 v[162:163],v16 offset:1024
v_mfma_f32_16x16x32_bf16 a[68:71],v[232:235],v[196:199],a[68:71]
ds_read_b64_tr_b16 v[164:165],v17 offset:0
v_mfma_f32_16x16x32_bf16 a[72:75],v[232:235],v[200:203],a[72:75]
ds_read_b64_tr_b16 v[166:167],v17 offset:1024
v_mfma_f32_16x16x32_bf16 a[76:79],v[232:235],v[204:207],a[76:79]
s_add_u32 m0,s80,69632
s_add_u32 s81,s76,s69
buffer_load_dwordx4 v4,s[56:59],s81 offen lds
v_mfma_f32_16x16x32_bf16 a[96:99],v[236:239],v[192:195],a[96:99]
ds_read_b64_tr_b16 v[168:169],v18 offset:0
v_mfma_f32_16x16x32_bf16 a[100:103],v[236:239],v[196:199],a[100:103]
ds_read_b64_tr_b16 v[170:171],v18 offset:1024
v_mfma_f32_16x16x32_bf16 a[104:107],v[236:239],v[200:203],a[104:107]
ds_read_b64_tr_b16 v[172:173],v19 offset:0
v_mfma_f32_16x16x32_bf16 a[108:111],v[236:239],v[204:207],a[108:111]
s_add_u32 m0,s80,70656
s_add_u32 s81,s81,s68
buffer_load_dwordx4 v4,s[56:59],s81 offen lds
s_add_u32 s76,s76,s70
v_mfma_f32_16x16x32_bf16 a[128:131],v[240:243],v[192:195],a[128:131]
ds_read_b64_tr_b16 v[174:175],v19 offset:1024
v_mfma_f32_16x16x32_bf16 a[132:135],v[240:243],v[196:199],a[132:135]
ds_read_b64_tr_b16 v[176:177],v20 offset:0
v_mfma_f32_16x16x32_bf16 a[136:139],v[240:243],v[200:203],a[136:139]
ds_read_b64_tr_b16 v[178:179],v20 offset:1024
v_mfma_f32_16x16x32_bf16 a[140:143],v[240:243],v[204:207],a[140:143]
s_add_u32 m0,s79,65536
s_add_u32 s81,s75,7168
buffer_load_dwordx4 v3,s[8:11],s81 offen sc1 lds
v_mfma_f32_16x16x32_bf16 a[160:163],v[244:247],v[192:195],a[160:163]
ds_read_b64_tr_b16 v[180:181],v21 offset:0
v_mfma_f32_16x16x32_bf16 a[164:167],v[244:247],v[196:199],a[164:167]
ds_read_b64_tr_b16 v[182:183],v21 offset:1024
v_mfma_f32_16x16x32_bf16 a[168:171],v[244:247],v[200:203],a[168:171]
ds_read_b64_tr_b16 v[184:185],v22 offset:0
v_mfma_f32_16x16x32_bf16 a[172:175],v[244:247],v[204:207],a[172:175]
s_add_u32 m0,s79,66560
s_add_u32 s81,s75,25600
buffer_load_dwordx4 v3,s[8:11],s81 offen sc1 lds
v_mfma_f32_16x16x32_bf16 a[192:195],v[248:251],v[192:195],a[192:195]
ds_read_b64_tr_b16 v[186:187],v22 offset:1024
v_mfma_f32_16x16x32_bf16 a[196:199],v[248:251],v[196:199],a[196:199]
ds_read_b64_tr_b16 v[188:189],v23 offset:0
v_mfma_f32_16x16x32_bf16 a[200:203],v[248:251],v[200:203],a[200:203]
ds_read_b64_tr_b16 v[190:191],v23 offset:1024
v_mfma_f32_16x16x32_bf16 a[204:207],v[248:251],v[204:207],a[204:207]
s_add_u32 m0,s79,67584
s_add_u32 s81,s75,44032
buffer_load_dwordx4 v3,s[8:11],s81 offen sc1 lds
v_mfma_f32_16x16x32_bf16 a[224:227],v[252:255],v[192:195],a[224:227]
v_mfma_f32_16x16x32_bf16 a[228:231],v[252:255],v[196:199],a[228:231]
v_mfma_f32_16x16x32_bf16 a[232:235],v[252:255],v[200:203],a[232:235]
v_mfma_f32_16x16x32_bf16 a[236:239],v[252:255],v[204:207],a[236:239]
s_add_u32 m0,s79,68608
s_add_u32 s81,s75,62464
buffer_load_dwordx4 v3,s[8:11],s81 offen sc1 lds
s_waitcnt vmcnt(16) lgkmcnt(0)
s_barrier
v_mfma_f32_16x16x32_bf16 a[0:3],v[160:163],v[128:131],a[0:3]
v_add_u32 v8,0,v5
v_mfma_f32_16x16x32_bf16 a[4:7],v[160:163],v[132:135],a[4:7]
ds_read_b128 v[192:195],v8 offset:0
v_add_u32 v16,16384,v24
v_add_u32 v17,16384,v25
v_mfma_f32_16x16x32_bf16 a[8:11],v[160:163],v[136:139],a[8:11]
ds_read_b128 v[196:199],v8 offset:1024
v_add_u32 v18,16384,v26
v_add_u32 v19,16384,v27
v_mfma_f32_16x16x32_bf16 a[12:15],v[160:163],v[140:143],a[12:15]
s_add_u32 m0,s80,98304
s_mov_b32 s81,s76
buffer_load_dwordx4 v4,s[56:59],s81 offen lds
v_mfma_f32_16x16x32_bf16 a[32:35],v[164:167],v[128:131],a[32:35]
ds_read_b128 v[200:203],v8 offset:2048
v_add_u32 v20,16384,v28
v_add_u32 v21,16384,v29
v_mfma_f32_16x16x32_bf16 a[36:39],v[164:167],v[132:135],a[36:39]
ds_read_b128 v[204:207],v8 offset:3072
v_add_u32 v22,16384,v30
v_add_u32 v23,16384,v31
v_mfma_f32_16x16x32_bf16 a[40:43],v[164:167],v[136:139],a[40:43]
ds_read_b64_tr_b16 v[224:225],v16 offset:0
v_mfma_f32_16x16x32_bf16 a[44:47],v[164:167],v[140:143],a[44:47]
s_add_u32 m0,s80,99328
s_add_u32 s81,s76,s68
buffer_load_dwordx4 v4,s[56:59],s81 offen lds
v_mfma_f32_16x16x32_bf16 a[64:67],v[168:171],v[128:131],a[64:67]
ds_read_b64_tr_b16 v[226:227],v16 offset:1024
v_mfma_f32_16x16x32_bf16 a[68:71],v[168:171],v[132:135],a[68:71]
ds_read_b64_tr_b16 v[228:229],v17 offset:0
v_mfma_f32_16x16x32_bf16 a[72:75],v[168:171],v[136:139],a[72:75]
ds_read_b64_tr_b16 v[230:231],v17 offset:1024
v_mfma_f32_16x16x32_bf16 a[76:79],v[168:171],v[140:143],a[76:79]
s_add_u32 m0,s80,102400
s_add_u32 s81,s76,s69
buffer_load_dwordx4 v4,s[56:59],s81 offen lds
v_mfma_f32_16x16x32_bf16 a[96:99],v[172:175],v[128:131],a[96:99]
ds_read_b64_tr_b16 v[232:233],v18 offset:0
v_mfma_f32_16x16x32_bf16 a[100:103],v[172:175],v[132:135],a[100:103]
ds_read_b64_tr_b16 v[234:235],v18 offset:1024
v_mfma_f32_16x16x32_bf16 a[104:107],v[172:175],v[136:139],a[104:107]
ds_read_b64_tr_b16 v[236:237],v19 offset:0
v_mfma_f32_16x16x32_bf16 a[108:111],v[172:175],v[140:143],a[108:111]
s_add_u32 m0,s80,103424
s_add_u32 s81,s81,s68
buffer_load_dwordx4 v4,s[56:59],s81 offen lds
s_add_u32 s76,s76,s70
v_mfma_f32_16x16x32_bf16 a[128:131],v[176:179],v[128:131],a[128:131]
ds_read_b64_tr_b16 v[238:239],v19 offset:1024
v_mfma_f32_16x16x32_bf16 a[132:135],v[176:179],v[132:135],a[132:135]
ds_read_b64_tr_b16 v[240:241],v20 offset:0
v_mfma_f32_16x16x32_bf16 a[136:139],v[176:179],v[136:139],a[136:139]
ds_read_b64_tr_b16 v[242:243],v20 offset:1024
v_mfma_f32_16x16x32_bf16 a[140:143],v[176:179],v[140:143],a[140:143]
s_add_u32 m0,s79,98304
s_add_u32 s81,s75,8192
buffer_load_dwordx4 v3,s[8:11],s81 offen sc1 lds
v_mfma_f32_16x16x32_bf16 a[160:163],v[180:183],v[128:131],a[160:163]
ds_read_b64_tr_b16 v[244:245],v21 offset:0
v_mfma_f32_16x16x32_bf16 a[164:167],v[180:183],v[132:135],a[164:167]
ds_read_b64_tr_b16 v[246:247],v21 offset:1024
v_mfma_f32_16x16x32_bf16 a[168:171],v[180:183],v[136:139],a[168:171]
ds_read_b64_tr_b16 v[248:249],v22 offset:0
v_mfma_f32_16x16x32_bf16 a[172:175],v[180:183],v[140:143],a[172:175]
s_add_u32 m0,s79,99328
s_add_u32 s81,s75,26624
buffer_load_dwordx4 v3,s[8:11],s81 offen sc1 lds
v_mfma_f32_16x16x32_bf16 a[192:195],v[184:187],v[128:131],a[192:195]
ds_read_b64_tr_b16 v[250:251],v22 offset:1024
v_mfma_f32_16x16x32_bf16 a[196:199],v[184:187],v[132:135],a[196:199]
ds_read_b64_tr_b16 v[252:253],v23 offset:0
v_mfma_f32_16x16x32_bf16 a[200:203],v[184:187],v[136:139],a[200:203]
ds_read_b64_tr_b16 v[254:255],v23 offset:1024
v_mfma_f32_16x16x32_bf16 a[204:207],v[184:187],v[140:143],a[204:207]
s_add_u32 m0,s79,100352
s_add_u32 s81,s75,45056
buffer_load_dwordx4 v3,s[8:11],s81 offen sc1 lds
v_mfma_f32_16x16x32_bf16 a[224:227],v[188:191],v[128:131],a[224:227]
v_mfma_f32_16x16x32_bf16 a[228:231],v[188:191],v[132:135],a[228:231]
v_mfma_f32_16x16x32_bf16 a[232:235],v[188:191],v[136:139],a[232:235]
v_mfma_f32_16x16x32_bf16 a[236:239],v[188:191],v[140:143],a[236:239]
s_add_u32 m0,s79,101376
s_add_u32 s81,s75,63488
buffer_load_dwordx4 v3,s[8:11],s81 offen sc1 lds
s_waitcnt vmcnt(16) lgkmcnt(0)
s_barrier
v_mfma_f32_16x16x32_bf16 a[0:3],v[224:227],v[192:195],a[0:3]
v_add_u32 v8,32768,v5
v_mfma_f32_16x16x32_bf16 a[4:7],v[224:227],v[196:199],a[4:7]
ds_read_b128 v[128:131],v8 offset:0
v_add_u32 v16,49152,v24
v_add_u32 v17,49152,v25
v_mfma_f32_16x16x32_bf16 a[8:11],v[224:227],v[200:203],a[8:11]
ds_read_b128 v[132:135],v8 offset:1024
v_add_u32 v18,49152,v26
v_add_u32 v19,49152,v27
v_mfma_f32_16x16x32_bf16 a[12:15],v[224:227],v[204:207],a[12:15]
s_add_u32 m0,s80,131072
s_mov_b32 s81,s76
buffer_load_dwordx4 v4,s[56:59],s81 offen lds
v_mfma_f32_16x16x32_bf16 a[32:35],v[228:231],v[192:195],a[32:35]
ds_read_b128 v[136:139],v8 offset:2048
v_add_u32 v20,49152,v28
v_add_u32 v21,49152,v29
v_mfma_f32_16x16x32_bf16 a[36:39],v[228:231],v[196:199],a[36:39]
ds_read_b128 v[140:143],v8 offset:3072
v_add_u32 v22,49152,v30
v_add_u32 v23,49152,v31
v_mfma_f32_16x16x32_bf16 a[40:43],v[228:231],v[200:203],a[40:43]
ds_read_b64_tr_b16 v[160:161],v16 offset:0
v_mfma_f32_16x16x32_bf16 a[44:47],v[228:231],v[204:207],a[44:47]
s_add_u32 m0,s80,132096
s_add_u32 s81,s76,s68
buffer_load_dwordx4 v4,s[56:59],s81 offen lds
v_mfma_f32_16x16x32_bf16 a[64:67],v[232:235],v[192:195],a[64:67]
ds_read_b64_tr_b16 v[162:163],v16 offset:1024
v_mfma_f32_16x16x32_bf16 a[68:71],v[232:235],v[196:199],a[68:71]
ds_read_b64_tr_b16 v[164:165],v17 offset:0
v_mfma_f32_16x16x32_bf16 a[72:75],v[232:235],v[200:203],a[72:75]
ds_read_b64_tr_b16 v[166:167],v17 offset:1024
v_mfma_f32_16x16x32_bf16 a[76:79],v[232:235],v[204:207],a[76:79]
s_add_u32 m0,s80,135168
s_add_u32 s81,s76,s69
buffer_load_dwordx4 v4,s[56:59],s81 offen lds
v_mfma_f32_16x16x32_bf16 a[96:99],v[236:239],v[192:195],a[96:99]
ds_read_b64_tr_b16 v[168:169],v18 offset:0
v_mfma_f32_16x16x32_bf16 a[100:103],v[236:239],v[196:199],a[100:103]
ds_read_b64_tr_b16 v[170:171],v18 offset:1024
v_mfma_f32_16x16x32_bf16 a[104:107],v[236:239],v[200:203],a[104:107]
ds_read_b64_tr_b16 v[172:173],v19 offset:0
v_mfma_f32_16x16x32_bf16 a[108:111],v[236:239],v[204:207],a[108:111]
s_add_u32 m0,s80,136192
s_add_u32 s81,s81,s68
buffer_load_dwordx4 v4,s[56:59],s81 offen lds
s_add_u32 s76,s76,s70
v_mfma_f32_16x16x32_bf16 a[128:131],v[240:243],v[192:195],a[128:131]
ds_read_b64_tr_b16 v[174:175],v19 offset:1024
v_mfma_f32_16x16x32_bf16 a[132:135],v[240:243],v[196:199],a[132:135]
ds_read_b64_tr_b16 v[176:177],v20 offset:0
v_mfma_f32_16x16x32_bf16 a[136:139],v[240:243],v[200:203],a[136:139]
ds_read_b64_tr_b16 v[178:179],v20 offset:1024
v_mfma_f32_16x16x32_bf16 a[140:143],v[240:243],v[204:207],a[140:143]
s_add_u32 m0,s79,131072
s_add_u32 s81,s75,9216
buffer_load_dwordx4 v3,s[8:11],s81 offen sc1 lds
v_mfma_f32_16x16x32_bf16 a[160:163],v[244:247],v[192:195],a[160:163]
ds_read_b64_tr_b16 v[180:181],v21 offset:0
v_mfma_f32_16x16x32_bf16 a[164:167],v[244:247],v[196:199],a[164:167]
ds_read_b64_tr_b16 v[182:183],v21 offset:1024
v_mfma_f32_16x16x32_bf16 a[168:171],v[244:247],v[200:203],a[168:171]
ds_read_b64_tr_b16 v[184:185],v22 offset:0
v_mfma_f32_16x16x32_bf16 a[172:175],v[244:247],v[204:207],a[172:175]
s_add_u32 m0,s79,132096
s_add_u32 s81,s75,27648
buffer_load_dwordx4 v3,s[8:11],s81 offen sc1 lds
v_mfma_f32_16x16x32_bf16 a[192:195],v[248:251],v[192:195],a[192:195]
ds_read_b64_tr_b16 v[186:187],v22 offset:1024
v_mfma_f32_16x16x32_bf16 a[196:199],v[248:251],v[196:199],a[196:199]
ds_read_b64_tr_b16 v[188:189],v23 offset:0
v_mfma_f32_16x16x32_bf16 a[200:203],v[248:251],v[200:203],a[200:203]
ds_read_b64_tr_b16 v[190:191],v23 offset:1024
v_mfma_f32_16x16x32_bf16 a[204:207],v[248:251],v[204:207],a[204:207]
s_add_u32 m0,s79,133120
s_add_u32 s81,s75,46080
buffer_load_dwordx4 v3,s[8:11],s81 offen sc1 lds
v_mfma_f32_16x16x32_bf16 a[224:227],v[252:255],v[192:195],a[224:227]
v_mfma_f32_16x16x32_bf16 a[228:231],v[252:255],v[196:199],a[228:231]
v_mfma_f32_16x16x32_bf16 a[232:235],v[252:255],v[200:203],a[232:235]
v_mfma_f32_16x16x32_bf16 a[236:239],v[252:255],v[204:207],a[236:239]
s_add_u32 m0,s79,134144
s_add_u32 s81,s75,64512
buffer_load_dwordx4 v3,s[8:11],s81 offen sc1 lds
s_waitcnt vmcnt(16) lgkmcnt(0)
s_barrier
v_mfma_f32_16x16x32_bf16 a[0:3],v[160:163],v[128:131],a[0:3]
v_add_u32 v8,65536,v5
v_mfma_f32_16x16x32_bf16 a[4:7],v[160:163],v[132:135],a[4:7]
ds_read_b128 v[192:195],v8 offset:0
v_add_u32 v16,81920,v24
v_add_u32 v17,81920,v25
v_mfma_f32_16x16x32_bf16 a[8:11],v[160:163],v[136:139],a[8:11]
ds_read_b128 v[196:199],v8 offset:1024
v_add_u32 v18,81920,v26
v_add_u32 v19,81920,v27
v_mfma_f32_16x16x32_bf16 a[12:15],v[160:163],v[140:143],a[12:15]
s_add_u32 m0,s80,0
s_mov_b32 s81,s76
buffer_load_dwordx4 v4,s[56:59],s81 offen lds
v_mfma_f32_16x16x32_bf16 a[32:35],v[164:167],v[128:131],a[32:35]
ds_read_b128 v[200:203],v8 offset:2048
v_add_u32 v20,81920,v28
v_add_u32 v21,81920,v29
v_mfma_f32_16x16x32_bf16 a[36:39],v[164:167],v[132:135],a[36:39]
ds_read_b128 v[204:207],v8 offset:3072
v_add_u32 v22,81920,v30
v_add_u32 v23,81920,v31
v_mfma_f32_16x16x32_bf16 a[40:43],v[164:167],v[136:139],a[40:43]
ds_read_b64_tr_b16 v[224:225],v16 offset:0
v_mfma_f32_16x16x32_bf16 a[44:47],v[164:167],v[140:143],a[44:47]
s_add_u32 m0,s80,1024
s_add_u32 s81,s76,s68
buffer_load_dwordx4 v4,s[56:59],s81 offen lds
v_mfma_f32_16x16x32_bf16 a[64:67],v[168:171],v[128:131],a[64:67]
ds_read_b64_tr_b16 v[226:227],v16 offset:1024
v_mfma_f32_16x16x32_bf16 a[68:71],v[168:171],v[132:135],a[68:71]
ds_read_b64_tr_b16 v[228:229],v17 offset:0
v_mfma_f32_16x16x32_bf16 a[72:75],v[168:171],v[136:139],a[72:75]
ds_read_b64_tr_b16 v[230:231],v17 offset:1024
v_mfma_f32_16x16x32_bf16 a[76:79],v[168:171],v[140:143],a[76:79]
s_add_u32 m0,s80,4096
s_add_u32 s81,s76,s69
buffer_load_dwordx4 v4,s[56:59],s81 offen lds
v_mfma_f32_16x16x32_bf16 a[96:99],v[172:175],v[128:131],a[96:99]
ds_read_b64_tr_b16 v[232:233],v18 offset:0
v_mfma_f32_16x16x32_bf16 a[100:103],v[172:175],v[132:135],a[100:103]
ds_read_b64_tr_b16 v[234:235],v18 offset:1024
v_mfma_f32_16x16x32_bf16 a[104:107],v[172:175],v[136:139],a[104:107]
ds_read_b64_tr_b16 v[236:237],v19 offset:0
v_mfma_f32_16x16x32_bf16 a[108:111],v[172:175],v[140:143],a[108:111]
s_add_u32 m0,s80,5120
s_add_u32 s81,s81,s68
buffer_load_dwordx4 v4,s[56:59],s81 offen lds
s_add_u32 s76,s76,s70
v_mfma_f32_16x16x32_bf16 a[128:131],v[176:179],v[128:131],a[128:131]
ds_read_b64_tr_b16 v[238:239],v19 offset:1024
v_mfma_f32_16x16x32_bf16 a[132:135],v[176:179],v[132:135],a[132:135]
ds_read_b64_tr_b16 v[240:241],v20 offset:0
v_mfma_f32_16x16x32_bf16 a[136:139],v[176:179],v[136:139],a[136:139]
ds_read_b64_tr_b16 v[242:243],v20 offset:1024
v_mfma_f32_16x16x32_bf16 a[140:143],v[176:179],v[140:143],a[140:143]
s_add_u32 m0,s79,0
s_add_u32 s81,s75,10240
buffer_load_dwordx4 v3,s[8:11],s81 offen sc1 lds
v_mfma_f32_16x16x32_bf16 a[160:163],v[180:183],v[128:131],a[160:163]
ds_read_b64_tr_b16 v[244:245],v21 offset:0
v_mfma_f32_16x16x32_bf16 a[164:167],v[180:183],v[132:135],a[164:167]
ds_read_b64_tr_b16 v[246:247],v21 offset:1024
v_mfma_f32_16x16x32_bf16 a[168:171],v[180:183],v[136:139],a[168:171]
ds_read_b64_tr_b16 v[248:249],v22 offset:0
v_mfma_f32_16x16x32_bf16 a[172:175],v[180:183],v[140:143],a[172:175]
s_add_u32 m0,s79,1024
s_add_u32 s81,s75,28672
buffer_load_dwordx4 v3,s[8:11],s81 offen sc1 lds
v_mfma_f32_16x16x32_bf16 a[192:195],v[184:187],v[128:131],a[192:195]
ds_read_b64_tr_b16 v[250:251],v22 offset:1024
v_mfma_f32_16x16x32_bf16 a[196:199],v[184:187],v[132:135],a[196:199]
ds_read_b64_tr_b16 v[252:253],v23 offset:0
v_mfma_f32_16x16x32_bf16 a[200:203],v[184:187],v[136:139],a[200:203]
ds_read_b64_tr_b16 v[254:255],v23 offset:1024
v_mfma_f32_16x16x32_bf16 a[204:207],v[184:187],v[140:143],a[204:207]
s_add_u32 m0,s79,2048
s_add_u32 s81,s75,47104
buffer_load_dwordx4 v3,s[8:11],s81 offen sc1 lds
v_mfma_f32_16x16x32_bf16 a[224:227],v[188:191],v[128:131],a[224:227]
v_mfma_f32_16x16x32_bf16 a[228:231],v[188:191],v[132:135],a[228:231]
v_mfma_f32_16x16x32_bf16 a[232:235],v[188:191],v[136:139],a[232:235]
v_mfma_f32_16x16x32_bf16 a[236:239],v[188:191],v[140:143],a[236:239]
s_add_u32 m0,s79,3072
s_add_u32 s81,s75,65536
buffer_load_dwordx4 v3,s[8:11],s81 offen sc1 lds
s_waitcnt vmcnt(16) lgkmcnt(0)
s_barrier
v_mfma_f32_16x16x32_bf16 a[0:3],v[224:227],v[192:195],a[0:3]
v_add_u32 v8,98304,v5
v_mfma_f32_16x16x32_bf16 a[4:7],v[224:227],v[196:199],a[4:7]
ds_read_b128 v[128:131],v8 offset:0
v_add_u32 v16,114688,v24
v_add_u32 v17,114688,v25
v_mfma_f32_16x16x32_bf16 a[8:11],v[224:227],v[200:203],a[8:11]
ds_read_b128 v[132:135],v8 offset:1024
v_add_u32 v18,114688,v26
v_add_u32 v19,114688,v27
v_mfma_f32_16x16x32_bf16 a[12:15],v[224:227],v[204:207],a[12:15]
s_add_u32 m0,s80,32768
s_mov_b32 s81,s76
buffer_load_dwordx4 v4,s[56:59],s81 offen lds
v_mfma_f32_16x16x32_bf16 a[32:35],v[228:231],v[192:195],a[32:35]
ds_read_b128 v[136:139],v8 offset:2048
v_add_u32 v20,114688,v28
v_add_u32 v21,114688,v29
v_mfma_f32_16x16x32_bf16 a[36:39],v[228:231],v[196:199],a[36:39]
ds_read_b128 v[140:143],v8 offset:3072
v_add_u32 v22,114688,v30
v_add_u32 v23,114688,v31
v_mfma_f32_16x16x32_bf16 a[40:43],v[228:231],v[200:203],a[40:43]
ds_read_b64_tr_b16 v[160:161],v16 offset:0
v_mfma_f32_16x16x32_bf16 a[44:47],v[228:231],v[204:207],a[44:47]
s_add_u32 m0,s80,33792
s_add_u32 s81,s76,s68
buffer_load_dwordx4 v4,s[56:59],s81 offen lds
v_mfma_f32_16x16x32_bf16 a[64:67],v[232:235],v[192:195],a[64:67]
ds_read_b64_tr_b16 v[162:163],v16 offset:1024
v_mfma_f32_16x16x32_bf16 a[68:71],v[232:235],v[196:199],a[68:71]
ds_read_b64_tr_b16 v[164:165],v17 offset:0
v_mfma_f32_16x16x32_bf16 a[72:75],v[232:235],v[200:203],a[72:75]
ds_read_b64_tr_b16 v[166:167],v17 offset:1024
v_mfma_f32_16x16x32_bf16 a[76:79],v[232:235],v[204:207],a[76:79]
s_add_u32 m0,s80,36864
s_add_u32 s81,s76,s69
buffer_load_dwordx4 v4,s[56:59],s81 offen lds
v_mfma_f32_16x16x32_bf16 a[96:99],v[236:239],v[192:195],a[96:99]
ds_read_b64_tr_b16 v[168:169],v18 offset:0
v_mfma_f32_16x16x32_bf16 a[100:103],v[236:239],v[196:199],a[100:103]
ds_read_b64_tr_b16 v[170:171],v18 offset:1024
v_mfma_f32_16x16x32_bf16 a[104:107],v[236:239],v[200:203],a[104:107]
ds_read_b64_tr_b16 v[172:173],v19 offset:0
v_mfma_f32_16x16x32_bf16 a[108:111],v[236:239],v[204:207],a[108:111]
s_add_u32 m0,s80,37888
s_add_u32 s81,s81,s68
buffer_load_dwordx4 v4,s[56:59],s81 offen lds
s_add_u32 s76,s76,s70
v_mfma_f32_16x16x32_bf16 a[128:131],v[240:243],v[192:195],a[128:131]
ds_read_b64_tr_b16 v[174:175],v19 offset:1024
v_mfma_f32_16x16x32_bf16 a[132:135],v[240:243],v[196:199],a[132:135]
ds_read_b64_tr_b16 v[176:177],v20 offset:0
v_mfma_f32_16x16x32_bf16 a[136:139],v[240:243],v[200:203],a[136:139]
ds_read_b64_tr_b16 v[178:179],v20 offset:1024
v_mfma_f32_16x16x32_bf16 a[140:143],v[240:243],v[204:207],a[140:143]
s_add_u32 m0,s79,32768
s_add_u32 s81,s75,11264
buffer_load_dwordx4 v3,s[8:11],s81 offen sc1 lds
v_mfma_f32_16x16x32_bf16 a[160:163],v[244:247],v[192:195],a[160:163]
ds_read_b64_tr_b16 v[180:181],v21 offset:0
v_mfma_f32_16x16x32_bf16 a[164:167],v[244:247],v[196:199],a[164:167]
ds_read_b64_tr_b16 v[182:183],v21 offset:1024
v_mfma_f32_16x16x32_bf16 a[168:171],v[244:247],v[200:203],a[168:171]
ds_read_b64_tr_b16 v[184:185],v22 offset:0
v_mfma_f32_16x16x32_bf16 a[172:175],v[244:247],v[204:207],a[172:175]
s_add_u32 m0,s79,33792
s_add_u32 s81,s75,29696
buffer_load_dwordx4 v3,s[8:11],s81 offen sc1 lds
v_mfma_f32_16x16x32_bf16 a[192:195],v[248:251],v[192:195],a[192:195]
ds_read_b64_tr_b16 v[186:187],v22 offset:1024
v_mfma_f32_16x16x32_bf16 a[196:199],v[248:251],v[196:199],a[196:199]
ds_read_b64_tr_b16 v[188:189],v23 offset:0
v_mfma_f32_16x16x32_bf16 a[200:203],v[248:251],v[200:203],a[200:203]
ds_read_b64_tr_b16 v[190:191],v23 offset:1024
v_mfma_f32_16x16x32_bf16 a[204:207],v[248:251],v[204:207],a[204:207]
s_add_u32 m0,s79,34816
s_add_u32 s81,s75,48128
buffer_load_dwordx4 v3,s[8:11],s81 offen sc1 lds
v_mfma_f32_16x16x32_bf16 a[224:227],v[252:255],v[192:195],a[224:227]
v_mfma_f32_16x16x32_bf16 a[228:231],v[252:255],v[196:199],a[228:231]
v_mfma_f32_16x16x32_bf16 a[232:235],v[252:255],v[200:203],a[232:235]
v_mfma_f32_16x16x32_bf16 a[236:239],v[252:255],v[204:207],a[236:239]
s_add_u32 m0,s79,35840
s_add_u32 s81,s75,66560
buffer_load_dwordx4 v3,s[8:11],s81 offen sc1 lds
s_waitcnt vmcnt(16) lgkmcnt(0)
s_barrier
v_mfma_f32_16x16x32_bf16 a[0:3],v[160:163],v[128:131],a[0:3]
v_add_u32 v8,131072,v5
v_mfma_f32_16x16x32_bf16 a[4:7],v[160:163],v[132:135],a[4:7]
ds_read_b128 v[192:195],v8 offset:0
v_add_u32 v16,147456,v24
v_add_u32 v17,147456,v25
v_mfma_f32_16x16x32_bf16 a[8:11],v[160:163],v[136:139],a[8:11]
ds_read_b128 v[196:199],v8 offset:1024
v_add_u32 v18,147456,v26
v_add_u32 v19,147456,v27
v_mfma_f32_16x16x32_bf16 a[12:15],v[160:163],v[140:143],a[12:15]
s_add_u32 m0,s80,65536
s_mov_b32 s81,s76
buffer_load_dwordx4 v4,s[56:59],s81 offen lds
v_mfma_f32_16x16x32_bf16 a[32:35],v[164:167],v[128:131],a[32:35]
ds_read_b128 v[200:203],v8 offset:2048
v_add_u32 v20,147456,v28
v_add_u32 v21,147456,v29
v_mfma_f32_16x16x32_bf16 a[36:39],v[164:167],v[132:135],a[36:39]
ds_read_b128 v[204:207],v8 offset:3072
v_add_u32 v22,147456,v30
v_add_u32 v23,147456,v31
v_mfma_f32_16x16x32_bf16 a[40:43],v[164:167],v[136:139],a[40:43]
ds_read_b64_tr_b16 v[224:225],v16 offset:0
v_mfma_f32_16x16x32_bf16 a[44:47],v[164:167],v[140:143],a[44:47]
s_add_u32 m0,s80,66560
s_add_u32 s81,s76,s68
buffer_load_dwordx4 v4,s[56:59],s81 offen lds
v_mfma_f32_16x16x32_bf16 a[64:67],v[168:171],v[128:131],a[64:67]
ds_read_b64_tr_b16 v[226:227],v16 offset:1024
v_mfma_f32_16x16x32_bf16 a[68:71],v[168:171],v[132:135],a[68:71]
ds_read_b64_tr_b16 v[228:229],v17 offset:0
v_mfma_f32_16x16x32_bf16 a[72:75],v[168:171],v[136:139],a[72:75]
ds_read_b64_tr_b16 v[230:231],v17 offset:1024
v_mfma_f32_16x16x32_bf16 a[76:79],v[168:171],v[140:143],a[76:79]
s_add_u32 m0,s80,69632
s_add_u32 s81,s76,s69
buffer_load_dwordx4 v4,s[56:59],s81 offen lds
v_mfma_f32_16x16x32_bf16 a[96:99],v[172:175],v[128:131],a[96:99]
ds_read_b64_tr_b16 v[232:233],v18 offset:0
v_mfma_f32_16x16x32_bf16 a[100:103],v[172:175],v[132:135],a[100:103]
ds_read_b64_tr_b16 v[234:235],v18 offset:1024
v_mfma_f32_16x16x32_bf16 a[104:107],v[172:175],v[136:139],a[104:107]
ds_read_b64_tr_b16 v[236:237],v19 offset:0
v_mfma_f32_16x16x32_bf16 a[108:111],v[172:175],v[140:143],a[108:111]
s_add_u32 m0,s80,70656
s_add_u32 s81,s81,s68
buffer_load_dwordx4 v4,s[56:59],s81 offen lds
s_add_u32 s76,s76,s70
v_mfma_f32_16x16x32_bf16 a[128:131],v[176:179],v[128:131],a[128:131]
ds_read_b64_tr_b16 v[238:239],v19 offset:1024
v_mfma_f32_16x16x32_bf16 a[132:135],v[176:179],v[132:135],a[132:135]
ds_read_b64_tr_b16 v[240:241],v20 offset:0
v_mfma_f32_16x16x32_bf16 a[136:139],v[176:179],v[136:139],a[136:139]
ds_read_b64_tr_b16 v[242:243],v20 offset:1024
v_mfma_f32_16x16x32_bf16 a[140:143],v[176:179],v[140:143],a[140:143]
s_add_u32 m0,s79,65536
s_add_u32 s81,s75,12288
buffer_load_dwordx4 v3,s[8:11],s81 offen sc1 lds
v_mfma_f32_16x16x32_bf16 a[160:163],v[180:183],v[128:131],a[160:163]
ds_read_b64_tr_b16 v[244:245],v21 offset:0
v_mfma_f32_16x16x32_bf16 a[164:167],v[180:183],v[132:135],a[164:167]
ds_read_b64_tr_b16 v[246:247],v21 offset:1024
v_mfma_f32_16x16x32_bf16 a[168:171],v[180:183],v[136:139],a[168:171]
ds_read_b64_tr_b16 v[248:249],v22 offset:0
v_mfma_f32_16x16x32_bf16 a[172:175],v[180:183],v[140:143],a[172:175]
s_add_u32 m0,s79,66560
s_add_u32 s81,s75,30720
buffer_load_dwordx4 v3,s[8:11],s81 offen sc1 lds
v_mfma_f32_16x16x32_bf16 a[192:195],v[184:187],v[128:131],a[192:195]
ds_read_b64_tr_b16 v[250:251],v22 offset:1024
v_mfma_f32_16x16x32_bf16 a[196:199],v[184:187],v[132:135],a[196:199]
ds_read_b64_tr_b16 v[252:253],v23 offset:0
v_mfma_f32_16x16x32_bf16 a[200:203],v[184:187],v[136:139],a[200:203]
ds_read_b64_tr_b16 v[254:255],v23 offset:1024
v_mfma_f32_16x16x32_bf16 a[204:207],v[184:187],v[140:143],a[204:207]
s_add_u32 m0,s79,67584
s_add_u32 s81,s75,49152
buffer_load_dwordx4 v3,s[8:11],s81 offen sc1 lds
v_mfma_f32_16x16x32_bf16 a[224:227],v[188:191],v[128:131],a[224:227]
v_mfma_f32_16x16x32_bf16 a[228:231],v[188:191],v[132:135],a[228:231]
v_mfma_f32_16x16x32_bf16 a[232:235],v[188:191],v[136:139],a[232:235]
v_mfma_f32_16x16x32_bf16 a[236:239],v[188:191],v[140:143],a[236:239]
s_add_u32 m0,s79,68608
s_add_u32 s81,s75,67584
buffer_load_dwordx4 v3,s[8:11],s81 offen sc1 lds
s_waitcnt vmcnt(16) lgkmcnt(0)
s_barrier
v_mfma_f32_16x16x32_bf16 a[0:3],v[224:227],v[192:195],a[0:3]
v_add_u32 v8,0,v5
v_mfma_f32_16x16x32_bf16 a[4:7],v[224:227],v[196:199],a[4:7]
ds_read_b128 v[128:131],v8 offset:0
v_add_u32 v16,16384,v24
v_add_u32 v17,16384,v25
v_mfma_f32_16x16x32_bf16 a[8:11],v[224:227],v[200:203],a[8:11]
ds_read_b128 v[132:135],v8 offset:1024
v_add_u32 v18,16384,v26
v_add_u32 v19,16384,v27
v_mfma_f32_16x16x32_bf16 a[12:15],v[224:227],v[204:207],a[12:15]
s_add_u32 m0,s80,98304
s_mov_b32 s81,s76
buffer_load_dwordx4 v4,s[56:59],s81 offen lds
v_mfma_f32_16x16x32_bf16 a[32:35],v[228:231],v[192:195],a[32:35]
ds_read_b128 v[136:139],v8 offset:2048
v_add_u32 v20,16384,v28
v_add_u32 v21,16384,v29
v_mfma_f32_16x16x32_bf16 a[36:39],v[228:231],v[196:199],a[36:39]
ds_read_b128 v[140:143],v8 offset:3072
v_add_u32 v22,16384,v30
v_add_u32 v23,16384,v31
v_mfma_f32_16x16x32_bf16 a[40:43],v[228:231],v[200:203],a[40:43]
ds_read_b64_tr_b16 v[160:161],v16 offset:0
v_mfma_f32_16x16x32_bf16 a[44:47],v[228:231],v[204:207],a[44:47]
s_add_u32 m0,s80,99328
s_add_u32 s81,s76,s68
buffer_load_dwordx4 v4,s[56:59],s81 offen lds
v_mfma_f32_16x16x32_bf16 a[64:67],v[232:235],v[192:195],a[64:67]
ds_read_b64_tr_b16 v[162:163],v16 offset:1024
v_mfma_f32_16x16x32_bf16 a[68:71],v[232:235],v[196:199],a[68:71]
ds_read_b64_tr_b16 v[164:165],v17 offset:0
v_mfma_f32_16x16x32_bf16 a[72:75],v[232:235],v[200:203],a[72:75]
ds_read_b64_tr_b16 v[166:167],v17 offset:1024
v_mfma_f32_16x16x32_bf16 a[76:79],v[232:235],v[204:207],a[76:79]
s_add_u32 m0,s80,102400
s_add_u32 s81,s76,s69
buffer_load_dwordx4 v4,s[56:59],s81 offen lds
v_mfma_f32_16x16x32_bf16 a[96:99],v[236:239],v[192:195],a[96:99]
ds_read_b64_tr_b16 v[168:169],v18 offset:0
v_mfma_f32_16x16x32_bf16 a[100:103],v[236:239],v[196:199],a[100:103]
ds_read_b64_tr_b16 v[170:171],v18 offset:1024
v_mfma_f32_16x16x32_bf16 a[104:107],v[236:239],v[200:203],a[104:107]
ds_read_b64_tr_b16 v[172:173],v19 offset:0
v_mfma_f32_16x16x32_bf16 a[108:111],v[236:239],v[204:207],a[108:111]
s_add_u32 m0,s80,103424
s_add_u32 s81,s81,s68
buffer_load_dwordx4 v4,s[56:59],s81 offen lds
s_add_u32 s76,s76,s70
v_mfma_f32_16x16x32_bf16 a[128:131],v[240:243],v[192:195],a[128:131]
ds_read_b64_tr_b16 v[174:175],v19 offset:1024
v_mfma_f32_16x16x32_bf16 a[132:135],v[240:243],v[196:199],a[132:135]
ds_read_b64_tr_b16 v[176:177],v20 offset:0
v_mfma_f32_16x16x32_bf16 a[136:139],v[240:243],v[200:203],a[136:139]
ds_read_b64_tr_b16 v[178:179],v20 offset:1024
v_mfma_f32_16x16x32_bf16 a[140:143],v[240:243],v[204:207],a[140:143]
s_add_u32 m0,s79,98304
s_add_u32 s81,s75,13312
buffer_load_dwordx4 v3,s[8:11],s81 offen sc1 lds
v_mfma_f32_16x16x32_bf16 a[160:163],v[244:247],v[192:195],a[160:163]
ds_read_b64_tr_b16 v[180:181],v21 offset:0
v_mfma_f32_16x16x32_bf16 a[164:167],v[244:247],v[196:199],a[164:167]
ds_read_b64_tr_b16 v[182:183],v21 offset:1024
v_mfma_f32_16x16x32_bf16 a[168:171],v[244:247],v[200:203],a[168:171]
ds_read_b64_tr_b16 v[184:185],v22 offset:0
v_mfma_f32_16x16x32_bf16 a[172:175],v[244:247],v[204:207],a[172:175]
s_add_u32 m0,s79,99328
s_add_u32 s81,s75,31744
buffer_load_dwordx4 v3,s[8:11],s81 offen sc1 lds
v_mfma_f32_16x16x32_bf16 a[192:195],v[248:251],v[192:195],a[192:195]
ds_read_b64_tr_b16 v[186:187],v22 offset:1024
v_mfma_f32_16x16x32_bf16 a[196:199],v[248:251],v[196:199],a[196:199]
ds_read_b64_tr_b16 v[188:189],v23 offset:0
v_mfma_f32_16x16x32_bf16 a[200:203],v[248:251],v[200:203],a[200:203]
ds_read_b64_tr_b16 v[190:191],v23 offset:1024
v_mfma_f32_16x16x32_bf16 a[204:207],v[248:251],v[204:207],a[204:207]
s_add_u32 m0,s79,100352
s_add_u32 s81,s75,50176
buffer_load_dwordx4 v3,s[8:11],s81 offen sc1 lds
v_mfma_f32_16x16x32_bf16 a[224:227],v[252:255],v[192:195],a[224:227]
v_mfma_f32_16x16x32_bf16 a[228:231],v[252:255],v[196:199],a[228:231]
v_mfma_f32_16x16x32_bf16 a[232:235],v[252:255],v[200:203],a[232:235]
v_mfma_f32_16x16x32_bf16 a[236:239],v[252:255],v[204:207],a[236:239]
s_add_u32 m0,s79,101376
s_add_u32 s81,s75,68608
buffer_load_dwordx4 v3,s[8:11],s81 offen sc1 lds
s_waitcnt vmcnt(16) lgkmcnt(0)
s_barrier
v_mfma_f32_16x16x32_bf16 a[0:3],v[160:163],v[128:131],a[0:3]
v_add_u32 v8,32768,v5
v_mfma_f32_16x16x32_bf16 a[4:7],v[160:163],v[132:135],a[4:7]
ds_read_b128 v[192:195],v8 offset:0
v_add_u32 v16,49152,v24
v_add_u32 v17,49152,v25
v_mfma_f32_16x16x32_bf16 a[8:11],v[160:163],v[136:139],a[8:11]
ds_read_b128 v[196:199],v8 offset:1024
v_add_u32 v18,49152,v26
v_add_u32 v19,49152,v27
v_mfma_f32_16x16x32_bf16 a[12:15],v[160:163],v[140:143],a[12:15]
s_add_u32 m0,s80,131072
s_mov_b32 s81,s76
buffer_load_dwordx4 v4,s[56:59],s81 offen lds
v_mfma_f32_16x16x32_bf16 a[32:35],v[164:167],v[128:131],a[32:35]
ds_read_b128 v[200:203],v8 offset:2048
v_add_u32 v20,49152,v28
v_add_u32 v21,49152,v29
v_mfma_f32_16x16x32_bf16 a[36:39],v[164:167],v[132:135],a[36:39]
ds_read_b128 v[204:207],v8 offset:3072
v_add_u32 v22,49152,v30
v_add_u32 v23,49152,v31
v_mfma_f32_16x16x32_bf16 a[40:43],v[164:167],v[136:139],a[40:43]
ds_read_b64_tr_b16 v[224:225],v16 offset:0
v_mfma_f32_16x16x32_bf16 a[44:47],v[164:167],v[140:143],a[44:47]
s_add_u32 m0,s80,132096
s_add_u32 s81,s76,s68
buffer_load_dwordx4 v4,s[56:59],s81 offen lds
v_mfma_f32_16x16x32_bf16 a[64:67],v[168:171],v[128:131],a[64:67]
ds_read_b64_tr_b16 v[226:227],v16 offset:1024
v_mfma_f32_16x16x32_bf16 a[68:71],v[168:171],v[132:135],a[68:71]
ds_read_b64_tr_b16 v[228:229],v17 offset:0
v_mfma_f32_16x16x32_bf16 a[72:75],v[168:171],v[136:139],a[72:75]
ds_read_b64_tr_b16 v[230:231],v17 offset:1024
v_mfma_f32_16x16x32_bf16 a[76:79],v[168:171],v[140:143],a[76:79]
s_add_u32 m0,s80,135168
s_add_u32 s81,s76,s69
buffer_load_dwordx4 v4,s[56:59],s81 offen lds
v_mfma_f32_16x16x32_bf16 a[96:99],v[172:175],v[128:131],a[96:99]
ds_read_b64_tr_b16 v[232:233],v18 offset:0
v_mfma_f32_16x16x32_bf16 a[100:103],v[172:175],v[132:135],a[100:103]
ds_read_b64_tr_b16 v[234:235],v18 offset:1024
v_mfma_f32_16x16x32_bf16 a[104:107],v[172:175],v[136:139],a[104:107]
ds_read_b64_tr_b16 v[236:237],v19 offset:0
v_mfma_f32_16x16x32_bf16 a[108:111],v[172:175],v[140:143],a[108:111]
s_add_u32 m0,s80,136192
s_add_u32 s81,s81,s68
buffer_load_dwordx4 v4,s[56:59],s81 offen lds
s_add_u32 s76,s76,s70
v_mfma_f32_16x16x32_bf16 a[128:131],v[176:179],v[128:131],a[128:131]
ds_read_b64_tr_b16 v[238:239],v19 offset:1024
v_mfma_f32_16x16x32_bf16 a[132:135],v[176:179],v[132:135],a[132:135]
ds_read_b64_tr_b16 v[240:241],v20 offset:0
v_mfma_f32_16x16x32_bf16 a[136:139],v[176:179],v[136:139],a[136:139]
ds_read_b64_tr_b16 v[242:243],v20 offset:1024
v_mfma_f32_16x16x32_bf16 a[140:143],v[176:179],v[140:143],a[140:143]
s_add_u32 m0,s79,131072
s_add_u32 s81,s75,14336
buffer_load_dwordx4 v3,s[8:11],s81 offen sc1 lds
v_mfma_f32_16x16x32_bf16 a[160:163],v[180:183],v[128:131],a[160:163]
ds_read_b64_tr_b16 v[244:245],v21 offset:0
v_mfma_f32_16x16x32_bf16 a[164:167],v[180:183],v[132:135],a[164:167]
ds_read_b64_tr_b16 v[246:247],v21 offset:1024
v_mfma_f32_16x16x32_bf16 a[168:171],v[180:183],v[136:139],a[168:171]
ds_read_b64_tr_b16 v[248:249],v22 offset:0
v_mfma_f32_16x16x32_bf16 a[172:175],v[180:183],v[140:143],a[172:175]
s_add_u32 m0,s79,132096
s_add_u32 s81,s75,32768
buffer_load_dwordx4 v3,s[8:11],s81 offen sc1 lds
v_mfma_f32_16x16x32_bf16 a[192:195],v[184:187],v[128:131],a[192:195]
ds_read_b64_tr_b16 v[250:251],v22 offset:1024
v_mfma_f32_16x16x32_bf16 a[196:199],v[184:187],v[132:135],a[196:199]
ds_read_b64_tr_b16 v[252:253],v23 offset:0
v_mfma_f32_16x16x32_bf16 a[200:203],v[184:187],v[136:139],a[200:203]
ds_read_b64_tr_b16 v[254:255],v23 offset:1024
v_mfma_f32_16x16x32_bf16 a[204:207],v[184:187],v[140:143],a[204:207]
s_add_u32 m0,s79,133120
s_add_u32 s81,s75,51200
buffer_load_dwordx4 v3,s[8:11],s81 offen sc1 lds
v_mfma_f32_16x16x32_bf16 a[224:227],v[188:191],v[128:131],a[224:227]
v_mfma_f32_16x16x32_bf16 a[228:231],v[188:191],v[132:135],a[228:231]
v_mfma_f32_16x16x32_bf16 a[232:235],v[188:191],v[136:139],a[232:235]
v_mfma_f32_16x16x32_bf16 a[236:239],v[188:191],v[140:143],a[236:239]
s_add_u32 m0,s79,134144
s_add_u32 s81,s75,69632
buffer_load_dwordx4 v3,s[8:11],s81 offen sc1 lds
s_waitcnt vmcnt(16) lgkmcnt(0)
s_barrier
v_mfma_f32_16x16x32_bf16 a[0:3],v[224:227],v[192:195],a[0:3]
v_add_u32 v8,65536,v5
v_mfma_f32_16x16x32_bf16 a[4:7],v[224:227],v[196:199],a[4:7]
ds_read_b128 v[128:131],v8 offset:0
v_add_u32 v16,81920,v24
v_add_u32 v17,81920,v25
v_mfma_f32_16x16x32_bf16 a[8:11],v[224:227],v[200:203],a[8:11]
ds_read_b128 v[132:135],v8 offset:1024
v_add_u32 v18,81920,v26
v_add_u32 v19,81920,v27
v_mfma_f32_16x16x32_bf16 a[12:15],v[224:227],v[204:207],a[12:15]
s_add_u32 m0,s80,0
s_mov_b32 s81,s76
buffer_load_dwordx4 v4,s[56:59],s81 offen lds
v_mfma_f32_16x16x32_bf16 a[32:35],v[228:231],v[192:195],a[32:35]
ds_read_b128 v[136:139],v8 offset:2048
v_add_u32 v20,81920,v28
v_add_u32 v21,81920,v29
v_mfma_f32_16x16x32_bf16 a[36:39],v[228:231],v[196:199],a[36:39]
ds_read_b128 v[140:143],v8 offset:3072
v_add_u32 v22,81920,v30
v_add_u32 v23,81920,v31
v_mfma_f32_16x16x32_bf16 a[40:43],v[228:231],v[200:203],a[40:43]
ds_read_b64_tr_b16 v[160:161],v16 offset:0
v_mfma_f32_16x16x32_bf16 a[44:47],v[228:231],v[204:207],a[44:47]
s_add_u32 m0,s80,1024
s_add_u32 s81,s76,s68
buffer_load_dwordx4 v4,s[56:59],s81 offen lds
v_mfma_f32_16x16x32_bf16 a[64:67],v[232:235],v[192:195],a[64:67]
ds_read_b64_tr_b16 v[162:163],v16 offset:1024
v_mfma_f32_16x16x32_bf16 a[68:71],v[232:235],v[196:199],a[68:71]
ds_read_b64_tr_b16 v[164:165],v17 offset:0
v_mfma_f32_16x16x32_bf16 a[72:75],v[232:235],v[200:203],a[72:75]
ds_read_b64_tr_b16 v[166:167],v17 offset:1024
v_mfma_f32_16x16x32_bf16 a[76:79],v[232:235],v[204:207],a[76:79]
s_add_u32 m0,s80,4096
s_add_u32 s81,s76,s69
buffer_load_dwordx4 v4,s[56:59],s81 offen lds
v_mfma_f32_16x16x32_bf16 a[96:99],v[236:239],v[192:195],a[96:99]
ds_read_b64_tr_b16 v[168:169],v18 offset:0
v_mfma_f32_16x16x32_bf16 a[100:103],v[236:239],v[196:199],a[100:103]
ds_read_b64_tr_b16 v[170:171],v18 offset:1024
v_mfma_f32_16x16x32_bf16 a[104:107],v[236:239],v[200:203],a[104:107]
ds_read_b64_tr_b16 v[172:173],v19 offset:0
v_mfma_f32_16x16x32_bf16 a[108:111],v[236:239],v[204:207],a[108:111]
s_add_u32 m0,s80,5120
s_add_u32 s81,s81,s68
buffer_load_dwordx4 v4,s[56:59],s81 offen lds
s_add_u32 s76,s76,s70
v_mfma_f32_16x16x32_bf16 a[128:131],v[240:243],v[192:195],a[128:131]
ds_read_b64_tr_b16 v[174:175],v19 offset:1024
v_mfma_f32_16x16x32_bf16 a[132:135],v[240:243],v[196:199],a[132:135]
ds_read_b64_tr_b16 v[176:177],v20 offset:0
v_mfma_f32_16x16x32_bf16 a[136:139],v[240:243],v[200:203],a[136:139]
ds_read_b64_tr_b16 v[178:179],v20 offset:1024
v_mfma_f32_16x16x32_bf16 a[140:143],v[240:243],v[204:207],a[140:143]
s_add_u32 m0,s79,0
s_add_u32 s81,s75,15360
buffer_load_dwordx4 v3,s[8:11],s81 offen sc1 lds
v_mfma_f32_16x16x32_bf16 a[160:163],v[244:247],v[192:195],a[160:163]
ds_read_b64_tr_b16 v[180:181],v21 offset:0
v_mfma_f32_16x16x32_bf16 a[164:167],v[244:247],v[196:199],a[164:167]
ds_read_b64_tr_b16 v[182:183],v21 offset:1024
v_mfma_f32_16x16x32_bf16 a[168:171],v[244:247],v[200:203],a[168:171]
ds_read_b64_tr_b16 v[184:185],v22 offset:0
v_mfma_f32_16x16x32_bf16 a[172:175],v[244:247],v[204:207],a[172:175]
s_add_u32 m0,s79,1024
s_add_u32 s81,s75,33792
buffer_load_dwordx4 v3,s[8:11],s81 offen sc1 lds
v_mfma_f32_16x16x32_bf16 a[192:195],v[248:251],v[192:195],a[192:195]
ds_read_b64_tr_b16 v[186:187],v22 offset:1024
v_mfma_f32_16x16x32_bf16 a[196:199],v[248:251],v[196:199],a[196:199]
ds_read_b64_tr_b16 v[188:189],v23 offset:0
v_mfma_f32_16x16x32_bf16 a[200:203],v[248:251],v[200:203],a[200:203]
ds_read_b64_tr_b16 v[190:191],v23 offset:1024
v_mfma_f32_16x16x32_bf16 a[204:207],v[248:251],v[204:207],a[204:207]
s_add_u32 m0,s79,2048
s_add_u32 s81,s75,52224
buffer_load_dwordx4 v3,s[8:11],s81 offen sc1 lds
v_mfma_f32_16x16x32_bf16 a[224:227],v[252:255],v[192:195],a[224:227]
v_mfma_f32_16x16x32_bf16 a[228:231],v[252:255],v[196:199],a[228:231]
v_mfma_f32_16x16x32_bf16 a[232:235],v[252:255],v[200:203],a[232:235]
v_mfma_f32_16x16x32_bf16 a[236:239],v[252:255],v[204:207],a[236:239]
s_add_u32 m0,s79,3072
s_add_u32 s81,s75,70656
buffer_load_dwordx4 v3,s[8:11],s81 offen sc1 lds
s_waitcnt vmcnt(16) lgkmcnt(0)
s_barrier
v_mfma_f32_16x16x32_bf16 a[0:3],v[160:163],v[128:131],a[0:3]
v_add_u32 v8,98304,v5
v_mfma_f32_16x16x32_bf16 a[4:7],v[160:163],v[132:135],a[4:7]
ds_read_b128 v[192:195],v8 offset:0
v_add_u32 v16,114688,v24
v_add_u32 v17,114688,v25
v_mfma_f32_16x16x32_bf16 a[8:11],v[160:163],v[136:139],a[8:11]
ds_read_b128 v[196:199],v8 offset:1024
v_add_u32 v18,114688,v26
v_add_u32 v19,114688,v27
v_mfma_f32_16x16x32_bf16 a[12:15],v[160:163],v[140:143],a[12:15]
s_add_u32 m0,s80,32768
s_mov_b32 s81,s76
buffer_load_dwordx4 v4,s[56:59],s81 offen lds
v_mfma_f32_16x16x32_bf16 a[32:35],v[164:167],v[128:131],a[32:35]
ds_read_b128 v[200:203],v8 offset:2048
v_add_u32 v20,114688,v28
v_add_u32 v21,114688,v29
v_mfma_f32_16x16x32_bf16 a[36:39],v[164:167],v[132:135],a[36:39]
ds_read_b128 v[204:207],v8 offset:3072
v_add_u32 v22,114688,v30
v_add_u32 v23,114688,v31
v_mfma_f32_16x16x32_bf16 a[40:43],v[164:167],v[136:139],a[40:43]
ds_read_b64_tr_b16 v[224:225],v16 offset:0
v_mfma_f32_16x16x32_bf16 a[44:47],v[164:167],v[140:143],a[44:47]
s_add_u32 m0,s80,33792
s_add_u32 s81,s76,s68
buffer_load_dwordx4 v4,s[56:59],s81 offen lds
v_mfma_f32_16x16x32_bf16 a[64:67],v[168:171],v[128:131],a[64:67]
ds_read_b64_tr_b16 v[226:227],v16 offset:1024
v_mfma_f32_16x16x32_bf16 a[68:71],v[168:171],v[132:135],a[68:71]
ds_read_b64_tr_b16 v[228:229],v17 offset:0
v_mfma_f32_16x16x32_bf16 a[72:75],v[168:171],v[136:139],a[72:75]
ds_read_b64_tr_b16 v[230:231],v17 offset:1024
v_mfma_f32_16x16x32_bf16 a[76:79],v[168:171],v[140:143],a[76:79]
s_add_u32 m0,s80,36864
s_add_u32 s81,s76,s69
buffer_load_dwordx4 v4,s[56:59],s81 offen lds
v_mfma_f32_16x16x32_bf16 a[96:99],v[172:175],v[128:131],a[96:99]
ds_read_b64_tr_b16 v[232:233],v18 offset:0
v_mfma_f32_16x16x32_bf16 a[100:103],v[172:175],v[132:135],a[100:103]
ds_read_b64_tr_b16 v[234:235],v18 offset:1024
v_mfma_f32_16x16x32_bf16 a[104:107],v[172:175],v[136:139],a[104:107]
ds_read_b64_tr_b16 v[236:237],v19 offset:0
v_mfma_f32_16x16x32_bf16 a[108:111],v[172:175],v[140:143],a[108:111]
s_add_u32 m0,s80,37888
s_add_u32 s81,s81,s68
buffer_load_dwordx4 v4,s[56:59],s81 offen lds
s_add_u32 s76,s76,s70
v_mfma_f32_16x16x32_bf16 a[128:131],v[176:179],v[128:131],a[128:131]
ds_read_b64_tr_b16 v[238:239],v19 offset:1024
v_mfma_f32_16x16x32_bf16 a[132:135],v[176:179],v[132:135],a[132:135]
ds_read_b64_tr_b16 v[240:241],v20 offset:0
v_mfma_f32_16x16x32_bf16 a[136:139],v[176:179],v[136:139],a[136:139]
ds_read_b64_tr_b16 v[242:243],v20 offset:1024
v_mfma_f32_16x16x32_bf16 a[140:143],v[176:179],v[140:143],a[140:143]
s_add_u32 m0,s79,32768
s_add_u32 s81,s75,16384
buffer_load_dwordx4 v3,s[8:11],s81 offen sc1 lds
v_mfma_f32_16x16x32_bf16 a[160:163],v[180:183],v[128:131],a[160:163]
ds_read_b64_tr_b16 v[244:245],v21 offset:0
v_mfma_f32_16x16x32_bf16 a[164:167],v[180:183],v[132:135],a[164:167]
ds_read_b64_tr_b16 v[246:247],v21 offset:1024
v_mfma_f32_16x16x32_bf16 a[168:171],v[180:183],v[136:139],a[168:171]
ds_read_b64_tr_b16 v[248:249],v22 offset:0
v_mfma_f32_16x16x32_bf16 a[172:175],v[180:183],v[140:143],a[172:175]
s_add_u32 m0,s79,33792
s_add_u32 s81,s75,34816
buffer_load_dwordx4 v3,s[8:11],s81 offen sc1 lds
v_mfma_f32_16x16x32_bf16 a[192:195],v[184:187],v[128:131],a[192:195]
ds_read_b64_tr_b16 v[250:251],v22 offset:1024
v_mfma_f32_16x16x32_bf16 a[196:199],v[184:187],v[132:135],a[196:199]
ds_read_b64_tr_b16 v[252:253],v23 offset:0
v_mfma_f32_16x16x32_bf16 a[200:203],v[184:187],v[136:139],a[200:203]
ds_read_b64_tr_b16 v[254:255],v23 offset:1024
v_mfma_f32_16x16x32_bf16 a[204:207],v[184:187],v[140:143],a[204:207]
s_add_u32 m0,s79,34816
s_add_u32 s81,s75,53248
buffer_load_dwordx4 v3,s[8:11],s81 offen sc1 lds
v_mfma_f32_16x16x32_bf16 a[224:227],v[188:191],v[128:131],a[224:227]
v_mfma_f32_16x16x32_bf16 a[228:231],v[188:191],v[132:135],a[228:231]
v_mfma_f32_16x16x32_bf16 a[232:235],v[188:191],v[136:139],a[232:235]
v_mfma_f32_16x16x32_bf16 a[236:239],v[188:191],v[140:143],a[236:239]
s_add_u32 m0,s79,35840
s_add_u32 s81,s75,71680
buffer_load_dwordx4 v3,s[8:11],s81 offen sc1 lds
s_waitcnt vmcnt(16) lgkmcnt(0)
s_barrier
v_mfma_f32_16x16x32_bf16 a[0:3],v[224:227],v[192:195],a[0:3]
v_add_u32 v8,131072,v5
v_mfma_f32_16x16x32_bf16 a[4:7],v[224:227],v[196:199],a[4:7]
ds_read_b128 v[128:131],v8 offset:0
v_add_u32 v16,147456,v24
v_add_u32 v17,147456,v25
v_mfma_f32_16x16x32_bf16 a[8:11],v[224:227],v[200:203],a[8:11]
ds_read_b128 v[132:135],v8 offset:1024
v_add_u32 v18,147456,v26
v_add_u32 v19,147456,v27
v_mfma_f32_16x16x32_bf16 a[12:15],v[224:227],v[204:207],a[12:15]
s_add_u32 m0,s80,65536
s_mov_b32 s81,s76
buffer_load_dwordx4 v4,s[56:59],s81 offen lds
v_mfma_f32_16x16x32_bf16 a[32:35],v[228:231],v[192:195],a[32:35]
ds_read_b128 v[136:139],v8 offset:2048
v_add_u32 v20,147456,v28
v_add_u32 v21,147456,v29
v_mfma_f32_16x16x32_bf16 a[36:39],v[228:231],v[196:199],a[36:39]
ds_read_b128 v[140:143],v8 offset:3072
v_add_u32 v22,147456,v30
v_add_u32 v23,147456,v31
v_mfma_f32_16x16x32_bf16 a[40:43],v[228:231],v[200:203],a[40:43]
ds_read_b64_tr_b16 v[160:161],v16 offset:0
v_mfma_f32_16x16x32_bf16 a[44:47],v[228:231],v[204:207],a[44:47]
s_add_u32 m0,s80,66560
s_add_u32 s81,s76,s68
buffer_load_dwordx4 v4,s[56:59],s81 offen lds
v_mfma_f32_16x16x32_bf16 a[64:67],v[232:235],v[192:195],a[64:67]
ds_read_b64_tr_b16 v[162:163],v16 offset:1024
v_mfma_f32_16x16x32_bf16 a[68:71],v[232:235],v[196:199],a[68:71]
ds_read_b64_tr_b16 v[164:165],v17 offset:0
v_mfma_f32_16x16x32_bf16 a[72:75],v[232:235],v[200:203],a[72:75]
ds_read_b64_tr_b16 v[166:167],v17 offset:1024
v_mfma_f32_16x16x32_bf16 a[76:79],v[232:235],v[204:207],a[76:79]
s_add_u32 m0,s80,69632
s_add_u32 s81,s76,s69
buffer_load_dwordx4 v4,s[56:59],s81 offen lds
v_mfma_f32_16x16x32_bf16 a[96:99],v[236:239],v[192:195],a[96:99]
ds_read_b64_tr_b16 v[168:169],v18 offset:0
v_mfma_f32_16x16x32_bf16 a[100:103],v[236:239],v[196:199],a[100:103]
ds_read_b64_tr_b16 v[170:171],v18 offset:1024
v_mfma_f32_16x16x32_bf16 a[104:107],v[236:239],v[200:203],a[104:107]
ds_read_b64_tr_b16 v[172:173],v19 offset:0
v_mfma_f32_16x16x32_bf16 a[108:111],v[236:239],v[204:207],a[108:111]
s_add_u32 m0,s80,70656
s_add_u32 s81,s81,s68
buffer_load_dwordx4 v4,s[56:59],s81 offen lds
s_add_u32 s76,s76,s70
v_mfma_f32_16x16x32_bf16 a[128:131],v[240:243],v[192:195],a[128:131]
ds_read_b64_tr_b16 v[174:175],v19 offset:1024
v_mfma_f32_16x16x32_bf16 a[132:135],v[240:243],v[196:199],a[132:135]
ds_read_b64_tr_b16 v[176:177],v20 offset:0
v_mfma_f32_16x16x32_bf16 a[136:139],v[240:243],v[200:203],a[136:139]
ds_read_b64_tr_b16 v[178:179],v20 offset:1024
v_mfma_f32_16x16x32_bf16 a[140:143],v[240:243],v[204:207],a[140:143]
s_add_u32 m0,s79,65536
s_add_u32 s81,s75,17408
buffer_load_dwordx4 v3,s[8:11],s81 offen sc1 lds
v_mfma_f32_16x16x32_bf16 a[160:163],v[244:247],v[192:195],a[160:163]
ds_read_b64_tr_b16 v[180:181],v21 offset:0
v_mfma_f32_16x16x32_bf16 a[164:167],v[244:247],v[196:199],a[164:167]
ds_read_b64_tr_b16 v[182:183],v21 offset:1024
v_mfma_f32_16x16x32_bf16 a[168:171],v[244:247],v[200:203],a[168:171]
ds_read_b64_tr_b16 v[184:185],v22 offset:0
v_mfma_f32_16x16x32_bf16 a[172:175],v[244:247],v[204:207],a[172:175]
s_add_u32 m0,s79,66560
s_add_u32 s81,s75,35840
buffer_load_dwordx4 v3,s[8:11],s81 offen sc1 lds
v_mfma_f32_16x16x32_bf16 a[192:195],v[248:251],v[192:195],a[192:195]
ds_read_b64_tr_b16 v[186:187],v22 offset:1024
v_mfma_f32_16x16x32_bf16 a[196:199],v[248:251],v[196:199],a[196:199]
ds_read_b64_tr_b16 v[188:189],v23 offset:0
v_mfma_f32_16x16x32_bf16 a[200:203],v[248:251],v[200:203],a[200:203]
ds_read_b64_tr_b16 v[190:191],v23 offset:1024
v_mfma_f32_16x16x32_bf16 a[204:207],v[248:251],v[204:207],a[204:207]
s_add_u32 m0,s79,67584
s_add_u32 s81,s75,54272
buffer_load_dwordx4 v3,s[8:11],s81 offen sc1 lds
v_mfma_f32_16x16x32_bf16 a[224:227],v[252:255],v[192:195],a[224:227]
v_mfma_f32_16x16x32_bf16 a[228:231],v[252:255],v[196:199],a[228:231]
v_mfma_f32_16x16x32_bf16 a[232:235],v[252:255],v[200:203],a[232:235]
v_mfma_f32_16x16x32_bf16 a[236:239],v[252:255],v[204:207],a[236:239]
s_add_u32 m0,s79,68608
s_add_u32 s81,s75,72704
buffer_load_dwordx4 v3,s[8:11],s81 offen sc1 lds
s_waitcnt vmcnt(16) lgkmcnt(0)
s_barrier
v_mfma_f32_16x16x32_bf16 a[0:3],v[160:163],v[128:131],a[0:3]
v_add_u32 v8,0,v5
v_mfma_f32_16x16x32_bf16 a[4:7],v[160:163],v[132:135],a[4:7]
ds_read_b128 v[192:195],v8 offset:0
v_add_u32 v16,16384,v24
v_add_u32 v17,16384,v25
v_mfma_f32_16x16x32_bf16 a[8:11],v[160:163],v[136:139],a[8:11]
ds_read_b128 v[196:199],v8 offset:1024
v_add_u32 v18,16384,v26
v_add_u32 v19,16384,v27
v_mfma_f32_16x16x32_bf16 a[12:15],v[160:163],v[140:143],a[12:15]
ds_read_b128 v[200:203],v8 offset:2048
v_add_u32 v20,16384,v28
v_add_u32 v21,16384,v29
v_mfma_f32_16x16x32_bf16 a[32:35],v[164:167],v[128:131],a[32:35]
ds_read_b128 v[204:207],v8 offset:3072
v_add_u32 v22,16384,v30
v_add_u32 v23,16384,v31
v_mfma_f32_16x16x32_bf16 a[36:39],v[164:167],v[132:135],a[36:39]
ds_read_b64_tr_b16 v[224:225],v16 offset:0
v_mfma_f32_16x16x32_bf16 a[40:43],v[164:167],v[136:139],a[40:43]
ds_read_b64_tr_b16 v[226:227],v16 offset:1024
v_mfma_f32_16x16x32_bf16 a[44:47],v[164:167],v[140:143],a[44:47]
ds_read_b64_tr_b16 v[228:229],v17 offset:0
v_mfma_f32_16x16x32_bf16 a[64:67],v[168:171],v[128:131],a[64:67]
ds_read_b64_tr_b16 v[230:231],v17 offset:1024
v_mfma_f32_16x16x32_bf16 a[68:71],v[168:171],v[132:135],a[68:71]
ds_read_b64_tr_b16 v[232:233],v18 offset:0
v_mfma_f32_16x16x32_bf16 a[72:75],v[168:171],v[136:139],a[72:75]
ds_read_b64_tr_b16 v[234:235],v18 offset:1024
v_mfma_f32_16x16x32_bf16 a[76:79],v[168:171],v[140:143],a[76:79]
ds_read_b64_tr_b16 v[236:237],v19 offset:0
v_mfma_f32_16x16x32_bf16 a[96:99],v[172:175],v[128:131],a[96:99]
ds_read_b64_tr_b16 v[238:239],v19 offset:1024
v_mfma_f32_16x16x32_bf16 a[100:103],v[172:175],v[132:135],a[100:103]
ds_read_b64_tr_b16 v[240:241],v20 offset:0
v_mfma_f32_16x16x32_bf16 a[104:107],v[172:175],v[136:139],a[104:107]
ds_read_b64_tr_b16 v[242:243],v20 offset:1024
v_mfma_f32_16x16x32_bf16 a[108:111],v[172:175],v[140:143],a[108:111]
ds_read_b64_tr_b16 v[244:245],v21 offset:0
v_mfma_f32_16x16x32_bf16 a[128:131],v[176:179],v[128:131],a[128:131]
ds_read_b64_tr_b16 v[246:247],v21 offset:1024
v_mfma_f32_16x16x32_bf16 a[132:135],v[176:179],v[132:135],a[132:135]
ds_read_b64_tr_b16 v[248:249],v22 offset:0
v_mfma_f32_16x16x32_bf16 a[136:139],v[176:179],v[136:139],a[136:139]
ds_read_b64_tr_b16 v[250:251],v22 offset:1024
v_mfma_f32_16x16x32_bf16 a[140:143],v[176:179],v[140:143],a[140:143]
ds_read_b64_tr_b16 v[252:253],v23 offset:0
v_mfma_f32_16x16x32_bf16 a[160:163],v[180:183],v[128:131],a[160:163]
ds_read_b64_tr_b16 v[254:255],v23 offset:1024
v_mfma_f32_16x16x32_bf16 a[164:167],v[180:183],v[132:135],a[164:167]
v_mfma_f32_16x16x32_bf16 a[168:171],v[180:183],v[136:139],a[168:171]
v_mfma_f32_16x16x32_bf16 a[172:175],v[180:183],v[140:143],a[172:175]
v_mfma_f32_16x16x32_bf16 a[192:195],v[184:187],v[128:131],a[192:195]
v_mfma_f32_16x16x32_bf16 a[196:199],v[184:187],v[132:135],a[196:199]
v_mfma_f32_16x16x32_bf16 a[200:203],v[184:187],v[136:139],a[200:203]
v_mfma_f32_16x16x32_bf16 a[204:207],v[184:187],v[140:143],a[204:207]
v_mfma_f32_16x16x32_bf16 a[224:227],v[188:191],v[128:131],a[224:227]
v_mfma_f32_16x16x32_bf16 a[228:231],v[188:191],v[132:135],a[228:231]
v_mfma_f32_16x16x32_bf16 a[232:235],v[188:191],v[136:139],a[232:235]
v_mfma_f32_16x16x32_bf16 a[236:239],v[188:191],v[140:143],a[236:239]
s_waitcnt vmcnt(8) lgkmcnt(0)
s_barrier
v_mfma_f32_16x16x32_bf16 a[0:3],v[224:227],v[192:195],a[0:3]
v_add_u32 v8,32768,v5
v_mfma_f32_16x16x32_bf16 a[4:7],v[224:227],v[196:199],a[4:7]
ds_read_b128 v[128:131],v8 offset:0
v_add_u32 v16,49152,v24
v_add_u32 v17,49152,v25
v_mfma_f32_16x16x32_bf16 a[8:11],v[224:227],v[200:203],a[8:11]
ds_read_b128 v[132:135],v8 offset:1024
v_add_u32 v18,49152,v26
v_add_u32 v19,49152,v27
v_mfma_f32_16x16x32_bf16 a[12:15],v[224:227],v[204:207],a[12:15]
ds_read_b128 v[136:139],v8 offset:2048
v_add_u32 v20,49152,v28
v_add_u32 v21,49152,v29
v_mfma_f32_16x16x32_bf16 a[32:35],v[228:231],v[192:195],a[32:35]
ds_read_b128 v[140:143],v8 offset:3072
v_add_u32 v22,49152,v30
v_add_u32 v23,49152,v31
v_mfma_f32_16x16x32_bf16 a[36:39],v[228:231],v[196:199],a[36:39]
ds_read_b64_tr_b16 v[160:161],v16 offset:0
v_mfma_f32_16x16x32_bf16 a[40:43],v[228:231],v[200:203],a[40:43]
ds_read_b64_tr_b16 v[162:163],v16 offset:1024
v_mfma_f32_16x16x32_bf16 a[44:47],v[228:231],v[204:207],a[44:47]
ds_read_b64_tr_b16 v[164:165],v17 offset:0
v_mfma_f32_16x16x32_bf16 a[64:67],v[232:235],v[192:195],a[64:67]
ds_read_b64_tr_b16 v[166:167],v17 offset:1024
v_mfma_f32_16x16x32_bf16 a[68:71],v[232:235],v[196:199],a[68:71]
ds_read_b64_tr_b16 v[168:169],v18 offset:0
v_mfma_f32_16x16x32_bf16 a[72:75],v[232:235],v[200:203],a[72:75]
ds_read_b64_tr_b16 v[170:171],v18 offset:1024
v_mfma_f32_16x16x32_bf16 a[76:79],v[232:235],v[204:207],a[76:79]
ds_read_b64_tr_b16 v[172:173],v19 offset:0
v_mfma_f32_16x16x32_bf16 a[96:99],v[236:239],v[192:195],a[96:99]
ds_read_b64_tr_b16 v[174:175],v19 offset:1024
v_mfma_f32_16x16x32_bf16 a[100:103],v[236:239],v[196:199],a[100:103]
ds_read_b64_tr_b16 v[176:177],v20 offset:0
v_mfma_f32_16x16x32_bf16 a[104:107],v[236:239],v[200:203],a[104:107]
ds_read_b64_tr_b16 v[178:179],v20 offset:1024
v_mfma_f32_16x16x32_bf16 a[108:111],v[236:239],v[204:207],a[108:111]
ds_read_b64_tr_b16 v[180:181],v21 offset:0
v_mfma_f32_16x16x32_bf16 a[128:131],v[240:243],v[192:195],a[128:131]
ds_read_b64_tr_b16 v[182:183],v21 offset:1024
v_mfma_f32_16x16x32_bf16 a[132:135],v[240:243],v[196:199],a[132:135]
ds_read_b64_tr_b16 v[184:185],v22 offset:0
v_mfma_f32_16x16x32_bf16 a[136:139],v[240:243],v[200:203],a[136:139]
ds_read_b64_tr_b16 v[186:187],v22 offset:1024
v_mfma_f32_16x16x32_bf16 a[140:143],v[240:243],v[204:207],a[140:143]
ds_read_b64_tr_b16 v[188:189],v23 offset:0
v_mfma_f32_16x16x32_bf16 a[160:163],v[244:247],v[192:195],a[160:163]
ds_read_b64_tr_b16 v[190:191],v23 offset:1024
v_mfma_f32_16x16x32_bf16 a[164:167],v[244:247],v[196:199],a[164:167]
s_mov_b64 exec,s[64:65]
ds_write_b32 v11,v9
s_mov_b64 exec,-1
v_mfma_f32_16x16x32_bf16 a[168:171],v[244:247],v[200:203],a[168:171]
v_mfma_f32_16x16x32_bf16 a[172:175],v[244:247],v[204:207],a[172:175]
v_mfma_f32_16x16x32_bf16 a[192:195],v[248:251],v[192:195],a[192:195]
v_mfma_f32_16x16x32_bf16 a[196:199],v[248:251],v[196:199],a[196:199]
v_mfma_f32_16x16x32_bf16 a[200:203],v[248:251],v[200:203],a[200:203]
v_mfma_f32_16x16x32_bf16 a[204:207],v[248:251],v[204:207],a[204:207]
v_mfma_f32_16x16x32_bf16 a[224:227],v[252:255],v[192:195],a[224:227]
v_mfma_f32_16x16x32_bf16 a[228:231],v[252:255],v[196:199],a[228:231]
v_mfma_f32_16x16x32_bf16 a[232:235],v[252:255],v[200:203],a[232:235]
v_mfma_f32_16x16x32_bf16 a[236:239],v[252:255],v[204:207],a[236:239]
s_waitcnt vmcnt(0) lgkmcnt(0)
s_barrier
v_mfma_f32_16x16x32_bf16 a[0:3],v[160:163],v[128:131],a[0:3]
v_add_u32 v8,65536,v5
v_mfma_f32_16x16x32_bf16 a[4:7],v[160:163],v[132:135],a[4:7]
ds_read_b128 v[192:195],v8 offset:0
v_add_u32 v16,81920,v24
v_add_u32 v17,81920,v25
v_mfma_f32_16x16x32_bf16 a[8:11],v[160:163],v[136:139],a[8:11]
ds_read_b128 v[196:199],v8 offset:1024
v_add_u32 v18,81920,v26
v_add_u32 v19,81920,v27
v_mfma_f32_16x16x32_bf16 a[12:15],v[160:163],v[140:143],a[12:15]
ds_read_b128 v[200:203],v8 offset:2048
v_add_u32 v20,81920,v28
v_add_u32 v21,81920,v29
v_mfma_f32_16x16x32_bf16 a[32:35],v[164:167],v[128:131],a[32:35]
ds_read_b128 v[204:207],v8 offset:3072
v_add_u32 v22,81920,v30
v_add_u32 v23,81920,v31
v_mfma_f32_16x16x32_bf16 a[36:39],v[164:167],v[132:135],a[36:39]
ds_read_b64_tr_b16 v[224:225],v16 offset:0
v_mfma_f32_16x16x32_bf16 a[40:43],v[164:167],v[136:139],a[40:43]
ds_read_b64_tr_b16 v[226:227],v16 offset:1024
v_mfma_f32_16x16x32_bf16 a[44:47],v[164:167],v[140:143],a[44:47]
ds_read_b64_tr_b16 v[228:229],v17 offset:0
v_mfma_f32_16x16x32_bf16 a[64:67],v[168:171],v[128:131],a[64:67]
ds_read_b64_tr_b16 v[230:231],v17 offset:1024
v_mfma_f32_16x16x32_bf16 a[68:71],v[168:171],v[132:135],a[68:71]
ds_read_b64_tr_b16 v[232:233],v18 offset:0
v_mfma_f32_16x16x32_bf16 a[72:75],v[168:171],v[136:139],a[72:75]
ds_read_b64_tr_b16 v[234:235],v18 offset:1024
v_mfma_f32_16x16x32_bf16 a[76:79],v[168:171],v[140:143],a[76:79]
ds_read_b64_tr_b16 v[236:237],v19 offset:0
v_mfma_f32_16x16x32_bf16 a[96:99],v[172:175],v[128:131],a[96:99]
ds_read_b64_tr_b16 v[238:239],v19 offset:1024
v_mfma_f32_16x16x32_bf16 a[100:103],v[172:175],v[132:135],a[100:103]
ds_read_b64_tr_b16 v[240:241],v20 offset:0
v_mfma_f32_16x16x32_bf16 a[104:107],v[172:175],v[136:139],a[104:107]
ds_read_b64_tr_b16 v[242:243],v20 offset:1024
v_mfma_f32_16x16x32_bf16 a[108:111],v[172:175],v[140:143],a[108:111]
ds_read_b64_tr_b16 v[244:245],v21 offset:0
v_mfma_f32_16x16x32_bf16 a[128:131],v[176:179],v[128:131],a[128:131]
ds_read_b64_tr_b16 v[246:247],v21 offset:1024
v_mfma_f32_16x16x32_bf16 a[132:135],v[176:179],v[132:135],a[132:135]
ds_read_b64_tr_b16 v[248:249],v22 offset:0
v_mfma_f32_16x16x32_bf16 a[136:139],v[176:179],v[136:139],a[136:139]
ds_read_b64_tr_b16 v[250:251],v22 offset:1024
v_mfma_f32_16x16x32_bf16 a[140:143],v[176:179],v[140:143],a[140:143]
ds_read_b64_tr_b16 v[252:253],v23 offset:0
v_mfma_f32_16x16x32_bf16 a[160:163],v[180:183],v[128:131],a[160:163]
ds_read_b64_tr_b16 v[254:255],v23 offset:1024
v_mfma_f32_16x16x32_bf16 a[164:167],v[180:183],v[132:135],a[164:167]
ds_read_b32 v9,v11
v_mfma_f32_16x16x32_bf16 a[168:171],v[180:183],v[136:139],a[168:171]
v_mfma_f32_16x16x32_bf16 a[172:175],v[180:183],v[140:143],a[172:175]
v_mfma_f32_16x16x32_bf16 a[192:195],v[184:187],v[128:131],a[192:195]
v_mfma_f32_16x16x32_bf16 a[196:199],v[184:187],v[132:135],a[196:199]
v_mfma_f32_16x16x32_bf16 a[200:203],v[184:187],v[136:139],a[200:203]
v_mfma_f32_16x16x32_bf16 a[204:207],v[184:187],v[140:143],a[204:207]
v_mfma_f32_16x16x32_bf16 a[224:227],v[188:191],v[128:131],a[224:227]
v_mfma_f32_16x16x32_bf16 a[228:231],v[188:191],v[132:135],a[228:231]
v_mfma_f32_16x16x32_bf16 a[232:235],v[188:191],v[136:139],a[232:235]
v_mfma_f32_16x16x32_bf16 a[236:239],v[188:191],v[140:143],a[236:239]
s_waitcnt lgkmcnt(0)
v_mfma_f32_16x16x32_bf16 a[0:3],v[224:227],v[192:195],a[0:3]
v_mfma_f32_16x16x32_bf16 a[4:7],v[224:227],v[196:199],a[4:7]
v_mfma_f32_16x16x32_bf16 a[8:11],v[224:227],v[200:203],a[8:11]
v_mfma_f32_16x16x32_bf16 a[12:15],v[224:227],v[204:207],a[12:15]
v_mfma_f32_16x16x32_bf16 a[32:35],v[228:231],v[192:195],a[32:35]
v_mfma_f32_16x16x32_bf16 a[36:39],v[228:231],v[196:199],a[36:39]
v_mfma_f32_16x16x32_bf16 a[40:43],v[228:231],v[200:203],a[40:43]
v_mfma_f32_16x16x32_bf16 a[44:47],v[228:231],v[204:207],a[44:47]
v_mfma_f32_16x16x32_bf16 a[64:67],v[232:235],v[192:195],a[64:67]
v_mfma_f32_16x16x32_bf16 a[68:71],v[232:235],v[196:199],a[68:71]
v_mfma_f32_16x16x32_bf16 a[72:75],v[232:235],v[200:203],a[72:75]
v_mfma_f32_16x16x32_bf16 a[76:79],v[232:235],v[204:207],a[76:79]
v_mfma_f32_16x16x32_bf16 a[96:99],v[236:239],v[192:195],a[96:99]
v_mfma_f32_16x16x32_bf16 a[100:103],v[236:239],v[196:199],a[100:103]
v_mfma_f32_16x16x32_bf16 a[104:107],v[236:239],v[200:203],a[104:107]
v_mfma_f32_16x16x32_bf16 a[108:111],v[236:239],v[204:207],a[108:111]
v_mfma_f32_16x16x32_bf16 a[128:131],v[240:243],v[192:195],a[128:131]
v_mfma_f32_16x16x32_bf16 a[132:135],v[240:243],v[196:199],a[132:135]
v_mfma_f32_16x16x32_bf16 a[136:139],v[240:243],v[200:203],a[136:139]
v_mfma_f32_16x16x32_bf16 a[140:143],v[240:243],v[204:207],a[140:143]
v_mfma_f32_16x16x32_bf16 a[160:163],v[244:247],v[192:195],a[160:163]
v_mfma_f32_16x16x32_bf16 a[164:167],v[244:247],v[196:199],a[164:167]
v_mfma_f32_16x16x32_bf16 a[168:171],v[244:247],v[200:203],a[168:171]
v_mfma_f32_16x16x32_bf16 a[172:175],v[244:247],v[204:207],a[172:175]
v_mfma_f32_16x16x32_bf16 a[192:195],v[248:251],v[192:195],a[192:195]
v_mfma_f32_16x16x32_bf16 a[196:199],v[248:251],v[196:199],a[196:199]
v_mfma_f32_16x16x32_bf16 a[200:203],v[248:251],v[200:203],a[200:203]
v_mfma_f32_16x16x32_bf16 a[204:207],v[248:251],v[204:207],a[204:207]
v_mfma_f32_16x16x32_bf16 a[224:227],v[252:255],v[192:195],a[224:227]
v_mfma_f32_16x16x32_bf16 a[228:231],v[252:255],v[196:199],a[228:231]
v_mfma_f32_16x16x32_bf16 a[232:235],v[252:255],v[200:203],a[232:235]
v_mfma_f32_16x16x32_bf16 a[236:239],v[252:255],v[204:207],a[236:239]
s_nop 7
v_accvgpr_read_b32 v32,a0
v_accvgpr_read_b32 v33,a1
v_accvgpr_read_b32 v34,a2
v_accvgpr_read_b32 v35,a3
v_accvgpr_read_b32 v36,a32
v_accvgpr_read_b32 v37,a33
v_accvgpr_read_b32 v38,a34
v_accvgpr_read_b32 v39,a35
s_add_u32 s81,s83,0
v_cvt_pk_bf16_f32 v40,v32,v33
v_cvt_pk_bf16_f32 v41,v34,v35
v_cvt_pk_bf16_f32 v42,v36,v37
v_cvt_pk_bf16_f32 v43,v38,v39
buffer_store_dwordx4 v[40:43],v3,s[8:11],s81 offen offset:0 sc1
v_accvgpr_read_b32 v44,a64
v_accvgpr_read_b32 v45,a65
v_accvgpr_read_b32 v46,a66
v_accvgpr_read_b32 v47,a67
v_accvgpr_read_b32 v48,a96
v_accvgpr_read_b32 v49,a97
v_accvgpr_read_b32 v50,a98
v_accvgpr_read_b32 v51,a99
v_cvt_pk_bf16_f32 v52,v44,v45
v_cvt_pk_bf16_f32 v53,v46,v47
v_cvt_pk_bf16_f32 v54,v48,v49
v_cvt_pk_bf16_f32 v55,v50,v51
buffer_store_dwordx4 v[52:55],v3,s[8:11],s81 offen offset:2048 sc1
v_accvgpr_read_b32 v56,a128
v_accvgpr_read_b32 v57,a129
v_accvgpr_read_b32 v58,a130
v_accvgpr_read_b32 v59,a131
v_accvgpr_read_b32 v60,a160
v_accvgpr_read_b32 v61,a161
v_accvgpr_read_b32 v62,a162
v_accvgpr_read_b32 v63,a163
s_add_u32 s81,s83,4096
v_cvt_pk_bf16_f32 v64,v56,v57
v_cvt_pk_bf16_f32 v65,v58,v59
v_cvt_pk_bf16_f32 v66,v60,v61
v_cvt_pk_bf16_f32 v67,v62,v63
buffer_store_dwordx4 v[64:67],v3,s[8:11],s81 offen offset:0 sc1
v_accvgpr_read_b32 v68,a192
v_accvgpr_read_b32 v69,a193
v_accvgpr_read_b32 v70,a194
v_accvgpr_read_b32 v71,a195
v_accvgpr_read_b32 v72,a224
v_accvgpr_read_b32 v73,a225
v_accvgpr_read_b32 v74,a226
v_accvgpr_read_b32 v75,a227
v_cvt_pk_bf16_f32 v76,v68,v69
v_cvt_pk_bf16_f32 v77,v70,v71
v_cvt_pk_bf16_f32 v78,v72,v73
v_cvt_pk_bf16_f32 v79,v74,v75
buffer_store_dwordx4 v[76:79],v3,s[8:11],s81 offen offset:2048 sc1
v_accvgpr_read_b32 v32,a4
v_accvgpr_read_b32 v33,a5
v_accvgpr_read_b32 v34,a6
v_accvgpr_read_b32 v35,a7
v_accvgpr_read_b32 v36,a36
v_accvgpr_read_b32 v37,a37
v_accvgpr_read_b32 v38,a38
v_accvgpr_read_b32 v39,a39
s_add_u32 s81,s83,0
v_cvt_pk_bf16_f32 v40,v32,v33
v_cvt_pk_bf16_f32 v41,v34,v35
v_cvt_pk_bf16_f32 v42,v36,v37
v_cvt_pk_bf16_f32 v43,v38,v39
buffer_store_dwordx4 v[40:43],v3,s[8:11],s81 offen offset:1024 sc1
v_accvgpr_read_b32 v44,a68
v_accvgpr_read_b32 v45,a69
v_accvgpr_read_b32 v46,a70
v_accvgpr_read_b32 v47,a71
v_accvgpr_read_b32 v48,a100
v_accvgpr_read_b32 v49,a101
v_accvgpr_read_b32 v50,a102
v_accvgpr_read_b32 v51,a103
v_cvt_pk_bf16_f32 v52,v44,v45
v_cvt_pk_bf16_f32 v53,v46,v47
v_cvt_pk_bf16_f32 v54,v48,v49
v_cvt_pk_bf16_f32 v55,v50,v51
buffer_store_dwordx4 v[52:55],v3,s[8:11],s81 offen offset:3072 sc1
v_accvgpr_read_b32 v56,a132
v_accvgpr_read_b32 v57,a133
v_accvgpr_read_b32 v58,a134
v_accvgpr_read_b32 v59,a135
v_accvgpr_read_b32 v60,a164
v_accvgpr_read_b32 v61,a165
v_accvgpr_read_b32 v62,a166
v_accvgpr_read_b32 v63,a167
s_add_u32 s81,s83,4096
v_cvt_pk_bf16_f32 v64,v56,v57
v_cvt_pk_bf16_f32 v65,v58,v59
v_cvt_pk_bf16_f32 v66,v60,v61
v_cvt_pk_bf16_f32 v67,v62,v63
buffer_store_dwordx4 v[64:67],v3,s[8:11],s81 offen offset:1024 sc1
v_accvgpr_read_b32 v68,a196
v_accvgpr_read_b32 v69,a197
v_accvgpr_read_b32 v70,a198
v_accvgpr_read_b32 v71,a199
v_accvgpr_read_b32 v72,a228
v_accvgpr_read_b32 v73,a229
v_accvgpr_read_b32 v74,a230
v_accvgpr_read_b32 v75,a231
v_cvt_pk_bf16_f32 v76,v68,v69
v_cvt_pk_bf16_f32 v77,v70,v71
v_cvt_pk_bf16_f32 v78,v72,v73
v_cvt_pk_bf16_f32 v79,v74,v75
buffer_store_dwordx4 v[76:79],v3,s[8:11],s81 offen offset:3072 sc1
v_accvgpr_read_b32 v32,a8
v_accvgpr_read_b32 v33,a9
v_accvgpr_read_b32 v34,a10
v_accvgpr_read_b32 v35,a11
v_accvgpr_read_b32 v36,a40
v_accvgpr_read_b32 v37,a41
v_accvgpr_read_b32 v38,a42
v_accvgpr_read_b32 v39,a43
s_add_u32 s81,s83,262144
v_cvt_pk_bf16_f32 v40,v32,v33
v_cvt_pk_bf16_f32 v41,v34,v35
v_cvt_pk_bf16_f32 v42,v36,v37
v_cvt_pk_bf16_f32 v43,v38,v39
buffer_store_dwordx4 v[40:43],v3,s[8:11],s81 offen offset:0 sc1
v_accvgpr_read_b32 v44,a72
v_accvgpr_read_b32 v45,a73
v_accvgpr_read_b32 v46,a74
v_accvgpr_read_b32 v47,a75
v_accvgpr_read_b32 v48,a104
v_accvgpr_read_b32 v49,a105
v_accvgpr_read_b32 v50,a106
v_accvgpr_read_b32 v51,a107
v_cvt_pk_bf16_f32 v52,v44,v45
v_cvt_pk_bf16_f32 v53,v46,v47
v_cvt_pk_bf16_f32 v54,v48,v49
v_cvt_pk_bf16_f32 v55,v50,v51
buffer_store_dwordx4 v[52:55],v3,s[8:11],s81 offen offset:2048 sc1
v_accvgpr_read_b32 v56,a136
v_accvgpr_read_b32 v57,a137
v_accvgpr_read_b32 v58,a138
v_accvgpr_read_b32 v59,a139
v_accvgpr_read_b32 v60,a168
v_accvgpr_read_b32 v61,a169
v_accvgpr_read_b32 v62,a170
v_accvgpr_read_b32 v63,a171
s_add_u32 s81,s83,266240
v_cvt_pk_bf16_f32 v64,v56,v57
v_cvt_pk_bf16_f32 v65,v58,v59
v_cvt_pk_bf16_f32 v66,v60,v61
v_cvt_pk_bf16_f32 v67,v62,v63
buffer_store_dwordx4 v[64:67],v3,s[8:11],s81 offen offset:0 sc1
v_accvgpr_read_b32 v68,a200
v_accvgpr_read_b32 v69,a201
v_accvgpr_read_b32 v70,a202
v_accvgpr_read_b32 v71,a203
v_accvgpr_read_b32 v72,a232
v_accvgpr_read_b32 v73,a233
v_accvgpr_read_b32 v74,a234
v_accvgpr_read_b32 v75,a235
v_cvt_pk_bf16_f32 v76,v68,v69
v_cvt_pk_bf16_f32 v77,v70,v71
v_cvt_pk_bf16_f32 v78,v72,v73
v_cvt_pk_bf16_f32 v79,v74,v75
buffer_store_dwordx4 v[76:79],v3,s[8:11],s81 offen offset:2048 sc1
v_accvgpr_read_b32 v32,a12
v_accvgpr_read_b32 v33,a13
v_accvgpr_read_b32 v34,a14
v_accvgpr_read_b32 v35,a15
v_accvgpr_read_b32 v36,a44
v_accvgpr_read_b32 v37,a45
v_accvgpr_read_b32 v38,a46
v_accvgpr_read_b32 v39,a47
s_add_u32 s81,s83,262144
v_cvt_pk_bf16_f32 v40,v32,v33
v_cvt_pk_bf16_f32 v41,v34,v35
v_cvt_pk_bf16_f32 v42,v36,v37
v_cvt_pk_bf16_f32 v43,v38,v39
buffer_store_dwordx4 v[40:43],v3,s[8:11],s81 offen offset:1024 sc1
v_accvgpr_read_b32 v44,a76
v_accvgpr_read_b32 v45,a77
v_accvgpr_read_b32 v46,a78
v_accvgpr_read_b32 v47,a79
v_accvgpr_read_b32 v48,a108
v_accvgpr_read_b32 v49,a109
v_accvgpr_read_b32 v50,a110
v_accvgpr_read_b32 v51,a111
v_cvt_pk_bf16_f32 v52,v44,v45
v_cvt_pk_bf16_f32 v53,v46,v47
v_cvt_pk_bf16_f32 v54,v48,v49
v_cvt_pk_bf16_f32 v55,v50,v51
buffer_store_dwordx4 v[52:55],v3,s[8:11],s81 offen offset:3072 sc1
v_accvgpr_read_b32 v56,a140
v_accvgpr_read_b32 v57,a141
v_accvgpr_read_b32 v58,a142
v_accvgpr_read_b32 v59,a143
v_accvgpr_read_b32 v60,a172
v_accvgpr_read_b32 v61,a173
v_accvgpr_read_b32 v62,a174
v_accvgpr_read_b32 v63,a175
s_add_u32 s81,s83,266240
v_cvt_pk_bf16_f32 v64,v56,v57
v_cvt_pk_bf16_f32 v65,v58,v59
v_cvt_pk_bf16_f32 v66,v60,v61
v_cvt_pk_bf16_f32 v67,v62,v63
buffer_store_dwordx4 v[64:67],v3,s[8:11],s81 offen offset:1024 sc1
v_accvgpr_read_b32 v68,a204
v_accvgpr_read_b32 v69,a205
v_accvgpr_read_b32 v70,a206
v_accvgpr_read_b32 v71,a207
v_accvgpr_read_b32 v72,a236
v_accvgpr_read_b32 v73,a237
v_accvgpr_read_b32 v74,a238
v_accvgpr_read_b32 v75,a239
v_cvt_pk_bf16_f32 v76,v68,v69
v_cvt_pk_bf16_f32 v77,v70,v71
v_cvt_pk_bf16_f32 v78,v72,v73
v_cvt_pk_bf16_f32 v79,v74,v75
buffer_store_dwordx4 v[76:79],v3,s[8:11],s81 offen offset:3072 sc1
s_branch Lg1_xe
Lg1_xv:
s_waitcnt vmcnt(40)
s_barrier
v_add_u32 v8,0,v5
v_add_u32 v16,16384,v24
v_add_u32 v17,16384,v25
v_add_u32 v18,16384,v26
v_add_u32 v19,16384,v27
v_add_u32 v20,16384,v28
v_add_u32 v21,16384,v29
v_add_u32 v22,16384,v30
v_add_u32 v23,16384,v31
ds_read_b128 v[128:131],v8 offset:0
ds_read_b128 v[132:135],v8 offset:1024
ds_read_b128 v[136:139],v8 offset:2048
ds_read_b128 v[140:143],v8 offset:3072
ds_read_b64_tr_b16 v[160:161],v16 offset:0
ds_read_b64_tr_b16 v[162:163],v16 offset:1024
ds_read_b64_tr_b16 v[164:165],v17 offset:0
ds_read_b64_tr_b16 v[166:167],v17 offset:1024
ds_read_b64_tr_b16 v[168:169],v18 offset:0
ds_read_b64_tr_b16 v[170:171],v18 offset:1024
ds_read_b64_tr_b16 v[172:173],v19 offset:0
ds_read_b64_tr_b16 v[174:175],v19 offset:1024
ds_read_b64_tr_b16 v[176:177],v20 offset:0
ds_read_b64_tr_b16 v[178:179],v20 offset:1024
ds_read_b64_tr_b16 v[180:181],v21 offset:0
ds_read_b64_tr_b16 v[182:183],v21 offset:1024
ds_read_b64_tr_b16 v[184:185],v22 offset:0
ds_read_b64_tr_b16 v[186:187],v22 offset:1024
ds_read_b64_tr_b16 v[188:189],v23 offset:0
ds_read_b64_tr_b16 v[190:191],v23 offset:1024
s_waitcnt vmcnt(32) lgkmcnt(0)
s_barrier
v_mfma_f32_16x16x32_bf16 a[0:3],v[128:131],v[160:163],0
v_add_u32 v8,32768,v5
v_mfma_f32_16x16x32_bf16 a[4:7],v[132:135],v[160:163],0
ds_read_b128 v[192:195],v8 offset:0
v_add_u32 v16,49152,v24
v_add_u32 v17,49152,v25
v_mfma_f32_16x16x32_bf16 a[8:11],v[136:139],v[160:163],0
ds_read_b128 v[196:199],v8 offset:1024
v_add_u32 v18,49152,v26
v_add_u32 v19,49152,v27
v_mfma_f32_16x16x32_bf16 a[12:15],v[140:143],v[160:163],0
s_add_u32 m0,s80,131072
s_mov_b32 s81,s76
buffer_load_dwordx4 v4,s[56:59],s81 offen lds
v_mfma_f32_16x16x32_bf16 a[32:35],v[128:131],v[164:167],0
ds_read_b128 v[200:203],v8 offset:2048
v_add_u32 v20,49152,v28
v_add_u32 v21,49152,v29
v_mfma_f32_16x16x32_bf16 a[36:39],v[132:135],v[164:167],0
ds_read_b128 v[204:207],v8 offset:3072
v_add_u32 v22,49152,v30
v_add_u32 v23,49152,v31
v_mfma_f32_16x16x32_bf16 a[40:43],v[136:139],v[164:167],0
ds_read_b64_tr_b16 v[224:225],v16 offset:0
v_mfma_f32_16x16x32_bf16 a[44:47],v[140:143],v[164:167],0
s_add_u32 m0,s80,132096
s_add_u32 s81,s76,s68
buffer_load_dwordx4 v4,s[56:59],s81 offen lds
v_mfma_f32_16x16x32_bf16 a[64:67],v[128:131],v[168:171],0
ds_read_b64_tr_b16 v[226:227],v16 offset:1024
v_mfma_f32_16x16x32_bf16 a[68:71],v[132:135],v[168:171],0
ds_read_b64_tr_b16 v[228:229],v17 offset:0
v_mfma_f32_16x16x32_bf16 a[72:75],v[136:139],v[168:171],0
ds_read_b64_tr_b16 v[230:231],v17 offset:1024
v_mfma_f32_16x16x32_bf16 a[76:79],v[140:143],v[168:171],0
s_add_u32 m0,s80,135168
s_add_u32 s81,s76,s69
buffer_load_dwordx4 v4,s[56:59],s81 offen lds
v_mfma_f32_16x16x32_bf16 a[96:99],v[128:131],v[172:175],0
ds_read_b64_tr_b16 v[232:233],v18 offset:0
v_mfma_f32_16x16x32_bf16 a[100:103],v[132:135],v[172:175],0
ds_read_b64_tr_b16 v[234:235],v18 offset:1024
v_mfma_f32_16x16x32_bf16 a[104:107],v[136:139],v[172:175],0
ds_read_b64_tr_b16 v[236:237],v19 offset:0
v_mfma_f32_16x16x32_bf16 a[108:111],v[140:143],v[172:175],0
s_add_u32 m0,s80,136192
s_add_u32 s81,s81,s68
buffer_load_dwordx4 v4,s[56:59],s81 offen lds
s_add_u32 s76,s76,s70
v_mfma_f32_16x16x32_bf16 a[128:131],v[128:131],v[176:179],0
ds_read_b64_tr_b16 v[238:239],v19 offset:1024
v_mfma_f32_16x16x32_bf16 a[132:135],v[132:135],v[176:179],0
ds_read_b64_tr_b16 v[240:241],v20 offset:0
v_mfma_f32_16x16x32_bf16 a[136:139],v[136:139],v[176:179],0
ds_read_b64_tr_b16 v[242:243],v20 offset:1024
v_mfma_f32_16x16x32_bf16 a[140:143],v[140:143],v[176:179],0
s_add_u32 m0,s79,131072
s_add_u32 s81,s75,4096
buffer_load_dwordx4 v3,s[8:11],s81 offen sc1 lds
v_mfma_f32_16x16x32_bf16 a[160:163],v[128:131],v[180:183],0
ds_read_b64_tr_b16 v[244:245],v21 offset:0
v_mfma_f32_16x16x32_bf16 a[164:167],v[132:135],v[180:183],0
ds_read_b64_tr_b16 v[246:247],v21 offset:1024
v_mfma_f32_16x16x32_bf16 a[168:171],v[136:139],v[180:183],0
ds_read_b64_tr_b16 v[248:249],v22 offset:0
v_mfma_f32_16x16x32_bf16 a[172:175],v[140:143],v[180:183],0
s_add_u32 m0,s79,132096
s_add_u32 s81,s75,22528
buffer_load_dwordx4 v3,s[8:11],s81 offen sc1 lds
v_mfma_f32_16x16x32_bf16 a[192:195],v[128:131],v[184:187],0
ds_read_b64_tr_b16 v[250:251],v22 offset:1024
v_mfma_f32_16x16x32_bf16 a[196:199],v[132:135],v[184:187],0
ds_read_b64_tr_b16 v[252:253],v23 offset:0
v_mfma_f32_16x16x32_bf16 a[200:203],v[136:139],v[184:187],0
ds_read_b64_tr_b16 v[254:255],v23 offset:1024
v_mfma_f32_16x16x32_bf16 a[204:207],v[140:143],v[184:187],0
s_add_u32 m0,s79,133120
s_add_u32 s81,s75,40960
buffer_load_dwordx4 v3,s[8:11],s81 offen sc1 lds
v_mfma_f32_16x16x32_bf16 a[224:227],v[128:131],v[188:191],0
v_mfma_f32_16x16x32_bf16 a[228:231],v[132:135],v[188:191],0
v_mfma_f32_16x16x32_bf16 a[232:235],v[136:139],v[188:191],0
v_mfma_f32_16x16x32_bf16 a[236:239],v[140:143],v[188:191],0
s_add_u32 m0,s79,134144
s_add_u32 s81,s75,59392
buffer_load_dwordx4 v3,s[8:11],s81 offen sc1 lds
s_waitcnt vmcnt(32) lgkmcnt(0)
s_barrier
v_mfma_f32_16x16x32_bf16 a[0:3],v[192:195],v[224:227],a[0:3]
v_add_u32 v8,65536,v5
v_mfma_f32_16x16x32_bf16 a[4:7],v[196:199],v[224:227],a[4:7]
ds_read_b128 v[128:131],v8 offset:0
v_add_u32 v16,81920,v24
v_add_u32 v17,81920,v25
v_mfma_f32_16x16x32_bf16 a[8:11],v[200:203],v[224:227],a[8:11]
ds_read_b128 v[132:135],v8 offset:1024
v_add_u32 v18,81920,v26
v_add_u32 v19,81920,v27
v_mfma_f32_16x16x32_bf16 a[12:15],v[204:207],v[224:227],a[12:15]
s_add_u32 m0,s80,0
s_mov_b32 s81,s76
buffer_load_dwordx4 v4,s[56:59],s81 offen lds
v_mfma_f32_16x16x32_bf16 a[32:35],v[192:195],v[228:231],a[32:35]
ds_read_b128 v[136:139],v8 offset:2048
v_add_u32 v20,81920,v28
v_add_u32 v21,81920,v29
v_mfma_f32_16x16x32_bf16 a[36:39],v[196:199],v[228:231],a[36:39]
ds_read_b128 v[140:143],v8 offset:3072
v_add_u32 v22,81920,v30
v_add_u32 v23,81920,v31
v_mfma_f32_16x16x32_bf16 a[40:43],v[200:203],v[228:231],a[40:43]
ds_read_b64_tr_b16 v[160:161],v16 offset:0
v_mfma_f32_16x16x32_bf16 a[44:47],v[204:207],v[228:231],a[44:47]
s_add_u32 m0,s80,1024
s_add_u32 s81,s76,s68
buffer_load_dwordx4 v4,s[56:59],s81 offen lds
v_mfma_f32_16x16x32_bf16 a[64:67],v[192:195],v[232:235],a[64:67]
ds_read_b64_tr_b16 v[162:163],v16 offset:1024
v_mfma_f32_16x16x32_bf16 a[68:71],v[196:199],v[232:235],a[68:71]
ds_read_b64_tr_b16 v[164:165],v17 offset:0
v_mfma_f32_16x16x32_bf16 a[72:75],v[200:203],v[232:235],a[72:75]
ds_read_b64_tr_b16 v[166:167],v17 offset:1024
v_mfma_f32_16x16x32_bf16 a[76:79],v[204:207],v[232:235],a[76:79]
s_add_u32 m0,s80,4096
s_add_u32 s81,s76,s69
buffer_load_dwordx4 v4,s[56:59],s81 offen lds
v_mfma_f32_16x16x32_bf16 a[96:99],v[192:195],v[236:239],a[96:99]
ds_read_b64_tr_b16 v[168:169],v18 offset:0
v_mfma_f32_16x16x32_bf16 a[100:103],v[196:199],v[236:239],a[100:103]
ds_read_b64_tr_b16 v[170:171],v18 offset:1024
v_mfma_f32_16x16x32_bf16 a[104:107],v[200:203],v[236:239],a[104:107]
ds_read_b64_tr_b16 v[172:173],v19 offset:0
v_mfma_f32_16x16x32_bf16 a[108:111],v[204:207],v[236:239],a[108:111]
s_add_u32 m0,s80,5120
s_add_u32 s81,s81,s68
buffer_load_dwordx4 v4,s[56:59],s81 offen lds
s_add_u32 s76,s76,s70
v_mfma_f32_16x16x32_bf16 a[128:131],v[192:195],v[240:243],a[128:131]
ds_read_b64_tr_b16 v[174:175],v19 offset:1024
v_mfma_f32_16x16x32_bf16 a[132:135],v[196:199],v[240:243],a[132:135]
ds_read_b64_tr_b16 v[176:177],v20 offset:0
v_mfma_f32_16x16x32_bf16 a[136:139],v[200:203],v[240:243],a[136:139]
ds_read_b64_tr_b16 v[178:179],v20 offset:1024
v_mfma_f32_16x16x32_bf16 a[140:143],v[204:207],v[240:243],a[140:143]
s_add_u32 m0,s79,0
s_add_u32 s81,s75,5120
buffer_load_dwordx4 v3,s[8:11],s81 offen sc1 lds
v_mfma_f32_16x16x32_bf16 a[160:163],v[192:195],v[244:247],a[160:163]
ds_read_b64_tr_b16 v[180:181],v21 offset:0
v_mfma_f32_16x16x32_bf16 a[164:167],v[196:199],v[244:247],a[164:167]
ds_read_b64_tr_b16 v[182:183],v21 offset:1024
v_mfma_f32_16x16x32_bf16 a[168:171],v[200:203],v[244:247],a[168:171]
ds_read_b64_tr_b16 v[184:185],v22 offset:0
v_mfma_f32_16x16x32_bf16 a[172:175],v[204:207],v[244:247],a[172:175]
s_add_u32 m0,s79,1024
s_add_u32 s81,s75,23552
buffer_load_dwordx4 v3,s[8:11],s81 offen sc1 lds
v_mfma_f32_16x16x32_bf16 a[192:195],v[192:195],v[248:251],a[192:195]
ds_read_b64_tr_b16 v[186:187],v22 offset:1024
v_mfma_f32_16x16x32_bf16 a[196:199],v[196:199],v[248:251],a[196:199]
ds_read_b64_tr_b16 v[188:189],v23 offset:0
v_mfma_f32_16x16x32_bf16 a[200:203],v[200:203],v[248:251],a[200:203]
ds_read_b64_tr_b16 v[190:191],v23 offset:1024
v_mfma_f32_16x16x32_bf16 a[204:207],v[204:207],v[248:251],a[204:207]
s_add_u32 m0,s79,2048
s_add_u32 s81,s75,41984
buffer_load_dwordx4 v3,s[8:11],s81 offen sc1 lds
v_mfma_f32_16x16x32_bf16 a[224:227],v[192:195],v[252:255],a[224:227]
v_mfma_f32_16x16x32_bf16 a[228:231],v[196:199],v[252:255],a[228:231]
v_mfma_f32_16x16x32_bf16 a[232:235],v[200:203],v[252:255],a[232:235]
v_mfma_f32_16x16x32_bf16 a[236:239],v[204:207],v[252:255],a[236:239]
s_add_u32 m0,s79,3072
s_add_u32 s81,s75,60416
buffer_load_dwordx4 v3,s[8:11],s81 offen sc1 lds
s_waitcnt vmcnt(32) lgkmcnt(0)
s_barrier
v_mfma_f32_16x16x32_bf16 a[0:3],v[128:131],v[160:163],a[0:3]
v_add_u32 v8,98304,v5
v_mfma_f32_16x16x32_bf16 a[4:7],v[132:135],v[160:163],a[4:7]
ds_read_b128 v[192:195],v8 offset:0
v_add_u32 v16,114688,v24
v_add_u32 v17,114688,v25
v_mfma_f32_16x16x32_bf16 a[8:11],v[136:139],v[160:163],a[8:11]
ds_read_b128 v[196:199],v8 offset:1024
v_add_u32 v18,114688,v26
v_add_u32 v19,114688,v27
v_mfma_f32_16x16x32_bf16 a[12:15],v[140:143],v[160:163],a[12:15]
s_add_u32 m0,s80,32768
s_mov_b32 s81,s76
buffer_load_dwordx4 v4,s[56:59],s81 offen lds
v_mfma_f32_16x16x32_bf16 a[32:35],v[128:131],v[164:167],a[32:35]
ds_read_b128 v[200:203],v8 offset:2048
v_add_u32 v20,114688,v28
v_add_u32 v21,114688,v29
v_mfma_f32_16x16x32_bf16 a[36:39],v[132:135],v[164:167],a[36:39]
ds_read_b128 v[204:207],v8 offset:3072
v_add_u32 v22,114688,v30
v_add_u32 v23,114688,v31
v_mfma_f32_16x16x32_bf16 a[40:43],v[136:139],v[164:167],a[40:43]
ds_read_b64_tr_b16 v[224:225],v16 offset:0
v_mfma_f32_16x16x32_bf16 a[44:47],v[140:143],v[164:167],a[44:47]
s_add_u32 m0,s80,33792
s_add_u32 s81,s76,s68
buffer_load_dwordx4 v4,s[56:59],s81 offen lds
v_mfma_f32_16x16x32_bf16 a[64:67],v[128:131],v[168:171],a[64:67]
ds_read_b64_tr_b16 v[226:227],v16 offset:1024
v_mfma_f32_16x16x32_bf16 a[68:71],v[132:135],v[168:171],a[68:71]
ds_read_b64_tr_b16 v[228:229],v17 offset:0
v_mfma_f32_16x16x32_bf16 a[72:75],v[136:139],v[168:171],a[72:75]
ds_read_b64_tr_b16 v[230:231],v17 offset:1024
v_mfma_f32_16x16x32_bf16 a[76:79],v[140:143],v[168:171],a[76:79]
s_add_u32 m0,s80,36864
s_add_u32 s81,s76,s69
buffer_load_dwordx4 v4,s[56:59],s81 offen lds
v_mfma_f32_16x16x32_bf16 a[96:99],v[128:131],v[172:175],a[96:99]
ds_read_b64_tr_b16 v[232:233],v18 offset:0
v_mfma_f32_16x16x32_bf16 a[100:103],v[132:135],v[172:175],a[100:103]
ds_read_b64_tr_b16 v[234:235],v18 offset:1024
v_mfma_f32_16x16x32_bf16 a[104:107],v[136:139],v[172:175],a[104:107]
ds_read_b64_tr_b16 v[236:237],v19 offset:0
v_mfma_f32_16x16x32_bf16 a[108:111],v[140:143],v[172:175],a[108:111]
s_add_u32 m0,s80,37888
s_add_u32 s81,s81,s68
buffer_load_dwordx4 v4,s[56:59],s81 offen lds
s_add_u32 s76,s76,s70
v_mfma_f32_16x16x32_bf16 a[128:131],v[128:131],v[176:179],a[128:131]
ds_read_b64_tr_b16 v[238:239],v19 offset:1024
v_mfma_f32_16x16x32_bf16 a[132:135],v[132:135],v[176:179],a[132:135]
ds_read_b64_tr_b16 v[240:241],v20 offset:0
v_mfma_f32_16x16x32_bf16 a[136:139],v[136:139],v[176:179],a[136:139]
ds_read_b64_tr_b16 v[242:243],v20 offset:1024
v_mfma_f32_16x16x32_bf16 a[140:143],v[140:143],v[176:179],a[140:143]
s_add_u32 m0,s79,32768
s_add_u32 s81,s75,6144
buffer_load_dwordx4 v3,s[8:11],s81 offen sc1 lds
v_mfma_f32_16x16x32_bf16 a[160:163],v[128:131],v[180:183],a[160:163]
ds_read_b64_tr_b16 v[244:245],v21 offset:0
v_mfma_f32_16x16x32_bf16 a[164:167],v[132:135],v[180:183],a[164:167]
ds_read_b64_tr_b16 v[246:247],v21 offset:1024
v_mfma_f32_16x16x32_bf16 a[168:171],v[136:139],v[180:183],a[168:171]
ds_read_b64_tr_b16 v[248:249],v22 offset:0
v_mfma_f32_16x16x32_bf16 a[172:175],v[140:143],v[180:183],a[172:175]
s_add_u32 m0,s79,33792
s_add_u32 s81,s75,24576
buffer_load_dwordx4 v3,s[8:11],s81 offen sc1 lds
v_mfma_f32_16x16x32_bf16 a[192:195],v[128:131],v[184:187],a[192:195]
ds_read_b64_tr_b16 v[250:251],v22 offset:1024
v_mfma_f32_16x16x32_bf16 a[196:199],v[132:135],v[184:187],a[196:199]
ds_read_b64_tr_b16 v[252:253],v23 offset:0
v_mfma_f32_16x16x32_bf16 a[200:203],v[136:139],v[184:187],a[200:203]
ds_read_b64_tr_b16 v[254:255],v23 offset:1024
v_mfma_f32_16x16x32_bf16 a[204:207],v[140:143],v[184:187],a[204:207]
s_add_u32 m0,s79,34816
s_add_u32 s81,s75,43008
buffer_load_dwordx4 v3,s[8:11],s81 offen sc1 lds
v_mfma_f32_16x16x32_bf16 a[224:227],v[128:131],v[188:191],a[224:227]
v_mfma_f32_16x16x32_bf16 a[228:231],v[132:135],v[188:191],a[228:231]
v_mfma_f32_16x16x32_bf16 a[232:235],v[136:139],v[188:191],a[232:235]
v_mfma_f32_16x16x32_bf16 a[236:239],v[140:143],v[188:191],a[236:239]
s_add_u32 m0,s79,35840
s_add_u32 s81,s75,61440
buffer_load_dwordx4 v3,s[8:11],s81 offen sc1 lds
s_waitcnt vmcnt(16) lgkmcnt(0)
s_barrier
v_mfma_f32_16x16x32_bf16 a[0:3],v[192:195],v[224:227],a[0:3]
v_add_u32 v8,131072,v5
v_mfma_f32_16x16x32_bf16 a[4:7],v[196:199],v[224:227],a[4:7]
ds_read_b128 v[128:131],v8 offset:0
v_add_u32 v16,147456,v24
v_add_u32 v17,147456,v25
v_mfma_f32_16x16x32_bf16 a[8:11],v[200:203],v[224:227],a[8:11]
ds_read_b128 v[132:135],v8 offset:1024
v_add_u32 v18,147456,v26
v_add_u32 v19,147456,v27
v_mfma_f32_16x16x32_bf16 a[12:15],v[204:207],v[224:227],a[12:15]
s_add_u32 m0,s80,65536
s_mov_b32 s81,s76
buffer_load_dwordx4 v4,s[56:59],s81 offen lds
v_mfma_f32_16x16x32_bf16 a[32:35],v[192:195],v[228:231],a[32:35]
ds_read_b128 v[136:139],v8 offset:2048
v_add_u32 v20,147456,v28
v_add_u32 v21,147456,v29
v_mfma_f32_16x16x32_bf16 a[36:39],v[196:199],v[228:231],a[36:39]
ds_read_b128 v[140:143],v8 offset:3072
v_add_u32 v22,147456,v30
v_add_u32 v23,147456,v31
v_mfma_f32_16x16x32_bf16 a[40:43],v[200:203],v[228:231],a[40:43]
ds_read_b64_tr_b16 v[160:161],v16 offset:0
v_mfma_f32_16x16x32_bf16 a[44:47],v[204:207],v[228:231],a[44:47]
s_add_u32 m0,s80,66560
s_add_u32 s81,s76,s68
buffer_load_dwordx4 v4,s[56:59],s81 offen lds
v_mfma_f32_16x16x32_bf16 a[64:67],v[192:195],v[232:235],a[64:67]
ds_read_b64_tr_b16 v[162:163],v16 offset:1024
v_mfma_f32_16x16x32_bf16 a[68:71],v[196:199],v[232:235],a[68:71]
ds_read_b64_tr_b16 v[164:165],v17 offset:0
v_mfma_f32_16x16x32_bf16 a[72:75],v[200:203],v[232:235],a[72:75]
ds_read_b64_tr_b16 v[166:167],v17 offset:1024
v_mfma_f32_16x16x32_bf16 a[76:79],v[204:207],v[232:235],a[76:79]
s_add_u32 m0,s80,69632
s_add_u32 s81,s76,s69
buffer_load_dwordx4 v4,s[56:59],s81 offen lds
v_mfma_f32_16x16x32_bf16 a[96:99],v[192:195],v[236:239],a[96:99]
ds_read_b64_tr_b16 v[168:169],v18 offset:0
v_mfma_f32_16x16x32_bf16 a[100:103],v[196:199],v[236:239],a[100:103]
ds_read_b64_tr_b16 v[170:171],v18 offset:1024
v_mfma_f32_16x16x32_bf16 a[104:107],v[200:203],v[236:239],a[104:107]
ds_read_b64_tr_b16 v[172:173],v19 offset:0
v_mfma_f32_16x16x32_bf16 a[108:111],v[204:207],v[236:239],a[108:111]
s_add_u32 m0,s80,70656
s_add_u32 s81,s81,s68
buffer_load_dwordx4 v4,s[56:59],s81 offen lds
s_add_u32 s76,s76,s70
v_mfma_f32_16x16x32_bf16 a[128:131],v[192:195],v[240:243],a[128:131]
ds_read_b64_tr_b16 v[174:175],v19 offset:1024
v_mfma_f32_16x16x32_bf16 a[132:135],v[196:199],v[240:243],a[132:135]
ds_read_b64_tr_b16 v[176:177],v20 offset:0
v_mfma_f32_16x16x32_bf16 a[136:139],v[200:203],v[240:243],a[136:139]
ds_read_b64_tr_b16 v[178:179],v20 offset:1024
v_mfma_f32_16x16x32_bf16 a[140:143],v[204:207],v[240:243],a[140:143]
s_add_u32 m0,s79,65536
s_add_u32 s81,s75,7168
buffer_load_dwordx4 v3,s[8:11],s81 offen sc1 lds
v_mfma_f32_16x16x32_bf16 a[160:163],v[192:195],v[244:247],a[160:163]
ds_read_b64_tr_b16 v[180:181],v21 offset:0
v_mfma_f32_16x16x32_bf16 a[164:167],v[196:199],v[244:247],a[164:167]
ds_read_b64_tr_b16 v[182:183],v21 offset:1024
v_mfma_f32_16x16x32_bf16 a[168:171],v[200:203],v[244:247],a[168:171]
ds_read_b64_tr_b16 v[184:185],v22 offset:0
v_mfma_f32_16x16x32_bf16 a[172:175],v[204:207],v[244:247],a[172:175]
s_add_u32 m0,s79,66560
s_add_u32 s81,s75,25600
buffer_load_dwordx4 v3,s[8:11],s81 offen sc1 lds
v_mfma_f32_16x16x32_bf16 a[192:195],v[192:195],v[248:251],a[192:195]
ds_read_b64_tr_b16 v[186:187],v22 offset:1024
v_mfma_f32_16x16x32_bf16 a[196:199],v[196:199],v[248:251],a[196:199]
ds_read_b64_tr_b16 v[188:189],v23 offset:0
v_mfma_f32_16x16x32_bf16 a[200:203],v[200:203],v[248:251],a[200:203]
ds_read_b64_tr_b16 v[190:191],v23 offset:1024
v_mfma_f32_16x16x32_bf16 a[204:207],v[204:207],v[248:251],a[204:207]
s_add_u32 m0,s79,67584
s_add_u32 s81,s75,44032
buffer_load_dwordx4 v3,s[8:11],s81 offen sc1 lds
v_mfma_f32_16x16x32_bf16 a[224:227],v[192:195],v[252:255],a[224:227]
v_mfma_f32_16x16x32_bf16 a[228:231],v[196:199],v[252:255],a[228:231]
v_mfma_f32_16x16x32_bf16 a[232:235],v[200:203],v[252:255],a[232:235]
v_mfma_f32_16x16x32_bf16 a[236:239],v[204:207],v[252:255],a[236:239]
s_add_u32 m0,s79,68608
s_add_u32 s81,s75,62464
buffer_load_dwordx4 v3,s[8:11],s81 offen sc1 lds
s_waitcnt vmcnt(16) lgkmcnt(0)
s_barrier
v_mfma_f32_16x16x32_bf16 a[0:3],v[128:131],v[160:163],a[0:3]
v_add_u32 v8,0,v5
v_mfma_f32_16x16x32_bf16 a[4:7],v[132:135],v[160:163],a[4:7]
ds_read_b128 v[192:195],v8 offset:0
v_add_u32 v16,16384,v24
v_add_u32 v17,16384,v25
v_mfma_f32_16x16x32_bf16 a[8:11],v[136:139],v[160:163],a[8:11]
ds_read_b128 v[196:199],v8 offset:1024
v_add_u32 v18,16384,v26
v_add_u32 v19,16384,v27
v_mfma_f32_16x16x32_bf16 a[12:15],v[140:143],v[160:163],a[12:15]
s_add_u32 m0,s80,98304
s_mov_b32 s81,s76
buffer_load_dwordx4 v4,s[56:59],s81 offen lds
v_mfma_f32_16x16x32_bf16 a[32:35],v[128:131],v[164:167],a[32:35]
ds_read_b128 v[200:203],v8 offset:2048
v_add_u32 v20,16384,v28
v_add_u32 v21,16384,v29
v_mfma_f32_16x16x32_bf16 a[36:39],v[132:135],v[164:167],a[36:39]
ds_read_b128 v[204:207],v8 offset:3072
v_add_u32 v22,16384,v30
v_add_u32 v23,16384,v31
v_mfma_f32_16x16x32_bf16 a[40:43],v[136:139],v[164:167],a[40:43]
ds_read_b64_tr_b16 v[224:225],v16 offset:0
v_mfma_f32_16x16x32_bf16 a[44:47],v[140:143],v[164:167],a[44:47]
s_add_u32 m0,s80,99328
s_add_u32 s81,s76,s68
buffer_load_dwordx4 v4,s[56:59],s81 offen lds
v_mfma_f32_16x16x32_bf16 a[64:67],v[128:131],v[168:171],a[64:67]
ds_read_b64_tr_b16 v[226:227],v16 offset:1024
v_mfma_f32_16x16x32_bf16 a[68:71],v[132:135],v[168:171],a[68:71]
ds_read_b64_tr_b16 v[228:229],v17 offset:0
v_mfma_f32_16x16x32_bf16 a[72:75],v[136:139],v[168:171],a[72:75]
ds_read_b64_tr_b16 v[230:231],v17 offset:1024
v_mfma_f32_16x16x32_bf16 a[76:79],v[140:143],v[168:171],a[76:79]
s_add_u32 m0,s80,102400
s_add_u32 s81,s76,s69
buffer_load_dwordx4 v4,s[56:59],s81 offen lds
v_mfma_f32_16x16x32_bf16 a[96:99],v[128:131],v[172:175],a[96:99]
ds_read_b64_tr_b16 v[232:233],v18 offset:0
v_mfma_f32_16x16x32_bf16 a[100:103],v[132:135],v[172:175],a[100:103]
ds_read_b64_tr_b16 v[234:235],v18 offset:1024
v_mfma_f32_16x16x32_bf16 a[104:107],v[136:139],v[172:175],a[104:107]
ds_read_b64_tr_b16 v[236:237],v19 offset:0
v_mfma_f32_16x16x32_bf16 a[108:111],v[140:143],v[172:175],a[108:111]
s_add_u32 m0,s80,103424
s_add_u32 s81,s81,s68
buffer_load_dwordx4 v4,s[56:59],s81 offen lds
s_add_u32 s76,s76,s70
v_mfma_f32_16x16x32_bf16 a[128:131],v[128:131],v[176:179],a[128:131]
ds_read_b64_tr_b16 v[238:239],v19 offset:1024
v_mfma_f32_16x16x32_bf16 a[132:135],v[132:135],v[176:179],a[132:135]
ds_read_b64_tr_b16 v[240:241],v20 offset:0
v_mfma_f32_16x16x32_bf16 a[136:139],v[136:139],v[176:179],a[136:139]
ds_read_b64_tr_b16 v[242:243],v20 offset:1024
v_mfma_f32_16x16x32_bf16 a[140:143],v[140:143],v[176:179],a[140:143]
s_add_u32 m0,s79,98304
s_add_u32 s81,s75,8192
buffer_load_dwordx4 v3,s[8:11],s81 offen sc1 lds
v_mfma_f32_16x16x32_bf16 a[160:163],v[128:131],v[180:183],a[160:163]
ds_read_b64_tr_b16 v[244:245],v21 offset:0
v_mfma_f32_16x16x32_bf16 a[164:167],v[132:135],v[180:183],a[164:167]
ds_read_b64_tr_b16 v[246:247],v21 offset:1024
v_mfma_f32_16x16x32_bf16 a[168:171],v[136:139],v[180:183],a[168:171]
ds_read_b64_tr_b16 v[248:249],v22 offset:0
v_mfma_f32_16x16x32_bf16 a[172:175],v[140:143],v[180:183],a[172:175]
s_add_u32 m0,s79,99328
s_add_u32 s81,s75,26624
buffer_load_dwordx4 v3,s[8:11],s81 offen sc1 lds
v_mfma_f32_16x16x32_bf16 a[192:195],v[128:131],v[184:187],a[192:195]
ds_read_b64_tr_b16 v[250:251],v22 offset:1024
v_mfma_f32_16x16x32_bf16 a[196:199],v[132:135],v[184:187],a[196:199]
ds_read_b64_tr_b16 v[252:253],v23 offset:0
v_mfma_f32_16x16x32_bf16 a[200:203],v[136:139],v[184:187],a[200:203]
ds_read_b64_tr_b16 v[254:255],v23 offset:1024
v_mfma_f32_16x16x32_bf16 a[204:207],v[140:143],v[184:187],a[204:207]
s_add_u32 m0,s79,100352
s_add_u32 s81,s75,45056
buffer_load_dwordx4 v3,s[8:11],s81 offen sc1 lds
v_mfma_f32_16x16x32_bf16 a[224:227],v[128:131],v[188:191],a[224:227]
v_mfma_f32_16x16x32_bf16 a[228:231],v[132:135],v[188:191],a[228:231]
v_mfma_f32_16x16x32_bf16 a[232:235],v[136:139],v[188:191],a[232:235]
v_mfma_f32_16x16x32_bf16 a[236:239],v[140:143],v[188:191],a[236:239]
s_add_u32 m0,s79,101376
s_add_u32 s81,s75,63488
buffer_load_dwordx4 v3,s[8:11],s81 offen sc1 lds
s_waitcnt vmcnt(16) lgkmcnt(0)
s_barrier
v_mfma_f32_16x16x32_bf16 a[0:3],v[192:195],v[224:227],a[0:3]
v_add_u32 v8,32768,v5
v_mfma_f32_16x16x32_bf16 a[4:7],v[196:199],v[224:227],a[4:7]
ds_read_b128 v[128:131],v8 offset:0
v_add_u32 v16,49152,v24
v_add_u32 v17,49152,v25
v_mfma_f32_16x16x32_bf16 a[8:11],v[200:203],v[224:227],a[8:11]
ds_read_b128 v[132:135],v8 offset:1024
v_add_u32 v18,49152,v26
v_add_u32 v19,49152,v27
v_mfma_f32_16x16x32_bf16 a[12:15],v[204:207],v[224:227],a[12:15]
s_add_u32 m0,s80,131072
s_mov_b32 s81,s76
buffer_load_dwordx4 v4,s[56:59],s81 offen lds
v_mfma_f32_16x16x32_bf16 a[32:35],v[192:195],v[228:231],a[32:35]
ds_read_b128 v[136:139],v8 offset:2048
v_add_u32 v20,49152,v28
v_add_u32 v21,49152,v29
v_mfma_f32_16x16x32_bf16 a[36:39],v[196:199],v[228:231],a[36:39]
ds_read_b128 v[140:143],v8 offset:3072
v_add_u32 v22,49152,v30
v_add_u32 v23,49152,v31
v_mfma_f32_16x16x32_bf16 a[40:43],v[200:203],v[228:231],a[40:43]
ds_read_b64_tr_b16 v[160:161],v16 offset:0
v_mfma_f32_16x16x32_bf16 a[44:47],v[204:207],v[228:231],a[44:47]
s_add_u32 m0,s80,132096
s_add_u32 s81,s76,s68
buffer_load_dwordx4 v4,s[56:59],s81 offen lds
v_mfma_f32_16x16x32_bf16 a[64:67],v[192:195],v[232:235],a[64:67]
ds_read_b64_tr_b16 v[162:163],v16 offset:1024
v_mfma_f32_16x16x32_bf16 a[68:71],v[196:199],v[232:235],a[68:71]
ds_read_b64_tr_b16 v[164:165],v17 offset:0
v_mfma_f32_16x16x32_bf16 a[72:75],v[200:203],v[232:235],a[72:75]
ds_read_b64_tr_b16 v[166:167],v17 offset:1024
v_mfma_f32_16x16x32_bf16 a[76:79],v[204:207],v[232:235],a[76:79]
s_add_u32 m0,s80,135168
s_add_u32 s81,s76,s69
buffer_load_dwordx4 v4,s[56:59],s81 offen lds
v_mfma_f32_16x16x32_bf16 a[96:99],v[192:195],v[236:239],a[96:99]
ds_read_b64_tr_b16 v[168:169],v18 offset:0
v_mfma_f32_16x16x32_bf16 a[100:103],v[196:199],v[236:239],a[100:103]
ds_read_b64_tr_b16 v[170:171],v18 offset:1024
v_mfma_f32_16x16x32_bf16 a[104:107],v[200:203],v[236:239],a[104:107]
ds_read_b64_tr_b16 v[172:173],v19 offset:0
v_mfma_f32_16x16x32_bf16 a[108:111],v[204:207],v[236:239],a[108:111]
s_add_u32 m0,s80,136192
s_add_u32 s81,s81,s68
buffer_load_dwordx4 v4,s[56:59],s81 offen lds
s_add_u32 s76,s76,s70
v_mfma_f32_16x16x32_bf16 a[128:131],v[192:195],v[240:243],a[128:131]
ds_read_b64_tr_b16 v[174:175],v19 offset:1024
v_mfma_f32_16x16x32_bf16 a[132:135],v[196:199],v[240:243],a[132:135]
ds_read_b64_tr_b16 v[176:177],v20 offset:0
v_mfma_f32_16x16x32_bf16 a[136:139],v[200:203],v[240:243],a[136:139]
ds_read_b64_tr_b16 v[178:179],v20 offset:1024
v_mfma_f32_16x16x32_bf16 a[140:143],v[204:207],v[240:243],a[140:143]
s_add_u32 m0,s79,131072
s_add_u32 s81,s75,9216
buffer_load_dwordx4 v3,s[8:11],s81 offen sc1 lds
v_mfma_f32_16x16x32_bf16 a[160:163],v[192:195],v[244:247],a[160:163]
ds_read_b64_tr_b16 v[180:181],v21 offset:0
v_mfma_f32_16x16x32_bf16 a[164:167],v[196:199],v[244:247],a[164:167]
ds_read_b64_tr_b16 v[182:183],v21 offset:1024
v_mfma_f32_16x16x32_bf16 a[168:171],v[200:203],v[244:247],a[168:171]
ds_read_b64_tr_b16 v[184:185],v22 offset:0
v_mfma_f32_16x16x32_bf16 a[172:175],v[204:207],v[244:247],a[172:175]
s_add_u32 m0,s79,132096
s_add_u32 s81,s75,27648
buffer_load_dwordx4 v3,s[8:11],s81 offen sc1 lds
v_mfma_f32_16x16x32_bf16 a[192:195],v[192:195],v[248:251],a[192:195]
ds_read_b64_tr_b16 v[186:187],v22 offset:1024
v_mfma_f32_16x16x32_bf16 a[196:199],v[196:199],v[248:251],a[196:199]
ds_read_b64_tr_b16 v[188:189],v23 offset:0
v_mfma_f32_16x16x32_bf16 a[200:203],v[200:203],v[248:251],a[200:203]
ds_read_b64_tr_b16 v[190:191],v23 offset:1024
v_mfma_f32_16x16x32_bf16 a[204:207],v[204:207],v[248:251],a[204:207]
s_add_u32 m0,s79,133120
s_add_u32 s81,s75,46080
buffer_load_dwordx4 v3,s[8:11],s81 offen sc1 lds
v_mfma_f32_16x16x32_bf16 a[224:227],v[192:195],v[252:255],a[224:227]
v_mfma_f32_16x16x32_bf16 a[228:231],v[196:199],v[252:255],a[228:231]
v_mfma_f32_16x16x32_bf16 a[232:235],v[200:203],v[252:255],a[232:235]
v_mfma_f32_16x16x32_bf16 a[236:239],v[204:207],v[252:255],a[236:239]
s_add_u32 m0,s79,134144
s_add_u32 s81,s75,64512
buffer_load_dwordx4 v3,s[8:11],s81 offen sc1 lds
s_waitcnt vmcnt(16) lgkmcnt(0)
s_barrier
v_mfma_f32_16x16x32_bf16 a[0:3],v[128:131],v[160:163],a[0:3]
v_add_u32 v8,65536,v5
v_mfma_f32_16x16x32_bf16 a[4:7],v[132:135],v[160:163],a[4:7]
ds_read_b128 v[192:195],v8 offset:0
v_add_u32 v16,81920,v24
v_add_u32 v17,81920,v25
v_mfma_f32_16x16x32_bf16 a[8:11],v[136:139],v[160:163],a[8:11]
ds_read_b128 v[196:199],v8 offset:1024
v_add_u32 v18,81920,v26
v_add_u32 v19,81920,v27
v_mfma_f32_16x16x32_bf16 a[12:15],v[140:143],v[160:163],a[12:15]
s_add_u32 m0,s80,0
s_mov_b32 s81,s76
buffer_load_dwordx4 v4,s[56:59],s81 offen lds
v_mfma_f32_16x16x32_bf16 a[32:35],v[128:131],v[164:167],a[32:35]
ds_read_b128 v[200:203],v8 offset:2048
v_add_u32 v20,81920,v28
v_add_u32 v21,81920,v29
v_mfma_f32_16x16x32_bf16 a[36:39],v[132:135],v[164:167],a[36:39]
ds_read_b128 v[204:207],v8 offset:3072
v_add_u32 v22,81920,v30
v_add_u32 v23,81920,v31
v_mfma_f32_16x16x32_bf16 a[40:43],v[136:139],v[164:167],a[40:43]
ds_read_b64_tr_b16 v[224:225],v16 offset:0
v_mfma_f32_16x16x32_bf16 a[44:47],v[140:143],v[164:167],a[44:47]
s_add_u32 m0,s80,1024
s_add_u32 s81,s76,s68
buffer_load_dwordx4 v4,s[56:59],s81 offen lds
v_mfma_f32_16x16x32_bf16 a[64:67],v[128:131],v[168:171],a[64:67]
ds_read_b64_tr_b16 v[226:227],v16 offset:1024
v_mfma_f32_16x16x32_bf16 a[68:71],v[132:135],v[168:171],a[68:71]
ds_read_b64_tr_b16 v[228:229],v17 offset:0
v_mfma_f32_16x16x32_bf16 a[72:75],v[136:139],v[168:171],a[72:75]
ds_read_b64_tr_b16 v[230:231],v17 offset:1024
v_mfma_f32_16x16x32_bf16 a[76:79],v[140:143],v[168:171],a[76:79]
s_add_u32 m0,s80,4096
s_add_u32 s81,s76,s69
buffer_load_dwordx4 v4,s[56:59],s81 offen lds
v_mfma_f32_16x16x32_bf16 a[96:99],v[128:131],v[172:175],a[96:99]
ds_read_b64_tr_b16 v[232:233],v18 offset:0
v_mfma_f32_16x16x32_bf16 a[100:103],v[132:135],v[172:175],a[100:103]
ds_read_b64_tr_b16 v[234:235],v18 offset:1024
v_mfma_f32_16x16x32_bf16 a[104:107],v[136:139],v[172:175],a[104:107]
ds_read_b64_tr_b16 v[236:237],v19 offset:0
v_mfma_f32_16x16x32_bf16 a[108:111],v[140:143],v[172:175],a[108:111]
s_add_u32 m0,s80,5120
s_add_u32 s81,s81,s68
buffer_load_dwordx4 v4,s[56:59],s81 offen lds
s_add_u32 s76,s76,s70
v_mfma_f32_16x16x32_bf16 a[128:131],v[128:131],v[176:179],a[128:131]
ds_read_b64_tr_b16 v[238:239],v19 offset:1024
v_mfma_f32_16x16x32_bf16 a[132:135],v[132:135],v[176:179],a[132:135]
ds_read_b64_tr_b16 v[240:241],v20 offset:0
v_mfma_f32_16x16x32_bf16 a[136:139],v[136:139],v[176:179],a[136:139]
ds_read_b64_tr_b16 v[242:243],v20 offset:1024
v_mfma_f32_16x16x32_bf16 a[140:143],v[140:143],v[176:179],a[140:143]
s_add_u32 m0,s79,0
s_add_u32 s81,s75,10240
buffer_load_dwordx4 v3,s[8:11],s81 offen sc1 lds
v_mfma_f32_16x16x32_bf16 a[160:163],v[128:131],v[180:183],a[160:163]
ds_read_b64_tr_b16 v[244:245],v21 offset:0
v_mfma_f32_16x16x32_bf16 a[164:167],v[132:135],v[180:183],a[164:167]
ds_read_b64_tr_b16 v[246:247],v21 offset:1024
v_mfma_f32_16x16x32_bf16 a[168:171],v[136:139],v[180:183],a[168:171]
ds_read_b64_tr_b16 v[248:249],v22 offset:0
v_mfma_f32_16x16x32_bf16 a[172:175],v[140:143],v[180:183],a[172:175]
s_add_u32 m0,s79,1024
s_add_u32 s81,s75,28672
buffer_load_dwordx4 v3,s[8:11],s81 offen sc1 lds
v_mfma_f32_16x16x32_bf16 a[192:195],v[128:131],v[184:187],a[192:195]
ds_read_b64_tr_b16 v[250:251],v22 offset:1024
v_mfma_f32_16x16x32_bf16 a[196:199],v[132:135],v[184:187],a[196:199]
ds_read_b64_tr_b16 v[252:253],v23 offset:0
v_mfma_f32_16x16x32_bf16 a[200:203],v[136:139],v[184:187],a[200:203]
ds_read_b64_tr_b16 v[254:255],v23 offset:1024
v_mfma_f32_16x16x32_bf16 a[204:207],v[140:143],v[184:187],a[204:207]
s_add_u32 m0,s79,2048
s_add_u32 s81,s75,47104
buffer_load_dwordx4 v3,s[8:11],s81 offen sc1 lds
v_mfma_f32_16x16x32_bf16 a[224:227],v[128:131],v[188:191],a[224:227]
v_mfma_f32_16x16x32_bf16 a[228:231],v[132:135],v[188:191],a[228:231]
v_mfma_f32_16x16x32_bf16 a[232:235],v[136:139],v[188:191],a[232:235]
v_mfma_f32_16x16x32_bf16 a[236:239],v[140:143],v[188:191],a[236:239]
s_add_u32 m0,s79,3072
s_add_u32 s81,s75,65536
buffer_load_dwordx4 v3,s[8:11],s81 offen sc1 lds
s_waitcnt vmcnt(16) lgkmcnt(0)
s_barrier
v_mfma_f32_16x16x32_bf16 a[0:3],v[192:195],v[224:227],a[0:3]
v_add_u32 v8,98304,v5
v_mfma_f32_16x16x32_bf16 a[4:7],v[196:199],v[224:227],a[4:7]
ds_read_b128 v[128:131],v8 offset:0
v_add_u32 v16,114688,v24
v_add_u32 v17,114688,v25
v_mfma_f32_16x16x32_bf16 a[8:11],v[200:203],v[224:227],a[8:11]
ds_read_b128 v[132:135],v8 offset:1024
v_add_u32 v18,114688,v26
v_add_u32 v19,114688,v27
v_mfma_f32_16x16x32_bf16 a[12:15],v[204:207],v[224:227],a[12:15]
s_add_u32 m0,s80,32768
s_mov_b32 s81,s76
buffer_load_dwordx4 v4,s[56:59],s81 offen lds
v_mfma_f32_16x16x32_bf16 a[32:35],v[192:195],v[228:231],a[32:35]
ds_read_b128 v[136:139],v8 offset:2048
v_add_u32 v20,114688,v28
v_add_u32 v21,114688,v29
v_mfma_f32_16x16x32_bf16 a[36:39],v[196:199],v[228:231],a[36:39]
ds_read_b128 v[140:143],v8 offset:3072
v_add_u32 v22,114688,v30
v_add_u32 v23,114688,v31
v_mfma_f32_16x16x32_bf16 a[40:43],v[200:203],v[228:231],a[40:43]
ds_read_b64_tr_b16 v[160:161],v16 offset:0
v_mfma_f32_16x16x32_bf16 a[44:47],v[204:207],v[228:231],a[44:47]
s_add_u32 m0,s80,33792
s_add_u32 s81,s76,s68
buffer_load_dwordx4 v4,s[56:59],s81 offen lds
v_mfma_f32_16x16x32_bf16 a[64:67],v[192:195],v[232:235],a[64:67]
ds_read_b64_tr_b16 v[162:163],v16 offset:1024
v_mfma_f32_16x16x32_bf16 a[68:71],v[196:199],v[232:235],a[68:71]
ds_read_b64_tr_b16 v[164:165],v17 offset:0
v_mfma_f32_16x16x32_bf16 a[72:75],v[200:203],v[232:235],a[72:75]
ds_read_b64_tr_b16 v[166:167],v17 offset:1024
v_mfma_f32_16x16x32_bf16 a[76:79],v[204:207],v[232:235],a[76:79]
s_add_u32 m0,s80,36864
s_add_u32 s81,s76,s69
buffer_load_dwordx4 v4,s[56:59],s81 offen lds
v_mfma_f32_16x16x32_bf16 a[96:99],v[192:195],v[236:239],a[96:99]
ds_read_b64_tr_b16 v[168:169],v18 offset:0
v_mfma_f32_16x16x32_bf16 a[100:103],v[196:199],v[236:239],a[100:103]
ds_read_b64_tr_b16 v[170:171],v18 offset:1024
v_mfma_f32_16x16x32_bf16 a[104:107],v[200:203],v[236:239],a[104:107]
ds_read_b64_tr_b16 v[172:173],v19 offset:0
v_mfma_f32_16x16x32_bf16 a[108:111],v[204:207],v[236:239],a[108:111]
s_add_u32 m0,s80,37888
s_add_u32 s81,s81,s68
buffer_load_dwordx4 v4,s[56:59],s81 offen lds
s_add_u32 s76,s76,s70
v_mfma_f32_16x16x32_bf16 a[128:131],v[192:195],v[240:243],a[128:131]
ds_read_b64_tr_b16 v[174:175],v19 offset:1024
v_mfma_f32_16x16x32_bf16 a[132:135],v[196:199],v[240:243],a[132:135]
ds_read_b64_tr_b16 v[176:177],v20 offset:0
v_mfma_f32_16x16x32_bf16 a[136:139],v[200:203],v[240:243],a[136:139]
ds_read_b64_tr_b16 v[178:179],v20 offset:1024
v_mfma_f32_16x16x32_bf16 a[140:143],v[204:207],v[240:243],a[140:143]
s_add_u32 m0,s79,32768
s_add_u32 s81,s75,11264
buffer_load_dwordx4 v3,s[8:11],s81 offen sc1 lds
v_mfma_f32_16x16x32_bf16 a[160:163],v[192:195],v[244:247],a[160:163]
ds_read_b64_tr_b16 v[180:181],v21 offset:0
v_mfma_f32_16x16x32_bf16 a[164:167],v[196:199],v[244:247],a[164:167]
ds_read_b64_tr_b16 v[182:183],v21 offset:1024
v_mfma_f32_16x16x32_bf16 a[168:171],v[200:203],v[244:247],a[168:171]
ds_read_b64_tr_b16 v[184:185],v22 offset:0
v_mfma_f32_16x16x32_bf16 a[172:175],v[204:207],v[244:247],a[172:175]
s_add_u32 m0,s79,33792
s_add_u32 s81,s75,29696
buffer_load_dwordx4 v3,s[8:11],s81 offen sc1 lds
v_mfma_f32_16x16x32_bf16 a[192:195],v[192:195],v[248:251],a[192:195]
ds_read_b64_tr_b16 v[186:187],v22 offset:1024
v_mfma_f32_16x16x32_bf16 a[196:199],v[196:199],v[248:251],a[196:199]
ds_read_b64_tr_b16 v[188:189],v23 offset:0
v_mfma_f32_16x16x32_bf16 a[200:203],v[200:203],v[248:251],a[200:203]
ds_read_b64_tr_b16 v[190:191],v23 offset:1024
v_mfma_f32_16x16x32_bf16 a[204:207],v[204:207],v[248:251],a[204:207]
s_add_u32 m0,s79,34816
s_add_u32 s81,s75,48128
buffer_load_dwordx4 v3,s[8:11],s81 offen sc1 lds
v_mfma_f32_16x16x32_bf16 a[224:227],v[192:195],v[252:255],a[224:227]
v_mfma_f32_16x16x32_bf16 a[228:231],v[196:199],v[252:255],a[228:231]
v_mfma_f32_16x16x32_bf16 a[232:235],v[200:203],v[252:255],a[232:235]
v_mfma_f32_16x16x32_bf16 a[236:239],v[204:207],v[252:255],a[236:239]
s_add_u32 m0,s79,35840
s_add_u32 s81,s75,66560
buffer_load_dwordx4 v3,s[8:11],s81 offen sc1 lds
s_waitcnt vmcnt(16) lgkmcnt(0)
s_barrier
v_mfma_f32_16x16x32_bf16 a[0:3],v[128:131],v[160:163],a[0:3]
v_add_u32 v8,131072,v5
v_mfma_f32_16x16x32_bf16 a[4:7],v[132:135],v[160:163],a[4:7]
ds_read_b128 v[192:195],v8 offset:0
v_add_u32 v16,147456,v24
v_add_u32 v17,147456,v25
v_mfma_f32_16x16x32_bf16 a[8:11],v[136:139],v[160:163],a[8:11]
ds_read_b128 v[196:199],v8 offset:1024
v_add_u32 v18,147456,v26
v_add_u32 v19,147456,v27
v_mfma_f32_16x16x32_bf16 a[12:15],v[140:143],v[160:163],a[12:15]
s_add_u32 m0,s80,65536
s_mov_b32 s81,s76
buffer_load_dwordx4 v4,s[56:59],s81 offen lds
v_mfma_f32_16x16x32_bf16 a[32:35],v[128:131],v[164:167],a[32:35]
ds_read_b128 v[200:203],v8 offset:2048
v_add_u32 v20,147456,v28
v_add_u32 v21,147456,v29
v_mfma_f32_16x16x32_bf16 a[36:39],v[132:135],v[164:167],a[36:39]
ds_read_b128 v[204:207],v8 offset:3072
v_add_u32 v22,147456,v30
v_add_u32 v23,147456,v31
v_mfma_f32_16x16x32_bf16 a[40:43],v[136:139],v[164:167],a[40:43]
ds_read_b64_tr_b16 v[224:225],v16 offset:0
v_mfma_f32_16x16x32_bf16 a[44:47],v[140:143],v[164:167],a[44:47]
s_add_u32 m0,s80,66560
s_add_u32 s81,s76,s68
buffer_load_dwordx4 v4,s[56:59],s81 offen lds
v_mfma_f32_16x16x32_bf16 a[64:67],v[128:131],v[168:171],a[64:67]
ds_read_b64_tr_b16 v[226:227],v16 offset:1024
v_mfma_f32_16x16x32_bf16 a[68:71],v[132:135],v[168:171],a[68:71]
ds_read_b64_tr_b16 v[228:229],v17 offset:0
v_mfma_f32_16x16x32_bf16 a[72:75],v[136:139],v[168:171],a[72:75]
ds_read_b64_tr_b16 v[230:231],v17 offset:1024
v_mfma_f32_16x16x32_bf16 a[76:79],v[140:143],v[168:171],a[76:79]
s_add_u32 m0,s80,69632
s_add_u32 s81,s76,s69
buffer_load_dwordx4 v4,s[56:59],s81 offen lds
v_mfma_f32_16x16x32_bf16 a[96:99],v[128:131],v[172:175],a[96:99]
ds_read_b64_tr_b16 v[232:233],v18 offset:0
v_mfma_f32_16x16x32_bf16 a[100:103],v[132:135],v[172:175],a[100:103]
ds_read_b64_tr_b16 v[234:235],v18 offset:1024
v_mfma_f32_16x16x32_bf16 a[104:107],v[136:139],v[172:175],a[104:107]
ds_read_b64_tr_b16 v[236:237],v19 offset:0
v_mfma_f32_16x16x32_bf16 a[108:111],v[140:143],v[172:175],a[108:111]
s_add_u32 m0,s80,70656
s_add_u32 s81,s81,s68
buffer_load_dwordx4 v4,s[56:59],s81 offen lds
s_add_u32 s76,s76,s70
v_mfma_f32_16x16x32_bf16 a[128:131],v[128:131],v[176:179],a[128:131]
ds_read_b64_tr_b16 v[238:239],v19 offset:1024
v_mfma_f32_16x16x32_bf16 a[132:135],v[132:135],v[176:179],a[132:135]
ds_read_b64_tr_b16 v[240:241],v20 offset:0
v_mfma_f32_16x16x32_bf16 a[136:139],v[136:139],v[176:179],a[136:139]
ds_read_b64_tr_b16 v[242:243],v20 offset:1024
v_mfma_f32_16x16x32_bf16 a[140:143],v[140:143],v[176:179],a[140:143]
s_add_u32 m0,s79,65536
s_add_u32 s81,s75,12288
buffer_load_dwordx4 v3,s[8:11],s81 offen sc1 lds
v_mfma_f32_16x16x32_bf16 a[160:163],v[128:131],v[180:183],a[160:163]
ds_read_b64_tr_b16 v[244:245],v21 offset:0
v_mfma_f32_16x16x32_bf16 a[164:167],v[132:135],v[180:183],a[164:167]
ds_read_b64_tr_b16 v[246:247],v21 offset:1024
v_mfma_f32_16x16x32_bf16 a[168:171],v[136:139],v[180:183],a[168:171]
ds_read_b64_tr_b16 v[248:249],v22 offset:0
v_mfma_f32_16x16x32_bf16 a[172:175],v[140:143],v[180:183],a[172:175]
s_add_u32 m0,s79,66560
s_add_u32 s81,s75,30720
buffer_load_dwordx4 v3,s[8:11],s81 offen sc1 lds
v_mfma_f32_16x16x32_bf16 a[192:195],v[128:131],v[184:187],a[192:195]
ds_read_b64_tr_b16 v[250:251],v22 offset:1024
v_mfma_f32_16x16x32_bf16 a[196:199],v[132:135],v[184:187],a[196:199]
ds_read_b64_tr_b16 v[252:253],v23 offset:0
v_mfma_f32_16x16x32_bf16 a[200:203],v[136:139],v[184:187],a[200:203]
ds_read_b64_tr_b16 v[254:255],v23 offset:1024
v_mfma_f32_16x16x32_bf16 a[204:207],v[140:143],v[184:187],a[204:207]
s_add_u32 m0,s79,67584
s_add_u32 s81,s75,49152
buffer_load_dwordx4 v3,s[8:11],s81 offen sc1 lds
v_mfma_f32_16x16x32_bf16 a[224:227],v[128:131],v[188:191],a[224:227]
v_mfma_f32_16x16x32_bf16 a[228:231],v[132:135],v[188:191],a[228:231]
v_mfma_f32_16x16x32_bf16 a[232:235],v[136:139],v[188:191],a[232:235]
v_mfma_f32_16x16x32_bf16 a[236:239],v[140:143],v[188:191],a[236:239]
s_add_u32 m0,s79,68608
s_add_u32 s81,s75,67584
buffer_load_dwordx4 v3,s[8:11],s81 offen sc1 lds
s_waitcnt vmcnt(16) lgkmcnt(0)
s_barrier
v_mfma_f32_16x16x32_bf16 a[0:3],v[192:195],v[224:227],a[0:3]
v_add_u32 v8,0,v5
v_mfma_f32_16x16x32_bf16 a[4:7],v[196:199],v[224:227],a[4:7]
ds_read_b128 v[128:131],v8 offset:0
v_add_u32 v16,16384,v24
v_add_u32 v17,16384,v25
v_mfma_f32_16x16x32_bf16 a[8:11],v[200:203],v[224:227],a[8:11]
ds_read_b128 v[132:135],v8 offset:1024
v_add_u32 v18,16384,v26
v_add_u32 v19,16384,v27
v_mfma_f32_16x16x32_bf16 a[12:15],v[204:207],v[224:227],a[12:15]
s_add_u32 m0,s80,98304
s_mov_b32 s81,s76
buffer_load_dwordx4 v4,s[56:59],s81 offen lds
v_mfma_f32_16x16x32_bf16 a[32:35],v[192:195],v[228:231],a[32:35]
ds_read_b128 v[136:139],v8 offset:2048
v_add_u32 v20,16384,v28
v_add_u32 v21,16384,v29
v_mfma_f32_16x16x32_bf16 a[36:39],v[196:199],v[228:231],a[36:39]
ds_read_b128 v[140:143],v8 offset:3072
v_add_u32 v22,16384,v30
v_add_u32 v23,16384,v31
v_mfma_f32_16x16x32_bf16 a[40:43],v[200:203],v[228:231],a[40:43]
ds_read_b64_tr_b16 v[160:161],v16 offset:0
v_mfma_f32_16x16x32_bf16 a[44:47],v[204:207],v[228:231],a[44:47]
s_add_u32 m0,s80,99328
s_add_u32 s81,s76,s68
buffer_load_dwordx4 v4,s[56:59],s81 offen lds
v_mfma_f32_16x16x32_bf16 a[64:67],v[192:195],v[232:235],a[64:67]
ds_read_b64_tr_b16 v[162:163],v16 offset:1024
v_mfma_f32_16x16x32_bf16 a[68:71],v[196:199],v[232:235],a[68:71]
ds_read_b64_tr_b16 v[164:165],v17 offset:0
v_mfma_f32_16x16x32_bf16 a[72:75],v[200:203],v[232:235],a[72:75]
ds_read_b64_tr_b16 v[166:167],v17 offset:1024
v_mfma_f32_16x16x32_bf16 a[76:79],v[204:207],v[232:235],a[76:79]
s_add_u32 m0,s80,102400
s_add_u32 s81,s76,s69
buffer_load_dwordx4 v4,s[56:59],s81 offen lds
v_mfma_f32_16x16x32_bf16 a[96:99],v[192:195],v[236:239],a[96:99]
ds_read_b64_tr_b16 v[168:169],v18 offset:0
v_mfma_f32_16x16x32_bf16 a[100:103],v[196:199],v[236:239],a[100:103]
ds_read_b64_tr_b16 v[170:171],v18 offset:1024
v_mfma_f32_16x16x32_bf16 a[104:107],v[200:203],v[236:239],a[104:107]
ds_read_b64_tr_b16 v[172:173],v19 offset:0
v_mfma_f32_16x16x32_bf16 a[108:111],v[204:207],v[236:239],a[108:111]
s_add_u32 m0,s80,103424
s_add_u32 s81,s81,s68
buffer_load_dwordx4 v4,s[56:59],s81 offen lds
s_add_u32 s76,s76,s70
v_mfma_f32_16x16x32_bf16 a[128:131],v[192:195],v[240:243],a[128:131]
ds_read_b64_tr_b16 v[174:175],v19 offset:1024
v_mfma_f32_16x16x32_bf16 a[132:135],v[196:199],v[240:243],a[132:135]
ds_read_b64_tr_b16 v[176:177],v20 offset:0
v_mfma_f32_16x16x32_bf16 a[136:139],v[200:203],v[240:243],a[136:139]
ds_read_b64_tr_b16 v[178:179],v20 offset:1024
v_mfma_f32_16x16x32_bf16 a[140:143],v[204:207],v[240:243],a[140:143]
s_add_u32 m0,s79,98304
s_add_u32 s81,s75,13312
buffer_load_dwordx4 v3,s[8:11],s81 offen sc1 lds
v_mfma_f32_16x16x32_bf16 a[160:163],v[192:195],v[244:247],a[160:163]
ds_read_b64_tr_b16 v[180:181],v21 offset:0
v_mfma_f32_16x16x32_bf16 a[164:167],v[196:199],v[244:247],a[164:167]
ds_read_b64_tr_b16 v[182:183],v21 offset:1024
v_mfma_f32_16x16x32_bf16 a[168:171],v[200:203],v[244:247],a[168:171]
ds_read_b64_tr_b16 v[184:185],v22 offset:0
v_mfma_f32_16x16x32_bf16 a[172:175],v[204:207],v[244:247],a[172:175]
s_add_u32 m0,s79,99328
s_add_u32 s81,s75,31744
buffer_load_dwordx4 v3,s[8:11],s81 offen sc1 lds
v_mfma_f32_16x16x32_bf16 a[192:195],v[192:195],v[248:251],a[192:195]
ds_read_b64_tr_b16 v[186:187],v22 offset:1024
v_mfma_f32_16x16x32_bf16 a[196:199],v[196:199],v[248:251],a[196:199]
ds_read_b64_tr_b16 v[188:189],v23 offset:0
v_mfma_f32_16x16x32_bf16 a[200:203],v[200:203],v[248:251],a[200:203]
ds_read_b64_tr_b16 v[190:191],v23 offset:1024
v_mfma_f32_16x16x32_bf16 a[204:207],v[204:207],v[248:251],a[204:207]
s_add_u32 m0,s79,100352
s_add_u32 s81,s75,50176
buffer_load_dwordx4 v3,s[8:11],s81 offen sc1 lds
v_mfma_f32_16x16x32_bf16 a[224:227],v[192:195],v[252:255],a[224:227]
v_mfma_f32_16x16x32_bf16 a[228:231],v[196:199],v[252:255],a[228:231]
v_mfma_f32_16x16x32_bf16 a[232:235],v[200:203],v[252:255],a[232:235]
v_mfma_f32_16x16x32_bf16 a[236:239],v[204:207],v[252:255],a[236:239]
s_add_u32 m0,s79,101376
s_add_u32 s81,s75,68608
buffer_load_dwordx4 v3,s[8:11],s81 offen sc1 lds
s_waitcnt vmcnt(16) lgkmcnt(0)
s_barrier
v_mfma_f32_16x16x32_bf16 a[0:3],v[128:131],v[160:163],a[0:3]
v_add_u32 v8,32768,v5
v_mfma_f32_16x16x32_bf16 a[4:7],v[132:135],v[160:163],a[4:7]
ds_read_b128 v[192:195],v8 offset:0
v_add_u32 v16,49152,v24
v_add_u32 v17,49152,v25
v_mfma_f32_16x16x32_bf16 a[8:11],v[136:139],v[160:163],a[8:11]
ds_read_b128 v[196:199],v8 offset:1024
v_add_u32 v18,49152,v26
v_add_u32 v19,49152,v27
v_mfma_f32_16x16x32_bf16 a[12:15],v[140:143],v[160:163],a[12:15]
s_add_u32 m0,s80,131072
s_mov_b32 s81,s76
buffer_load_dwordx4 v4,s[56:59],s81 offen lds
v_mfma_f32_16x16x32_bf16 a[32:35],v[128:131],v[164:167],a[32:35]
ds_read_b128 v[200:203],v8 offset:2048
v_add_u32 v20,49152,v28
v_add_u32 v21,49152,v29
v_mfma_f32_16x16x32_bf16 a[36:39],v[132:135],v[164:167],a[36:39]
ds_read_b128 v[204:207],v8 offset:3072
v_add_u32 v22,49152,v30
v_add_u32 v23,49152,v31
v_mfma_f32_16x16x32_bf16 a[40:43],v[136:139],v[164:167],a[40:43]
ds_read_b64_tr_b16 v[224:225],v16 offset:0
v_mfma_f32_16x16x32_bf16 a[44:47],v[140:143],v[164:167],a[44:47]
s_add_u32 m0,s80,132096
s_add_u32 s81,s76,s68
buffer_load_dwordx4 v4,s[56:59],s81 offen lds
v_mfma_f32_16x16x32_bf16 a[64:67],v[128:131],v[168:171],a[64:67]
ds_read_b64_tr_b16 v[226:227],v16 offset:1024
v_mfma_f32_16x16x32_bf16 a[68:71],v[132:135],v[168:171],a[68:71]
ds_read_b64_tr_b16 v[228:229],v17 offset:0
v_mfma_f32_16x16x32_bf16 a[72:75],v[136:139],v[168:171],a[72:75]
ds_read_b64_tr_b16 v[230:231],v17 offset:1024
v_mfma_f32_16x16x32_bf16 a[76:79],v[140:143],v[168:171],a[76:79]
s_add_u32 m0,s80,135168
s_add_u32 s81,s76,s69
buffer_load_dwordx4 v4,s[56:59],s81 offen lds
v_mfma_f32_16x16x32_bf16 a[96:99],v[128:131],v[172:175],a[96:99]
ds_read_b64_tr_b16 v[232:233],v18 offset:0
v_mfma_f32_16x16x32_bf16 a[100:103],v[132:135],v[172:175],a[100:103]
ds_read_b64_tr_b16 v[234:235],v18 offset:1024
v_mfma_f32_16x16x32_bf16 a[104:107],v[136:139],v[172:175],a[104:107]
ds_read_b64_tr_b16 v[236:237],v19 offset:0
v_mfma_f32_16x16x32_bf16 a[108:111],v[140:143],v[172:175],a[108:111]
s_add_u32 m0,s80,136192
s_add_u32 s81,s81,s68
buffer_load_dwordx4 v4,s[56:59],s81 offen lds
s_add_u32 s76,s76,s70
v_mfma_f32_16x16x32_bf16 a[128:131],v[128:131],v[176:179],a[128:131]
ds_read_b64_tr_b16 v[238:239],v19 offset:1024
v_mfma_f32_16x16x32_bf16 a[132:135],v[132:135],v[176:179],a[132:135]
ds_read_b64_tr_b16 v[240:241],v20 offset:0
v_mfma_f32_16x16x32_bf16 a[136:139],v[136:139],v[176:179],a[136:139]
ds_read_b64_tr_b16 v[242:243],v20 offset:1024
v_mfma_f32_16x16x32_bf16 a[140:143],v[140:143],v[176:179],a[140:143]
s_add_u32 m0,s79,131072
s_add_u32 s81,s75,14336
buffer_load_dwordx4 v3,s[8:11],s81 offen sc1 lds
v_mfma_f32_16x16x32_bf16 a[160:163],v[128:131],v[180:183],a[160:163]
ds_read_b64_tr_b16 v[244:245],v21 offset:0
v_mfma_f32_16x16x32_bf16 a[164:167],v[132:135],v[180:183],a[164:167]
ds_read_b64_tr_b16 v[246:247],v21 offset:1024
v_mfma_f32_16x16x32_bf16 a[168:171],v[136:139],v[180:183],a[168:171]
ds_read_b64_tr_b16 v[248:249],v22 offset:0
v_mfma_f32_16x16x32_bf16 a[172:175],v[140:143],v[180:183],a[172:175]
s_add_u32 m0,s79,132096
s_add_u32 s81,s75,32768
buffer_load_dwordx4 v3,s[8:11],s81 offen sc1 lds
v_mfma_f32_16x16x32_bf16 a[192:195],v[128:131],v[184:187],a[192:195]
ds_read_b64_tr_b16 v[250:251],v22 offset:1024
v_mfma_f32_16x16x32_bf16 a[196:199],v[132:135],v[184:187],a[196:199]
ds_read_b64_tr_b16 v[252:253],v23 offset:0
v_mfma_f32_16x16x32_bf16 a[200:203],v[136:139],v[184:187],a[200:203]
ds_read_b64_tr_b16 v[254:255],v23 offset:1024
v_mfma_f32_16x16x32_bf16 a[204:207],v[140:143],v[184:187],a[204:207]
s_add_u32 m0,s79,133120
s_add_u32 s81,s75,51200
buffer_load_dwordx4 v3,s[8:11],s81 offen sc1 lds
v_mfma_f32_16x16x32_bf16 a[224:227],v[128:131],v[188:191],a[224:227]
v_mfma_f32_16x16x32_bf16 a[228:231],v[132:135],v[188:191],a[228:231]
v_mfma_f32_16x16x32_bf16 a[232:235],v[136:139],v[188:191],a[232:235]
v_mfma_f32_16x16x32_bf16 a[236:239],v[140:143],v[188:191],a[236:239]
s_add_u32 m0,s79,134144
s_add_u32 s81,s75,69632
buffer_load_dwordx4 v3,s[8:11],s81 offen sc1 lds
s_waitcnt vmcnt(16) lgkmcnt(0)
s_barrier
v_mfma_f32_16x16x32_bf16 a[0:3],v[192:195],v[224:227],a[0:3]
v_add_u32 v8,65536,v5
v_mfma_f32_16x16x32_bf16 a[4:7],v[196:199],v[224:227],a[4:7]
ds_read_b128 v[128:131],v8 offset:0
v_add_u32 v16,81920,v24
v_add_u32 v17,81920,v25
v_mfma_f32_16x16x32_bf16 a[8:11],v[200:203],v[224:227],a[8:11]
ds_read_b128 v[132:135],v8 offset:1024
v_add_u32 v18,81920,v26
v_add_u32 v19,81920,v27
v_mfma_f32_16x16x32_bf16 a[12:15],v[204:207],v[224:227],a[12:15]
s_add_u32 m0,s80,0
s_mov_b32 s81,s76
buffer_load_dwordx4 v4,s[56:59],s81 offen lds
v_mfma_f32_16x16x32_bf16 a[32:35],v[192:195],v[228:231],a[32:35]
ds_read_b128 v[136:139],v8 offset:2048
v_add_u32 v20,81920,v28
v_add_u32 v21,81920,v29
v_mfma_f32_16x16x32_bf16 a[36:39],v[196:199],v[228:231],a[36:39]
ds_read_b128 v[140:143],v8 offset:3072
v_add_u32 v22,81920,v30
v_add_u32 v23,81920,v31
v_mfma_f32_16x16x32_bf16 a[40:43],v[200:203],v[228:231],a[40:43]
ds_read_b64_tr_b16 v[160:161],v16 offset:0
v_mfma_f32_16x16x32_bf16 a[44:47],v[204:207],v[228:231],a[44:47]
s_add_u32 m0,s80,1024
s_add_u32 s81,s76,s68
buffer_load_dwordx4 v4,s[56:59],s81 offen lds
v_mfma_f32_16x16x32_bf16 a[64:67],v[192:195],v[232:235],a[64:67]
ds_read_b64_tr_b16 v[162:163],v16 offset:1024
v_mfma_f32_16x16x32_bf16 a[68:71],v[196:199],v[232:235],a[68:71]
ds_read_b64_tr_b16 v[164:165],v17 offset:0
v_mfma_f32_16x16x32_bf16 a[72:75],v[200:203],v[232:235],a[72:75]
ds_read_b64_tr_b16 v[166:167],v17 offset:1024
v_mfma_f32_16x16x32_bf16 a[76:79],v[204:207],v[232:235],a[76:79]
s_add_u32 m0,s80,4096
s_add_u32 s81,s76,s69
buffer_load_dwordx4 v4,s[56:59],s81 offen lds
v_mfma_f32_16x16x32_bf16 a[96:99],v[192:195],v[236:239],a[96:99]
ds_read_b64_tr_b16 v[168:169],v18 offset:0
v_mfma_f32_16x16x32_bf16 a[100:103],v[196:199],v[236:239],a[100:103]
ds_read_b64_tr_b16 v[170:171],v18 offset:1024
v_mfma_f32_16x16x32_bf16 a[104:107],v[200:203],v[236:239],a[104:107]
ds_read_b64_tr_b16 v[172:173],v19 offset:0
v_mfma_f32_16x16x32_bf16 a[108:111],v[204:207],v[236:239],a[108:111]
s_add_u32 m0,s80,5120
s_add_u32 s81,s81,s68
buffer_load_dwordx4 v4,s[56:59],s81 offen lds
s_add_u32 s76,s76,s70
v_mfma_f32_16x16x32_bf16 a[128:131],v[192:195],v[240:243],a[128:131]
ds_read_b64_tr_b16 v[174:175],v19 offset:1024
v_mfma_f32_16x16x32_bf16 a[132:135],v[196:199],v[240:243],a[132:135]
ds_read_b64_tr_b16 v[176:177],v20 offset:0
v_mfma_f32_16x16x32_bf16 a[136:139],v[200:203],v[240:243],a[136:139]
ds_read_b64_tr_b16 v[178:179],v20 offset:1024
v_mfma_f32_16x16x32_bf16 a[140:143],v[204:207],v[240:243],a[140:143]
s_add_u32 m0,s79,0
s_add_u32 s81,s75,15360
buffer_load_dwordx4 v3,s[8:11],s81 offen sc1 lds
v_mfma_f32_16x16x32_bf16 a[160:163],v[192:195],v[244:247],a[160:163]
ds_read_b64_tr_b16 v[180:181],v21 offset:0
v_mfma_f32_16x16x32_bf16 a[164:167],v[196:199],v[244:247],a[164:167]
ds_read_b64_tr_b16 v[182:183],v21 offset:1024
v_mfma_f32_16x16x32_bf16 a[168:171],v[200:203],v[244:247],a[168:171]
ds_read_b64_tr_b16 v[184:185],v22 offset:0
v_mfma_f32_16x16x32_bf16 a[172:175],v[204:207],v[244:247],a[172:175]
s_add_u32 m0,s79,1024
s_add_u32 s81,s75,33792
buffer_load_dwordx4 v3,s[8:11],s81 offen sc1 lds
v_mfma_f32_16x16x32_bf16 a[192:195],v[192:195],v[248:251],a[192:195]
ds_read_b64_tr_b16 v[186:187],v22 offset:1024
v_mfma_f32_16x16x32_bf16 a[196:199],v[196:199],v[248:251],a[196:199]
ds_read_b64_tr_b16 v[188:189],v23 offset:0
v_mfma_f32_16x16x32_bf16 a[200:203],v[200:203],v[248:251],a[200:203]
ds_read_b64_tr_b16 v[190:191],v23 offset:1024
v_mfma_f32_16x16x32_bf16 a[204:207],v[204:207],v[248:251],a[204:207]
s_add_u32 m0,s79,2048
s_add_u32 s81,s75,52224
buffer_load_dwordx4 v3,s[8:11],s81 offen sc1 lds
v_mfma_f32_16x16x32_bf16 a[224:227],v[192:195],v[252:255],a[224:227]
v_mfma_f32_16x16x32_bf16 a[228:231],v[196:199],v[252:255],a[228:231]
v_mfma_f32_16x16x32_bf16 a[232:235],v[200:203],v[252:255],a[232:235]
v_mfma_f32_16x16x32_bf16 a[236:239],v[204:207],v[252:255],a[236:239]
s_add_u32 m0,s79,3072
s_add_u32 s81,s75,70656
buffer_load_dwordx4 v3,s[8:11],s81 offen sc1 lds
s_waitcnt vmcnt(16) lgkmcnt(0)
s_barrier
v_mfma_f32_16x16x32_bf16 a[0:3],v[128:131],v[160:163],a[0:3]
v_add_u32 v8,98304,v5
v_mfma_f32_16x16x32_bf16 a[4:7],v[132:135],v[160:163],a[4:7]
ds_read_b128 v[192:195],v8 offset:0
v_add_u32 v16,114688,v24
v_add_u32 v17,114688,v25
v_mfma_f32_16x16x32_bf16 a[8:11],v[136:139],v[160:163],a[8:11]
ds_read_b128 v[196:199],v8 offset:1024
v_add_u32 v18,114688,v26
v_add_u32 v19,114688,v27
v_mfma_f32_16x16x32_bf16 a[12:15],v[140:143],v[160:163],a[12:15]
s_add_u32 m0,s80,32768
s_mov_b32 s81,s76
buffer_load_dwordx4 v4,s[56:59],s81 offen lds
v_mfma_f32_16x16x32_bf16 a[32:35],v[128:131],v[164:167],a[32:35]
ds_read_b128 v[200:203],v8 offset:2048
v_add_u32 v20,114688,v28
v_add_u32 v21,114688,v29
v_mfma_f32_16x16x32_bf16 a[36:39],v[132:135],v[164:167],a[36:39]
ds_read_b128 v[204:207],v8 offset:3072
v_add_u32 v22,114688,v30
v_add_u32 v23,114688,v31
v_mfma_f32_16x16x32_bf16 a[40:43],v[136:139],v[164:167],a[40:43]
ds_read_b64_tr_b16 v[224:225],v16 offset:0
v_mfma_f32_16x16x32_bf16 a[44:47],v[140:143],v[164:167],a[44:47]
s_add_u32 m0,s80,33792
s_add_u32 s81,s76,s68
buffer_load_dwordx4 v4,s[56:59],s81 offen lds
v_mfma_f32_16x16x32_bf16 a[64:67],v[128:131],v[168:171],a[64:67]
ds_read_b64_tr_b16 v[226:227],v16 offset:1024
v_mfma_f32_16x16x32_bf16 a[68:71],v[132:135],v[168:171],a[68:71]
ds_read_b64_tr_b16 v[228:229],v17 offset:0
v_mfma_f32_16x16x32_bf16 a[72:75],v[136:139],v[168:171],a[72:75]
ds_read_b64_tr_b16 v[230:231],v17 offset:1024
v_mfma_f32_16x16x32_bf16 a[76:79],v[140:143],v[168:171],a[76:79]
s_add_u32 m0,s80,36864
s_add_u32 s81,s76,s69
buffer_load_dwordx4 v4,s[56:59],s81 offen lds
v_mfma_f32_16x16x32_bf16 a[96:99],v[128:131],v[172:175],a[96:99]
ds_read_b64_tr_b16 v[232:233],v18 offset:0
v_mfma_f32_16x16x32_bf16 a[100:103],v[132:135],v[172:175],a[100:103]
ds_read_b64_tr_b16 v[234:235],v18 offset:1024
v_mfma_f32_16x16x32_bf16 a[104:107],v[136:139],v[172:175],a[104:107]
ds_read_b64_tr_b16 v[236:237],v19 offset:0
v_mfma_f32_16x16x32_bf16 a[108:111],v[140:143],v[172:175],a[108:111]
s_add_u32 m0,s80,37888
s_add_u32 s81,s81,s68
buffer_load_dwordx4 v4,s[56:59],s81 offen lds
s_add_u32 s76,s76,s70
v_mfma_f32_16x16x32_bf16 a[128:131],v[128:131],v[176:179],a[128:131]
ds_read_b64_tr_b16 v[238:239],v19 offset:1024
v_mfma_f32_16x16x32_bf16 a[132:135],v[132:135],v[176:179],a[132:135]
ds_read_b64_tr_b16 v[240:241],v20 offset:0
v_mfma_f32_16x16x32_bf16 a[136:139],v[136:139],v[176:179],a[136:139]
ds_read_b64_tr_b16 v[242:243],v20 offset:1024
v_mfma_f32_16x16x32_bf16 a[140:143],v[140:143],v[176:179],a[140:143]
s_add_u32 m0,s79,32768
s_add_u32 s81,s75,16384
buffer_load_dwordx4 v3,s[8:11],s81 offen sc1 lds
v_mfma_f32_16x16x32_bf16 a[160:163],v[128:131],v[180:183],a[160:163]
ds_read_b64_tr_b16 v[244:245],v21 offset:0
v_mfma_f32_16x16x32_bf16 a[164:167],v[132:135],v[180:183],a[164:167]
ds_read_b64_tr_b16 v[246:247],v21 offset:1024
v_mfma_f32_16x16x32_bf16 a[168:171],v[136:139],v[180:183],a[168:171]
ds_read_b64_tr_b16 v[248:249],v22 offset:0
v_mfma_f32_16x16x32_bf16 a[172:175],v[140:143],v[180:183],a[172:175]
s_add_u32 m0,s79,33792
s_add_u32 s81,s75,34816
buffer_load_dwordx4 v3,s[8:11],s81 offen sc1 lds
v_mfma_f32_16x16x32_bf16 a[192:195],v[128:131],v[184:187],a[192:195]
ds_read_b64_tr_b16 v[250:251],v22 offset:1024
v_mfma_f32_16x16x32_bf16 a[196:199],v[132:135],v[184:187],a[196:199]
ds_read_b64_tr_b16 v[252:253],v23 offset:0
v_mfma_f32_16x16x32_bf16 a[200:203],v[136:139],v[184:187],a[200:203]
ds_read_b64_tr_b16 v[254:255],v23 offset:1024
v_mfma_f32_16x16x32_bf16 a[204:207],v[140:143],v[184:187],a[204:207]
s_add_u32 m0,s79,34816
s_add_u32 s81,s75,53248
buffer_load_dwordx4 v3,s[8:11],s81 offen sc1 lds
v_mfma_f32_16x16x32_bf16 a[224:227],v[128:131],v[188:191],a[224:227]
v_mfma_f32_16x16x32_bf16 a[228:231],v[132:135],v[188:191],a[228:231]
v_mfma_f32_16x16x32_bf16 a[232:235],v[136:139],v[188:191],a[232:235]
v_mfma_f32_16x16x32_bf16 a[236:239],v[140:143],v[188:191],a[236:239]
s_add_u32 m0,s79,35840
s_add_u32 s81,s75,71680
buffer_load_dwordx4 v3,s[8:11],s81 offen sc1 lds
s_waitcnt vmcnt(16) lgkmcnt(0)
s_barrier
v_mfma_f32_16x16x32_bf16 a[0:3],v[192:195],v[224:227],a[0:3]
v_add_u32 v8,131072,v5
v_mfma_f32_16x16x32_bf16 a[4:7],v[196:199],v[224:227],a[4:7]
ds_read_b128 v[128:131],v8 offset:0
v_add_u32 v16,147456,v24
v_add_u32 v17,147456,v25
v_mfma_f32_16x16x32_bf16 a[8:11],v[200:203],v[224:227],a[8:11]
ds_read_b128 v[132:135],v8 offset:1024
v_add_u32 v18,147456,v26
v_add_u32 v19,147456,v27
v_mfma_f32_16x16x32_bf16 a[12:15],v[204:207],v[224:227],a[12:15]
s_add_u32 m0,s80,65536
s_mov_b32 s81,s76
buffer_load_dwordx4 v4,s[56:59],s81 offen lds
v_mfma_f32_16x16x32_bf16 a[32:35],v[192:195],v[228:231],a[32:35]
ds_read_b128 v[136:139],v8 offset:2048
v_add_u32 v20,147456,v28
v_add_u32 v21,147456,v29
v_mfma_f32_16x16x32_bf16 a[36:39],v[196:199],v[228:231],a[36:39]
ds_read_b128 v[140:143],v8 offset:3072
v_add_u32 v22,147456,v30
v_add_u32 v23,147456,v31
v_mfma_f32_16x16x32_bf16 a[40:43],v[200:203],v[228:231],a[40:43]
ds_read_b64_tr_b16 v[160:161],v16 offset:0
v_mfma_f32_16x16x32_bf16 a[44:47],v[204:207],v[228:231],a[44:47]
s_add_u32 m0,s80,66560
s_add_u32 s81,s76,s68
buffer_load_dwordx4 v4,s[56:59],s81 offen lds
v_mfma_f32_16x16x32_bf16 a[64:67],v[192:195],v[232:235],a[64:67]
ds_read_b64_tr_b16 v[162:163],v16 offset:1024
v_mfma_f32_16x16x32_bf16 a[68:71],v[196:199],v[232:235],a[68:71]
ds_read_b64_tr_b16 v[164:165],v17 offset:0
v_mfma_f32_16x16x32_bf16 a[72:75],v[200:203],v[232:235],a[72:75]
ds_read_b64_tr_b16 v[166:167],v17 offset:1024
v_mfma_f32_16x16x32_bf16 a[76:79],v[204:207],v[232:235],a[76:79]
s_add_u32 m0,s80,69632
s_add_u32 s81,s76,s69
buffer_load_dwordx4 v4,s[56:59],s81 offen lds
v_mfma_f32_16x16x32_bf16 a[96:99],v[192:195],v[236:239],a[96:99]
ds_read_b64_tr_b16 v[168:169],v18 offset:0
v_mfma_f32_16x16x32_bf16 a[100:103],v[196:199],v[236:239],a[100:103]
ds_read_b64_tr_b16 v[170:171],v18 offset:1024
v_mfma_f32_16x16x32_bf16 a[104:107],v[200:203],v[236:239],a[104:107]
ds_read_b64_tr_b16 v[172:173],v19 offset:0
v_mfma_f32_16x16x32_bf16 a[108:111],v[204:207],v[236:239],a[108:111]
s_add_u32 m0,s80,70656
s_add_u32 s81,s81,s68
buffer_load_dwordx4 v4,s[56:59],s81 offen lds
s_add_u32 s76,s76,s70
v_mfma_f32_16x16x32_bf16 a[128:131],v[192:195],v[240:243],a[128:131]
ds_read_b64_tr_b16 v[174:175],v19 offset:1024
v_mfma_f32_16x16x32_bf16 a[132:135],v[196:199],v[240:243],a[132:135]
ds_read_b64_tr_b16 v[176:177],v20 offset:0
v_mfma_f32_16x16x32_bf16 a[136:139],v[200:203],v[240:243],a[136:139]
ds_read_b64_tr_b16 v[178:179],v20 offset:1024
v_mfma_f32_16x16x32_bf16 a[140:143],v[204:207],v[240:243],a[140:143]
s_add_u32 m0,s79,65536
s_add_u32 s81,s75,17408
buffer_load_dwordx4 v3,s[8:11],s81 offen sc1 lds
v_mfma_f32_16x16x32_bf16 a[160:163],v[192:195],v[244:247],a[160:163]
ds_read_b64_tr_b16 v[180:181],v21 offset:0
v_mfma_f32_16x16x32_bf16 a[164:167],v[196:199],v[244:247],a[164:167]
ds_read_b64_tr_b16 v[182:183],v21 offset:1024
v_mfma_f32_16x16x32_bf16 a[168:171],v[200:203],v[244:247],a[168:171]
ds_read_b64_tr_b16 v[184:185],v22 offset:0
v_mfma_f32_16x16x32_bf16 a[172:175],v[204:207],v[244:247],a[172:175]
s_add_u32 m0,s79,66560
s_add_u32 s81,s75,35840
buffer_load_dwordx4 v3,s[8:11],s81 offen sc1 lds
v_mfma_f32_16x16x32_bf16 a[192:195],v[192:195],v[248:251],a[192:195]
ds_read_b64_tr_b16 v[186:187],v22 offset:1024
v_mfma_f32_16x16x32_bf16 a[196:199],v[196:199],v[248:251],a[196:199]
ds_read_b64_tr_b16 v[188:189],v23 offset:0
v_mfma_f32_16x16x32_bf16 a[200:203],v[200:203],v[248:251],a[200:203]
ds_read_b64_tr_b16 v[190:191],v23 offset:1024
v_mfma_f32_16x16x32_bf16 a[204:207],v[204:207],v[248:251],a[204:207]
s_add_u32 m0,s79,67584
s_add_u32 s81,s75,54272
buffer_load_dwordx4 v3,s[8:11],s81 offen sc1 lds
v_mfma_f32_16x16x32_bf16 a[224:227],v[192:195],v[252:255],a[224:227]
v_mfma_f32_16x16x32_bf16 a[228:231],v[196:199],v[252:255],a[228:231]
v_mfma_f32_16x16x32_bf16 a[232:235],v[200:203],v[252:255],a[232:235]
v_mfma_f32_16x16x32_bf16 a[236:239],v[204:207],v[252:255],a[236:239]
s_add_u32 m0,s79,68608
s_add_u32 s81,s75,72704
buffer_load_dwordx4 v3,s[8:11],s81 offen sc1 lds
s_waitcnt vmcnt(16) lgkmcnt(0)
s_barrier
v_mfma_f32_16x16x32_bf16 a[0:3],v[128:131],v[160:163],a[0:3]
v_add_u32 v8,0,v5
v_mfma_f32_16x16x32_bf16 a[4:7],v[132:135],v[160:163],a[4:7]
ds_read_b128 v[192:195],v8 offset:0
v_add_u32 v16,16384,v24
v_add_u32 v17,16384,v25
v_mfma_f32_16x16x32_bf16 a[8:11],v[136:139],v[160:163],a[8:11]
ds_read_b128 v[196:199],v8 offset:1024
v_add_u32 v18,16384,v26
v_add_u32 v19,16384,v27
v_mfma_f32_16x16x32_bf16 a[12:15],v[140:143],v[160:163],a[12:15]
ds_read_b128 v[200:203],v8 offset:2048
v_add_u32 v20,16384,v28
v_add_u32 v21,16384,v29
v_mfma_f32_16x16x32_bf16 a[32:35],v[128:131],v[164:167],a[32:35]
ds_read_b128 v[204:207],v8 offset:3072
v_add_u32 v22,16384,v30
v_add_u32 v23,16384,v31
v_mfma_f32_16x16x32_bf16 a[36:39],v[132:135],v[164:167],a[36:39]
ds_read_b64_tr_b16 v[224:225],v16 offset:0
v_mfma_f32_16x16x32_bf16 a[40:43],v[136:139],v[164:167],a[40:43]
ds_read_b64_tr_b16 v[226:227],v16 offset:1024
v_mfma_f32_16x16x32_bf16 a[44:47],v[140:143],v[164:167],a[44:47]
ds_read_b64_tr_b16 v[228:229],v17 offset:0
v_mfma_f32_16x16x32_bf16 a[64:67],v[128:131],v[168:171],a[64:67]
ds_read_b64_tr_b16 v[230:231],v17 offset:1024
v_mfma_f32_16x16x32_bf16 a[68:71],v[132:135],v[168:171],a[68:71]
ds_read_b64_tr_b16 v[232:233],v18 offset:0
v_mfma_f32_16x16x32_bf16 a[72:75],v[136:139],v[168:171],a[72:75]
ds_read_b64_tr_b16 v[234:235],v18 offset:1024
v_mfma_f32_16x16x32_bf16 a[76:79],v[140:143],v[168:171],a[76:79]
ds_read_b64_tr_b16 v[236:237],v19 offset:0
v_mfma_f32_16x16x32_bf16 a[96:99],v[128:131],v[172:175],a[96:99]
ds_read_b64_tr_b16 v[238:239],v19 offset:1024
v_mfma_f32_16x16x32_bf16 a[100:103],v[132:135],v[172:175],a[100:103]
ds_read_b64_tr_b16 v[240:241],v20 offset:0
v_mfma_f32_16x16x32_bf16 a[104:107],v[136:139],v[172:175],a[104:107]
ds_read_b64_tr_b16 v[242:243],v20 offset:1024
v_mfma_f32_16x16x32_bf16 a[108:111],v[140:143],v[172:175],a[108:111]
ds_read_b64_tr_b16 v[244:245],v21 offset:0
v_mfma_f32_16x16x32_bf16 a[128:131],v[128:131],v[176:179],a[128:131]
ds_read_b64_tr_b16 v[246:247],v21 offset:1024
v_mfma_f32_16x16x32_bf16 a[132:135],v[132:135],v[176:179],a[132:135]
ds_read_b64_tr_b16 v[248:249],v22 offset:0
v_mfma_f32_16x16x32_bf16 a[136:139],v[136:139],v[176:179],a[136:139]
ds_read_b64_tr_b16 v[250:251],v22 offset:1024
v_mfma_f32_16x16x32_bf16 a[140:143],v[140:143],v[176:179],a[140:143]
ds_read_b64_tr_b16 v[252:253],v23 offset:0
v_mfma_f32_16x16x32_bf16 a[160:163],v[128:131],v[180:183],a[160:163]
ds_read_b64_tr_b16 v[254:255],v23 offset:1024
v_mfma_f32_16x16x32_bf16 a[164:167],v[132:135],v[180:183],a[164:167]
v_mfma_f32_16x16x32_bf16 a[168:171],v[136:139],v[180:183],a[168:171]
v_mfma_f32_16x16x32_bf16 a[172:175],v[140:143],v[180:183],a[172:175]
v_mfma_f32_16x16x32_bf16 a[192:195],v[128:131],v[184:187],a[192:195]
v_mfma_f32_16x16x32_bf16 a[196:199],v[132:135],v[184:187],a[196:199]
v_mfma_f32_16x16x32_bf16 a[200:203],v[136:139],v[184:187],a[200:203]
v_mfma_f32_16x16x32_bf16 a[204:207],v[140:143],v[184:187],a[204:207]
v_mfma_f32_16x16x32_bf16 a[224:227],v[128:131],v[188:191],a[224:227]
v_mfma_f32_16x16x32_bf16 a[228:231],v[132:135],v[188:191],a[228:231]
v_mfma_f32_16x16x32_bf16 a[232:235],v[136:139],v[188:191],a[232:235]
v_mfma_f32_16x16x32_bf16 a[236:239],v[140:143],v[188:191],a[236:239]
s_waitcnt vmcnt(8) lgkmcnt(0)
s_barrier
v_mfma_f32_16x16x32_bf16 a[0:3],v[192:195],v[224:227],a[0:3]
v_add_u32 v8,32768,v5
v_mfma_f32_16x16x32_bf16 a[4:7],v[196:199],v[224:227],a[4:7]
ds_read_b128 v[128:131],v8 offset:0
v_add_u32 v16,49152,v24
v_add_u32 v17,49152,v25
v_mfma_f32_16x16x32_bf16 a[8:11],v[200:203],v[224:227],a[8:11]
ds_read_b128 v[132:135],v8 offset:1024
v_add_u32 v18,49152,v26
v_add_u32 v19,49152,v27
v_mfma_f32_16x16x32_bf16 a[12:15],v[204:207],v[224:227],a[12:15]
ds_read_b128 v[136:139],v8 offset:2048
v_add_u32 v20,49152,v28
v_add_u32 v21,49152,v29
v_mfma_f32_16x16x32_bf16 a[32:35],v[192:195],v[228:231],a[32:35]
ds_read_b128 v[140:143],v8 offset:3072
v_add_u32 v22,49152,v30
v_add_u32 v23,49152,v31
v_mfma_f32_16x16x32_bf16 a[36:39],v[196:199],v[228:231],a[36:39]
ds_read_b64_tr_b16 v[160:161],v16 offset:0
v_mfma_f32_16x16x32_bf16 a[40:43],v[200:203],v[228:231],a[40:43]
ds_read_b64_tr_b16 v[162:163],v16 offset:1024
v_mfma_f32_16x16x32_bf16 a[44:47],v[204:207],v[228:231],a[44:47]
ds_read_b64_tr_b16 v[164:165],v17 offset:0
v_mfma_f32_16x16x32_bf16 a[64:67],v[192:195],v[232:235],a[64:67]
ds_read_b64_tr_b16 v[166:167],v17 offset:1024
v_mfma_f32_16x16x32_bf16 a[68:71],v[196:199],v[232:235],a[68:71]
ds_read_b64_tr_b16 v[168:169],v18 offset:0
v_mfma_f32_16x16x32_bf16 a[72:75],v[200:203],v[232:235],a[72:75]
ds_read_b64_tr_b16 v[170:171],v18 offset:1024
v_mfma_f32_16x16x32_bf16 a[76:79],v[204:207],v[232:235],a[76:79]
ds_read_b64_tr_b16 v[172:173],v19 offset:0
v_mfma_f32_16x16x32_bf16 a[96:99],v[192:195],v[236:239],a[96:99]
ds_read_b64_tr_b16 v[174:175],v19 offset:1024
v_mfma_f32_16x16x32_bf16 a[100:103],v[196:199],v[236:239],a[100:103]
ds_read_b64_tr_b16 v[176:177],v20 offset:0
v_mfma_f32_16x16x32_bf16 a[104:107],v[200:203],v[236:239],a[104:107]
ds_read_b64_tr_b16 v[178:179],v20 offset:1024
v_mfma_f32_16x16x32_bf16 a[108:111],v[204:207],v[236:239],a[108:111]
ds_read_b64_tr_b16 v[180:181],v21 offset:0
v_mfma_f32_16x16x32_bf16 a[128:131],v[192:195],v[240:243],a[128:131]
ds_read_b64_tr_b16 v[182:183],v21 offset:1024
v_mfma_f32_16x16x32_bf16 a[132:135],v[196:199],v[240:243],a[132:135]
ds_read_b64_tr_b16 v[184:185],v22 offset:0
v_mfma_f32_16x16x32_bf16 a[136:139],v[200:203],v[240:243],a[136:139]
ds_read_b64_tr_b16 v[186:187],v22 offset:1024
v_mfma_f32_16x16x32_bf16 a[140:143],v[204:207],v[240:243],a[140:143]
ds_read_b64_tr_b16 v[188:189],v23 offset:0
v_mfma_f32_16x16x32_bf16 a[160:163],v[192:195],v[244:247],a[160:163]
ds_read_b64_tr_b16 v[190:191],v23 offset:1024
v_mfma_f32_16x16x32_bf16 a[164:167],v[196:199],v[244:247],a[164:167]
s_mov_b64 exec,s[64:65]
ds_write_b32 v11,v9
s_mov_b64 exec,-1
v_mfma_f32_16x16x32_bf16 a[168:171],v[200:203],v[244:247],a[168:171]
v_mfma_f32_16x16x32_bf16 a[172:175],v[204:207],v[244:247],a[172:175]
v_mfma_f32_16x16x32_bf16 a[192:195],v[192:195],v[248:251],a[192:195]
v_mfma_f32_16x16x32_bf16 a[196:199],v[196:199],v[248:251],a[196:199]
v_mfma_f32_16x16x32_bf16 a[200:203],v[200:203],v[248:251],a[200:203]
v_mfma_f32_16x16x32_bf16 a[204:207],v[204:207],v[248:251],a[204:207]
v_mfma_f32_16x16x32_bf16 a[224:227],v[192:195],v[252:255],a[224:227]
v_mfma_f32_16x16x32_bf16 a[228:231],v[196:199],v[252:255],a[228:231]
v_mfma_f32_16x16x32_bf16 a[232:235],v[200:203],v[252:255],a[232:235]
v_mfma_f32_16x16x32_bf16 a[236:239],v[204:207],v[252:255],a[236:239]
s_waitcnt vmcnt(0) lgkmcnt(0)
s_barrier
v_mfma_f32_16x16x32_bf16 a[0:3],v[128:131],v[160:163],a[0:3]
v_add_u32 v8,65536,v5
v_mfma_f32_16x16x32_bf16 a[4:7],v[132:135],v[160:163],a[4:7]
ds_read_b128 v[192:195],v8 offset:0
v_add_u32 v16,81920,v24
v_add_u32 v17,81920,v25
v_mfma_f32_16x16x32_bf16 a[8:11],v[136:139],v[160:163],a[8:11]
ds_read_b128 v[196:199],v8 offset:1024
v_add_u32 v18,81920,v26
v_add_u32 v19,81920,v27
v_mfma_f32_16x16x32_bf16 a[12:15],v[140:143],v[160:163],a[12:15]
ds_read_b128 v[200:203],v8 offset:2048
v_add_u32 v20,81920,v28
v_add_u32 v21,81920,v29
v_mfma_f32_16x16x32_bf16 a[32:35],v[128:131],v[164:167],a[32:35]
ds_read_b128 v[204:207],v8 offset:3072
v_add_u32 v22,81920,v30
v_add_u32 v23,81920,v31
v_mfma_f32_16x16x32_bf16 a[36:39],v[132:135],v[164:167],a[36:39]
ds_read_b64_tr_b16 v[224:225],v16 offset:0
v_mfma_f32_16x16x32_bf16 a[40:43],v[136:139],v[164:167],a[40:43]
ds_read_b64_tr_b16 v[226:227],v16 offset:1024
v_mfma_f32_16x16x32_bf16 a[44:47],v[140:143],v[164:167],a[44:47]
ds_read_b64_tr_b16 v[228:229],v17 offset:0
v_mfma_f32_16x16x32_bf16 a[64:67],v[128:131],v[168:171],a[64:67]
ds_read_b64_tr_b16 v[230:231],v17 offset:1024
v_mfma_f32_16x16x32_bf16 a[68:71],v[132:135],v[168:171],a[68:71]
ds_read_b64_tr_b16 v[232:233],v18 offset:0
v_mfma_f32_16x16x32_bf16 a[72:75],v[136:139],v[168:171],a[72:75]
ds_read_b64_tr_b16 v[234:235],v18 offset:1024
v_mfma_f32_16x16x32_bf16 a[76:79],v[140:143],v[168:171],a[76:79]
ds_read_b64_tr_b16 v[236:237],v19 offset:0
v_mfma_f32_16x16x32_bf16 a[96:99],v[128:131],v[172:175],a[96:99]
ds_read_b64_tr_b16 v[238:239],v19 offset:1024
v_mfma_f32_16x16x32_bf16 a[100:103],v[132:135],v[172:175],a[100:103]
ds_read_b64_tr_b16 v[240:241],v20 offset:0
v_mfma_f32_16x16x32_bf16 a[104:107],v[136:139],v[172:175],a[104:107]
ds_read_b64_tr_b16 v[242:243],v20 offset:1024
v_mfma_f32_16x16x32_bf16 a[108:111],v[140:143],v[172:175],a[108:111]
ds_read_b64_tr_b16 v[244:245],v21 offset:0
v_mfma_f32_16x16x32_bf16 a[128:131],v[128:131],v[176:179],a[128:131]
ds_read_b64_tr_b16 v[246:247],v21 offset:1024
v_mfma_f32_16x16x32_bf16 a[132:135],v[132:135],v[176:179],a[132:135]
ds_read_b64_tr_b16 v[248:249],v22 offset:0
v_mfma_f32_16x16x32_bf16 a[136:139],v[136:139],v[176:179],a[136:139]
ds_read_b64_tr_b16 v[250:251],v22 offset:1024
v_mfma_f32_16x16x32_bf16 a[140:143],v[140:143],v[176:179],a[140:143]
ds_read_b64_tr_b16 v[252:253],v23 offset:0
v_mfma_f32_16x16x32_bf16 a[160:163],v[128:131],v[180:183],a[160:163]
ds_read_b64_tr_b16 v[254:255],v23 offset:1024
v_mfma_f32_16x16x32_bf16 a[164:167],v[132:135],v[180:183],a[164:167]
ds_read_b32 v9,v11
v_mfma_f32_16x16x32_bf16 a[168:171],v[136:139],v[180:183],a[168:171]
v_mfma_f32_16x16x32_bf16 a[172:175],v[140:143],v[180:183],a[172:175]
v_mfma_f32_16x16x32_bf16 a[192:195],v[128:131],v[184:187],a[192:195]
v_mfma_f32_16x16x32_bf16 a[196:199],v[132:135],v[184:187],a[196:199]
v_mfma_f32_16x16x32_bf16 a[200:203],v[136:139],v[184:187],a[200:203]
v_mfma_f32_16x16x32_bf16 a[204:207],v[140:143],v[184:187],a[204:207]
v_mfma_f32_16x16x32_bf16 a[224:227],v[128:131],v[188:191],a[224:227]
v_mfma_f32_16x16x32_bf16 a[228:231],v[132:135],v[188:191],a[228:231]
v_mfma_f32_16x16x32_bf16 a[232:235],v[136:139],v[188:191],a[232:235]
v_mfma_f32_16x16x32_bf16 a[236:239],v[140:143],v[188:191],a[236:239]
s_waitcnt lgkmcnt(0)
v_mfma_f32_16x16x32_bf16 a[0:3],v[192:195],v[224:227],a[0:3]
v_mfma_f32_16x16x32_bf16 a[4:7],v[196:199],v[224:227],a[4:7]
v_mfma_f32_16x16x32_bf16 a[8:11],v[200:203],v[224:227],a[8:11]
v_mfma_f32_16x16x32_bf16 a[12:15],v[204:207],v[224:227],a[12:15]
v_mfma_f32_16x16x32_bf16 a[32:35],v[192:195],v[228:231],a[32:35]
v_mfma_f32_16x16x32_bf16 a[36:39],v[196:199],v[228:231],a[36:39]
v_mfma_f32_16x16x32_bf16 a[40:43],v[200:203],v[228:231],a[40:43]
v_mfma_f32_16x16x32_bf16 a[44:47],v[204:207],v[228:231],a[44:47]
v_mfma_f32_16x16x32_bf16 a[64:67],v[192:195],v[232:235],a[64:67]
v_mfma_f32_16x16x32_bf16 a[68:71],v[196:199],v[232:235],a[68:71]
v_mfma_f32_16x16x32_bf16 a[72:75],v[200:203],v[232:235],a[72:75]
v_mfma_f32_16x16x32_bf16 a[76:79],v[204:207],v[232:235],a[76:79]
v_mfma_f32_16x16x32_bf16 a[96:99],v[192:195],v[236:239],a[96:99]
v_mfma_f32_16x16x32_bf16 a[100:103],v[196:199],v[236:239],a[100:103]
v_mfma_f32_16x16x32_bf16 a[104:107],v[200:203],v[236:239],a[104:107]
v_mfma_f32_16x16x32_bf16 a[108:111],v[204:207],v[236:239],a[108:111]
v_mfma_f32_16x16x32_bf16 a[128:131],v[192:195],v[240:243],a[128:131]
v_mfma_f32_16x16x32_bf16 a[132:135],v[196:199],v[240:243],a[132:135]
v_mfma_f32_16x16x32_bf16 a[136:139],v[200:203],v[240:243],a[136:139]
v_mfma_f32_16x16x32_bf16 a[140:143],v[204:207],v[240:243],a[140:143]
v_mfma_f32_16x16x32_bf16 a[160:163],v[192:195],v[244:247],a[160:163]
v_mfma_f32_16x16x32_bf16 a[164:167],v[196:199],v[244:247],a[164:167]
v_mfma_f32_16x16x32_bf16 a[168:171],v[200:203],v[244:247],a[168:171]
v_mfma_f32_16x16x32_bf16 a[172:175],v[204:207],v[244:247],a[172:175]
v_mfma_f32_16x16x32_bf16 a[192:195],v[192:195],v[248:251],a[192:195]
v_mfma_f32_16x16x32_bf16 a[196:199],v[196:199],v[248:251],a[196:199]
v_mfma_f32_16x16x32_bf16 a[200:203],v[200:203],v[248:251],a[200:203]
v_mfma_f32_16x16x32_bf16 a[204:207],v[204:207],v[248:251],a[204:207]
v_mfma_f32_16x16x32_bf16 a[224:227],v[192:195],v[252:255],a[224:227]
v_mfma_f32_16x16x32_bf16 a[228:231],v[196:199],v[252:255],a[228:231]
v_mfma_f32_16x16x32_bf16 a[232:235],v[200:203],v[252:255],a[232:235]
v_mfma_f32_16x16x32_bf16 a[236:239],v[204:207],v[252:255],a[236:239]
s_nop 7
v_accvgpr_read_b32 v32,a0
v_accvgpr_read_b32 v33,a1
v_accvgpr_read_b32 v34,a2
v_accvgpr_read_b32 v35,a3
v_accvgpr_read_b32 v36,a4
v_accvgpr_read_b32 v37,a5
v_accvgpr_read_b32 v38,a6
v_accvgpr_read_b32 v39,a7
s_add_u32 s81,s83,0
v_cvt_pk_bf16_f32 v40,v32,v33
v_cvt_pk_bf16_f32 v41,v34,v35
v_cvt_pk_bf16_f32 v42,v36,v37
v_cvt_pk_bf16_f32 v43,v38,v39
buffer_store_dwordx4 v[40:43],v3,s[8:11],s81 offen offset:0 sc1
v_accvgpr_read_b32 v44,a32
v_accvgpr_read_b32 v45,a33
v_accvgpr_read_b32 v46,a34
v_accvgpr_read_b32 v47,a35
v_accvgpr_read_b32 v48,a36
v_accvgpr_read_b32 v49,a37
v_accvgpr_read_b32 v50,a38
v_accvgpr_read_b32 v51,a39
v_cvt_pk_bf16_f32 v52,v44,v45
v_cvt_pk_bf16_f32 v53,v46,v47
v_cvt_pk_bf16_f32 v54,v48,v49
v_cvt_pk_bf16_f32 v55,v50,v51
buffer_store_dwordx4 v[52:55],v3,s[8:11],s81 offen offset:1024 sc1
v_accvgpr_read_b32 v56,a64
v_accvgpr_read_b32 v57,a65
v_accvgpr_read_b32 v58,a66
v_accvgpr_read_b32 v59,a67
v_accvgpr_read_b32 v60,a68
v_accvgpr_read_b32 v61,a69
v_accvgpr_read_b32 v62,a70
v_accvgpr_read_b32 v63,a71
v_cvt_pk_bf16_f32 v64,v56,v57
v_cvt_pk_bf16_f32 v65,v58,v59
v_cvt_pk_bf16_f32 v66,v60,v61
v_cvt_pk_bf16_f32 v67,v62,v63
buffer_store_dwordx4 v[64:67],v3,s[8:11],s81 offen offset:2048 sc1
v_accvgpr_read_b32 v68,a96
v_accvgpr_read_b32 v69,a97
v_accvgpr_read_b32 v70,a98
v_accvgpr_read_b32 v71,a99
v_accvgpr_read_b32 v72,a100
v_accvgpr_read_b32 v73,a101
v_accvgpr_read_b32 v74,a102
v_accvgpr_read_b32 v75,a103
v_cvt_pk_bf16_f32 v76,v68,v69
v_cvt_pk_bf16_f32 v77,v70,v71
v_cvt_pk_bf16_f32 v78,v72,v73
v_cvt_pk_bf16_f32 v79,v74,v75
buffer_store_dwordx4 v[76:79],v3,s[8:11],s81 offen offset:3072 sc1
v_accvgpr_read_b32 v32,a128
v_accvgpr_read_b32 v33,a129
v_accvgpr_read_b32 v34,a130
v_accvgpr_read_b32 v35,a131
v_accvgpr_read_b32 v36,a132
v_accvgpr_read_b32 v37,a133
v_accvgpr_read_b32 v38,a134
v_accvgpr_read_b32 v39,a135
s_add_u32 s81,s83,4096
v_cvt_pk_bf16_f32 v40,v32,v33
v_cvt_pk_bf16_f32 v41,v34,v35
v_cvt_pk_bf16_f32 v42,v36,v37
v_cvt_pk_bf16_f32 v43,v38,v39
buffer_store_dwordx4 v[40:43],v3,s[8:11],s81 offen offset:0 sc1
v_accvgpr_read_b32 v44,a160
v_accvgpr_read_b32 v45,a161
v_accvgpr_read_b32 v46,a162
v_accvgpr_read_b32 v47,a163
v_accvgpr_read_b32 v48,a164
v_accvgpr_read_b32 v49,a165
v_accvgpr_read_b32 v50,a166
v_accvgpr_read_b32 v51,a167
v_cvt_pk_bf16_f32 v52,v44,v45
v_cvt_pk_bf16_f32 v53,v46,v47
v_cvt_pk_bf16_f32 v54,v48,v49
v_cvt_pk_bf16_f32 v55,v50,v51
buffer_store_dwordx4 v[52:55],v3,s[8:11],s81 offen offset:1024 sc1
v_accvgpr_read_b32 v56,a192
v_accvgpr_read_b32 v57,a193
v_accvgpr_read_b32 v58,a194
v_accvgpr_read_b32 v59,a195
v_accvgpr_read_b32 v60,a196
v_accvgpr_read_b32 v61,a197
v_accvgpr_read_b32 v62,a198
v_accvgpr_read_b32 v63,a199
v_cvt_pk_bf16_f32 v64,v56,v57
v_cvt_pk_bf16_f32 v65,v58,v59
v_cvt_pk_bf16_f32 v66,v60,v61
v_cvt_pk_bf16_f32 v67,v62,v63
buffer_store_dwordx4 v[64:67],v3,s[8:11],s81 offen offset:2048 sc1
v_accvgpr_read_b32 v68,a224
v_accvgpr_read_b32 v69,a225
v_accvgpr_read_b32 v70,a226
v_accvgpr_read_b32 v71,a227
v_accvgpr_read_b32 v72,a228
v_accvgpr_read_b32 v73,a229
v_accvgpr_read_b32 v74,a230
v_accvgpr_read_b32 v75,a231
v_cvt_pk_bf16_f32 v76,v68,v69
v_cvt_pk_bf16_f32 v77,v70,v71
v_cvt_pk_bf16_f32 v78,v72,v73
v_cvt_pk_bf16_f32 v79,v74,v75
buffer_store_dwordx4 v[76:79],v3,s[8:11],s81 offen offset:3072 sc1
v_accvgpr_read_b32 v32,a8
v_accvgpr_read_b32 v33,a9
v_accvgpr_read_b32 v34,a10
v_accvgpr_read_b32 v35,a11
v_accvgpr_read_b32 v36,a12
v_accvgpr_read_b32 v37,a13
v_accvgpr_read_b32 v38,a14
v_accvgpr_read_b32 v39,a15
s_add_u32 s81,s83,262144
v_cvt_pk_bf16_f32 v40,v32,v33
v_cvt_pk_bf16_f32 v41,v34,v35
v_cvt_pk_bf16_f32 v42,v36,v37
v_cvt_pk_bf16_f32 v43,v38,v39
buffer_store_dwordx4 v[40:43],v3,s[8:11],s81 offen offset:0 sc1
v_accvgpr_read_b32 v44,a40
v_accvgpr_read_b32 v45,a41
v_accvgpr_read_b32 v46,a42
v_accvgpr_read_b32 v47,a43
v_accvgpr_read_b32 v48,a44
v_accvgpr_read_b32 v49,a45
v_accvgpr_read_b32 v50,a46
v_accvgpr_read_b32 v51,a47
v_cvt_pk_bf16_f32 v52,v44,v45
v_cvt_pk_bf16_f32 v53,v46,v47
v_cvt_pk_bf16_f32 v54,v48,v49
v_cvt_pk_bf16_f32 v55,v50,v51
buffer_store_dwordx4 v[52:55],v3,s[8:11],s81 offen offset:1024 sc1
v_accvgpr_read_b32 v56,a72
v_accvgpr_read_b32 v57,a73
v_accvgpr_read_b32 v58,a74
v_accvgpr_read_b32 v59,a75
v_accvgpr_read_b32 v60,a76
v_accvgpr_read_b32 v61,a77
v_accvgpr_read_b32 v62,a78
v_accvgpr_read_b32 v63,a79
v_cvt_pk_bf16_f32 v64,v56,v57
v_cvt_pk_bf16_f32 v65,v58,v59
v_cvt_pk_bf16_f32 v66,v60,v61
v_cvt_pk_bf16_f32 v67,v62,v63
buffer_store_dwordx4 v[64:67],v3,s[8:11],s81 offen offset:2048 sc1
v_accvgpr_read_b32 v68,a104
v_accvgpr_read_b32 v69,a105
v_accvgpr_read_b32 v70,a106
v_accvgpr_read_b32 v71,a107
v_accvgpr_read_b32 v72,a108
v_accvgpr_read_b32 v73,a109
v_accvgpr_read_b32 v74,a110
v_accvgpr_read_b32 v75,a111
v_cvt_pk_bf16_f32 v76,v68,v69
v_cvt_pk_bf16_f32 v77,v70,v71
v_cvt_pk_bf16_f32 v78,v72,v73
v_cvt_pk_bf16_f32 v79,v74,v75
buffer_store_dwordx4 v[76:79],v3,s[8:11],s81 offen offset:3072 sc1
v_accvgpr_read_b32 v32,a136
v_accvgpr_read_b32 v33,a137
v_accvgpr_read_b32 v34,a138
v_accvgpr_read_b32 v35,a139
v_accvgpr_read_b32 v36,a140
v_accvgpr_read_b32 v37,a141
v_accvgpr_read_b32 v38,a142
v_accvgpr_read_b32 v39,a143
s_add_u32 s81,s83,266240
v_cvt_pk_bf16_f32 v40,v32,v33
v_cvt_pk_bf16_f32 v41,v34,v35
v_cvt_pk_bf16_f32 v42,v36,v37
v_cvt_pk_bf16_f32 v43,v38,v39
buffer_store_dwordx4 v[40:43],v3,s[8:11],s81 offen offset:0 sc1
v_accvgpr_read_b32 v44,a168
v_accvgpr_read_b32 v45,a169
v_accvgpr_read_b32 v46,a170
v_accvgpr_read_b32 v47,a171
v_accvgpr_read_b32 v48,a172
v_accvgpr_read_b32 v49,a173
v_accvgpr_read_b32 v50,a174
v_accvgpr_read_b32 v51,a175
v_cvt_pk_bf16_f32 v52,v44,v45
v_cvt_pk_bf16_f32 v53,v46,v47
v_cvt_pk_bf16_f32 v54,v48,v49
v_cvt_pk_bf16_f32 v55,v50,v51
buffer_store_dwordx4 v[52:55],v3,s[8:11],s81 offen offset:1024 sc1
v_accvgpr_read_b32 v56,a200
v_accvgpr_read_b32 v57,a201
v_accvgpr_read_b32 v58,a202
v_accvgpr_read_b32 v59,a203
v_accvgpr_read_b32 v60,a204
v_accvgpr_read_b32 v61,a205
v_accvgpr_read_b32 v62,a206
v_accvgpr_read_b32 v63,a207
v_cvt_pk_bf16_f32 v64,v56,v57
v_cvt_pk_bf16_f32 v65,v58,v59
v_cvt_pk_bf16_f32 v66,v60,v61
v_cvt_pk_bf16_f32 v67,v62,v63
buffer_store_dwordx4 v[64:67],v3,s[8:11],s81 offen offset:2048 sc1
v_accvgpr_read_b32 v68,a232
v_accvgpr_read_b32 v69,a233
v_accvgpr_read_b32 v70,a234
v_accvgpr_read_b32 v71,a235
v_accvgpr_read_b32 v72,a236
v_accvgpr_read_b32 v73,a237
v_accvgpr_read_b32 v74,a238
v_accvgpr_read_b32 v75,a239
v_cvt_pk_bf16_f32 v76,v68,v69
v_cvt_pk_bf16_f32 v77,v70,v71
v_cvt_pk_bf16_f32 v78,v72,v73
v_cvt_pk_bf16_f32 v79,v74,v75
buffer_store_dwordx4 v[76:79],v3,s[8:11],s81 offen offset:3072 sc1
Lg1_xe:
s_waitcnt vmcnt(0)
s_barrier
s_cmp_lg_u32 s60,0
s_cbranch_scc1 Lsg_g1x
v_mov_b32 v1,1
v_mov_b32 v2,0
s_mov_b64 exec,1
buffer_atomic_add v1,v2,s[8:11],s87 offen
s_mov_b64 exec,-1
Lsg_g1x:
v_readfirstlane_b32 s66,v9
s_lshr_b32 s81,s60,1
s_lshl_b32 s81,s81,13
v_add_u32 v5,s81,v3
s_branch Lg1_fresh
Lg1_done:
L_g1done:
s_barrier
s_cmp_lg_u32 s60,0
s_cbranch_scc1 Lat_peek
v_mov_b32 v1,0
v_mov_b32 v2,0
s_mov_b64 exec,1
buffer_atomic_add v1,v2,s[32:35],0 offen offset:0 sc0
s_waitcnt vmcnt(0)
ds_write_b32 v2,v1
s_mov_b64 exec,-1
s_waitcnt lgkmcnt(0)
Lat_peek:
s_barrier
v_mov_b32 v2,0
ds_read_b32 v1,v2
s_waitcnt lgkmcnt(0)
v_readfirstlane_b32 s64,v1
s_barrier
s_cmp_eq_u32 s64,-1
s_cbranch_scc1 L_p23
s_ff0_i32_b32 s61,s64
s_mov_b32 s3,1
s_branch L_rec2
L_p23:
s_add_u32 s84,s62,6
s_mul_hi_u32 s64,s84,613566757
s_mul_i32 s64,s64,7
s_sub_u32 s84,s84,s64
L_p23q:
s_lshl_b32 s86,s84,2
s_barrier
s_cmp_lg_u32 s60,0
s_cbranch_scc1 Lat_p23
v_mov_b32 v1,1
v_mov_b32 v2,0
s_mov_b64 exec,1
buffer_atomic_add v1,v2,s[32:35],s86 offen offset:64 sc0
s_waitcnt vmcnt(0)
ds_write_b32 v2,v1
s_mov_b64 exec,-1
s_waitcnt lgkmcnt(0)
Lat_p23:
s_barrier
v_mov_b32 v2,0
ds_read_b32 v1,v2
s_waitcnt lgkmcnt(0)
v_readfirstlane_b32 s65,v1
s_barrier
s_cmp_lt_u32 s65,31
s_cbranch_scc1 L_p23go
s_cmp_lg_u32 s60,0
s_cbranch_scc1 Lst_p23
v_and_b32 v1,7,v0
v_lshlrev_b32 v1,2,v1
buffer_load_dword v2,v1,s[32:35],0 offen offset:64 sc1
s_waitcnt vmcnt(0)
s_waitcnt vmcnt(0)
v_cmp_gt_u32 vcc,31,v2
s_and_b32 s67,vcc_lo,0x7f
v_mov_b32 v2,s67
v_mov_b32 v1,0
ds_write_b32 v1,v2
s_waitcnt lgkmcnt(0)
Lst_p23:
s_barrier
v_mov_b32 v1,0
ds_read_b32 v2,v1
s_waitcnt lgkmcnt(0)
v_readfirstlane_b32 s67,v2
s_barrier
s_cmp_eq_u32 s67,0
s_cbranch_scc1 L_fin
s_ff1_i32_b32 s84,s67
s_branch L_p23q
L_p23go:
s_mul_i32 s64,s84,31
s_add_u32 s64,s64,s65
s_cmp_ge_u32 s64,216
s_cbranch_scc1 L_p23q
s_mul_hi_u32 s72,s64,238609295
s_mul_i32 s75,s72,18
s_sub_u32 s73,s64,s75
v_and_b32 v11,63,v0
v_lshlrev_b32 v3,4,v11

v_lshrrev_b32 v12,2,v11
v_mul_u32_u24 v12,1152,v12
v_and_b32 v13,3,v11
v_lshl_add_u32 v4,v13,4,v12

v_lshrrev_b32 v12,2,v11
v_lshlrev_b32 v12,6,v12
v_lshl_add_u32 v12,v13,3,v12
s_mul_i32 s75,s60,40960
v_add_u32 v5,s75,v12

v_and_b32 v12,15,v11
s_and_b32 s75,s60,1
s_lshl_b32 s75,s75,4
v_add_u32 v12,s75,v12
v_mul_u32_u24 v12,1152,v12
v_lshrrev_b32 v13,4,v11
v_lshl_add_u32 v12,v13,3,v12
s_lshl_b32 s75,s73,6
s_lshr_b32 s81,s60,1
s_lshl_b32 s81,s81,5
s_add_u32 s75,s75,s81
v_add_u32 v6,s75,v12
s_mov_b32 s80,0
s_barrier
s_mul_i32 s76,s60,1327104
s_lshl_b32 s75,s73,6
s_add_u32 s76,s76,s75
s_mul_i32 s81,s60,40960
s_add_u32 m0,s81,0
s_add_u32 s75,s76,0
buffer_load_dwordx4 v4,s[48:51],s75 offen lds
s_add_u32 m0,s81,1024
s_add_u32 s75,s76,18432
buffer_load_dwordx4 v4,s[48:51],s75 offen lds
s_add_u32 m0,s81,2048
s_add_u32 s75,s76,36864
buffer_load_dwordx4 v4,s[48:51],s75 offen lds
s_add_u32 m0,s81,3072
s_add_u32 s75,s76,55296
buffer_load_dwordx4 v4,s[48:51],s75 offen lds
s_add_u32 m0,s81,4096
s_add_u32 s75,s76,73728
buffer_load_dwordx4 v4,s[48:51],s75 offen lds
s_add_u32 m0,s81,5120
s_add_u32 s75,s76,92160
buffer_load_dwordx4 v4,s[48:51],s75 offen lds
s_add_u32 m0,s81,6144
s_add_u32 s75,s76,110592
buffer_load_dwordx4 v4,s[48:51],s75 offen lds
s_add_u32 m0,s81,7168
s_add_u32 s75,s76,129024
buffer_load_dwordx4 v4,s[48:51],s75 offen lds
s_add_u32 m0,s81,8192
s_add_u32 s75,s76,147456
buffer_load_dwordx4 v4,s[48:51],s75 offen lds
s_add_u32 m0,s81,9216
s_add_u32 s75,s76,165888
buffer_load_dwordx4 v4,s[48:51],s75 offen lds
s_add_u32 m0,s81,10240
s_add_u32 s75,s76,184320
buffer_load_dwordx4 v4,s[48:51],s75 offen lds
s_add_u32 m0,s81,11264
s_add_u32 s75,s76,202752
buffer_load_dwordx4 v4,s[48:51],s75 offen lds
s_add_u32 m0,s81,12288
s_add_u32 s75,s76,221184
buffer_load_dwordx4 v4,s[48:51],s75 offen lds
s_add_u32 m0,s81,13312
s_add_u32 s75,s76,239616
buffer_load_dwordx4 v4,s[48:51],s75 offen lds
s_add_u32 m0,s81,14336
s_add_u32 s75,s76,258048
buffer_load_dwordx4 v4,s[48:51],s75 offen lds
s_add_u32 m0,s81,15360
s_add_u32 s75,s76,276480
buffer_load_dwordx4 v4,s[48:51],s75 offen lds
s_add_u32 m0,s81,16384
s_add_u32 s75,s76,294912
buffer_load_dwordx4 v4,s[48:51],s75 offen lds
s_add_u32 m0,s81,17408
s_add_u32 s75,s76,313344
buffer_load_dwordx4 v4,s[48:51],s75 offen lds
s_add_u32 m0,s81,18432
s_add_u32 s75,s76,331776
buffer_load_dwordx4 v4,s[48:51],s75 offen lds
s_add_u32 m0,s81,19456
s_add_u32 s75,s76,350208
buffer_load_dwordx4 v4,s[48:51],s75 offen lds
s_add_u32 m0,s81,20480
s_add_u32 s75,s76,368640
buffer_load_dwordx4 v4,s[48:51],s75 offen lds
s_add_u32 m0,s81,21504
s_add_u32 s75,s76,387072
buffer_load_dwordx4 v4,s[48:51],s75 offen lds
s_add_u32 m0,s81,22528
s_add_u32 s75,s76,405504
buffer_load_dwordx4 v4,s[48:51],s75 offen lds
s_add_u32 m0,s81,23552
s_add_u32 s75,s76,423936
buffer_load_dwordx4 v4,s[48:51],s75 offen lds
s_add_u32 m0,s81,24576
s_add_u32 s75,s76,442368
buffer_load_dwordx4 v4,s[48:51],s75 offen lds
s_add_u32 m0,s81,25600
s_add_u32 s75,s76,460800
buffer_load_dwordx4 v4,s[48:51],s75 offen lds
s_add_u32 m0,s81,26624
s_add_u32 s75,s76,479232
buffer_load_dwordx4 v4,s[48:51],s75 offen lds
s_add_u32 m0,s81,27648
s_add_u32 s75,s76,497664
buffer_load_dwordx4 v4,s[48:51],s75 offen lds
s_add_u32 m0,s81,28672
s_add_u32 s75,s76,516096
buffer_load_dwordx4 v4,s[48:51],s75 offen lds
s_add_u32 m0,s81,29696
s_add_u32 s75,s76,534528
buffer_load_dwordx4 v4,s[48:51],s75 offen lds
s_add_u32 m0,s81,30720
s_add_u32 s75,s76,552960
buffer_load_dwordx4 v4,s[48:51],s75 offen lds
s_add_u32 m0,s81,31744
s_add_u32 s75,s76,571392
buffer_load_dwordx4 v4,s[48:51],s75 offen lds
s_waitcnt vmcnt(30)
ds_read_b64_tr_b16 a[0:1],v5 offset:0
ds_read_b64_tr_b16 a[2:3],v5 offset:1024
ds_read_b64_tr_b16 a[4:5],v5 offset:32
ds_read_b64_tr_b16 a[6:7],v5 offset:1056
s_waitcnt lgkmcnt(0)
s_add_u32 m0,s81,0
s_add_u32 s75,s76,589824
buffer_load_dwordx4 v4,s[48:51],s75 offen lds
s_add_u32 m0,s81,1024
s_add_u32 s75,s76,608256
buffer_load_dwordx4 v4,s[48:51],s75 offen lds
s_waitcnt vmcnt(30)
ds_read_b64_tr_b16 a[8:9],v5 offset:2048
ds_read_b64_tr_b16 a[10:11],v5 offset:3072
ds_read_b64_tr_b16 a[12:13],v5 offset:2080
ds_read_b64_tr_b16 a[14:15],v5 offset:3104
s_waitcnt lgkmcnt(0)
s_add_u32 m0,s81,2048
s_add_u32 s75,s76,626688
buffer_load_dwordx4 v4,s[48:51],s75 offen lds
s_add_u32 m0,s81,3072
s_add_u32 s75,s76,645120
buffer_load_dwordx4 v4,s[48:51],s75 offen lds
s_waitcnt vmcnt(30)
ds_read_b64_tr_b16 a[16:17],v5 offset:4096
ds_read_b64_tr_b16 a[18:19],v5 offset:5120
ds_read_b64_tr_b16 a[20:21],v5 offset:4128
ds_read_b64_tr_b16 a[22:23],v5 offset:5152
s_waitcnt lgkmcnt(0)
s_add_u32 m0,s81,4096
s_add_u32 s75,s76,663552
buffer_load_dwordx4 v4,s[48:51],s75 offen lds
s_add_u32 m0,s81,5120
s_add_u32 s75,s76,681984
buffer_load_dwordx4 v4,s[48:51],s75 offen lds
s_waitcnt vmcnt(30)
ds_read_b64_tr_b16 a[24:25],v5 offset:6144
ds_read_b64_tr_b16 a[26:27],v5 offset:7168
ds_read_b64_tr_b16 a[28:29],v5 offset:6176
ds_read_b64_tr_b16 a[30:31],v5 offset:7200
s_waitcnt lgkmcnt(0)
s_add_u32 m0,s81,6144
s_add_u32 s75,s76,700416
buffer_load_dwordx4 v4,s[48:51],s75 offen lds
s_add_u32 m0,s81,7168
s_add_u32 s75,s76,718848
buffer_load_dwordx4 v4,s[48:51],s75 offen lds
s_waitcnt vmcnt(30)
ds_read_b64_tr_b16 a[32:33],v5 offset:8192
ds_read_b64_tr_b16 a[34:35],v5 offset:9216
ds_read_b64_tr_b16 a[36:37],v5 offset:8224
ds_read_b64_tr_b16 a[38:39],v5 offset:9248
s_waitcnt lgkmcnt(0)
s_add_u32 m0,s81,8192
s_add_u32 s75,s76,737280
buffer_load_dwordx4 v4,s[48:51],s75 offen lds
s_add_u32 m0,s81,9216
s_add_u32 s75,s76,755712
buffer_load_dwordx4 v4,s[48:51],s75 offen lds
s_waitcnt vmcnt(30)
ds_read_b64_tr_b16 a[40:41],v5 offset:10240
ds_read_b64_tr_b16 a[42:43],v5 offset:11264
ds_read_b64_tr_b16 a[44:45],v5 offset:10272
ds_read_b64_tr_b16 a[46:47],v5 offset:11296
s_waitcnt lgkmcnt(0)
s_add_u32 m0,s81,10240
s_add_u32 s75,s76,774144
buffer_load_dwordx4 v4,s[48:51],s75 offen lds
s_add_u32 m0,s81,11264
s_add_u32 s75,s76,792576
buffer_load_dwordx4 v4,s[48:51],s75 offen lds
s_waitcnt vmcnt(30)
ds_read_b64_tr_b16 a[48:49],v5 offset:12288
ds_read_b64_tr_b16 a[50:51],v5 offset:13312
ds_read_b64_tr_b16 a[52:53],v5 offset:12320
ds_read_b64_tr_b16 a[54:55],v5 offset:13344
s_waitcnt lgkmcnt(0)
s_add_u32 m0,s81,12288
s_add_u32 s75,s76,811008
buffer_load_dwordx4 v4,s[48:51],s75 offen lds
s_add_u32 m0,s81,13312
s_add_u32 s75,s76,829440
buffer_load_dwordx4 v4,s[48:51],s75 offen lds
s_waitcnt vmcnt(30)
ds_read_b64_tr_b16 a[56:57],v5 offset:14336
ds_read_b64_tr_b16 a[58:59],v5 offset:15360
ds_read_b64_tr_b16 a[60:61],v5 offset:14368
ds_read_b64_tr_b16 a[62:63],v5 offset:15392
s_waitcnt lgkmcnt(0)
s_add_u32 m0,s81,14336
s_add_u32 s75,s76,847872
buffer_load_dwordx4 v4,s[48:51],s75 offen lds
s_add_u32 m0,s81,15360
s_add_u32 s75,s76,866304
buffer_load_dwordx4 v4,s[48:51],s75 offen lds
s_waitcnt vmcnt(30)
ds_read_b64_tr_b16 a[64:65],v5 offset:16384
ds_read_b64_tr_b16 a[66:67],v5 offset:17408
ds_read_b64_tr_b16 a[68:69],v5 offset:16416
ds_read_b64_tr_b16 a[70:71],v5 offset:17440
s_waitcnt lgkmcnt(0)
s_add_u32 m0,s81,16384
s_add_u32 s75,s76,884736
buffer_load_dwordx4 v4,s[48:51],s75 offen lds
s_add_u32 m0,s81,17408
s_add_u32 s75,s76,903168
buffer_load_dwordx4 v4,s[48:51],s75 offen lds
s_waitcnt vmcnt(30)
ds_read_b64_tr_b16 a[72:73],v5 offset:18432
ds_read_b64_tr_b16 a[74:75],v5 offset:19456
ds_read_b64_tr_b16 a[76:77],v5 offset:18464
ds_read_b64_tr_b16 a[78:79],v5 offset:19488
s_waitcnt lgkmcnt(0)
s_add_u32 m0,s81,18432
s_add_u32 s75,s76,921600
buffer_load_dwordx4 v4,s[48:51],s75 offen lds
s_add_u32 m0,s81,19456
s_add_u32 s75,s76,940032
buffer_load_dwordx4 v4,s[48:51],s75 offen lds
s_waitcnt vmcnt(30)
ds_read_b64_tr_b16 a[80:81],v5 offset:20480
ds_read_b64_tr_b16 a[82:83],v5 offset:21504
ds_read_b64_tr_b16 a[84:85],v5 offset:20512
ds_read_b64_tr_b16 a[86:87],v5 offset:21536
s_waitcnt lgkmcnt(0)
s_add_u32 m0,s81,20480
s_add_u32 s75,s76,958464
buffer_load_dwordx4 v4,s[48:51],s75 offen lds
s_add_u32 m0,s81,21504
s_add_u32 s75,s76,976896
buffer_load_dwordx4 v4,s[48:51],s75 offen lds
s_waitcnt vmcnt(30)
ds_read_b64_tr_b16 a[88:89],v5 offset:22528
ds_read_b64_tr_b16 a[90:91],v5 offset:23552
ds_read_b64_tr_b16 a[92:93],v5 offset:22560
ds_read_b64_tr_b16 a[94:95],v5 offset:23584
s_waitcnt lgkmcnt(0)
s_add_u32 m0,s81,22528
s_add_u32 s75,s76,995328
buffer_load_dwordx4 v4,s[48:51],s75 offen lds
s_add_u32 m0,s81,23552
s_add_u32 s75,s76,1013760
buffer_load_dwordx4 v4,s[48:51],s75 offen lds
s_waitcnt vmcnt(30)
ds_read_b64_tr_b16 a[96:97],v5 offset:24576
ds_read_b64_tr_b16 a[98:99],v5 offset:25600
ds_read_b64_tr_b16 a[100:101],v5 offset:24608
ds_read_b64_tr_b16 a[102:103],v5 offset:25632
s_waitcnt lgkmcnt(0)
s_add_u32 m0,s81,24576
s_add_u32 s75,s76,1032192
buffer_load_dwordx4 v4,s[48:51],s75 offen lds
s_add_u32 m0,s81,25600
s_add_u32 s75,s76,1050624
buffer_load_dwordx4 v4,s[48:51],s75 offen lds
s_waitcnt vmcnt(30)
ds_read_b64_tr_b16 a[104:105],v5 offset:26624
ds_read_b64_tr_b16 a[106:107],v5 offset:27648
ds_read_b64_tr_b16 a[108:109],v5 offset:26656
ds_read_b64_tr_b16 a[110:111],v5 offset:27680
s_waitcnt lgkmcnt(0)
s_add_u32 m0,s81,26624
s_add_u32 s75,s76,1069056
buffer_load_dwordx4 v4,s[48:51],s75 offen lds
s_add_u32 m0,s81,27648
s_add_u32 s75,s76,1087488
buffer_load_dwordx4 v4,s[48:51],s75 offen lds
s_waitcnt vmcnt(30)
ds_read_b64_tr_b16 a[112:113],v5 offset:28672
ds_read_b64_tr_b16 a[114:115],v5 offset:29696
ds_read_b64_tr_b16 a[116:117],v5 offset:28704
ds_read_b64_tr_b16 a[118:119],v5 offset:29728
s_waitcnt lgkmcnt(0)
s_add_u32 m0,s81,28672
s_add_u32 s75,s76,1105920
buffer_load_dwordx4 v4,s[48:51],s75 offen lds
s_add_u32 m0,s81,29696
s_add_u32 s75,s76,1124352
buffer_load_dwordx4 v4,s[48:51],s75 offen lds
s_waitcnt vmcnt(30)
ds_read_b64_tr_b16 a[120:121],v5 offset:30720
ds_read_b64_tr_b16 a[122:123],v5 offset:31744
ds_read_b64_tr_b16 a[124:125],v5 offset:30752
ds_read_b64_tr_b16 a[126:127],v5 offset:31776
s_waitcnt lgkmcnt(0)
s_add_u32 m0,s81,30720
s_add_u32 s75,s76,1142784
buffer_load_dwordx4 v4,s[48:51],s75 offen lds
s_add_u32 m0,s81,31744
s_add_u32 s75,s76,1161216
buffer_load_dwordx4 v4,s[48:51],s75 offen lds
s_waitcnt vmcnt(30)
ds_read_b64_tr_b16 a[128:129],v5 offset:0
ds_read_b64_tr_b16 a[130:131],v5 offset:1024
ds_read_b64_tr_b16 a[132:133],v5 offset:32
ds_read_b64_tr_b16 a[134:135],v5 offset:1056
s_waitcnt lgkmcnt(0)
s_add_u32 m0,s81,0
s_add_u32 s75,s76,1179648
buffer_load_dwordx4 v4,s[48:51],s75 offen lds
s_add_u32 m0,s81,1024
s_add_u32 s75,s76,1198080
buffer_load_dwordx4 v4,s[48:51],s75 offen lds
s_waitcnt vmcnt(30)
ds_read_b64_tr_b16 a[136:137],v5 offset:2048
ds_read_b64_tr_b16 a[138:139],v5 offset:3072
ds_read_b64_tr_b16 a[140:141],v5 offset:2080
ds_read_b64_tr_b16 a[142:143],v5 offset:3104
s_waitcnt lgkmcnt(0)
s_add_u32 m0,s81,2048
s_add_u32 s75,s76,1216512
buffer_load_dwordx4 v4,s[48:51],s75 offen lds
s_add_u32 m0,s81,3072
s_add_u32 s75,s76,1234944
buffer_load_dwordx4 v4,s[48:51],s75 offen lds
s_waitcnt vmcnt(30)
ds_read_b64_tr_b16 a[144:145],v5 offset:4096
ds_read_b64_tr_b16 a[146:147],v5 offset:5120
ds_read_b64_tr_b16 a[148:149],v5 offset:4128
ds_read_b64_tr_b16 a[150:151],v5 offset:5152
s_waitcnt lgkmcnt(0)
s_add_u32 m0,s81,4096
s_add_u32 s75,s76,1253376
buffer_load_dwordx4 v4,s[48:51],s75 offen lds
s_add_u32 m0,s81,5120
s_add_u32 s75,s76,1271808
buffer_load_dwordx4 v4,s[48:51],s75 offen lds
s_waitcnt vmcnt(30)
ds_read_b64_tr_b16 a[152:153],v5 offset:6144
ds_read_b64_tr_b16 a[154:155],v5 offset:7168
ds_read_b64_tr_b16 a[156:157],v5 offset:6176
ds_read_b64_tr_b16 a[158:159],v5 offset:7200
s_waitcnt lgkmcnt(0)
s_add_u32 m0,s81,6144
s_add_u32 s75,s76,1290240
buffer_load_dwordx4 v4,s[48:51],s75 offen lds
s_add_u32 m0,s81,7168
s_add_u32 s75,s76,1308672
buffer_load_dwordx4 v4,s[48:51],s75 offen lds
s_waitcnt vmcnt(30)
ds_read_b64_tr_b16 a[160:161],v5 offset:8192
ds_read_b64_tr_b16 a[162:163],v5 offset:9216
ds_read_b64_tr_b16 a[164:165],v5 offset:8224
ds_read_b64_tr_b16 a[166:167],v5 offset:9248
s_waitcnt vmcnt(28)
ds_read_b64_tr_b16 a[168:169],v5 offset:10240
ds_read_b64_tr_b16 a[170:171],v5 offset:11264
ds_read_b64_tr_b16 a[172:173],v5 offset:10272
ds_read_b64_tr_b16 a[174:175],v5 offset:11296
s_waitcnt vmcnt(26)
ds_read_b64_tr_b16 a[176:177],v5 offset:12288
ds_read_b64_tr_b16 a[178:179],v5 offset:13312
ds_read_b64_tr_b16 a[180:181],v5 offset:12320
ds_read_b64_tr_b16 a[182:183],v5 offset:13344
s_waitcnt vmcnt(24)
ds_read_b64_tr_b16 a[184:185],v5 offset:14336
ds_read_b64_tr_b16 a[186:187],v5 offset:15360
ds_read_b64_tr_b16 a[188:189],v5 offset:14368
ds_read_b64_tr_b16 a[190:191],v5 offset:15392
s_waitcnt vmcnt(22)
ds_read_b64_tr_b16 a[192:193],v5 offset:16384
ds_read_b64_tr_b16 a[194:195],v5 offset:17408
ds_read_b64_tr_b16 a[196:197],v5 offset:16416
ds_read_b64_tr_b16 a[198:199],v5 offset:17440
s_waitcnt vmcnt(20)
ds_read_b64_tr_b16 a[200:201],v5 offset:18432
ds_read_b64_tr_b16 a[202:203],v5 offset:19456
ds_read_b64_tr_b16 a[204:205],v5 offset:18464
ds_read_b64_tr_b16 a[206:207],v5 offset:19488
s_waitcnt vmcnt(18)
ds_read_b64_tr_b16 a[208:209],v5 offset:20480
ds_read_b64_tr_b16 a[210:211],v5 offset:21504
ds_read_b64_tr_b16 a[212:213],v5 offset:20512
ds_read_b64_tr_b16 a[214:215],v5 offset:21536
s_waitcnt vmcnt(16)
ds_read_b64_tr_b16 a[216:217],v5 offset:22528
ds_read_b64_tr_b16 a[218:219],v5 offset:23552
ds_read_b64_tr_b16 a[220:221],v5 offset:22560
ds_read_b64_tr_b16 a[222:223],v5 offset:23584
s_waitcnt vmcnt(14)
ds_read_b64_tr_b16 a[224:225],v5 offset:24576
ds_read_b64_tr_b16 a[226:227],v5 offset:25600
ds_read_b64_tr_b16 a[228:229],v5 offset:24608
ds_read_b64_tr_b16 a[230:231],v5 offset:25632
s_waitcnt vmcnt(12)
ds_read_b64_tr_b16 a[232:233],v5 offset:26624
ds_read_b64_tr_b16 a[234:235],v5 offset:27648
ds_read_b64_tr_b16 a[236:237],v5 offset:26656
ds_read_b64_tr_b16 a[238:239],v5 offset:27680
s_waitcnt vmcnt(10)
ds_read_b64_tr_b16 a[240:241],v5 offset:28672
ds_read_b64_tr_b16 a[242:243],v5 offset:29696
ds_read_b64_tr_b16 a[244:245],v5 offset:28704
ds_read_b64_tr_b16 a[246:247],v5 offset:29728
s_waitcnt vmcnt(8)
ds_read_b64_tr_b16 a[248:249],v5 offset:30720
ds_read_b64_tr_b16 a[250:251],v5 offset:31744
ds_read_b64_tr_b16 a[252:253],v5 offset:30752
ds_read_b64_tr_b16 a[254:255],v5 offset:31776
s_waitcnt vmcnt(6)
ds_read_b64_tr_b16 v[224:225],v5 offset:0
ds_read_b64_tr_b16 v[226:227],v5 offset:1024
ds_read_b64_tr_b16 v[228:229],v5 offset:32
ds_read_b64_tr_b16 v[230:231],v5 offset:1056
s_waitcnt vmcnt(4)
ds_read_b64_tr_b16 v[232:233],v5 offset:2048
ds_read_b64_tr_b16 v[234:235],v5 offset:3072
ds_read_b64_tr_b16 v[236:237],v5 offset:2080
ds_read_b64_tr_b16 v[238:239],v5 offset:3104
s_waitcnt vmcnt(2)
ds_read_b64_tr_b16 v[240:241],v5 offset:4096
ds_read_b64_tr_b16 v[242:243],v5 offset:5120
ds_read_b64_tr_b16 v[244:245],v5 offset:4128
ds_read_b64_tr_b16 v[246:247],v5 offset:5152
s_waitcnt vmcnt(0)
ds_read_b64_tr_b16 v[248:249],v5 offset:6144
ds_read_b64_tr_b16 v[250:251],v5 offset:7168
ds_read_b64_tr_b16 v[252:253],v5 offset:6176
ds_read_b64_tr_b16 v[254:255],v5 offset:7200
s_waitcnt lgkmcnt(0)
s_barrier
s_mov_b32 s74,s72
s_mov_b32 s77,0
Lp2_loop:
s_lshr_b32 s75,s74,3
s_lshl_b32 s75,s75,7
s_add_u32 s81,s75,7296
s_cmp_lg_u32 s60,0
s_cbranch_scc1 Lwd_p2h
s_mov_b32 s71,0x800000
v_mov_b32 v2,0
s_mov_b64 exec,1
Lw_p2h:
buffer_load_dword v1,v2,s[8:11],s81 offen sc1
s_sub_u32 s71,s71,1
s_cbranch_scc1 Lwe_p2h
s_waitcnt vmcnt(0)
v_cmp_gt_u32 vcc,36,v1
s_cbranch_vccz Lwe_p2h
s_sleep 2
s_branch Lw_p2h
Lwe_p2h:
s_waitcnt vmcnt(0)
s_mov_b64 exec,-1
Lwd_p2h:
s_barrier
s_mul_i32 s76,s74,294912
s_add_u32 s76,s76,83886080
s_mul_i32 s75,s60,36864
s_add_u32 s76,s76,s75
s_add_u32 s81,s76,147456
buffer_load_dwordx4 v[64:67],v3,s[8:11],s76 offen offset:0 sc1
buffer_load_dwordx4 v[68:71],v3,s[8:11],s81 offen offset:0 sc1
buffer_load_dwordx4 v[72:75],v3,s[8:11],s76 offen offset:1024 sc1
buffer_load_dwordx4 v[76:79],v3,s[8:11],s81 offen offset:1024 sc1
buffer_load_dwordx4 v[80:83],v3,s[8:11],s76 offen offset:2048 sc1
buffer_load_dwordx4 v[84:87],v3,s[8:11],s81 offen offset:2048 sc1
buffer_load_dwordx4 v[88:91],v3,s[8:11],s76 offen offset:3072 sc1
buffer_load_dwordx4 v[92:95],v3,s[8:11],s81 offen offset:3072 sc1
s_add_u32 s76,s76,4096
s_add_u32 s81,s81,4096
buffer_load_dwordx4 v[96:99],v3,s[8:11],s76 offen offset:0 sc1
buffer_load_dwordx4 v[100:103],v3,s[8:11],s81 offen offset:0 sc1
buffer_load_dwordx4 v[104:107],v3,s[8:11],s76 offen offset:1024 sc1
buffer_load_dwordx4 v[108:111],v3,s[8:11],s81 offen offset:1024 sc1
buffer_load_dwordx4 v[112:115],v3,s[8:11],s76 offen offset:2048 sc1
buffer_load_dwordx4 v[116:119],v3,s[8:11],s81 offen offset:2048 sc1
buffer_load_dwordx4 v[120:123],v3,s[8:11],s76 offen offset:3072 sc1
buffer_load_dwordx4 v[124:127],v3,s[8:11],s81 offen offset:3072 sc1
s_add_u32 s76,s76,4096
s_add_u32 s81,s81,4096
buffer_load_dwordx4 v[128:131],v3,s[8:11],s76 offen offset:0 sc1
buffer_load_dwordx4 v[132:135],v3,s[8:11],s81 offen offset:0 sc1
buffer_load_dwordx4 v[136:139],v3,s[8:11],s76 offen offset:1024 sc1
buffer_load_dwordx4 v[140:143],v3,s[8:11],s81 offen offset:1024 sc1
buffer_load_dwordx4 v[144:147],v3,s[8:11],s76 offen offset:2048 sc1
buffer_load_dwordx4 v[148:151],v3,s[8:11],s81 offen offset:2048 sc1
buffer_load_dwordx4 v[152:155],v3,s[8:11],s76 offen offset:3072 sc1
buffer_load_dwordx4 v[156:159],v3,s[8:11],s81 offen offset:3072 sc1
s_add_u32 s76,s76,4096
s_add_u32 s81,s81,4096
buffer_load_dwordx4 v[160:163],v3,s[8:11],s76 offen offset:0 sc1
buffer_load_dwordx4 v[164:167],v3,s[8:11],s81 offen offset:0 sc1
buffer_load_dwordx4 v[168:171],v3,s[8:11],s76 offen offset:1024 sc1
buffer_load_dwordx4 v[172:175],v3,s[8:11],s81 offen offset:1024 sc1
buffer_load_dwordx4 v[176:179],v3,s[8:11],s76 offen offset:2048 sc1
buffer_load_dwordx4 v[180:183],v3,s[8:11],s81 offen offset:2048 sc1
buffer_load_dwordx4 v[184:187],v3,s[8:11],s76 offen offset:3072 sc1
buffer_load_dwordx4 v[188:191],v3,s[8:11],s81 offen offset:3072 sc1
s_waitcnt vmcnt(30)
v_mfma_f32_16x16x32_bf16 v[20:23],a[0:3],v[64:67],0
v_mfma_f32_16x16x32_bf16 v[24:27],a[0:3],v[68:71],0
v_mfma_f32_16x16x32_bf16 v[28:31],a[4:7],v[64:67],0
v_mfma_f32_16x16x32_bf16 v[32:35],a[4:7],v[68:71],0
s_add_u32 s76,s76,4096
s_add_u32 s81,s81,4096
buffer_load_dwordx4 v[64:67],v3,s[8:11],s76 offen offset:0 sc1
buffer_load_dwordx4 v[68:71],v3,s[8:11],s81 offen offset:0 sc1
s_waitcnt vmcnt(30)
v_mfma_f32_16x16x32_bf16 v[20:23],a[8:11],v[72:75],v[20:23]
v_mfma_f32_16x16x32_bf16 v[24:27],a[8:11],v[76:79],v[24:27]
v_mfma_f32_16x16x32_bf16 v[28:31],a[12:15],v[72:75],v[28:31]
v_mfma_f32_16x16x32_bf16 v[32:35],a[12:15],v[76:79],v[32:35]
buffer_load_dwordx4 v[72:75],v3,s[8:11],s76 offen offset:1024 sc1
buffer_load_dwordx4 v[76:79],v3,s[8:11],s81 offen offset:1024 sc1
s_waitcnt vmcnt(30)
v_mfma_f32_16x16x32_bf16 v[20:23],a[16:19],v[80:83],v[20:23]
v_mfma_f32_16x16x32_bf16 v[24:27],a[16:19],v[84:87],v[24:27]
v_mfma_f32_16x16x32_bf16 v[28:31],a[20:23],v[80:83],v[28:31]
v_mfma_f32_16x16x32_bf16 v[32:35],a[20:23],v[84:87],v[32:35]
buffer_load_dwordx4 v[80:83],v3,s[8:11],s76 offen offset:2048 sc1
buffer_load_dwordx4 v[84:87],v3,s[8:11],s81 offen offset:2048 sc1
s_waitcnt vmcnt(30)
v_mfma_f32_16x16x32_bf16 v[20:23],a[24:27],v[88:91],v[20:23]
v_mfma_f32_16x16x32_bf16 v[24:27],a[24:27],v[92:95],v[24:27]
v_mfma_f32_16x16x32_bf16 v[28:31],a[28:31],v[88:91],v[28:31]
v_mfma_f32_16x16x32_bf16 v[32:35],a[28:31],v[92:95],v[32:35]
buffer_load_dwordx4 v[88:91],v3,s[8:11],s76 offen offset:3072 sc1
buffer_load_dwordx4 v[92:95],v3,s[8:11],s81 offen offset:3072 sc1
s_waitcnt vmcnt(30)
v_mfma_f32_16x16x32_bf16 v[20:23],a[32:35],v[96:99],v[20:23]
v_mfma_f32_16x16x32_bf16 v[24:27],a[32:35],v[100:103],v[24:27]
v_mfma_f32_16x16x32_bf16 v[28:31],a[36:39],v[96:99],v[28:31]
v_mfma_f32_16x16x32_bf16 v[32:35],a[36:39],v[100:103],v[32:35]
s_add_u32 s76,s76,4096
s_add_u32 s81,s81,4096
buffer_load_dwordx4 v[96:99],v3,s[8:11],s76 offen offset:0 sc1
buffer_load_dwordx4 v[100:103],v3,s[8:11],s81 offen offset:0 sc1
s_waitcnt vmcnt(30)
v_mfma_f32_16x16x32_bf16 v[20:23],a[40:43],v[104:107],v[20:23]
v_mfma_f32_16x16x32_bf16 v[24:27],a[40:43],v[108:111],v[24:27]
v_mfma_f32_16x16x32_bf16 v[28:31],a[44:47],v[104:107],v[28:31]
v_mfma_f32_16x16x32_bf16 v[32:35],a[44:47],v[108:111],v[32:35]
buffer_load_dwordx4 v[104:107],v3,s[8:11],s76 offen offset:1024 sc1
buffer_load_dwordx4 v[108:111],v3,s[8:11],s81 offen offset:1024 sc1
s_waitcnt vmcnt(30)
v_mfma_f32_16x16x32_bf16 v[20:23],a[48:51],v[112:115],v[20:23]
v_mfma_f32_16x16x32_bf16 v[24:27],a[48:51],v[116:119],v[24:27]
v_mfma_f32_16x16x32_bf16 v[28:31],a[52:55],v[112:115],v[28:31]
v_mfma_f32_16x16x32_bf16 v[32:35],a[52:55],v[116:119],v[32:35]
buffer_load_dwordx4 v[112:115],v3,s[8:11],s76 offen offset:2048 sc1
buffer_load_dwordx4 v[116:119],v3,s[8:11],s81 offen offset:2048 sc1
s_waitcnt vmcnt(30)
v_mfma_f32_16x16x32_bf16 v[20:23],a[56:59],v[120:123],v[20:23]
v_mfma_f32_16x16x32_bf16 v[24:27],a[56:59],v[124:127],v[24:27]
v_mfma_f32_16x16x32_bf16 v[28:31],a[60:63],v[120:123],v[28:31]
v_mfma_f32_16x16x32_bf16 v[32:35],a[60:63],v[124:127],v[32:35]
buffer_load_dwordx4 v[120:123],v3,s[8:11],s76 offen offset:3072 sc1
buffer_load_dwordx4 v[124:127],v3,s[8:11],s81 offen offset:3072 sc1
s_waitcnt vmcnt(30)
v_mfma_f32_16x16x32_bf16 v[20:23],a[64:67],v[128:131],v[20:23]
v_mfma_f32_16x16x32_bf16 v[24:27],a[64:67],v[132:135],v[24:27]
v_mfma_f32_16x16x32_bf16 v[28:31],a[68:71],v[128:131],v[28:31]
v_mfma_f32_16x16x32_bf16 v[32:35],a[68:71],v[132:135],v[32:35]
s_add_u32 s76,s76,4096
s_add_u32 s81,s81,4096
buffer_load_dwordx4 v[128:131],v3,s[8:11],s76 offen offset:0 sc1
buffer_load_dwordx4 v[132:135],v3,s[8:11],s81 offen offset:0 sc1
s_waitcnt vmcnt(30)
v_mfma_f32_16x16x32_bf16 v[20:23],a[72:75],v[136:139],v[20:23]
v_mfma_f32_16x16x32_bf16 v[24:27],a[72:75],v[140:143],v[24:27]
v_mfma_f32_16x16x32_bf16 v[28:31],a[76:79],v[136:139],v[28:31]
v_mfma_f32_16x16x32_bf16 v[32:35],a[76:79],v[140:143],v[32:35]
buffer_load_dwordx4 v[136:139],v3,s[8:11],s76 offen offset:1024 sc1
buffer_load_dwordx4 v[140:143],v3,s[8:11],s81 offen offset:1024 sc1
s_waitcnt vmcnt(30)
v_mfma_f32_16x16x32_bf16 v[20:23],a[80:83],v[144:147],v[20:23]
v_mfma_f32_16x16x32_bf16 v[24:27],a[80:83],v[148:151],v[24:27]
v_mfma_f32_16x16x32_bf16 v[28:31],a[84:87],v[144:147],v[28:31]
v_mfma_f32_16x16x32_bf16 v[32:35],a[84:87],v[148:151],v[32:35]
buffer_load_dwordx4 v[144:147],v3,s[8:11],s76 offen offset:2048 sc1
buffer_load_dwordx4 v[148:151],v3,s[8:11],s81 offen offset:2048 sc1
s_waitcnt vmcnt(30)
v_mfma_f32_16x16x32_bf16 v[20:23],a[88:91],v[152:155],v[20:23]
v_mfma_f32_16x16x32_bf16 v[24:27],a[88:91],v[156:159],v[24:27]
v_mfma_f32_16x16x32_bf16 v[28:31],a[92:95],v[152:155],v[28:31]
v_mfma_f32_16x16x32_bf16 v[32:35],a[92:95],v[156:159],v[32:35]
buffer_load_dwordx4 v[152:155],v3,s[8:11],s76 offen offset:3072 sc1
buffer_load_dwordx4 v[156:159],v3,s[8:11],s81 offen offset:3072 sc1
s_waitcnt vmcnt(30)
v_mfma_f32_16x16x32_bf16 v[20:23],a[96:99],v[160:163],v[20:23]
v_mfma_f32_16x16x32_bf16 v[24:27],a[96:99],v[164:167],v[24:27]
v_mfma_f32_16x16x32_bf16 v[28:31],a[100:103],v[160:163],v[28:31]
v_mfma_f32_16x16x32_bf16 v[32:35],a[100:103],v[164:167],v[32:35]
s_add_u32 s76,s76,4096
s_add_u32 s81,s81,4096
buffer_load_dwordx4 v[160:163],v3,s[8:11],s76 offen offset:0 sc1
buffer_load_dwordx4 v[164:167],v3,s[8:11],s81 offen offset:0 sc1
s_waitcnt vmcnt(30)
v_mfma_f32_16x16x32_bf16 v[20:23],a[104:107],v[168:171],v[20:23]
v_mfma_f32_16x16x32_bf16 v[24:27],a[104:107],v[172:175],v[24:27]
v_mfma_f32_16x16x32_bf16 v[28:31],a[108:111],v[168:171],v[28:31]
v_mfma_f32_16x16x32_bf16 v[32:35],a[108:111],v[172:175],v[32:35]
buffer_load_dwordx4 v[168:171],v3,s[8:11],s76 offen offset:1024 sc1
buffer_load_dwordx4 v[172:175],v3,s[8:11],s81 offen offset:1024 sc1
s_waitcnt vmcnt(30)
v_mfma_f32_16x16x32_bf16 v[20:23],a[112:115],v[176:179],v[20:23]
v_mfma_f32_16x16x32_bf16 v[24:27],a[112:115],v[180:183],v[24:27]
v_mfma_f32_16x16x32_bf16 v[28:31],a[116:119],v[176:179],v[28:31]
v_mfma_f32_16x16x32_bf16 v[32:35],a[116:119],v[180:183],v[32:35]
buffer_load_dwordx4 v[176:179],v3,s[8:11],s76 offen offset:2048 sc1
buffer_load_dwordx4 v[180:183],v3,s[8:11],s81 offen offset:2048 sc1
s_waitcnt vmcnt(30)
v_mfma_f32_16x16x32_bf16 v[20:23],a[120:123],v[184:187],v[20:23]
v_mfma_f32_16x16x32_bf16 v[24:27],a[120:123],v[188:191],v[24:27]
v_mfma_f32_16x16x32_bf16 v[28:31],a[124:127],v[184:187],v[28:31]
v_mfma_f32_16x16x32_bf16 v[32:35],a[124:127],v[188:191],v[32:35]
buffer_load_dwordx4 v[184:187],v3,s[8:11],s76 offen offset:3072 sc1
buffer_load_dwordx4 v[188:191],v3,s[8:11],s81 offen offset:3072 sc1
s_waitcnt vmcnt(30)
v_mfma_f32_16x16x32_bf16 v[20:23],a[128:131],v[64:67],v[20:23]
v_mfma_f32_16x16x32_bf16 v[24:27],a[128:131],v[68:71],v[24:27]
v_mfma_f32_16x16x32_bf16 v[28:31],a[132:135],v[64:67],v[28:31]
v_mfma_f32_16x16x32_bf16 v[32:35],a[132:135],v[68:71],v[32:35]
s_add_u32 s76,s76,4096
s_add_u32 s81,s81,4096
buffer_load_dwordx4 v[64:67],v3,s[8:11],s76 offen offset:0 sc1
buffer_load_dwordx4 v[68:71],v3,s[8:11],s81 offen offset:0 sc1
s_waitcnt vmcnt(30)
v_mfma_f32_16x16x32_bf16 v[20:23],a[136:139],v[72:75],v[20:23]
v_mfma_f32_16x16x32_bf16 v[24:27],a[136:139],v[76:79],v[24:27]
v_mfma_f32_16x16x32_bf16 v[28:31],a[140:143],v[72:75],v[28:31]
v_mfma_f32_16x16x32_bf16 v[32:35],a[140:143],v[76:79],v[32:35]
buffer_load_dwordx4 v[72:75],v3,s[8:11],s76 offen offset:1024 sc1
buffer_load_dwordx4 v[76:79],v3,s[8:11],s81 offen offset:1024 sc1
s_waitcnt vmcnt(30)
v_mfma_f32_16x16x32_bf16 v[20:23],a[144:147],v[80:83],v[20:23]
v_mfma_f32_16x16x32_bf16 v[24:27],a[144:147],v[84:87],v[24:27]
v_mfma_f32_16x16x32_bf16 v[28:31],a[148:151],v[80:83],v[28:31]
v_mfma_f32_16x16x32_bf16 v[32:35],a[148:151],v[84:87],v[32:35]
buffer_load_dwordx4 v[80:83],v3,s[8:11],s76 offen offset:2048 sc1
buffer_load_dwordx4 v[84:87],v3,s[8:11],s81 offen offset:2048 sc1
s_waitcnt vmcnt(30)
v_mfma_f32_16x16x32_bf16 v[20:23],a[152:155],v[88:91],v[20:23]
v_mfma_f32_16x16x32_bf16 v[24:27],a[152:155],v[92:95],v[24:27]
v_mfma_f32_16x16x32_bf16 v[28:31],a[156:159],v[88:91],v[28:31]
v_mfma_f32_16x16x32_bf16 v[32:35],a[156:159],v[92:95],v[32:35]
buffer_load_dwordx4 v[88:91],v3,s[8:11],s76 offen offset:3072 sc1
buffer_load_dwordx4 v[92:95],v3,s[8:11],s81 offen offset:3072 sc1
s_waitcnt vmcnt(30)
v_mfma_f32_16x16x32_bf16 v[20:23],a[160:163],v[96:99],v[20:23]
v_mfma_f32_16x16x32_bf16 v[24:27],a[160:163],v[100:103],v[24:27]
v_mfma_f32_16x16x32_bf16 v[28:31],a[164:167],v[96:99],v[28:31]
v_mfma_f32_16x16x32_bf16 v[32:35],a[164:167],v[100:103],v[32:35]
s_waitcnt vmcnt(28)
v_mfma_f32_16x16x32_bf16 v[20:23],a[168:171],v[104:107],v[20:23]
v_mfma_f32_16x16x32_bf16 v[24:27],a[168:171],v[108:111],v[24:27]
v_mfma_f32_16x16x32_bf16 v[28:31],a[172:175],v[104:107],v[28:31]
v_mfma_f32_16x16x32_bf16 v[32:35],a[172:175],v[108:111],v[32:35]
s_waitcnt vmcnt(26)
v_mfma_f32_16x16x32_bf16 v[20:23],a[176:179],v[112:115],v[20:23]
v_mfma_f32_16x16x32_bf16 v[24:27],a[176:179],v[116:119],v[24:27]
v_mfma_f32_16x16x32_bf16 v[28:31],a[180:183],v[112:115],v[28:31]
v_mfma_f32_16x16x32_bf16 v[32:35],a[180:183],v[116:119],v[32:35]
s_waitcnt vmcnt(24)
v_mfma_f32_16x16x32_bf16 v[20:23],a[184:187],v[120:123],v[20:23]
v_mfma_f32_16x16x32_bf16 v[24:27],a[184:187],v[124:127],v[24:27]
v_mfma_f32_16x16x32_bf16 v[28:31],a[188:191],v[120:123],v[28:31]
v_mfma_f32_16x16x32_bf16 v[32:35],a[188:191],v[124:127],v[32:35]
s_waitcnt vmcnt(22)
v_mfma_f32_16x16x32_bf16 v[20:23],a[192:195],v[128:131],v[20:23]
v_mfma_f32_16x16x32_bf16 v[24:27],a[192:195],v[132:135],v[24:27]
v_mfma_f32_16x16x32_bf16 v[28:31],a[196:199],v[128:131],v[28:31]
v_mfma_f32_16x16x32_bf16 v[32:35],a[196:199],v[132:135],v[32:35]
s_waitcnt vmcnt(20)
v_mfma_f32_16x16x32_bf16 v[20:23],a[200:203],v[136:139],v[20:23]
v_mfma_f32_16x16x32_bf16 v[24:27],a[200:203],v[140:143],v[24:27]
v_mfma_f32_16x16x32_bf16 v[28:31],a[204:207],v[136:139],v[28:31]
v_mfma_f32_16x16x32_bf16 v[32:35],a[204:207],v[140:143],v[32:35]
s_waitcnt vmcnt(18)
v_mfma_f32_16x16x32_bf16 v[20:23],a[208:211],v[144:147],v[20:23]
v_mfma_f32_16x16x32_bf16 v[24:27],a[208:211],v[148:151],v[24:27]
v_mfma_f32_16x16x32_bf16 v[28:31],a[212:215],v[144:147],v[28:31]
v_mfma_f32_16x16x32_bf16 v[32:35],a[212:215],v[148:151],v[32:35]
s_waitcnt vmcnt(16)
v_mfma_f32_16x16x32_bf16 v[20:23],a[216:219],v[152:155],v[20:23]
v_mfma_f32_16x16x32_bf16 v[24:27],a[216:219],v[156:159],v[24:27]
v_mfma_f32_16x16x32_bf16 v[28:31],a[220:223],v[152:155],v[28:31]
v_mfma_f32_16x16x32_bf16 v[32:35],a[220:223],v[156:159],v[32:35]
s_waitcnt vmcnt(14)
v_mfma_f32_16x16x32_bf16 v[20:23],a[224:227],v[160:163],v[20:23]
v_mfma_f32_16x16x32_bf16 v[24:27],a[224:227],v[164:167],v[24:27]
v_mfma_f32_16x16x32_bf16 v[28:31],a[228:231],v[160:163],v[28:31]
v_mfma_f32_16x16x32_bf16 v[32:35],a[228:231],v[164:167],v[32:35]
s_waitcnt vmcnt(12)
v_mfma_f32_16x16x32_bf16 v[20:23],a[232:235],v[168:171],v[20:23]
v_mfma_f32_16x16x32_bf16 v[24:27],a[232:235],v[172:175],v[24:27]
v_mfma_f32_16x16x32_bf16 v[28:31],a[236:239],v[168:171],v[28:31]
v_mfma_f32_16x16x32_bf16 v[32:35],a[236:239],v[172:175],v[32:35]
s_waitcnt vmcnt(10)
v_mfma_f32_16x16x32_bf16 v[20:23],a[240:243],v[176:179],v[20:23]
v_mfma_f32_16x16x32_bf16 v[24:27],a[240:243],v[180:183],v[24:27]
v_mfma_f32_16x16x32_bf16 v[28:31],a[244:247],v[176:179],v[28:31]
v_mfma_f32_16x16x32_bf16 v[32:35],a[244:247],v[180:183],v[32:35]
s_waitcnt vmcnt(8)
v_mfma_f32_16x16x32_bf16 v[20:23],a[248:251],v[184:187],v[20:23]
v_mfma_f32_16x16x32_bf16 v[24:27],a[248:251],v[188:191],v[24:27]
v_mfma_f32_16x16x32_bf16 v[28:31],a[252:255],v[184:187],v[28:31]
v_mfma_f32_16x16x32_bf16 v[32:35],a[252:255],v[188:191],v[32:35]
s_waitcnt vmcnt(6)
v_mfma_f32_16x16x32_bf16 v[20:23],v[224:227],v[64:67],v[20:23]
v_mfma_f32_16x16x32_bf16 v[24:27],v[224:227],v[68:71],v[24:27]
v_mfma_f32_16x16x32_bf16 v[28:31],v[228:231],v[64:67],v[28:31]
v_mfma_f32_16x16x32_bf16 v[32:35],v[228:231],v[68:71],v[32:35]
s_waitcnt vmcnt(4)
v_mfma_f32_16x16x32_bf16 v[20:23],v[232:235],v[72:75],v[20:23]
v_mfma_f32_16x16x32_bf16 v[24:27],v[232:235],v[76:79],v[24:27]
v_mfma_f32_16x16x32_bf16 v[28:31],v[236:239],v[72:75],v[28:31]
v_mfma_f32_16x16x32_bf16 v[32:35],v[236:239],v[76:79],v[32:35]
s_waitcnt vmcnt(2)
v_mfma_f32_16x16x32_bf16 v[20:23],v[240:243],v[80:83],v[20:23]
v_mfma_f32_16x16x32_bf16 v[24:27],v[240:243],v[84:87],v[24:27]
v_mfma_f32_16x16x32_bf16 v[28:31],v[244:247],v[80:83],v[28:31]
v_mfma_f32_16x16x32_bf16 v[32:35],v[244:247],v[84:87],v[32:35]
s_waitcnt vmcnt(0)
v_mfma_f32_16x16x32_bf16 v[20:23],v[248:251],v[88:91],v[20:23]
v_mfma_f32_16x16x32_bf16 v[24:27],v[248:251],v[92:95],v[24:27]
v_mfma_f32_16x16x32_bf16 v[28:31],v[252:255],v[88:91],v[28:31]
v_mfma_f32_16x16x32_bf16 v[32:35],v[252:255],v[92:95],v[32:35]
s_lshl_b32 s75,s60,12
s_add_u32 s75,s75,s80
v_add_u32 v7,s75,v3
s_nop 4
ds_write_b128 v7,v[20:23] offset:0
ds_write_b128 v7,v[24:27] offset:1024
ds_write_b128 v7,v[28:31] offset:2048
ds_write_b128 v7,v[32:35] offset:3072
s_lshl_b32 s75,s60,10
s_add_u32 s75,s75,s80
v_add_u32 v7,s75,v3
s_xor_b32 s80,s80,16384
s_waitcnt lgkmcnt(0)
s_barrier
ds_read_b128 v[20:23],v7 offset:0
ds_read_b128 v[24:27],v7 offset:4096
ds_read_b128 v[28:31],v7 offset:8192
ds_read_b128 v[32:35],v7 offset:12288
s_waitcnt lgkmcnt(0)
v_add_f32 v20,v20,v24
v_add_f32 v28,v28,v32
v_add_f32 v21,v21,v25
v_add_f32 v29,v29,v33
v_add_f32 v22,v22,v26
v_add_f32 v30,v30,v34
v_add_f32 v23,v23,v27
v_add_f32 v31,v31,v35
v_add_f32 v20,v20,v28
v_add_f32 v21,v21,v29
v_add_f32 v22,v22,v30
v_add_f32 v23,v23,v31
v_cvt_pk_bf16_f32 v24,v20,v21
v_cvt_pk_bf16_f32 v25,v22,v23
v_lshlrev_b32 v20,16,v24
v_and_b32 v21,0xffff0000,v24
v_lshlrev_b32 v22,16,v25
v_and_b32 v23,0xffff0000,v25
v_mul_f32 v24,0xbfb8aa3b,v20
v_mul_f32 v25,0xbfb8aa3b,v21
v_mul_f32 v26,0xbfb8aa3b,v22
v_mul_f32 v27,0xbfb8aa3b,v23
v_exp_f32 v24,v24
v_exp_f32 v25,v25
v_exp_f32 v26,v26
v_exp_f32 v27,v27
v_add_f32 v24,1.0,v24
v_add_f32 v25,1.0,v25
v_add_f32 v26,1.0,v26
v_add_f32 v27,1.0,v27
v_rcp_f32 v24,v24
v_rcp_f32 v25,v25
v_rcp_f32 v26,v26
v_rcp_f32 v27,v27
v_mul_f32 v20,v20,v24
v_mul_f32 v21,v21,v25
v_mul_f32 v22,v22,v26
v_mul_f32 v23,v23,v27
v_cvt_pk_bf16_f32 v24,v20,v21
v_cvt_pk_bf16_f32 v25,v22,v23
v_mov_b64 v[8:9],v[10:11]
v_mov_b64 v[10:11],v[12:13]
v_mov_b64 v[12:13],v[14:15]
v_mov_b64 v[14:15],v[16:17]
v_mov_b64 v[16:17],v[18:19]
v_mov_b64 v[18:19],v[24:25]
s_add_u32 s74,s74,12
s_add_u32 s77,s77,1
s_cmp_lt_u32 s74,64
s_cbranch_scc1 Lp2_loop
s_cmp_eq_u32 s77,6
s_cbranch_scc1 Lp2_done
v_mov_b64 v[8:9],v[10:11]
v_mov_b64 v[10:11],v[12:13]
v_mov_b64 v[12:13],v[14:15]
v_mov_b64 v[14:15],v[16:17]
v_mov_b64 v[16:17],v[18:19]
Lp2_done:
s_barrier
s_mul_i32 s76,s60,1179648
s_lshl_b32 s75,s73,6
s_add_u32 s76,s76,s75
s_mul_i32 s81,s60,40960
s_add_u32 m0,s81,0
s_add_u32 s75,s76,0
buffer_load_dwordx4 v4,s[24:27],s75 offen lds
s_add_u32 m0,s81,1024
s_add_u32 s75,s76,18432
buffer_load_dwordx4 v4,s[24:27],s75 offen lds
s_add_u32 m0,s81,2048
s_add_u32 s75,s76,36864
buffer_load_dwordx4 v4,s[24:27],s75 offen lds
s_add_u32 m0,s81,3072
s_add_u32 s75,s76,55296
buffer_load_dwordx4 v4,s[24:27],s75 offen lds
s_add_u32 m0,s81,4096
s_add_u32 s75,s76,73728
buffer_load_dwordx4 v4,s[24:27],s75 offen lds
s_add_u32 m0,s81,5120
s_add_u32 s75,s76,92160
buffer_load_dwordx4 v4,s[24:27],s75 offen lds
s_add_u32 m0,s81,6144
s_add_u32 s75,s76,110592
buffer_load_dwordx4 v4,s[24:27],s75 offen lds
s_add_u32 m0,s81,7168
s_add_u32 s75,s76,129024
buffer_load_dwordx4 v4,s[24:27],s75 offen lds
s_add_u32 m0,s81,8192
s_add_u32 s75,s76,147456
buffer_load_dwordx4 v4,s[24:27],s75 offen lds
s_add_u32 m0,s81,9216
s_add_u32 s75,s76,165888
buffer_load_dwordx4 v4,s[24:27],s75 offen lds
s_add_u32 m0,s81,10240
s_add_u32 s75,s76,184320
buffer_load_dwordx4 v4,s[24:27],s75 offen lds
s_add_u32 m0,s81,11264
s_add_u32 s75,s76,202752
buffer_load_dwordx4 v4,s[24:27],s75 offen lds
s_add_u32 m0,s81,12288
s_add_u32 s75,s76,221184
buffer_load_dwordx4 v4,s[24:27],s75 offen lds
s_add_u32 m0,s81,13312
s_add_u32 s75,s76,239616
buffer_load_dwordx4 v4,s[24:27],s75 offen lds
s_add_u32 m0,s81,14336
s_add_u32 s75,s76,258048
buffer_load_dwordx4 v4,s[24:27],s75 offen lds
s_add_u32 m0,s81,15360
s_add_u32 s75,s76,276480
buffer_load_dwordx4 v4,s[24:27],s75 offen lds
s_add_u32 m0,s81,16384
s_add_u32 s75,s76,294912
buffer_load_dwordx4 v4,s[24:27],s75 offen lds
s_add_u32 m0,s81,17408
s_add_u32 s75,s76,313344
buffer_load_dwordx4 v4,s[24:27],s75 offen lds
s_add_u32 m0,s81,18432
s_add_u32 s75,s76,331776
buffer_load_dwordx4 v4,s[24:27],s75 offen lds
s_add_u32 m0,s81,19456
s_add_u32 s75,s76,350208
buffer_load_dwordx4 v4,s[24:27],s75 offen lds
s_add_u32 m0,s81,20480
s_add_u32 s75,s76,368640
buffer_load_dwordx4 v4,s[24:27],s75 offen lds
s_add_u32 m0,s81,21504
s_add_u32 s75,s76,387072
buffer_load_dwordx4 v4,s[24:27],s75 offen lds
s_add_u32 m0,s81,22528
s_add_u32 s75,s76,405504
buffer_load_dwordx4 v4,s[24:27],s75 offen lds
s_add_u32 m0,s81,23552
s_add_u32 s75,s76,423936
buffer_load_dwordx4 v4,s[24:27],s75 offen lds
s_add_u32 m0,s81,24576
s_add_u32 s75,s76,442368
buffer_load_dwordx4 v4,s[24:27],s75 offen lds
s_add_u32 m0,s81,25600
s_add_u32 s75,s76,460800
buffer_load_dwordx4 v4,s[24:27],s75 offen lds
s_add_u32 m0,s81,26624
s_add_u32 s75,s76,479232
buffer_load_dwordx4 v4,s[24:27],s75 offen lds
s_add_u32 m0,s81,27648
s_add_u32 s75,s76,497664
buffer_load_dwordx4 v4,s[24:27],s75 offen lds
s_add_u32 m0,s81,28672
s_add_u32 s75,s76,516096
buffer_load_dwordx4 v4,s[24:27],s75 offen lds
s_add_u32 m0,s81,29696
s_add_u32 s75,s76,534528
buffer_load_dwordx4 v4,s[24:27],s75 offen lds
s_add_u32 m0,s81,30720
s_add_u32 s75,s76,552960
buffer_load_dwordx4 v4,s[24:27],s75 offen lds
s_add_u32 m0,s81,31744
s_add_u32 s75,s76,571392
buffer_load_dwordx4 v4,s[24:27],s75 offen lds
s_waitcnt vmcnt(30)
ds_read_b64_tr_b16 a[0:1],v5 offset:0
ds_read_b64_tr_b16 a[2:3],v5 offset:1024
ds_read_b64_tr_b16 a[4:5],v5 offset:32
ds_read_b64_tr_b16 a[6:7],v5 offset:1056
s_waitcnt lgkmcnt(0)
s_add_u32 m0,s81,0
s_add_u32 s75,s76,589824
buffer_load_dwordx4 v4,s[24:27],s75 offen lds
s_add_u32 m0,s81,1024
s_add_u32 s75,s76,608256
buffer_load_dwordx4 v4,s[24:27],s75 offen lds
s_waitcnt vmcnt(30)
ds_read_b64_tr_b16 a[8:9],v5 offset:2048
ds_read_b64_tr_b16 a[10:11],v5 offset:3072
ds_read_b64_tr_b16 a[12:13],v5 offset:2080
ds_read_b64_tr_b16 a[14:15],v5 offset:3104
s_waitcnt lgkmcnt(0)
s_add_u32 m0,s81,2048
s_add_u32 s75,s76,626688
buffer_load_dwordx4 v4,s[24:27],s75 offen lds
s_add_u32 m0,s81,3072
s_add_u32 s75,s76,645120
buffer_load_dwordx4 v4,s[24:27],s75 offen lds
s_waitcnt vmcnt(30)
ds_read_b64_tr_b16 a[16:17],v5 offset:4096
ds_read_b64_tr_b16 a[18:19],v5 offset:5120
ds_read_b64_tr_b16 a[20:21],v5 offset:4128
ds_read_b64_tr_b16 a[22:23],v5 offset:5152
s_waitcnt lgkmcnt(0)
s_add_u32 m0,s81,4096
s_add_u32 s75,s76,663552
buffer_load_dwordx4 v4,s[24:27],s75 offen lds
s_add_u32 m0,s81,5120
s_add_u32 s75,s76,681984
buffer_load_dwordx4 v4,s[24:27],s75 offen lds
s_waitcnt vmcnt(30)
ds_read_b64_tr_b16 a[24:25],v5 offset:6144
ds_read_b64_tr_b16 a[26:27],v5 offset:7168
ds_read_b64_tr_b16 a[28:29],v5 offset:6176
ds_read_b64_tr_b16 a[30:31],v5 offset:7200
s_waitcnt lgkmcnt(0)
s_add_u32 m0,s81,6144
s_add_u32 s75,s76,700416
buffer_load_dwordx4 v4,s[24:27],s75 offen lds
s_add_u32 m0,s81,7168
s_add_u32 s75,s76,718848
buffer_load_dwordx4 v4,s[24:27],s75 offen lds
s_waitcnt vmcnt(30)
ds_read_b64_tr_b16 a[32:33],v5 offset:8192
ds_read_b64_tr_b16 a[34:35],v5 offset:9216
ds_read_b64_tr_b16 a[36:37],v5 offset:8224
ds_read_b64_tr_b16 a[38:39],v5 offset:9248
s_waitcnt lgkmcnt(0)
s_add_u32 m0,s81,8192
s_add_u32 s75,s76,737280
buffer_load_dwordx4 v4,s[24:27],s75 offen lds
s_add_u32 m0,s81,9216
s_add_u32 s75,s76,755712
buffer_load_dwordx4 v4,s[24:27],s75 offen lds
s_waitcnt vmcnt(30)
ds_read_b64_tr_b16 a[40:41],v5 offset:10240
ds_read_b64_tr_b16 a[42:43],v5 offset:11264
ds_read_b64_tr_b16 a[44:45],v5 offset:10272
ds_read_b64_tr_b16 a[46:47],v5 offset:11296
s_waitcnt lgkmcnt(0)
s_add_u32 m0,s81,10240
s_add_u32 s75,s76,774144
buffer_load_dwordx4 v4,s[24:27],s75 offen lds
s_add_u32 m0,s81,11264
s_add_u32 s75,s76,792576
buffer_load_dwordx4 v4,s[24:27],s75 offen lds
s_waitcnt vmcnt(30)
ds_read_b64_tr_b16 a[48:49],v5 offset:12288
ds_read_b64_tr_b16 a[50:51],v5 offset:13312
ds_read_b64_tr_b16 a[52:53],v5 offset:12320
ds_read_b64_tr_b16 a[54:55],v5 offset:13344
s_waitcnt lgkmcnt(0)
s_add_u32 m0,s81,12288
s_add_u32 s75,s76,811008
buffer_load_dwordx4 v4,s[24:27],s75 offen lds
s_add_u32 m0,s81,13312
s_add_u32 s75,s76,829440
buffer_load_dwordx4 v4,s[24:27],s75 offen lds
s_waitcnt vmcnt(30)
ds_read_b64_tr_b16 a[56:57],v5 offset:14336
ds_read_b64_tr_b16 a[58:59],v5 offset:15360
ds_read_b64_tr_b16 a[60:61],v5 offset:14368
ds_read_b64_tr_b16 a[62:63],v5 offset:15392
s_waitcnt lgkmcnt(0)
s_add_u32 m0,s81,14336
s_add_u32 s75,s76,847872
buffer_load_dwordx4 v4,s[24:27],s75 offen lds
s_add_u32 m0,s81,15360
s_add_u32 s75,s76,866304
buffer_load_dwordx4 v4,s[24:27],s75 offen lds
s_waitcnt vmcnt(30)
ds_read_b64_tr_b16 a[64:65],v5 offset:16384
ds_read_b64_tr_b16 a[66:67],v5 offset:17408
ds_read_b64_tr_b16 a[68:69],v5 offset:16416
ds_read_b64_tr_b16 a[70:71],v5 offset:17440
s_waitcnt lgkmcnt(0)
s_add_u32 m0,s81,16384
s_add_u32 s75,s76,884736
buffer_load_dwordx4 v4,s[24:27],s75 offen lds
s_add_u32 m0,s81,17408
s_add_u32 s75,s76,903168
buffer_load_dwordx4 v4,s[24:27],s75 offen lds
s_waitcnt vmcnt(30)
ds_read_b64_tr_b16 a[72:73],v5 offset:18432
ds_read_b64_tr_b16 a[74:75],v5 offset:19456
ds_read_b64_tr_b16 a[76:77],v5 offset:18464
ds_read_b64_tr_b16 a[78:79],v5 offset:19488
s_waitcnt lgkmcnt(0)
s_add_u32 m0,s81,18432
s_add_u32 s75,s76,921600
buffer_load_dwordx4 v4,s[24:27],s75 offen lds
s_add_u32 m0,s81,19456
s_add_u32 s75,s76,940032
buffer_load_dwordx4 v4,s[24:27],s75 offen lds
s_waitcnt vmcnt(30)
ds_read_b64_tr_b16 a[80:81],v5 offset:20480
ds_read_b64_tr_b16 a[82:83],v5 offset:21504
ds_read_b64_tr_b16 a[84:85],v5 offset:20512
ds_read_b64_tr_b16 a[86:87],v5 offset:21536
s_waitcnt lgkmcnt(0)
s_add_u32 m0,s81,20480
s_add_u32 s75,s76,958464
buffer_load_dwordx4 v4,s[24:27],s75 offen lds
s_add_u32 m0,s81,21504
s_add_u32 s75,s76,976896
buffer_load_dwordx4 v4,s[24:27],s75 offen lds
s_waitcnt vmcnt(30)
ds_read_b64_tr_b16 a[88:89],v5 offset:22528
ds_read_b64_tr_b16 a[90:91],v5 offset:23552
ds_read_b64_tr_b16 a[92:93],v5 offset:22560
ds_read_b64_tr_b16 a[94:95],v5 offset:23584
s_waitcnt lgkmcnt(0)
s_add_u32 m0,s81,22528
s_add_u32 s75,s76,995328
buffer_load_dwordx4 v4,s[24:27],s75 offen lds
s_add_u32 m0,s81,23552
s_add_u32 s75,s76,1013760
buffer_load_dwordx4 v4,s[24:27],s75 offen lds
s_waitcnt vmcnt(30)
ds_read_b64_tr_b16 a[96:97],v5 offset:24576
ds_read_b64_tr_b16 a[98:99],v5 offset:25600
ds_read_b64_tr_b16 a[100:101],v5 offset:24608
ds_read_b64_tr_b16 a[102:103],v5 offset:25632
s_waitcnt lgkmcnt(0)
s_add_u32 m0,s81,24576
s_add_u32 s75,s76,1032192
buffer_load_dwordx4 v4,s[24:27],s75 offen lds
s_add_u32 m0,s81,25600
s_add_u32 s75,s76,1050624
buffer_load_dwordx4 v4,s[24:27],s75 offen lds
s_waitcnt vmcnt(30)
ds_read_b64_tr_b16 a[104:105],v5 offset:26624
ds_read_b64_tr_b16 a[106:107],v5 offset:27648
ds_read_b64_tr_b16 a[108:109],v5 offset:26656
ds_read_b64_tr_b16 a[110:111],v5 offset:27680
s_waitcnt lgkmcnt(0)
s_add_u32 m0,s81,26624
s_add_u32 s75,s76,1069056
buffer_load_dwordx4 v4,s[24:27],s75 offen lds
s_add_u32 m0,s81,27648
s_add_u32 s75,s76,1087488
buffer_load_dwordx4 v4,s[24:27],s75 offen lds
s_waitcnt vmcnt(30)
ds_read_b64_tr_b16 a[112:113],v5 offset:28672
ds_read_b64_tr_b16 a[114:115],v5 offset:29696
ds_read_b64_tr_b16 a[116:117],v5 offset:28704
ds_read_b64_tr_b16 a[118:119],v5 offset:29728
s_waitcnt lgkmcnt(0)
s_add_u32 m0,s81,28672
s_add_u32 s75,s76,1105920
buffer_load_dwordx4 v4,s[24:27],s75 offen lds
s_add_u32 m0,s81,29696
s_add_u32 s75,s76,1124352
buffer_load_dwordx4 v4,s[24:27],s75 offen lds
s_waitcnt vmcnt(30)
ds_read_b64_tr_b16 a[120:121],v5 offset:30720
ds_read_b64_tr_b16 a[122:123],v5 offset:31744
ds_read_b64_tr_b16 a[124:125],v5 offset:30752
ds_read_b64_tr_b16 a[126:127],v5 offset:31776
s_waitcnt lgkmcnt(0)
s_add_u32 m0,s81,30720
s_add_u32 s75,s76,1142784
buffer_load_dwordx4 v4,s[24:27],s75 offen lds
s_add_u32 m0,s81,31744
s_add_u32 s75,s76,1161216
buffer_load_dwordx4 v4,s[24:27],s75 offen lds
s_waitcnt vmcnt(30)
ds_read_b64_tr_b16 a[128:129],v5 offset:0
ds_read_b64_tr_b16 a[130:131],v5 offset:1024
ds_read_b64_tr_b16 a[132:133],v5 offset:32
ds_read_b64_tr_b16 a[134:135],v5 offset:1056
s_waitcnt vmcnt(28)
ds_read_b64_tr_b16 a[136:137],v5 offset:2048
ds_read_b64_tr_b16 a[138:139],v5 offset:3072
ds_read_b64_tr_b16 a[140:141],v5 offset:2080
ds_read_b64_tr_b16 a[142:143],v5 offset:3104
s_waitcnt vmcnt(26)
ds_read_b64_tr_b16 a[144:145],v5 offset:4096
ds_read_b64_tr_b16 a[146:147],v5 offset:5120
ds_read_b64_tr_b16 a[148:149],v5 offset:4128
ds_read_b64_tr_b16 a[150:151],v5 offset:5152
s_waitcnt vmcnt(24)
ds_read_b64_tr_b16 a[152:153],v5 offset:6144
ds_read_b64_tr_b16 a[154:155],v5 offset:7168
ds_read_b64_tr_b16 a[156:157],v5 offset:6176
ds_read_b64_tr_b16 a[158:159],v5 offset:7200
s_waitcnt vmcnt(22)
ds_read_b64_tr_b16 a[160:161],v5 offset:8192
ds_read_b64_tr_b16 a[162:163],v5 offset:9216
ds_read_b64_tr_b16 a[164:165],v5 offset:8224
ds_read_b64_tr_b16 a[166:167],v5 offset:9248
s_waitcnt vmcnt(20)
ds_read_b64_tr_b16 a[168:169],v5 offset:10240
ds_read_b64_tr_b16 a[170:171],v5 offset:11264
ds_read_b64_tr_b16 a[172:173],v5 offset:10272
ds_read_b64_tr_b16 a[174:175],v5 offset:11296
s_waitcnt vmcnt(18)
ds_read_b64_tr_b16 a[176:177],v5 offset:12288
ds_read_b64_tr_b16 a[178:179],v5 offset:13312
ds_read_b64_tr_b16 a[180:181],v5 offset:12320
ds_read_b64_tr_b16 a[182:183],v5 offset:13344
s_waitcnt vmcnt(16)
ds_read_b64_tr_b16 a[184:185],v5 offset:14336
ds_read_b64_tr_b16 a[186:187],v5 offset:15360
ds_read_b64_tr_b16 a[188:189],v5 offset:14368
ds_read_b64_tr_b16 a[190:191],v5 offset:15392
s_waitcnt vmcnt(14)
ds_read_b64_tr_b16 a[192:193],v5 offset:16384
ds_read_b64_tr_b16 a[194:195],v5 offset:17408
ds_read_b64_tr_b16 a[196:197],v5 offset:16416
ds_read_b64_tr_b16 a[198:199],v5 offset:17440
s_waitcnt vmcnt(12)
ds_read_b64_tr_b16 a[200:201],v5 offset:18432
ds_read_b64_tr_b16 a[202:203],v5 offset:19456
ds_read_b64_tr_b16 a[204:205],v5 offset:18464
ds_read_b64_tr_b16 a[206:207],v5 offset:19488
s_waitcnt vmcnt(10)
ds_read_b64_tr_b16 a[208:209],v5 offset:20480
ds_read_b64_tr_b16 a[210:211],v5 offset:21504
ds_read_b64_tr_b16 a[212:213],v5 offset:20512
ds_read_b64_tr_b16 a[214:215],v5 offset:21536
s_waitcnt vmcnt(8)
ds_read_b64_tr_b16 a[216:217],v5 offset:22528
ds_read_b64_tr_b16 a[218:219],v5 offset:23552
ds_read_b64_tr_b16 a[220:221],v5 offset:22560
ds_read_b64_tr_b16 a[222:223],v5 offset:23584
s_waitcnt vmcnt(6)
ds_read_b64_tr_b16 a[224:225],v5 offset:24576
ds_read_b64_tr_b16 a[226:227],v5 offset:25600
ds_read_b64_tr_b16 a[228:229],v5 offset:24608
ds_read_b64_tr_b16 a[230:231],v5 offset:25632
s_waitcnt vmcnt(4)
ds_read_b64_tr_b16 a[232:233],v5 offset:26624
ds_read_b64_tr_b16 a[234:235],v5 offset:27648
ds_read_b64_tr_b16 a[236:237],v5 offset:26656
ds_read_b64_tr_b16 a[238:239],v5 offset:27680
s_waitcnt vmcnt(2)
ds_read_b64_tr_b16 a[240:241],v5 offset:28672
ds_read_b64_tr_b16 a[242:243],v5 offset:29696
ds_read_b64_tr_b16 a[244:245],v5 offset:28704
ds_read_b64_tr_b16 a[246:247],v5 offset:29728
s_waitcnt vmcnt(0)
ds_read_b64_tr_b16 a[248:249],v5 offset:30720
ds_read_b64_tr_b16 a[250:251],v5 offset:31744
ds_read_b64_tr_b16 a[252:253],v5 offset:30752
ds_read_b64_tr_b16 a[254:255],v5 offset:31776
s_waitcnt lgkmcnt(0)
s_barrier

v_and_b32 v36,31,v0
v_min_u32 v36,16,v36
v_lshlrev_b32 v37,7,v36
v_cmp_gt_u32 vcc,9,v36
v_mov_b32 v38,16
v_mov_b32 v39,32
v_cndmask_b32 v38,v38,v39,vcc
s_mov_b32 s75,5120
s_mov_b32 s71,0x800000
Lp3_w1:
buffer_load_dword v39,v37,s[8:11],s75 offen sc1
s_sub_u32 s71,s71,1
s_cbranch_scc1 Lp3_w1d
s_waitcnt vmcnt(0)
v_cmp_gt_u32 vcc,v38,v39
s_cbranch_vccz Lp3_w1d
s_sleep 4
s_branch Lp3_w1
Lp3_w1d:
v_and_b32 v37,31,v0
Lp3_w2:
buffer_load_ubyte v39,v37,s[32:35],0 offen offset:128 sc1
s_sub_u32 s71,s71,1
s_cbranch_scc1 Lp3_w2d
s_waitcnt vmcnt(0)
v_cmp_eq_u32 vcc,0,v39
s_cbranch_vccz Lp3_w2d
s_sleep 4
s_branch Lp3_w2
Lp3_w2d:
s_waitcnt vmcnt(0)
s_lshl_b32 s75,s73,2
s_add_u32 s75,s75,s60
s_lshr_b32 s78,s75,1
s_and_b32 s79,s75,1
s_mov_b32 s82,0x3e0293ee
s_mov_b32 s74,s72
Lp3_loop:
s_mul_i32 s75,s74,36864
buffer_load_dwordx2 v[36:37],v6,s[36:39],s75 offen
s_cmp_ge_u32 s78,32
s_cbranch_scc1 Lp3_noattn
s_lshl_b32 s76,s74,18
s_lshl_b32 s75,s78,13
s_add_u32 s76,s76,s75
s_lshl_b32 s81,s79,10
s_add_u32 s81,s81,s76
s_add_u32 s75,s81,50331648
buffer_load_dwordx4 v[64:67],v3,s[8:11],s75 offen offset:0 sc1
buffer_load_dwordx4 v[68:71],v3,s[8:11],s75 offen offset:2048 sc1
s_add_u32 s75,s81,50335744
buffer_load_dwordx4 v[72:75],v3,s[8:11],s75 offen offset:0 sc1
buffer_load_dwordx4 v[76:79],v3,s[8:11],s75 offen offset:2048 sc1
s_add_u32 s75,s76,16777216
buffer_load_dwordx4 v[80:83],v3,s[8:11],s75 offen offset:0 sc1
buffer_load_dwordx4 v[84:87],v3,s[8:11],s75 offen offset:1024 sc1
buffer_load_dwordx4 v[88:91],v3,s[8:11],s75 offen offset:2048 sc1
buffer_load_dwordx4 v[92:95],v3,s[8:11],s75 offen offset:3072 sc1
s_add_u32 s75,s76,16781312
buffer_load_dwordx4 v[96:99],v3,s[8:11],s75 offen offset:0 sc1
buffer_load_dwordx4 v[100:103],v3,s[8:11],s75 offen offset:1024 sc1
buffer_load_dwordx4 v[104:107],v3,s[8:11],s75 offen offset:2048 sc1
buffer_load_dwordx4 v[108:111],v3,s[8:11],s75 offen offset:3072 sc1
s_add_u32 s75,s76,33554432
buffer_load_dwordx4 v[112:115],v3,s[8:11],s75 offen offset:0 sc1
buffer_load_dwordx4 v[116:119],v3,s[8:11],s75 offen offset:1024 sc1
buffer_load_dwordx4 v[120:123],v3,s[8:11],s75 offen offset:2048 sc1
buffer_load_dwordx4 v[124:127],v3,s[8:11],s75 offen offset:3072 sc1
s_add_u32 s75,s76,33558528
buffer_load_dwordx4 v[128:131],v3,s[8:11],s75 offen offset:0 sc1
buffer_load_dwordx4 v[132:135],v3,s[8:11],s75 offen offset:1024 sc1
buffer_load_dwordx4 v[136:139],v3,s[8:11],s75 offen offset:2048 sc1
buffer_load_dwordx4 v[140:143],v3,s[8:11],s75 offen offset:3072 sc1
s_waitcnt vmcnt(8)
v_mfma_f32_16x16x32_bf16 v[40:43],v[80:83],v[64:67],0
v_mfma_f32_16x16x32_bf16 v[44:47],v[84:87],v[64:67],0
v_mfma_f32_16x16x32_bf16 v[40:43],v[88:91],v[68:71],v[40:43]
v_mfma_f32_16x16x32_bf16 v[44:47],v[92:95],v[68:71],v[44:47]
v_mfma_f32_16x16x32_bf16 v[40:43],v[96:99],v[72:75],v[40:43]
v_mfma_f32_16x16x32_bf16 v[44:47],v[100:103],v[72:75],v[44:47]
v_mfma_f32_16x16x32_bf16 v[40:43],v[104:107],v[76:79],v[40:43]
v_mfma_f32_16x16x32_bf16 v[44:47],v[108:111],v[76:79],v[44:47]
v_and_b32 v62,63,v0
v_lshrrev_b32 v38,4,v62
v_lshlrev_b32 v38,2,v38
v_and_b32 v39,15,v62
v_sub_u32 v38,v38,v39
s_lshl_b32 s75,s79,4
v_subrev_u32 v38,s75,v38
v_mov_b32 v39,0xf149f2ca
s_lshl_b32 s75,s78,7
s_add_u32 s81,s75,0
s_add_u32 s77,s74,1
v_cmp_ge_i32 vcc,0,v38
s_nop 1
v_cndmask_b32 v40,v39,v40,vcc
v_cmp_ge_i32 vcc,-1,v38
s_nop 1
v_cndmask_b32 v41,v39,v41,vcc
v_cmp_ge_i32 vcc,-2,v38
s_nop 1
v_cndmask_b32 v42,v39,v42,vcc
v_cmp_ge_i32 vcc,-3,v38
s_nop 1
v_cndmask_b32 v43,v39,v43,vcc
v_cmp_ge_i32 vcc,-16,v38
s_nop 1
v_cndmask_b32 v44,v39,v44,vcc
v_cmp_ge_i32 vcc,0xffffffef,v38
s_nop 1
v_cndmask_b32 v45,v39,v45,vcc
v_cmp_ge_i32 vcc,0xffffffee,v38
s_nop 1
v_cndmask_b32 v46,v39,v46,vcc
v_cmp_ge_i32 vcc,0xffffffed,v38
s_nop 1
v_cndmask_b32 v47,v39,v47,vcc
s_mov_b32 s71,0x800000
v_mov_b32 v2,0
Lw_p3kvm:
buffer_load_dword v1,v2,s[8:11],s81 offen sc1
s_sub_u32 s71,s71,1
s_cbranch_scc1 Lwd_p3kvm
s_waitcnt vmcnt(0)
v_cmp_gt_u32 vcc,s77,v1
s_cbranch_vccz Lwd_p3kvm
s_sleep 2
s_branch Lw_p3kvm
Lwd_p3kvm:
s_waitcnt vmcnt(0)
s_lshr_b32 s75,s76,1
s_add_u32 s81,s75,67108864
s_lshr_b32 s75,s76,2
s_add_u32 s75,s75,75497472
v_lshrrev_b32 v38,1,v3
buffer_load_dwordx4 v[144:147],v3,s[8:11],s81 offen offset:0 sc1
buffer_load_dwordx4 v[148:151],v3,s[8:11],s81 offen offset:1024 sc1
buffer_load_dwordx4 v[152:155],v3,s[8:11],s81 offen offset:2048 sc1
buffer_load_dwordx4 v[156:159],v3,s[8:11],s81 offen offset:3072 sc1
buffer_load_dwordx2 v[160:161],v38,s[8:11],s75 offen offset:0 sc1
buffer_load_dwordx2 v[162:163],v38,s[8:11],s75 offen offset:512 sc1
buffer_load_dwordx2 v[164:165],v38,s[8:11],s75 offen offset:1024 sc1
buffer_load_dwordx2 v[166:167],v38,s[8:11],s75 offen offset:1536 sc1
v_mov_b64 v[168:169],0
v_max3_f32 v60,v40,v41,v42
v_max3_f32 v60,v60,v43,v44
v_max3_f32 v60,v60,v45,v46
v_max_f32 v60,v60,v47
s_waitcnt vmcnt(7)
v_mfma_f32_16x16x32_bf16 v[48:51],v[144:147],v[64:67],0
s_waitcnt vmcnt(6)
v_mfma_f32_16x16x32_bf16 v[48:51],v[148:151],v[68:71],v[48:51]
s_waitcnt vmcnt(5)
v_mfma_f32_16x16x32_bf16 v[48:51],v[152:155],v[72:75],v[48:51]
s_waitcnt vmcnt(4)
v_mfma_f32_16x16x32_bf16 v[48:51],v[156:159],v[76:79],v[48:51]
s_nop 7
v_max3_f32 v60,v60,v48,v49
v_mov_b32 v61,v60
s_nop 1
v_permlane16_swap_b32 v60,v61
v_max_f32 v60,v60,v61
v_mov_b32 v61,v60
s_nop 1
v_permlane32_swap_b32 v60,v61
v_max_f32 v60,v60,v61
v_mul_f32 v60,s82,v60
v_fma_f32 v40,v40,s82,-v60
v_fma_f32 v41,v41,s82,-v60
v_fma_f32 v42,v42,s82,-v60
v_fma_f32 v43,v43,s82,-v60
v_fma_f32 v44,v44,s82,-v60
v_fma_f32 v45,v45,s82,-v60
v_fma_f32 v46,v46,s82,-v60
v_fma_f32 v47,v47,s82,-v60
v_fma_f32 v48,v48,s82,-v60
v_fma_f32 v49,v49,s82,-v60
v_exp_f32 v40,v40
v_exp_f32 v41,v41
v_exp_f32 v42,v42
v_exp_f32 v43,v43
v_exp_f32 v44,v44
v_exp_f32 v45,v45
v_exp_f32 v46,v46
v_exp_f32 v47,v47
v_exp_f32 v48,v48
v_exp_f32 v49,v49
s_nop 0
v_add_f32 v60,v40,v41
v_add_f32 v60,v60,v42
v_add_f32 v60,v60,v43
v_add_f32 v60,v60,v44
v_add_f32 v60,v60,v45
v_add_f32 v60,v60,v46
v_add_f32 v60,v60,v47
v_add_f32 v60,v60,v48
v_add_f32 v60,v60,v49
v_mov_b32 v61,v60
s_nop 1
v_permlane16_swap_b32 v60,v61
v_add_f32 v60,v60,v61
v_mov_b32 v61,v60
s_nop 1
v_permlane32_swap_b32 v60,v61
v_add_f32 v60,v60,v61
v_rcp_f32 v60,v60
s_nop 0
v_mul_f32 v40,v40,v60
v_mul_f32 v41,v41,v60
v_mul_f32 v42,v42,v60
v_mul_f32 v43,v43,v60
v_mul_f32 v44,v44,v60
v_mul_f32 v45,v45,v60
v_mul_f32 v46,v46,v60
v_mul_f32 v47,v47,v60
v_mul_f32 v48,v48,v60
v_mul_f32 v49,v49,v60
v_cvt_pk_bf16_f32 v52,v40,v41
v_cvt_pk_bf16_f32 v53,v42,v43
v_cvt_pk_bf16_f32 v54,v44,v45
v_cvt_pk_bf16_f32 v55,v46,v47
v_mov_b64 v[58:59],0
v_mov_b64 v[42:43],0
v_mov_b32 v56,0
v_mov_b32 v41,0
v_cvt_pk_bf16_f32 v57,v48,v49
v_cvt_pk_bf16_f32 v40,v48,v49
s_waitcnt vmcnt(0)
v_mfma_f32_16x16x32_bf16 v[176:179],v[112:115],v[52:55],0
v_mfma_f32_16x16x32_bf16 v[180:183],v[116:119],v[52:55],0
v_mfma_f32_16x16x32_bf16 v[184:187],v[120:123],v[52:55],0
v_mfma_f32_16x16x32_bf16 v[188:191],v[124:127],v[52:55],0
v_mfma_f32_16x16x32_bf16 v[192:195],v[128:131],v[52:55],0
v_mfma_f32_16x16x32_bf16 v[196:199],v[132:135],v[52:55],0
v_mfma_f32_16x16x32_bf16 v[200:203],v[136:139],v[52:55],0
v_mfma_f32_16x16x32_bf16 v[204:207],v[140:143],v[52:55],0
v_mfma_f32_16x16x32_bf16 v[176:179],v[160:163],v[40:43],v[176:179]
v_mfma_f32_16x16x32_bf16 v[180:183],v[160:163],v[56:59],v[180:183]
v_mfma_f32_16x16x32_bf16 v[184:187],v[162:165],v[40:43],v[184:187]
v_mfma_f32_16x16x32_bf16 v[188:191],v[162:165],v[56:59],v[188:191]
v_mfma_f32_16x16x32_bf16 v[192:195],v[164:167],v[40:43],v[192:195]
v_mfma_f32_16x16x32_bf16 v[196:199],v[164:167],v[56:59],v[196:199]
v_mfma_f32_16x16x32_bf16 v[200:203],v[166:169],v[40:43],v[200:203]
v_mfma_f32_16x16x32_bf16 v[204:207],v[166:169],v[56:59],v[204:207]
s_lshl_b32 s75,s74,1
s_add_u32 s75,s75,s79
s_lshl_b32 s75,s75,17
s_lshl_b32 s81,s78,12
s_add_u32 s75,s75,s81
s_add_u32 s75,s75,117440512
v_cvt_pk_bf16_f32 v64,v176,v177
v_cvt_pk_bf16_f32 v65,v178,v179
v_cvt_pk_bf16_f32 v66,v180,v181
v_cvt_pk_bf16_f32 v67,v182,v183
buffer_store_dwordx4 v[64:67],v3,s[8:11],s75 offen offset:0 sc1
v_cvt_pk_bf16_f32 v68,v184,v185
v_cvt_pk_bf16_f32 v69,v186,v187
v_cvt_pk_bf16_f32 v70,v188,v189
v_cvt_pk_bf16_f32 v71,v190,v191
buffer_store_dwordx4 v[68:71],v3,s[8:11],s75 offen offset:1024 sc1
v_cvt_pk_bf16_f32 v72,v192,v193
v_cvt_pk_bf16_f32 v73,v194,v195
v_cvt_pk_bf16_f32 v74,v196,v197
v_cvt_pk_bf16_f32 v75,v198,v199
buffer_store_dwordx4 v[72:75],v3,s[8:11],s75 offen offset:2048 sc1
v_cvt_pk_bf16_f32 v76,v200,v201
v_cvt_pk_bf16_f32 v77,v202,v203
v_cvt_pk_bf16_f32 v78,v204,v205
v_cvt_pk_bf16_f32 v79,v206,v207
buffer_store_dwordx4 v[76:79],v3,s[8:11],s75 offen offset:3072 sc1
Lp3_noattn:
s_lshl_b32 s81,s74,7
s_add_u32 s81,s81,8320
s_waitcnt vmcnt(0)
s_barrier
s_cmp_lg_u32 s60,0
s_cbranch_scc1 Lsg_p3o
v_mov_b32 v1,1
v_mov_b32 v2,0
s_mov_b64 exec,1
buffer_atomic_add v1,v2,s[8:11],s81 offen
s_mov_b64 exec,-1
Lsg_p3o:
s_cmp_lg_u32 s60,0
s_cbranch_scc1 Lwd_p3o
s_mov_b32 s71,0x800000
v_mov_b32 v2,0
s_mov_b64 exec,1
Lw_p3o:
buffer_load_dword v1,v2,s[8:11],s81 offen sc1
s_sub_u32 s71,s71,1
s_cbranch_scc1 Lwe_p3o
s_waitcnt vmcnt(0)
v_cmp_gt_u32 vcc,18,v1
s_cbranch_vccz Lwe_p3o
s_sleep 1
s_branch Lw_p3o
Lwe_p3o:
s_waitcnt vmcnt(0)
s_mov_b64 exec,-1
Lwd_p3o:
s_barrier
s_lshl_b32 s76,s74,18
s_add_u32 s76,s76,117440512
s_mul_i32 s75,s60,32768
s_add_u32 s76,s76,s75
s_add_u32 s81,s76,131072
buffer_load_dwordx4 v[64:67],v3,s[8:11],s76 offen offset:0 sc1
buffer_load_dwordx4 v[68:71],v3,s[8:11],s81 offen offset:0 sc1
buffer_load_dwordx4 v[72:75],v3,s[8:11],s76 offen offset:1024 sc1
buffer_load_dwordx4 v[76:79],v3,s[8:11],s81 offen offset:1024 sc1
buffer_load_dwordx4 v[80:83],v3,s[8:11],s76 offen offset:2048 sc1
buffer_load_dwordx4 v[84:87],v3,s[8:11],s81 offen offset:2048 sc1
buffer_load_dwordx4 v[88:91],v3,s[8:11],s76 offen offset:3072 sc1
buffer_load_dwordx4 v[92:95],v3,s[8:11],s81 offen offset:3072 sc1
s_add_u32 s76,s76,4096
s_add_u32 s81,s81,4096
buffer_load_dwordx4 v[96:99],v3,s[8:11],s76 offen offset:0 sc1
buffer_load_dwordx4 v[100:103],v3,s[8:11],s81 offen offset:0 sc1
buffer_load_dwordx4 v[104:107],v3,s[8:11],s76 offen offset:1024 sc1
buffer_load_dwordx4 v[108:111],v3,s[8:11],s81 offen offset:1024 sc1
buffer_load_dwordx4 v[112:115],v3,s[8:11],s76 offen offset:2048 sc1
buffer_load_dwordx4 v[116:119],v3,s[8:11],s81 offen offset:2048 sc1
buffer_load_dwordx4 v[120:123],v3,s[8:11],s76 offen offset:3072 sc1
buffer_load_dwordx4 v[124:127],v3,s[8:11],s81 offen offset:3072 sc1
s_add_u32 s76,s76,4096
s_add_u32 s81,s81,4096
buffer_load_dwordx4 v[128:131],v3,s[8:11],s76 offen offset:0 sc1
buffer_load_dwordx4 v[132:135],v3,s[8:11],s81 offen offset:0 sc1
buffer_load_dwordx4 v[136:139],v3,s[8:11],s76 offen offset:1024 sc1
buffer_load_dwordx4 v[140:143],v3,s[8:11],s81 offen offset:1024 sc1
buffer_load_dwordx4 v[144:147],v3,s[8:11],s76 offen offset:2048 sc1
buffer_load_dwordx4 v[148:151],v3,s[8:11],s81 offen offset:2048 sc1
buffer_load_dwordx4 v[152:155],v3,s[8:11],s76 offen offset:3072 sc1
buffer_load_dwordx4 v[156:159],v3,s[8:11],s81 offen offset:3072 sc1
s_add_u32 s76,s76,4096
s_add_u32 s81,s81,4096
buffer_load_dwordx4 v[160:163],v3,s[8:11],s76 offen offset:0 sc1
buffer_load_dwordx4 v[164:167],v3,s[8:11],s81 offen offset:0 sc1
buffer_load_dwordx4 v[168:171],v3,s[8:11],s76 offen offset:1024 sc1
buffer_load_dwordx4 v[172:175],v3,s[8:11],s81 offen offset:1024 sc1
buffer_load_dwordx4 v[176:179],v3,s[8:11],s76 offen offset:2048 sc1
buffer_load_dwordx4 v[180:183],v3,s[8:11],s81 offen offset:2048 sc1
buffer_load_dwordx4 v[184:187],v3,s[8:11],s76 offen offset:3072 sc1
buffer_load_dwordx4 v[188:191],v3,s[8:11],s81 offen offset:3072 sc1
s_waitcnt vmcnt(30)
v_mfma_f32_16x16x32_bf16 v[20:23],a[0:3],v[64:67],0
v_mfma_f32_16x16x32_bf16 v[24:27],a[0:3],v[68:71],0
v_mfma_f32_16x16x32_bf16 v[28:31],a[4:7],v[64:67],0
v_mfma_f32_16x16x32_bf16 v[32:35],a[4:7],v[68:71],0
s_add_u32 s76,s76,4096
s_add_u32 s81,s81,4096
buffer_load_dwordx4 v[64:67],v3,s[8:11],s76 offen offset:0 sc1
buffer_load_dwordx4 v[68:71],v3,s[8:11],s81 offen offset:0 sc1
s_waitcnt vmcnt(30)
v_mfma_f32_16x16x32_bf16 v[20:23],a[8:11],v[72:75],v[20:23]
v_mfma_f32_16x16x32_bf16 v[24:27],a[8:11],v[76:79],v[24:27]
v_mfma_f32_16x16x32_bf16 v[28:31],a[12:15],v[72:75],v[28:31]
v_mfma_f32_16x16x32_bf16 v[32:35],a[12:15],v[76:79],v[32:35]
buffer_load_dwordx4 v[72:75],v3,s[8:11],s76 offen offset:1024 sc1
buffer_load_dwordx4 v[76:79],v3,s[8:11],s81 offen offset:1024 sc1
s_waitcnt vmcnt(30)
v_mfma_f32_16x16x32_bf16 v[20:23],a[16:19],v[80:83],v[20:23]
v_mfma_f32_16x16x32_bf16 v[24:27],a[16:19],v[84:87],v[24:27]
v_mfma_f32_16x16x32_bf16 v[28:31],a[20:23],v[80:83],v[28:31]
v_mfma_f32_16x16x32_bf16 v[32:35],a[20:23],v[84:87],v[32:35]
buffer_load_dwordx4 v[80:83],v3,s[8:11],s76 offen offset:2048 sc1
buffer_load_dwordx4 v[84:87],v3,s[8:11],s81 offen offset:2048 sc1
s_waitcnt vmcnt(30)
v_mfma_f32_16x16x32_bf16 v[20:23],a[24:27],v[88:91],v[20:23]
v_mfma_f32_16x16x32_bf16 v[24:27],a[24:27],v[92:95],v[24:27]
v_mfma_f32_16x16x32_bf16 v[28:31],a[28:31],v[88:91],v[28:31]
v_mfma_f32_16x16x32_bf16 v[32:35],a[28:31],v[92:95],v[32:35]
buffer_load_dwordx4 v[88:91],v3,s[8:11],s76 offen offset:3072 sc1
buffer_load_dwordx4 v[92:95],v3,s[8:11],s81 offen offset:3072 sc1
s_waitcnt vmcnt(30)
v_mfma_f32_16x16x32_bf16 v[20:23],a[32:35],v[96:99],v[20:23]
v_mfma_f32_16x16x32_bf16 v[24:27],a[32:35],v[100:103],v[24:27]
v_mfma_f32_16x16x32_bf16 v[28:31],a[36:39],v[96:99],v[28:31]
v_mfma_f32_16x16x32_bf16 v[32:35],a[36:39],v[100:103],v[32:35]
s_add_u32 s76,s76,4096
s_add_u32 s81,s81,4096
buffer_load_dwordx4 v[96:99],v3,s[8:11],s76 offen offset:0 sc1
buffer_load_dwordx4 v[100:103],v3,s[8:11],s81 offen offset:0 sc1
s_waitcnt vmcnt(30)
v_mfma_f32_16x16x32_bf16 v[20:23],a[40:43],v[104:107],v[20:23]
v_mfma_f32_16x16x32_bf16 v[24:27],a[40:43],v[108:111],v[24:27]
v_mfma_f32_16x16x32_bf16 v[28:31],a[44:47],v[104:107],v[28:31]
v_mfma_f32_16x16x32_bf16 v[32:35],a[44:47],v[108:111],v[32:35]
buffer_load_dwordx4 v[104:107],v3,s[8:11],s76 offen offset:1024 sc1
buffer_load_dwordx4 v[108:111],v3,s[8:11],s81 offen offset:1024 sc1
s_waitcnt vmcnt(30)
v_mfma_f32_16x16x32_bf16 v[20:23],a[48:51],v[112:115],v[20:23]
v_mfma_f32_16x16x32_bf16 v[24:27],a[48:51],v[116:119],v[24:27]
v_mfma_f32_16x16x32_bf16 v[28:31],a[52:55],v[112:115],v[28:31]
v_mfma_f32_16x16x32_bf16 v[32:35],a[52:55],v[116:119],v[32:35]
buffer_load_dwordx4 v[112:115],v3,s[8:11],s76 offen offset:2048 sc1
buffer_load_dwordx4 v[116:119],v3,s[8:11],s81 offen offset:2048 sc1
s_waitcnt vmcnt(30)
v_mfma_f32_16x16x32_bf16 v[20:23],a[56:59],v[120:123],v[20:23]
v_mfma_f32_16x16x32_bf16 v[24:27],a[56:59],v[124:127],v[24:27]
v_mfma_f32_16x16x32_bf16 v[28:31],a[60:63],v[120:123],v[28:31]
v_mfma_f32_16x16x32_bf16 v[32:35],a[60:63],v[124:127],v[32:35]
buffer_load_dwordx4 v[120:123],v3,s[8:11],s76 offen offset:3072 sc1
buffer_load_dwordx4 v[124:127],v3,s[8:11],s81 offen offset:3072 sc1
s_waitcnt vmcnt(30)
v_mfma_f32_16x16x32_bf16 v[20:23],a[64:67],v[128:131],v[20:23]
v_mfma_f32_16x16x32_bf16 v[24:27],a[64:67],v[132:135],v[24:27]
v_mfma_f32_16x16x32_bf16 v[28:31],a[68:71],v[128:131],v[28:31]
v_mfma_f32_16x16x32_bf16 v[32:35],a[68:71],v[132:135],v[32:35]
s_add_u32 s76,s76,4096
s_add_u32 s81,s81,4096
buffer_load_dwordx4 v[128:131],v3,s[8:11],s76 offen offset:0 sc1
buffer_load_dwordx4 v[132:135],v3,s[8:11],s81 offen offset:0 sc1
s_waitcnt vmcnt(30)
v_mfma_f32_16x16x32_bf16 v[20:23],a[72:75],v[136:139],v[20:23]
v_mfma_f32_16x16x32_bf16 v[24:27],a[72:75],v[140:143],v[24:27]
v_mfma_f32_16x16x32_bf16 v[28:31],a[76:79],v[136:139],v[28:31]
v_mfma_f32_16x16x32_bf16 v[32:35],a[76:79],v[140:143],v[32:35]
buffer_load_dwordx4 v[136:139],v3,s[8:11],s76 offen offset:1024 sc1
buffer_load_dwordx4 v[140:143],v3,s[8:11],s81 offen offset:1024 sc1
s_waitcnt vmcnt(30)
v_mfma_f32_16x16x32_bf16 v[20:23],a[80:83],v[144:147],v[20:23]
v_mfma_f32_16x16x32_bf16 v[24:27],a[80:83],v[148:151],v[24:27]
v_mfma_f32_16x16x32_bf16 v[28:31],a[84:87],v[144:147],v[28:31]
v_mfma_f32_16x16x32_bf16 v[32:35],a[84:87],v[148:151],v[32:35]
buffer_load_dwordx4 v[144:147],v3,s[8:11],s76 offen offset:2048 sc1
buffer_load_dwordx4 v[148:151],v3,s[8:11],s81 offen offset:2048 sc1
s_waitcnt vmcnt(30)
v_mfma_f32_16x16x32_bf16 v[20:23],a[88:91],v[152:155],v[20:23]
v_mfma_f32_16x16x32_bf16 v[24:27],a[88:91],v[156:159],v[24:27]
v_mfma_f32_16x16x32_bf16 v[28:31],a[92:95],v[152:155],v[28:31]
v_mfma_f32_16x16x32_bf16 v[32:35],a[92:95],v[156:159],v[32:35]
buffer_load_dwordx4 v[152:155],v3,s[8:11],s76 offen offset:3072 sc1
buffer_load_dwordx4 v[156:159],v3,s[8:11],s81 offen offset:3072 sc1
s_waitcnt vmcnt(30)
v_mfma_f32_16x16x32_bf16 v[20:23],a[96:99],v[160:163],v[20:23]
v_mfma_f32_16x16x32_bf16 v[24:27],a[96:99],v[164:167],v[24:27]
v_mfma_f32_16x16x32_bf16 v[28:31],a[100:103],v[160:163],v[28:31]
v_mfma_f32_16x16x32_bf16 v[32:35],a[100:103],v[164:167],v[32:35]
s_add_u32 s76,s76,4096
s_add_u32 s81,s81,4096
buffer_load_dwordx4 v[160:163],v3,s[8:11],s76 offen offset:0 sc1
buffer_load_dwordx4 v[164:167],v3,s[8:11],s81 offen offset:0 sc1
s_waitcnt vmcnt(30)
v_mfma_f32_16x16x32_bf16 v[20:23],a[104:107],v[168:171],v[20:23]
v_mfma_f32_16x16x32_bf16 v[24:27],a[104:107],v[172:175],v[24:27]
v_mfma_f32_16x16x32_bf16 v[28:31],a[108:111],v[168:171],v[28:31]
v_mfma_f32_16x16x32_bf16 v[32:35],a[108:111],v[172:175],v[32:35]
buffer_load_dwordx4 v[168:171],v3,s[8:11],s76 offen offset:1024 sc1
buffer_load_dwordx4 v[172:175],v3,s[8:11],s81 offen offset:1024 sc1
s_waitcnt vmcnt(30)
v_mfma_f32_16x16x32_bf16 v[20:23],a[112:115],v[176:179],v[20:23]
v_mfma_f32_16x16x32_bf16 v[24:27],a[112:115],v[180:183],v[24:27]
v_mfma_f32_16x16x32_bf16 v[28:31],a[116:119],v[176:179],v[28:31]
v_mfma_f32_16x16x32_bf16 v[32:35],a[116:119],v[180:183],v[32:35]
buffer_load_dwordx4 v[176:179],v3,s[8:11],s76 offen offset:2048 sc1
buffer_load_dwordx4 v[180:183],v3,s[8:11],s81 offen offset:2048 sc1
s_waitcnt vmcnt(30)
v_mfma_f32_16x16x32_bf16 v[20:23],a[120:123],v[184:187],v[20:23]
v_mfma_f32_16x16x32_bf16 v[24:27],a[120:123],v[188:191],v[24:27]
v_mfma_f32_16x16x32_bf16 v[28:31],a[124:127],v[184:187],v[28:31]
v_mfma_f32_16x16x32_bf16 v[32:35],a[124:127],v[188:191],v[32:35]
buffer_load_dwordx4 v[184:187],v3,s[8:11],s76 offen offset:3072 sc1
buffer_load_dwordx4 v[188:191],v3,s[8:11],s81 offen offset:3072 sc1
s_waitcnt vmcnt(30)
v_mfma_f32_16x16x32_bf16 v[20:23],a[128:131],v[64:67],v[20:23]
v_mfma_f32_16x16x32_bf16 v[24:27],a[128:131],v[68:71],v[24:27]
v_mfma_f32_16x16x32_bf16 v[28:31],a[132:135],v[64:67],v[28:31]
v_mfma_f32_16x16x32_bf16 v[32:35],a[132:135],v[68:71],v[32:35]
s_waitcnt vmcnt(28)
v_mfma_f32_16x16x32_bf16 v[20:23],a[136:139],v[72:75],v[20:23]
v_mfma_f32_16x16x32_bf16 v[24:27],a[136:139],v[76:79],v[24:27]
v_mfma_f32_16x16x32_bf16 v[28:31],a[140:143],v[72:75],v[28:31]
v_mfma_f32_16x16x32_bf16 v[32:35],a[140:143],v[76:79],v[32:35]
s_waitcnt vmcnt(26)
v_mfma_f32_16x16x32_bf16 v[20:23],a[144:147],v[80:83],v[20:23]
v_mfma_f32_16x16x32_bf16 v[24:27],a[144:147],v[84:87],v[24:27]
v_mfma_f32_16x16x32_bf16 v[28:31],a[148:151],v[80:83],v[28:31]
v_mfma_f32_16x16x32_bf16 v[32:35],a[148:151],v[84:87],v[32:35]
s_waitcnt vmcnt(24)
v_mfma_f32_16x16x32_bf16 v[20:23],a[152:155],v[88:91],v[20:23]
v_mfma_f32_16x16x32_bf16 v[24:27],a[152:155],v[92:95],v[24:27]
v_mfma_f32_16x16x32_bf16 v[28:31],a[156:159],v[88:91],v[28:31]
v_mfma_f32_16x16x32_bf16 v[32:35],a[156:159],v[92:95],v[32:35]
s_waitcnt vmcnt(22)
v_mfma_f32_16x16x32_bf16 v[20:23],a[160:163],v[96:99],v[20:23]
v_mfma_f32_16x16x32_bf16 v[24:27],a[160:163],v[100:103],v[24:27]
v_mfma_f32_16x16x32_bf16 v[28:31],a[164:167],v[96:99],v[28:31]
v_mfma_f32_16x16x32_bf16 v[32:35],a[164:167],v[100:103],v[32:35]
s_waitcnt vmcnt(20)
v_mfma_f32_16x16x32_bf16 v[20:23],a[168:171],v[104:107],v[20:23]
v_mfma_f32_16x16x32_bf16 v[24:27],a[168:171],v[108:111],v[24:27]
v_mfma_f32_16x16x32_bf16 v[28:31],a[172:175],v[104:107],v[28:31]
v_mfma_f32_16x16x32_bf16 v[32:35],a[172:175],v[108:111],v[32:35]
s_waitcnt vmcnt(18)
v_mfma_f32_16x16x32_bf16 v[20:23],a[176:179],v[112:115],v[20:23]
v_mfma_f32_16x16x32_bf16 v[24:27],a[176:179],v[116:119],v[24:27]
v_mfma_f32_16x16x32_bf16 v[28:31],a[180:183],v[112:115],v[28:31]
v_mfma_f32_16x16x32_bf16 v[32:35],a[180:183],v[116:119],v[32:35]
s_waitcnt vmcnt(16)
v_mfma_f32_16x16x32_bf16 v[20:23],a[184:187],v[120:123],v[20:23]
v_mfma_f32_16x16x32_bf16 v[24:27],a[184:187],v[124:127],v[24:27]
v_mfma_f32_16x16x32_bf16 v[28:31],a[188:191],v[120:123],v[28:31]
v_mfma_f32_16x16x32_bf16 v[32:35],a[188:191],v[124:127],v[32:35]
s_waitcnt vmcnt(14)
v_mfma_f32_16x16x32_bf16 v[20:23],a[192:195],v[128:131],v[20:23]
v_mfma_f32_16x16x32_bf16 v[24:27],a[192:195],v[132:135],v[24:27]
v_mfma_f32_16x16x32_bf16 v[28:31],a[196:199],v[128:131],v[28:31]
v_mfma_f32_16x16x32_bf16 v[32:35],a[196:199],v[132:135],v[32:35]
s_waitcnt vmcnt(12)
v_mfma_f32_16x16x32_bf16 v[20:23],a[200:203],v[136:139],v[20:23]
v_mfma_f32_16x16x32_bf16 v[24:27],a[200:203],v[140:143],v[24:27]
v_mfma_f32_16x16x32_bf16 v[28:31],a[204:207],v[136:139],v[28:31]
v_mfma_f32_16x16x32_bf16 v[32:35],a[204:207],v[140:143],v[32:35]
s_waitcnt vmcnt(10)
v_mfma_f32_16x16x32_bf16 v[20:23],a[208:211],v[144:147],v[20:23]
v_mfma_f32_16x16x32_bf16 v[24:27],a[208:211],v[148:151],v[24:27]
v_mfma_f32_16x16x32_bf16 v[28:31],a[212:215],v[144:147],v[28:31]
v_mfma_f32_16x16x32_bf16 v[32:35],a[212:215],v[148:151],v[32:35]
s_waitcnt vmcnt(8)
v_mfma_f32_16x16x32_bf16 v[20:23],a[216:219],v[152:155],v[20:23]
v_mfma_f32_16x16x32_bf16 v[24:27],a[216:219],v[156:159],v[24:27]
v_mfma_f32_16x16x32_bf16 v[28:31],a[220:223],v[152:155],v[28:31]
v_mfma_f32_16x16x32_bf16 v[32:35],a[220:223],v[156:159],v[32:35]
s_waitcnt vmcnt(6)
v_mfma_f32_16x16x32_bf16 v[20:23],a[224:227],v[160:163],v[20:23]
v_mfma_f32_16x16x32_bf16 v[24:27],a[224:227],v[164:167],v[24:27]
v_mfma_f32_16x16x32_bf16 v[28:31],a[228:231],v[160:163],v[28:31]
v_mfma_f32_16x16x32_bf16 v[32:35],a[228:231],v[164:167],v[32:35]
s_waitcnt vmcnt(4)
v_mfma_f32_16x16x32_bf16 v[20:23],a[232:235],v[168:171],v[20:23]
v_mfma_f32_16x16x32_bf16 v[24:27],a[232:235],v[172:175],v[24:27]
v_mfma_f32_16x16x32_bf16 v[28:31],a[236:239],v[168:171],v[28:31]
v_mfma_f32_16x16x32_bf16 v[32:35],a[236:239],v[172:175],v[32:35]
s_waitcnt vmcnt(2)
v_mfma_f32_16x16x32_bf16 v[20:23],a[240:243],v[176:179],v[20:23]
v_mfma_f32_16x16x32_bf16 v[24:27],a[240:243],v[180:183],v[24:27]
v_mfma_f32_16x16x32_bf16 v[28:31],a[244:247],v[176:179],v[28:31]
v_mfma_f32_16x16x32_bf16 v[32:35],a[244:247],v[180:183],v[32:35]
s_waitcnt vmcnt(0)
v_mfma_f32_16x16x32_bf16 v[20:23],a[248:251],v[184:187],v[20:23]
v_mfma_f32_16x16x32_bf16 v[24:27],a[248:251],v[188:191],v[24:27]
v_mfma_f32_16x16x32_bf16 v[28:31],a[252:255],v[184:187],v[28:31]
v_mfma_f32_16x16x32_bf16 v[32:35],a[252:255],v[188:191],v[32:35]
s_lshl_b32 s75,s60,12
s_add_u32 s75,s75,s80
v_add_u32 v7,s75,v3
s_nop 4
ds_write_b128 v7,v[20:23] offset:0
ds_write_b128 v7,v[24:27] offset:1024
ds_write_b128 v7,v[28:31] offset:2048
ds_write_b128 v7,v[32:35] offset:3072
s_lshl_b32 s75,s60,10
s_add_u32 s75,s75,s80
v_add_u32 v7,s75,v3
s_xor_b32 s80,s80,16384
s_waitcnt lgkmcnt(0)
s_barrier
ds_read_b128 v[20:23],v7 offset:0
ds_read_b128 v[24:27],v7 offset:4096
ds_read_b128 v[28:31],v7 offset:8192
ds_read_b128 v[32:35],v7 offset:12288
s_waitcnt lgkmcnt(0)
v_add_f32 v20,v20,v24
v_add_f32 v28,v28,v32
v_add_f32 v21,v21,v25
v_add_f32 v29,v29,v33
v_add_f32 v22,v22,v26
v_add_f32 v30,v30,v34
v_add_f32 v23,v23,v27
v_add_f32 v31,v31,v35
v_add_f32 v20,v20,v28
v_add_f32 v21,v21,v29
v_add_f32 v22,v22,v30
v_add_f32 v23,v23,v31
v_cvt_pk_bf16_f32 v24,v20,v21
v_cvt_pk_bf16_f32 v25,v22,v23
v_lshlrev_b32 v20,16,v24
v_and_b32 v21,0xffff0000,v24
v_lshlrev_b32 v22,16,v25
v_and_b32 v23,0xffff0000,v25
v_lshlrev_b32 v24,16,v8
v_and_b32 v25,0xffff0000,v8
v_lshlrev_b32 v28,16,v36
v_and_b32 v29,0xffff0000,v36
v_lshlrev_b32 v26,16,v9
v_and_b32 v27,0xffff0000,v9
v_lshlrev_b32 v30,16,v37
v_and_b32 v31,0xffff0000,v37
v_mul_f32 v20,v20,v24
v_mul_f32 v21,v21,v25
v_mul_f32 v22,v22,v26
v_mul_f32 v23,v23,v27
v_cvt_pk_bf16_f32 v24,v20,v21
v_cvt_pk_bf16_f32 v25,v22,v23
v_lshlrev_b32 v20,16,v24
v_and_b32 v21,0xffff0000,v24
v_lshlrev_b32 v22,16,v25
v_and_b32 v23,0xffff0000,v25
v_add_f32 v20,v20,v28
v_add_f32 v21,v21,v29
v_add_f32 v22,v22,v30
v_add_f32 v23,v23,v31
v_cvt_pk_bf16_f32 v24,v20,v21
v_cvt_pk_bf16_f32 v25,v22,v23
s_mul_i32 s75,s74,36864
buffer_store_dwordx2 v[24:25],v6,s[52:55],s75 offen
v_mov_b64 v[8:9],v[10:11]
v_mov_b64 v[10:11],v[12:13]
v_mov_b64 v[12:13],v[14:15]
v_mov_b64 v[14:15],v[16:17]
v_mov_b64 v[16:17],v[18:19]
s_add_u32 s74,s74,12
s_cmp_lt_u32 s74,64
s_cbranch_scc1 Lp3_loop
L_fin:
s_waitcnt vmcnt(0)
L_end:
s_endpgm
.section .rodata,"a"
.p2align 6
.amdhsa_kernel recurrent_scan__memory_aug_recurrent_mem_tr__geglu_ffn__prompt_kernel
  .amdhsa_next_free_vgpr 512
  .amdhsa_next_free_sgpr 102
  .amdhsa_accum_offset 256
  .amdhsa_group_segment_fixed_size 0
  .amdhsa_kernarg_size 112
  .amdhsa_user_sgpr_count 2
  .amdhsa_user_sgpr_kernarg_segment_ptr 1
  .amdhsa_system_sgpr_workgroup_id_x 1
.end_amdhsa_kernel
```
